```python
import torch

def _softmax(x, axis=-1):
    return torch.softmax(x, dim=axis)
def _gelu(x):
    return torch.nn.functional.gelu(x, approximate="tanh")
def _silu(x):
    return torch.nn.functional.silu(x)
def _sigmoid(x):
    return torch.sigmoid(x)
def _layernorm(x, axis=-1, eps=1e-5):
    m = x.mean(dim=axis, keepdim=True)
    v = x.var(dim=axis, keepdim=True, unbiased=False)
    return (x - m) / torch.sqrt(v + eps)
def _scatter_add(tgt, idx, src, axis=0):
    return tgt.clone().index_add_(axis, idx, src)
def _segment_sum(src, seg, n):
    out = torch.zeros((n,) + src.shape[1:], dtype=src.dtype)
    return out.index_add_(0, seg, src)
def _pad(x, pw):
    flat = tuple(v for pair in reversed(pw) for v in pair)
    return torch.nn.functional.pad(x, flat)

kernel_name = 'standalone__glu_gated_bilinear__prompt'

def setup_inputs():

    _w = (lambda a: (lambda t: t.to(torch.bfloat16) if t.is_floating_point() else t)(torch.as_tensor(a)))
    B, S, D, F = 1, 2048, 640, 1728
    return {
        "x": _w((lambda *s: torch.randn(*s, dtype=torch.bfloat16) * 0.05)(B, S, D)),
        "w_gate": _w((lambda *s: torch.randn(*s, dtype=torch.bfloat16) * 0.05)(D, F) * (D ** -0.5)),
        "w_up": _w((lambda *s: torch.randn(*s, dtype=torch.bfloat16) * 0.05)(D, F) * (D ** -0.5)),
        "w_down": _w((lambda *s: torch.randn(*s, dtype=torch.bfloat16) * 0.05)(F, D) * (F ** -0.5)),
    }

def reference(x, w_gate, w_up, w_down):
    g = torch.einsum("bsd,df->bsf", x, w_gate)
    u = torch.einsum("bsd,df->bsf", x, w_up)
    h = g * u
    return torch.einsum("bsf,fd->bsd", h, w_down)
```

```asm
; @launch grid=(256,1,1) block=(256,1,1) lds=163840
.amdgcn_target "amdgcn-amd-amdhsa--gfx950"
.text
.globl standalone__glu_gated_bilinear__prompt_kernel
.p2align 8
.type standalone__glu_gated_bilinear__prompt_kernel,@function
standalone__glu_gated_bilinear__prompt_kernel:
    s_load_dwordx4 s[4:7], s[0:1], 0
    s_load_dwordx4 s[64:67], s[0:1], 16
    s_load_dwordx4 s[24:27], s[0:1], 32
    s_load_dwordx2 s[68:69], s[0:1], 48
    s_cmp_ge_u32 s2, 256
    s_cbranch_scc1 L_end
    v_lshrrev_b32 v1, 6, v0
    v_and_b32 v0, 63, v0
    s_and_b32 s55, s2, 7
    v_readfirstlane_b32 s36, v1
    s_lshr_b32 s54, s2, 3
    s_cmp_ge_u32 s54, 27
    s_cbranch_scc0 L_normal
    s_getpc_b64 s[8:9]
    s_mov_b32 s10, L_code_end-L_normal
    s_mov_b32 s11, 0x00020000
    s_sub_u32 s3, s54, 27
    s_lshl_b32 s3, s3, 15
    v_lshl_add_u32 v2, v1, 13, s3
    v_lshl_add_u32 v2, v0, 7, v2
    buffer_load_dword v254, v2, s[8:11], 0 offen
    s_branch L_free
L_normal:
    s_lshr_b32 s60, s55, 1
    s_mul_i32 s60, s60, 27
    s_add_u32 s60, s60, s54
    s_lshr_b32 s37, s60, 2
    s_and_b32 s60, s60, 3
    s_and_b32 s38, s55, 1
    s_lshl_b32 s38, s38, 2
    s_add_u32 s38, s38, s60
    s_mul_i32 s39, s37, 37
    s_lshr_b32 s39, s39, 8
    s_lshl_b32 s39, s39, 1
    s_add_u32 s40, s37, s60
    s_and_b32 s40, s40, 3
    s_lshl_b32 s40, s40, 1
    v_lshrrev_b32 v2, 3, v0
    v_and_b32 v3, 7, v0
    v_lshrrev_b32 v4, 4, v0
    v_xor_b32 v5, v4, v3
    v_mul_u32_u24 v6, 1280, v2
    v_lshl_add_u32 v8, v5, 4, v6
    v_xor_b32 v5, 4, v5
    v_lshl_add_u32 v5, v5, 4, v6
    v_add_u32 v9, 9216, v5
    v_add_u32 v10, 18432, v8
    v_add_u32 v11, 27648, v5
    v_and_b32 v5, 1, v4
    v_mul_u32_u24 v6, 3456, v2
    v_lshlrev_b32 v5, 1, v5
    v_xor_b32 v5, v5, v3
    v_lshl_add_u32 v12, v5, 4, v6
    v_xor_b32 v5, 4, v5
    v_lshl_add_u32 v5, v5, 4, v6
    v_add_u32 v13, 26624, v5
    v_add_u32 v14, 53248, v12
    v_add_u32 v15, 79872, v5
    s_lshl_b32 s61, s38, 3
    s_add_u32 s60, s39, s36
    s_and_b32 s60, s60, 7
    s_add_u32 s60, s60, s61
    s_mul_i32 s60, s60, 40960
    s_lshl_b32 s62, s40, 7
    s_add_u32 s47, s60, s62
    s_and_b32 s60, s36, 1
    s_mul_i32 s60, s60, 110592
    s_lshl_b32 s62, s37, 7
    s_add_u32 s63, s60, s62
    s_mul_i32 s62, s40, 221184
    s_add_u32 s46, s63, s62
    s_lshl_b32 s44, s36, 12
    s_add_u32 s45, s44, 65536
    s_mov_b32 s10, 2621440
    s_mov_b32 s11, 0x00020000
    s_mov_b32 s14, 2211840
    s_mov_b32 s15, 0x00020000
    s_cmp_ge_u32 s36, 2
    s_waitcnt lgkmcnt(0)
    s_mov_b32 s8, s4
    s_mov_b32 s9, s5
    s_cselect_b32 s12, s64, s6
    s_cselect_b32 s13, s65, s7
    s_add_u32 m0, s45, 0
    s_nop 0
    buffer_load_dwordx4 v12, s[12:15], s46 offen offset:0 lds
    buffer_load_dwordx4 v13, s[12:15], s46 offen offset:1024 lds
    buffer_load_dwordx4 v14, s[12:15], s46 offen offset:2048 lds
    buffer_load_dwordx4 v15, s[12:15], s46 offen offset:3072 lds
    s_add_u32 m0, s44, 0
    s_nop 0
    buffer_load_dwordx4 v8, s[8:11], s47 offen offset:0 lds
    buffer_load_dwordx4 v9, s[8:11], s47 offen offset:1024 lds
    buffer_load_dwordx4 v10, s[8:11], s47 offen offset:2048 lds
    buffer_load_dwordx4 v11, s[8:11], s47 offen offset:3072 lds
    s_mov_b32 s16, s68
    s_mov_b32 s17, s69
    s_mov_b32 s18, 7077888
    s_mov_b32 s19, 0x00020000
    s_mov_b32 s20, s66
    s_mov_b32 s21, s67
    s_mov_b32 s22, 2211840
    s_mov_b32 s23, 0x00020000
    s_mov_b32 s32, s26
    s_mov_b32 s33, s27
    s_mov_b32 s34, 256
    s_mov_b32 s35, 0x00020000
    s_mov_b32 s26, 2621440
    s_mov_b32 s27, 0x00020000
    s_add_u32 s28, s68, 8388608
    s_addc_u32 s29, s69, 0
    s_mov_b32 s30, 138240
    s_mov_b32 s31, 0x00020000
    s_mov_b32 s52, 100000
    s_memrealtime s[4:5]
    s_or_b32 s6, s2, s36
    v_or_b32 v1, s6, v0
    v_cmp_eq_u32 vcc, 0, v1
    v_mov_b32 v2, 2146435072
    s_waitcnt lgkmcnt(0)
    s_or_b32 s4, s4, 1
    v_cndmask_b32 v1, v2, v1, vcc
    v_mov_b32 v3, s4
    buffer_store_dword v3, v1, s[32:35], 0 offen sc1
    s_mul_i32 s4, s38, 27
    s_add_u32 s4, s4, s37
    s_mul_i32 s4, s4, 640
    s_add_u32 s64, s28, s4
    s_addc_u32 s65, s29, 0
    s_lshl_b32 s5, s36, 7
    s_add_u32 s4, s4, s5
    buffer_load_dword v254, off, s[28:31], s4 sc1
    v_subrev_u32 v1, 10, v0
    v_lshlrev_b32 v1, 2, v1
    v_add_u32 v1, s36, v1
    v_and_b32 v1, 0xff, v1
    v_mul_u32_u24 v2, 26, v1
    v_lshrrev_b32 v2, 8, v2
    v_mul_u32_u24 v3, 10, v2
    v_sub_u32 v1, v1, v3
    v_add_u32 v2, 4, v2
    v_cmp_gt_u32 vcc, 10, v0
    v_mov_b32 v3, s36
    s_mov_b32 s4, 40960
    v_cndmask_b32 v1, v1, v0, vcc
    v_cndmask_b32 v2, v2, v3, vcc
    v_cmp_gt_u32 vcc, 8, v1
    v_add_u32 v4, s40, v1
    v_subrev_u32 v3, 8, v4
    v_min_u32 v4, v4, v3
    v_cndmask_b32 v1, v1, v4, vcc
    v_add_u32 v2, s39, v2
    v_and_b32 v2, 7, v2
    v_add_u32 v2, s61, v2
    v_mul_lo_u32 v2, v2, s4
    v_lshl_add_u32 v22, v1, 7, v2
    s_mov_b32 s4, 221184
    v_mul_lo_u32 v2, v1, s4
    v_add_u32 v23, s63, v2
    s_lshr_b32 s4, s36, 1
    s_lshl_b32 s5, s37, 1
    s_add_u32 s4, s4, s5
    s_lshl_b32 s4, s4, 7
    s_lshl_b32 s5, s38, 4
    s_add_u32 s4, s4, s5
    v_add_u32 v1, s39, v0
    v_and_b32 v1, 7, v1
    v_lshl_add_u32 v1, v1, 1, s4
    v_lshlrev_b32 v24, 10, v1
    v_lshrrev_b32 v3, 5, v0
    v_bfe_u32 v4, v0, 1, 3
    v_and_b32 v2, 15, v0
    v_lshrrev_b32 v6, 4, v0
    v_xor_b32 v4, v4, v6
    v_lshlrev_b32 v4, 4, v4
    v_lshl_add_u32 v16, v2, 7, v4
    v_xor_b32 v17, 64, v16
    v_bfe_u32 v4, v0, 4, 1
    v_bfe_u32 v5, v0, 2, 2
    v_lshl_add_u32 v6, v6, 3, v5
    v_lshlrev_b32 v6, 7, v6
    v_bfe_u32 v7, v0, 3, 2
    v_xor_b32 v7, s36, v7
    v_lshl_add_u32 v6, v7, 5, v6
    v_and_b32 v7, 3, v0
    v_lshl_add_u32 v6, v7, 3, v6
    v_add_u32 v20, 65536, v6
    s_and_b32 s4, s36, 1
    s_lshl_b32 s4, s4, 1
    v_add_u32 v6, s4, v3
    v_lshlrev_b32 v6, 8, v6
    v_lshl_add_u32 v6, v4, 10, v6
    v_and_b32 v7, 15, v0
    v_lshl_add_u32 v21, v7, 4, v6
    s_cmp_ge_u32 s55, 2
    s_cselect_b32 s4, 26, 0
    s_cmp_ge_u32 s55, 6
    s_cselect_b32 s4, 25, s4
    s_add_u32 s54, s54, s4
    s_cmp_ge_u32 s54, 27
    s_cselect_b32 s4, 27, 0
    s_sub_u32 s54, s54, s4
    s_mul_i32 s4, s54, 52
    s_lshr_b32 s4, s4, 8
    s_mul_i32 s5, s4, 5
    s_sub_u32 s6, s54, s5
    s_mov_b32 s48, s4
    s_and_b32 s7, s55, 1
    s_mul_i32 s7, s7, 5
    s_add_u32 s42, s6, s7
    s_lshr_b32 s7, s55, 1
    s_lshl_b32 s7, s7, 5
    s_cmp_ge_u32 s4, 3
    s_cselect_b32 s6, 7, 0
    s_add_u32 s7, s7, s6
    s_add_u32 s41, s5, s7
    s_mul_i32 s43, s36, 20480
    s_and_b32 s5, s55, 6
    s_add_u32 s6, s42, s5
    s_add_u32 s5, s5, s54
    s_cmp_eq_u32 s4, 5
    s_cselect_b32 s42, s6, s42
    s_cselect_b32 s41, 15, s41
    s_cselect_b32 s5, s5, 0
    s_cmp_ge_u32 s5, 30
    s_cselect_b32 s48, 6, s48
    s_and_b32 s4, s55, 6
    s_mul_i32 s4, s4, 17280
    s_mov_b32 s7, 27
    s_mov_b32 s60, 4096
    s_cmp_eq_u32 s48, 5
    s_cselect_b32 s4, 0, s4
    s_cselect_b32 s7, 54, s7
    s_cselect_b32 s60, 32768, s60
    s_add_u32 s72, s28, s4
    s_addc_u32 s73, s29, 0
    s_lshr_b32 s5, s36, 1
    s_mul_i32 s6, s5, 640
    s_add_u32 s70, s72, s6
    s_addc_u32 s71, s73, 0
    v_and_b32 v1, 15, v0
    v_lshl_add_u32 v1, v1, 1, s5
    v_min_u32 v1, 26, v1
    v_lshrrev_b32 v2, 4, v0
    v_mul_u32_u24 v2, s7, v2
    v_add_u32 v1, v1, v2
    v_mul_u32_u24 v1, 640, v1
    v_add_u32 v25, s4, v1
    v_lshlrev_b32 v30, 4, v0
    v_add_u32 v31, s60, v30
    v_add_u32 v27, s60, v31
    v_add_u32 v28, s60, v27
    s_lshl_b32 s6, s42, 7
    s_mul_i32 s53, s41, 20480
    s_add_u32 s53, s53, s6
    s_mul_i32 s4, s36, 40960
    s_add_u32 s54, s4, s6
    s_mov_b32 s55, 163840
    s_lshl_b32 s4, s36, 7
    s_add_u32 s4, s4, s41
    s_lshl_b32 s4, s4, 10
    s_mov_b32 s5, 524288
    s_cmp_eq_u32 s48, 6
    s_cselect_b32 s54, 2211840, s54
    s_cselect_b32 s55, 0, s55
    s_cselect_b32 s4, 7077888, s4
    s_cselect_b32 s5, 0, s5
    s_mov_b32 s37, s4
    s_add_u32 s38, s37, s5
    s_add_u32 s39, s38, s5
    s_add_u32 s40, s39, s5
    s_add_u32 s41, s40, s5
    s_add_u32 s42, s41, s5
    s_add_u32 s49, s42, s5
    s_add_u32 s57, s49, s5
    s_add_u32 s58, s57, s5
    s_add_u32 s59, s58, s5
    s_add_u32 s66, s59, s5
    s_add_u32 s67, s66, s5
    s_add_u32 s68, s67, s5
    s_add_u32 s69, s68, s5
    s_min_u32 s69, s69, 7077888
    v_lshrrev_b32 v1, 4, v0
    v_bfe_u32 v2, v0, 2, 2
    v_lshl_add_u32 v1, v1, 3, v2
    v_lshlrev_b32 v1, 7, v1
    v_bfe_u32 v2, v0, 3, 2
    v_lshlrev_b32 v2, 5, v2
    v_and_b32 v3, 3, v0
    v_lshlrev_b32 v3, 3, v3
    v_add3_u32 v1, v1, v2, v3
    v_add_u32 v4, s45, v1
    v_xor_b32 v5, 32, v4
    v_xor_b32 v6, 64, v4
    v_xor_b32 v7, 96, v4
    v_bfe_u32 v1, v0, 4, 1
    v_lshlrev_b32 v1, 1, v1
    v_and_b32 v2, 7, v0
    v_xor_b32 v1, v1, v2
    v_lshrrev_b32 v2, 3, v0
    v_mul_u32_u24 v2, 1280, v2
    v_lshl_add_u32 v232, v1, 4, v2
    v_xor_b32 v1, 4, v1
    v_lshl_add_u32 v1, v1, 4, v2
    v_add_u32 v233, 9216, v1
    v_add_u32 v234, 18432, v232
    v_add_u32 v235, 27648, v1
    v_add_u32 v236, 65536, v4
    v_add_u32 v237, 65536, v5
    v_add_u32 v238, 65536, v6
    v_add_u32 v239, 65536, v7
    v_readlane_b32 s46, v23, 1
    s_add_u32 m0, s45, 16384
    s_nop 0
    s_nop 2
    buffer_load_dwordx4 v12, s[12:15], s46 offen offset:0 lds
    buffer_load_dwordx4 v13, s[12:15], s46 offen offset:1024 lds
    buffer_load_dwordx4 v14, s[12:15], s46 offen offset:2048 lds
    buffer_load_dwordx4 v15, s[12:15], s46 offen offset:3072 lds
    v_readlane_b32 s47, v22, 1
    s_add_u32 m0, s44, 16384
    s_nop 0
    s_nop 2
    buffer_load_dwordx4 v8, s[8:11], s47 offen offset:0 lds
    buffer_load_dwordx4 v9, s[8:11], s47 offen offset:1024 lds
    buffer_load_dwordx4 v10, s[8:11], s47 offen offset:2048 lds
    buffer_load_dwordx4 v11, s[8:11], s47 offen offset:3072 lds
    s_mov_b64 exec, 0
    s_cmp_eq_u32 s36, 0
    s_cbranch_scc1 L_tc1
    s_cmp_eq_u32 s36, 1
    s_cbranch_scc1 L_tc2
    s_lshl_b32 s4, s48, 1
    s_add_u32 s4, s4, s36
    s_cmp_eq_u32 s4, 4
    s_cbranch_scc1 L_tv1_0
    s_cmp_eq_u32 s4, 5
    s_cbranch_scc1 L_tv1_1
    s_cmp_eq_u32 s4, 6
    s_cbranch_scc1 L_tv2_0
    s_cmp_eq_u32 s4, 7
    s_cbranch_scc1 L_tv2_1
    s_cmp_eq_u32 s4, 8
    s_cbranch_scc1 L_tv3_0
    s_cmp_eq_u32 s4, 9
    s_cbranch_scc1 L_tv3_1
    s_cmp_eq_u32 s4, 10
    s_cbranch_scc1 L_tv4_0
    s_cmp_eq_u32 s4, 11
    s_cbranch_scc1 L_tv4_1
    s_cmp_eq_u32 s4, 12
    s_cbranch_scc1 L_tv5_0
    s_cmp_eq_u32 s4, 13
    s_cbranch_scc1 L_tv5_1
    s_cmp_eq_u32 s36, 2
    s_cbranch_scc1 L_tv0_0
    s_branch L_tv0_1
L_fin:
L_end:
    s_endpgm
L_nslow_n:
    s_cmp_eq_u32 s52, 0
    s_cbranch_scc1 L_nok_n
    s_sub_u32 s52, s52, 1
    buffer_load_dword v29, off, s[32:35], 0 sc1
    s_waitcnt vmcnt(0)
    s_branch L_nchk_n
L_idle:
    s_nop 7
    s_nop 7
    v_readlane_b32 s89, v24, 7
    v_mul_f32 v32, v32, v40
    v_mul_f32 v33, v33, v41
    v_mul_f32 v34, v34, v42
    v_mul_f32 v35, v35, v43
    v_mul_f32 v36, v36, v44
    v_mul_f32 v37, v37, v45
    v_mul_f32 v38, v38, v46
    v_mul_f32 v39, v39, v47
    v_cvt_pk_bf16_f32 v40, v32, v33
    v_cvt_pk_bf16_f32 v42, v36, v37
    v_cvt_pk_bf16_f32 v41, v34, v35
    v_cvt_pk_bf16_f32 v43, v38, v39
    s_nop 1
    v_permlane16_swap_b32 v40, v42
    v_permlane16_swap_b32 v41, v43
    buffer_store_dwordx4 v[40:43], v21, s[16:19], s89 offen sc1
    s_waitcnt vmcnt(0)
    s_barrier
    s_cmp_lg_u32 s36, 0
    s_cbranch_scc1 L_pub_i2
    s_atomic_swap s50, s[64:65], 256
    s_atomic_swap s50, s[64:65], 384
L_pub_i2:
    s_branch L_fin
L_nslow_f:
    s_cmp_eq_u32 s52, 0
    s_cbranch_scc1 L_nok_f
    s_sub_u32 s52, s52, 1
    buffer_load_dword v29, off, s[32:35], 0 sc1
    s_waitcnt vmcnt(0)
    s_branch L_nchk_f
.p2align 12
L_base:
    s_mov_b64 exec, -1
    v_readlane_b32 s46, v23, 2
    s_waitcnt vmcnt(10)
    s_barrier
    ds_read_b128 v[112:115], v16 offset:0
    ds_read_b64_tr_b16 a[0:1], v20 offset:0
    s_add_u32 m0, s45, 32768
    ds_read_b128 v[116:119], v16 offset:2048
    ds_read_b64_tr_b16 a[2:3], v20 offset:512
    buffer_load_dwordx4 v12, s[12:15], s46 offen offset:0 lds
    ds_read_b128 v[120:123], v16 offset:4096
    ds_read_b64_tr_b16 a[4:5], v20 offset:8192
    ds_read_b128 v[124:127], v16 offset:6144
    ds_read_b64_tr_b16 a[6:7], v20 offset:8704
    buffer_load_dwordx4 v13, s[12:15], s46 offen offset:1024 lds
    ds_read_b128 v[128:131], v16 offset:8192
    v_readlane_b32 s47, v22, 2
    ds_read_b64_tr_b16 a[8:9], v20 offset:4096
    ds_read_b128 v[132:135], v16 offset:10240
    buffer_load_dwordx4 v14, s[12:15], s46 offen offset:2048 lds
    ds_read_b128 v[136:139], v16 offset:12288
    ds_read_b64_tr_b16 a[10:11], v20 offset:4608
    s_waitcnt lgkmcnt(5)
    v_mfma_f32_16x16x32_bf16 v[32:35], a[0:3], v[112:115], 0
    ds_read_b128 v[140:143], v16 offset:14336
    ds_read_b64_tr_b16 a[12:13], v20 offset:12288
    v_mfma_f32_16x16x32_bf16 v[40:43], a[4:7], v[112:115], 0
    buffer_load_dwordx4 v15, s[12:15], s46 offen offset:3072 lds
    v_mfma_f32_16x16x32_bf16 v[44:47], a[4:7], v[116:119], 0
    ds_read_b128 v[112:115], v17 offset:0
    s_add_u32 m0, s45, 65536
    s_mov_b32 s3, s54
    s_add_u32 s54, s54, s55
    v_mfma_f32_16x16x32_bf16 v[36:39], a[0:3], v[116:119], 0
    buffer_load_dwordx4 v232, s[20:23], s3 offen offset:0 lds
    v_mfma_f32_16x16x32_bf16 v[64:67], a[0:3], v[120:123], 0
    ds_read_b128 v[116:119], v17 offset:2048
    s_add_u32 m0, s44, 32768
    v_mfma_f32_16x16x32_bf16 v[72:75], a[4:7], v[120:123], 0
    buffer_load_dwordx4 v8, s[8:11], s47 offen offset:0 lds
    v_mfma_f32_16x16x32_bf16 v[76:79], a[4:7], v[124:127], 0
    ds_read_b128 v[120:123], v17 offset:4096
    v_mfma_f32_16x16x32_bf16 v[68:71], a[0:3], v[124:127], 0
    ds_read_b64_tr_b16 a[14:15], v20 offset:12800
    s_waitcnt lgkmcnt(8)
    v_mfma_f32_16x16x32_bf16 v[80:83], a[0:3], v[128:131], 0
    ds_read_b128 v[124:127], v17 offset:6144
    v_mfma_f32_16x16x32_bf16 v[88:91], a[4:7], v[128:131], 0
    buffer_load_dwordx4 v9, s[8:11], s47 offen offset:1024 lds
    v_mfma_f32_16x16x32_bf16 v[92:95], a[4:7], v[132:135], 0
    ds_read_b128 v[128:131], v17 offset:8192
    v_readlane_b32 s46, v23, 3
    v_mfma_f32_16x16x32_bf16 v[84:87], a[0:3], v[132:135], 0
    s_waitcnt lgkmcnt(7)
    v_mfma_f32_16x16x32_bf16 v[96:99], a[0:3], v[136:139], 0
    ds_read_b128 v[132:135], v17 offset:10240
    v_mfma_f32_16x16x32_bf16 v[104:107], a[4:7], v[136:139], 0
    buffer_load_dwordx4 v10, s[8:11], s47 offen offset:2048 lds
    v_mfma_f32_16x16x32_bf16 v[108:111], a[4:7], v[140:143], 0
    ds_read_b128 v[136:139], v17 offset:12288
    v_mfma_f32_16x16x32_bf16 v[100:103], a[0:3], v[140:143], 0
    s_waitcnt lgkmcnt(4)
    v_mfma_f32_16x16x32_bf16 v[32:35], a[8:11], v[112:115], v[32:35]
    ds_read_b128 v[140:143], v17 offset:14336
    v_mfma_f32_16x16x32_bf16 v[40:43], a[12:15], v[112:115], v[40:43]
    buffer_load_dwordx4 v11, s[8:11], s47 offen offset:3072 lds
    v_mfma_f32_16x16x32_bf16 v[44:47], a[12:15], v[116:119], v[44:47]
    s_waitcnt vmcnt(9)
    s_barrier
    ds_read_b128 v[112:115], v16 offset:16384
    v_mfma_f32_16x16x32_bf16 v[36:39], a[8:11], v[116:119], v[36:39]
    ds_read_b64_tr_b16 a[16:17], v20 offset:16384
    s_add_u32 m0, s45, 49152
    s_waitcnt lgkmcnt(6)
    v_mfma_f32_16x16x32_bf16 v[64:67], a[8:11], v[120:123], v[64:67]
    ds_read_b128 v[116:119], v16 offset:18432
    ds_read_b64_tr_b16 a[18:19], v20 offset:16896
    v_mfma_f32_16x16x32_bf16 v[72:75], a[12:15], v[120:123], v[72:75]
    buffer_load_dwordx4 v12, s[12:15], s46 offen offset:0 lds
    v_mfma_f32_16x16x32_bf16 v[76:79], a[12:15], v[124:127], v[76:79]
    ds_read_b128 v[120:123], v16 offset:20480
    v_mfma_f32_16x16x32_bf16 v[68:71], a[8:11], v[124:127], v[68:71]
    ds_read_b64_tr_b16 a[20:21], v20 offset:24576
    s_waitcnt lgkmcnt(8)
    v_mfma_f32_16x16x32_bf16 v[80:83], a[8:11], v[128:131], v[80:83]
    ds_read_b128 v[124:127], v16 offset:22528
    ds_read_b64_tr_b16 a[22:23], v20 offset:25088
    v_mfma_f32_16x16x32_bf16 v[88:91], a[12:15], v[128:131], v[88:91]
    buffer_load_dwordx4 v13, s[12:15], s46 offen offset:1024 lds
    v_mfma_f32_16x16x32_bf16 v[92:95], a[12:15], v[132:135], v[92:95]
    ds_read_b128 v[128:131], v16 offset:24576
    v_readlane_b32 s47, v22, 3
    v_mfma_f32_16x16x32_bf16 v[84:87], a[8:11], v[132:135], v[84:87]
    ds_read_b64_tr_b16 a[24:25], v20 offset:20480
    s_waitcnt lgkmcnt(10)
    v_mfma_f32_16x16x32_bf16 v[96:99], a[8:11], v[136:139], v[96:99]
    ds_read_b128 v[132:135], v16 offset:26624
    v_mfma_f32_16x16x32_bf16 v[104:107], a[12:15], v[136:139], v[104:107]
    buffer_load_dwordx4 v14, s[12:15], s46 offen offset:2048 lds
    v_mfma_f32_16x16x32_bf16 v[108:111], a[12:15], v[140:143], v[108:111]
    ds_read_b128 v[136:139], v16 offset:28672
    v_mfma_f32_16x16x32_bf16 v[100:103], a[8:11], v[140:143], v[100:103]
    ds_read_b64_tr_b16 a[26:27], v20 offset:20992
    s_waitcnt lgkmcnt(5)
    v_mfma_f32_16x16x32_bf16 v[32:35], a[16:19], v[112:115], v[32:35]
    ds_read_b128 v[140:143], v16 offset:30720
    ds_read_b64_tr_b16 a[28:29], v20 offset:28672
    v_mfma_f32_16x16x32_bf16 v[40:43], a[20:23], v[112:115], v[40:43]
    buffer_load_dwordx4 v15, s[12:15], s46 offen offset:3072 lds
    v_mfma_f32_16x16x32_bf16 v[44:47], a[20:23], v[116:119], v[44:47]
    ds_read_b128 v[112:115], v17 offset:16384
    s_add_u32 m0, s45, 65536
    v_mfma_f32_16x16x32_bf16 v[36:39], a[16:19], v[116:119], v[36:39]
    buffer_load_dwordx4 v233, s[20:23], s3 offen offset:1024 lds
    v_mfma_f32_16x16x32_bf16 v[64:67], a[16:19], v[120:123], v[64:67]
    ds_read_b128 v[116:119], v17 offset:18432
    s_add_u32 m0, s44, 49152
    v_mfma_f32_16x16x32_bf16 v[72:75], a[20:23], v[120:123], v[72:75]
    buffer_load_dwordx4 v8, s[8:11], s47 offen offset:0 lds
    v_mfma_f32_16x16x32_bf16 v[76:79], a[20:23], v[124:127], v[76:79]
    ds_read_b128 v[120:123], v17 offset:20480
    v_mfma_f32_16x16x32_bf16 v[68:71], a[16:19], v[124:127], v[68:71]
    ds_read_b64_tr_b16 a[30:31], v20 offset:29184
    s_waitcnt lgkmcnt(8)
    v_mfma_f32_16x16x32_bf16 v[80:83], a[16:19], v[128:131], v[80:83]
    ds_read_b128 v[124:127], v17 offset:22528
    v_mfma_f32_16x16x32_bf16 v[88:91], a[20:23], v[128:131], v[88:91]
    buffer_load_dwordx4 v9, s[8:11], s47 offen offset:1024 lds
    v_mfma_f32_16x16x32_bf16 v[92:95], a[20:23], v[132:135], v[92:95]
    ds_read_b128 v[128:131], v17 offset:24576
    v_readlane_b32 s46, v23, 4
    v_mfma_f32_16x16x32_bf16 v[84:87], a[16:19], v[132:135], v[84:87]
    s_waitcnt lgkmcnt(7)
    v_mfma_f32_16x16x32_bf16 v[96:99], a[16:19], v[136:139], v[96:99]
    ds_read_b128 v[132:135], v17 offset:26624
    v_mfma_f32_16x16x32_bf16 v[104:107], a[20:23], v[136:139], v[104:107]
    buffer_load_dwordx4 v10, s[8:11], s47 offen offset:2048 lds
    v_mfma_f32_16x16x32_bf16 v[108:111], a[20:23], v[140:143], v[108:111]
    ds_read_b128 v[136:139], v17 offset:28672
    v_mfma_f32_16x16x32_bf16 v[100:103], a[16:19], v[140:143], v[100:103]
    s_waitcnt lgkmcnt(4)
    v_mfma_f32_16x16x32_bf16 v[32:35], a[24:27], v[112:115], v[32:35]
    ds_read_b128 v[140:143], v17 offset:30720
    v_mfma_f32_16x16x32_bf16 v[40:43], a[28:31], v[112:115], v[40:43]
    buffer_load_dwordx4 v11, s[8:11], s47 offen offset:3072 lds
    v_mfma_f32_16x16x32_bf16 v[44:47], a[28:31], v[116:119], v[44:47]
    s_waitcnt vmcnt(9)
    s_barrier
    ds_read_b128 v[112:115], v16 offset:32768
    v_mfma_f32_16x16x32_bf16 v[36:39], a[24:27], v[116:119], v[36:39]
    ds_read_b64_tr_b16 a[32:33], v20 offset:32768
    s_add_u32 m0, s45, 0
    s_waitcnt lgkmcnt(6)
    v_mfma_f32_16x16x32_bf16 v[64:67], a[24:27], v[120:123], v[64:67]
    ds_read_b128 v[116:119], v16 offset:34816
    ds_read_b64_tr_b16 a[34:35], v20 offset:33280
    buffer_load_dword v29, off, s[32:35], 0 sc1
    v_mfma_f32_16x16x32_bf16 v[72:75], a[28:31], v[120:123], v[72:75]
    buffer_load_dwordx4 v12, s[12:15], s46 offen offset:0 lds
    v_mfma_f32_16x16x32_bf16 v[76:79], a[28:31], v[124:127], v[76:79]
    ds_read_b128 v[120:123], v16 offset:36864
    v_mfma_f32_16x16x32_bf16 v[68:71], a[24:27], v[124:127], v[68:71]
    ds_read_b64_tr_b16 a[36:37], v20 offset:40960
    s_waitcnt lgkmcnt(8)
    v_mfma_f32_16x16x32_bf16 v[80:83], a[24:27], v[128:131], v[80:83]
    ds_read_b128 v[124:127], v16 offset:38912
    ds_read_b64_tr_b16 a[38:39], v20 offset:41472
    v_mfma_f32_16x16x32_bf16 v[88:91], a[28:31], v[128:131], v[88:91]
    buffer_load_dwordx4 v13, s[12:15], s46 offen offset:1024 lds
    v_mfma_f32_16x16x32_bf16 v[92:95], a[28:31], v[132:135], v[92:95]
    ds_read_b128 v[128:131], v16 offset:40960
    v_readlane_b32 s47, v22, 4
    v_mfma_f32_16x16x32_bf16 v[84:87], a[24:27], v[132:135], v[84:87]
    ds_read_b64_tr_b16 a[40:41], v20 offset:36864
    s_waitcnt lgkmcnt(10)
    v_mfma_f32_16x16x32_bf16 v[96:99], a[24:27], v[136:139], v[96:99]
    ds_read_b128 v[132:135], v16 offset:43008
    v_mfma_f32_16x16x32_bf16 v[104:107], a[28:31], v[136:139], v[104:107]
    buffer_load_dwordx4 v14, s[12:15], s46 offen offset:2048 lds
    v_mfma_f32_16x16x32_bf16 v[108:111], a[28:31], v[140:143], v[108:111]
    ds_read_b128 v[136:139], v16 offset:45056
    v_mfma_f32_16x16x32_bf16 v[100:103], a[24:27], v[140:143], v[100:103]
    ds_read_b64_tr_b16 a[42:43], v20 offset:37376
    s_waitcnt lgkmcnt(5)
    v_mfma_f32_16x16x32_bf16 v[32:35], a[32:35], v[112:115], v[32:35]
    ds_read_b128 v[140:143], v16 offset:47104
    ds_read_b64_tr_b16 a[44:45], v20 offset:45056
    v_mfma_f32_16x16x32_bf16 v[40:43], a[36:39], v[112:115], v[40:43]
    buffer_load_dwordx4 v15, s[12:15], s46 offen offset:3072 lds
    v_mfma_f32_16x16x32_bf16 v[44:47], a[36:39], v[116:119], v[44:47]
    ds_read_b128 v[112:115], v17 offset:32768
    s_add_u32 m0, s45, 65536
    v_mfma_f32_16x16x32_bf16 v[36:39], a[32:35], v[116:119], v[36:39]
    buffer_load_dwordx4 v234, s[20:23], s3 offen offset:2048 lds
    v_mfma_f32_16x16x32_bf16 v[64:67], a[32:35], v[120:123], v[64:67]
    ds_read_b128 v[116:119], v17 offset:34816
    s_add_u32 m0, s44, 0
    v_mfma_f32_16x16x32_bf16 v[72:75], a[36:39], v[120:123], v[72:75]
    buffer_load_dwordx4 v8, s[8:11], s47 offen offset:0 lds
    v_mfma_f32_16x16x32_bf16 v[76:79], a[36:39], v[124:127], v[76:79]
    ds_read_b128 v[120:123], v17 offset:36864
    v_mfma_f32_16x16x32_bf16 v[68:71], a[32:35], v[124:127], v[68:71]
    ds_read_b64_tr_b16 a[46:47], v20 offset:45568
    s_waitcnt lgkmcnt(8)
    v_mfma_f32_16x16x32_bf16 v[80:83], a[32:35], v[128:131], v[80:83]
    ds_read_b128 v[124:127], v17 offset:38912
    v_mfma_f32_16x16x32_bf16 v[88:91], a[36:39], v[128:131], v[88:91]
    buffer_load_dwordx4 v9, s[8:11], s47 offen offset:1024 lds
    v_mfma_f32_16x16x32_bf16 v[92:95], a[36:39], v[132:135], v[92:95]
    ds_read_b128 v[128:131], v17 offset:40960
    v_readlane_b32 s46, v23, 5
    v_mfma_f32_16x16x32_bf16 v[84:87], a[32:35], v[132:135], v[84:87]
    s_waitcnt lgkmcnt(7)
    v_mfma_f32_16x16x32_bf16 v[96:99], a[32:35], v[136:139], v[96:99]
    ds_read_b128 v[132:135], v17 offset:43008
    v_mfma_f32_16x16x32_bf16 v[104:107], a[36:39], v[136:139], v[104:107]
    buffer_load_dwordx4 v10, s[8:11], s47 offen offset:2048 lds
    v_mfma_f32_16x16x32_bf16 v[108:111], a[36:39], v[140:143], v[108:111]
    ds_read_b128 v[136:139], v17 offset:45056
    v_mfma_f32_16x16x32_bf16 v[100:103], a[32:35], v[140:143], v[100:103]
    s_waitcnt lgkmcnt(4)
    v_mfma_f32_16x16x32_bf16 v[32:35], a[40:43], v[112:115], v[32:35]
    ds_read_b128 v[140:143], v17 offset:47104
    v_mfma_f32_16x16x32_bf16 v[40:43], a[44:47], v[112:115], v[40:43]
    buffer_load_dwordx4 v11, s[8:11], s47 offen offset:3072 lds
    v_mfma_f32_16x16x32_bf16 v[44:47], a[44:47], v[116:119], v[44:47]
    s_waitcnt vmcnt(10)
    s_barrier
    ds_read_b128 v[112:115], v16 offset:49152
    v_mfma_f32_16x16x32_bf16 v[36:39], a[40:43], v[116:119], v[36:39]
    ds_read_b64_tr_b16 a[48:49], v20 offset:49152
    s_add_u32 m0, s45, 16384
    s_waitcnt lgkmcnt(6)
    v_mfma_f32_16x16x32_bf16 v[64:67], a[40:43], v[120:123], v[64:67]
    ds_read_b128 v[116:119], v16 offset:51200
    ds_read_b64_tr_b16 a[50:51], v20 offset:49664
    v_mfma_f32_16x16x32_bf16 v[72:75], a[44:47], v[120:123], v[72:75]
    buffer_load_dwordx4 v12, s[12:15], s46 offen offset:0 lds
    v_mfma_f32_16x16x32_bf16 v[76:79], a[44:47], v[124:127], v[76:79]
    ds_read_b128 v[120:123], v16 offset:53248
    v_mfma_f32_16x16x32_bf16 v[68:71], a[40:43], v[124:127], v[68:71]
    ds_read_b64_tr_b16 a[52:53], v20 offset:57344
    s_waitcnt lgkmcnt(8)
    v_mfma_f32_16x16x32_bf16 v[80:83], a[40:43], v[128:131], v[80:83]
    ds_read_b128 v[124:127], v16 offset:55296
    ds_read_b64_tr_b16 a[54:55], v20 offset:57856
    v_mfma_f32_16x16x32_bf16 v[88:91], a[44:47], v[128:131], v[88:91]
    buffer_load_dwordx4 v13, s[12:15], s46 offen offset:1024 lds
    v_mfma_f32_16x16x32_bf16 v[92:95], a[44:47], v[132:135], v[92:95]
    ds_read_b128 v[128:131], v16 offset:57344
    v_readlane_b32 s47, v22, 5
    v_mfma_f32_16x16x32_bf16 v[84:87], a[40:43], v[132:135], v[84:87]
    ds_read_b64_tr_b16 a[56:57], v20 offset:53248
    s_waitcnt lgkmcnt(10)
    v_mfma_f32_16x16x32_bf16 v[96:99], a[40:43], v[136:139], v[96:99]
    ds_read_b128 v[132:135], v16 offset:59392
    v_mfma_f32_16x16x32_bf16 v[104:107], a[44:47], v[136:139], v[104:107]
    buffer_load_dwordx4 v14, s[12:15], s46 offen offset:2048 lds
    v_mfma_f32_16x16x32_bf16 v[108:111], a[44:47], v[140:143], v[108:111]
    ds_read_b128 v[136:139], v16 offset:61440
    v_mfma_f32_16x16x32_bf16 v[100:103], a[40:43], v[140:143], v[100:103]
    ds_read_b64_tr_b16 a[58:59], v20 offset:53760
    s_waitcnt lgkmcnt(5)
    v_mfma_f32_16x16x32_bf16 v[32:35], a[48:51], v[112:115], v[32:35]
    ds_read_b128 v[140:143], v16 offset:63488
    ds_read_b64_tr_b16 a[60:61], v20 offset:61440
    v_mfma_f32_16x16x32_bf16 v[40:43], a[52:55], v[112:115], v[40:43]
    buffer_load_dwordx4 v15, s[12:15], s46 offen offset:3072 lds
    v_mfma_f32_16x16x32_bf16 v[44:47], a[52:55], v[116:119], v[44:47]
    ds_read_b128 v[112:115], v17 offset:49152
    s_add_u32 m0, s45, 65536
    v_mfma_f32_16x16x32_bf16 v[36:39], a[48:51], v[116:119], v[36:39]
    buffer_load_dwordx4 v235, s[20:23], s3 offen offset:3072 lds
    v_mfma_f32_16x16x32_bf16 v[64:67], a[48:51], v[120:123], v[64:67]
    ds_read_b128 v[116:119], v17 offset:51200
    s_add_u32 m0, s44, 16384
    v_mfma_f32_16x16x32_bf16 v[72:75], a[52:55], v[120:123], v[72:75]
    buffer_load_dwordx4 v8, s[8:11], s47 offen offset:0 lds
    v_mfma_f32_16x16x32_bf16 v[76:79], a[52:55], v[124:127], v[76:79]
    ds_read_b128 v[120:123], v17 offset:53248
    v_mfma_f32_16x16x32_bf16 v[68:71], a[48:51], v[124:127], v[68:71]
    ds_read_b64_tr_b16 a[62:63], v20 offset:61952
    s_waitcnt lgkmcnt(8)
    v_mfma_f32_16x16x32_bf16 v[80:83], a[48:51], v[128:131], v[80:83]
    ds_read_b128 v[124:127], v17 offset:55296
    v_mfma_f32_16x16x32_bf16 v[88:91], a[52:55], v[128:131], v[88:91]
    buffer_load_dwordx4 v9, s[8:11], s47 offen offset:1024 lds
    v_mfma_f32_16x16x32_bf16 v[92:95], a[52:55], v[132:135], v[92:95]
    ds_read_b128 v[128:131], v17 offset:57344
    v_readlane_b32 s46, v23, 6
    v_mfma_f32_16x16x32_bf16 v[84:87], a[48:51], v[132:135], v[84:87]
    s_waitcnt lgkmcnt(7)
    v_mfma_f32_16x16x32_bf16 v[96:99], a[48:51], v[136:139], v[96:99]
    ds_read_b128 v[132:135], v17 offset:59392
    v_mfma_f32_16x16x32_bf16 v[104:107], a[52:55], v[136:139], v[104:107]
    buffer_load_dwordx4 v10, s[8:11], s47 offen offset:2048 lds
    v_mfma_f32_16x16x32_bf16 v[108:111], a[52:55], v[140:143], v[108:111]
    ds_read_b128 v[136:139], v17 offset:61440
    v_mfma_f32_16x16x32_bf16 v[100:103], a[48:51], v[140:143], v[100:103]
    s_waitcnt lgkmcnt(4)
    v_mfma_f32_16x16x32_bf16 v[32:35], a[56:59], v[112:115], v[32:35]
    ds_read_b128 v[140:143], v17 offset:63488
    v_mfma_f32_16x16x32_bf16 v[40:43], a[60:63], v[112:115], v[40:43]
    buffer_load_dwordx4 v11, s[8:11], s47 offen offset:3072 lds
    v_mfma_f32_16x16x32_bf16 v[44:47], a[60:63], v[116:119], v[44:47]
    s_waitcnt vmcnt(9)
    s_barrier
    ds_read_b128 v[112:115], v16 offset:0
    v_mfma_f32_16x16x32_bf16 v[36:39], a[56:59], v[116:119], v[36:39]
    ds_read_b64_tr_b16 a[64:65], v20 offset:0
    s_add_u32 m0, s45, 32768
    s_waitcnt lgkmcnt(6)
    v_mfma_f32_16x16x32_bf16 v[64:67], a[56:59], v[120:123], v[64:67]
    ds_read_b128 v[116:119], v16 offset:2048
    ds_read_b64_tr_b16 a[66:67], v20 offset:512
    v_mfma_f32_16x16x32_bf16 v[72:75], a[60:63], v[120:123], v[72:75]
    buffer_load_dwordx4 v12, s[12:15], s46 offen offset:0 lds
    v_mfma_f32_16x16x32_bf16 v[76:79], a[60:63], v[124:127], v[76:79]
    ds_read_b128 v[120:123], v16 offset:4096
    v_mfma_f32_16x16x32_bf16 v[68:71], a[56:59], v[124:127], v[68:71]
    ds_read_b64_tr_b16 a[68:69], v20 offset:8192
    s_waitcnt lgkmcnt(8)
    v_mfma_f32_16x16x32_bf16 v[80:83], a[56:59], v[128:131], v[80:83]
    ds_read_b128 v[124:127], v16 offset:6144
    ds_read_b64_tr_b16 a[70:71], v20 offset:8704
    v_mfma_f32_16x16x32_bf16 v[88:91], a[60:63], v[128:131], v[88:91]
    buffer_load_dwordx4 v13, s[12:15], s46 offen offset:1024 lds
    v_mfma_f32_16x16x32_bf16 v[92:95], a[60:63], v[132:135], v[92:95]
    ds_read_b128 v[128:131], v16 offset:8192
    v_readlane_b32 s47, v22, 6
    v_mfma_f32_16x16x32_bf16 v[84:87], a[56:59], v[132:135], v[84:87]
    ds_read_b64_tr_b16 a[72:73], v20 offset:4096
    s_waitcnt lgkmcnt(10)
    v_mfma_f32_16x16x32_bf16 v[96:99], a[56:59], v[136:139], v[96:99]
    ds_read_b128 v[132:135], v16 offset:10240
    v_mfma_f32_16x16x32_bf16 v[104:107], a[60:63], v[136:139], v[104:107]
    buffer_load_dwordx4 v14, s[12:15], s46 offen offset:2048 lds
    v_mfma_f32_16x16x32_bf16 v[108:111], a[60:63], v[140:143], v[108:111]
    ds_read_b128 v[136:139], v16 offset:12288
    v_mfma_f32_16x16x32_bf16 v[100:103], a[56:59], v[140:143], v[100:103]
    ds_read_b64_tr_b16 a[74:75], v20 offset:4608
    s_waitcnt lgkmcnt(5)
    v_mfma_f32_16x16x32_bf16 v[32:35], a[64:67], v[112:115], v[32:35]
    ds_read_b128 v[140:143], v16 offset:14336
    ds_read_b64_tr_b16 a[76:77], v20 offset:12288
    v_mfma_f32_16x16x32_bf16 v[40:43], a[68:71], v[112:115], v[40:43]
    buffer_load_dwordx4 v15, s[12:15], s46 offen offset:3072 lds
    v_mfma_f32_16x16x32_bf16 v[44:47], a[68:71], v[116:119], v[44:47]
    ds_read_b128 v[112:115], v17 offset:0
    s_add_u32 m0, s45, 81920
    s_mov_b32 s3, s54
    s_add_u32 s54, s54, s55
    v_mfma_f32_16x16x32_bf16 v[36:39], a[64:67], v[116:119], v[36:39]
    buffer_load_dwordx4 v232, s[20:23], s3 offen offset:0 lds
    v_mfma_f32_16x16x32_bf16 v[64:67], a[64:67], v[120:123], v[64:67]
    ds_read_b128 v[116:119], v17 offset:2048
    s_add_u32 m0, s44, 32768
    v_mfma_f32_16x16x32_bf16 v[72:75], a[68:71], v[120:123], v[72:75]
    buffer_load_dwordx4 v8, s[8:11], s47 offen offset:0 lds
    v_mfma_f32_16x16x32_bf16 v[76:79], a[68:71], v[124:127], v[76:79]
    ds_read_b128 v[120:123], v17 offset:4096
    v_mfma_f32_16x16x32_bf16 v[68:71], a[64:67], v[124:127], v[68:71]
    ds_read_b64_tr_b16 a[78:79], v20 offset:12800
    s_waitcnt lgkmcnt(8)
    v_mfma_f32_16x16x32_bf16 v[80:83], a[64:67], v[128:131], v[80:83]
    ds_read_b128 v[124:127], v17 offset:6144
    v_mfma_f32_16x16x32_bf16 v[88:91], a[68:71], v[128:131], v[88:91]
    buffer_load_dwordx4 v9, s[8:11], s47 offen offset:1024 lds
    v_mfma_f32_16x16x32_bf16 v[92:95], a[68:71], v[132:135], v[92:95]
    ds_read_b128 v[128:131], v17 offset:8192
    v_readlane_b32 s46, v23, 7
    v_mfma_f32_16x16x32_bf16 v[84:87], a[64:67], v[132:135], v[84:87]
    s_waitcnt lgkmcnt(7)
    v_mfma_f32_16x16x32_bf16 v[96:99], a[64:67], v[136:139], v[96:99]
    ds_read_b128 v[132:135], v17 offset:10240
    v_mfma_f32_16x16x32_bf16 v[104:107], a[68:71], v[136:139], v[104:107]
    buffer_load_dwordx4 v10, s[8:11], s47 offen offset:2048 lds
    v_mfma_f32_16x16x32_bf16 v[108:111], a[68:71], v[140:143], v[108:111]
    ds_read_b128 v[136:139], v17 offset:12288
    v_mfma_f32_16x16x32_bf16 v[100:103], a[64:67], v[140:143], v[100:103]
    s_waitcnt lgkmcnt(4)
    v_mfma_f32_16x16x32_bf16 v[32:35], a[72:75], v[112:115], v[32:35]
    ds_read_b128 v[140:143], v17 offset:14336
    v_mfma_f32_16x16x32_bf16 v[40:43], a[76:79], v[112:115], v[40:43]
    buffer_load_dwordx4 v11, s[8:11], s47 offen offset:3072 lds
    v_mfma_f32_16x16x32_bf16 v[44:47], a[76:79], v[116:119], v[44:47]
    s_waitcnt vmcnt(9)
    s_barrier
    ds_read_b128 v[112:115], v16 offset:16384
    v_mfma_f32_16x16x32_bf16 v[36:39], a[72:75], v[116:119], v[36:39]
    ds_read_b64_tr_b16 a[80:81], v20 offset:16384
    s_add_u32 m0, s45, 49152
    s_waitcnt lgkmcnt(6)
    v_mfma_f32_16x16x32_bf16 v[64:67], a[72:75], v[120:123], v[64:67]
    ds_read_b128 v[116:119], v16 offset:18432
    ds_read_b64_tr_b16 a[82:83], v20 offset:16896
    v_mfma_f32_16x16x32_bf16 v[72:75], a[76:79], v[120:123], v[72:75]
    buffer_load_dwordx4 v12, s[12:15], s46 offen offset:0 lds
    v_mfma_f32_16x16x32_bf16 v[76:79], a[76:79], v[124:127], v[76:79]
    ds_read_b128 v[120:123], v16 offset:20480
    v_mfma_f32_16x16x32_bf16 v[68:71], a[72:75], v[124:127], v[68:71]
    ds_read_b64_tr_b16 a[84:85], v20 offset:24576
    s_waitcnt lgkmcnt(8)
    v_mfma_f32_16x16x32_bf16 v[80:83], a[72:75], v[128:131], v[80:83]
    ds_read_b128 v[124:127], v16 offset:22528
    ds_read_b64_tr_b16 a[86:87], v20 offset:25088
    v_mfma_f32_16x16x32_bf16 v[88:91], a[76:79], v[128:131], v[88:91]
    buffer_load_dwordx4 v13, s[12:15], s46 offen offset:1024 lds
    v_mfma_f32_16x16x32_bf16 v[92:95], a[76:79], v[132:135], v[92:95]
    ds_read_b128 v[128:131], v16 offset:24576
    v_readlane_b32 s47, v22, 7
    v_mfma_f32_16x16x32_bf16 v[84:87], a[72:75], v[132:135], v[84:87]
    ds_read_b64_tr_b16 a[88:89], v20 offset:20480
    s_waitcnt lgkmcnt(10)
    v_mfma_f32_16x16x32_bf16 v[96:99], a[72:75], v[136:139], v[96:99]
    ds_read_b128 v[132:135], v16 offset:26624
    v_mfma_f32_16x16x32_bf16 v[104:107], a[76:79], v[136:139], v[104:107]
    buffer_load_dwordx4 v14, s[12:15], s46 offen offset:2048 lds
    v_mfma_f32_16x16x32_bf16 v[108:111], a[76:79], v[140:143], v[108:111]
    ds_read_b128 v[136:139], v16 offset:28672
    v_mfma_f32_16x16x32_bf16 v[100:103], a[72:75], v[140:143], v[100:103]
    ds_read_b64_tr_b16 a[90:91], v20 offset:20992
    s_waitcnt lgkmcnt(5)
    v_mfma_f32_16x16x32_bf16 v[32:35], a[80:83], v[112:115], v[32:35]
    ds_read_b128 v[140:143], v16 offset:30720
    ds_read_b64_tr_b16 a[92:93], v20 offset:28672
    v_mfma_f32_16x16x32_bf16 v[40:43], a[84:87], v[112:115], v[40:43]
    buffer_load_dwordx4 v15, s[12:15], s46 offen offset:3072 lds
    v_mfma_f32_16x16x32_bf16 v[44:47], a[84:87], v[116:119], v[44:47]
    ds_read_b128 v[112:115], v17 offset:16384
    s_add_u32 m0, s45, 81920
    v_mfma_f32_16x16x32_bf16 v[36:39], a[80:83], v[116:119], v[36:39]
    buffer_load_dwordx4 v233, s[20:23], s3 offen offset:1024 lds
    v_mfma_f32_16x16x32_bf16 v[64:67], a[80:83], v[120:123], v[64:67]
    ds_read_b128 v[116:119], v17 offset:18432
    s_add_u32 m0, s44, 49152
    v_mfma_f32_16x16x32_bf16 v[72:75], a[84:87], v[120:123], v[72:75]
    buffer_load_dwordx4 v8, s[8:11], s47 offen offset:0 lds
    v_mfma_f32_16x16x32_bf16 v[76:79], a[84:87], v[124:127], v[76:79]
    ds_read_b128 v[120:123], v17 offset:20480
    v_mfma_f32_16x16x32_bf16 v[68:71], a[80:83], v[124:127], v[68:71]
    ds_read_b64_tr_b16 a[94:95], v20 offset:29184
    s_waitcnt lgkmcnt(8)
    v_mfma_f32_16x16x32_bf16 v[80:83], a[80:83], v[128:131], v[80:83]
    ds_read_b128 v[124:127], v17 offset:22528
    v_mfma_f32_16x16x32_bf16 v[88:91], a[84:87], v[128:131], v[88:91]
    buffer_load_dwordx4 v9, s[8:11], s47 offen offset:1024 lds
    v_mfma_f32_16x16x32_bf16 v[92:95], a[84:87], v[132:135], v[92:95]
    ds_read_b128 v[128:131], v17 offset:24576
    v_readlane_b32 s46, v23, 8
    v_mfma_f32_16x16x32_bf16 v[84:87], a[80:83], v[132:135], v[84:87]
    ds_read_b64_tr_b16 a[160:161], v236 offset:0
    s_waitcnt lgkmcnt(8)
    v_mfma_f32_16x16x32_bf16 v[96:99], a[80:83], v[136:139], v[96:99]
    ds_read_b128 v[132:135], v17 offset:26624
    ds_read_b64_tr_b16 a[162:163], v236 offset:512
    v_mfma_f32_16x16x32_bf16 v[104:107], a[84:87], v[136:139], v[104:107]
    buffer_load_dwordx4 v10, s[8:11], s47 offen offset:2048 lds
    v_mfma_f32_16x16x32_bf16 v[108:111], a[84:87], v[140:143], v[108:111]
    ds_read_b128 v[136:139], v17 offset:28672
    v_mfma_f32_16x16x32_bf16 v[100:103], a[80:83], v[140:143], v[100:103]
    ds_read_b64_tr_b16 a[164:165], v237 offset:0
    s_waitcnt lgkmcnt(7)
    v_mfma_f32_16x16x32_bf16 v[32:35], a[88:91], v[112:115], v[32:35]
    ds_read_b128 v[140:143], v17 offset:30720
    ds_read_b64_tr_b16 a[166:167], v237 offset:512
    v_mfma_f32_16x16x32_bf16 v[40:43], a[92:95], v[112:115], v[40:43]
    buffer_load_dwordx4 v11, s[8:11], s47 offen offset:3072 lds
    v_mfma_f32_16x16x32_bf16 v[44:47], a[92:95], v[116:119], v[44:47]
    s_waitcnt vmcnt(9)
    s_barrier
    ds_read_b128 v[112:115], v16 offset:32768
    v_mfma_f32_16x16x32_bf16 v[36:39], a[88:91], v[116:119], v[36:39]
    ds_read_b64_tr_b16 a[96:97], v20 offset:32768
    s_add_u32 m0, s45, 0
    s_waitcnt lgkmcnt(10)
    v_mfma_f32_16x16x32_bf16 v[64:67], a[88:91], v[120:123], v[64:67]
    ds_read_b128 v[116:119], v16 offset:34816
    ds_read_b64_tr_b16 a[98:99], v20 offset:33280
L_nchk_n:
    v_readfirstlane_b32 s50, v29
    s_cmp_eq_u32 s50, 0
    s_cbranch_scc1 L_nslow_n
L_nok_n:
    s_mov_b32 s51, s50
    v_mfma_f32_16x16x32_bf16 v[72:75], a[92:95], v[120:123], v[72:75]
    buffer_load_dwordx4 v12, s[12:15], s46 offen offset:0 lds
    v_mfma_f32_16x16x32_bf16 v[76:79], a[92:95], v[124:127], v[76:79]
    ds_read_b128 v[120:123], v16 offset:36864
    v_mfma_f32_16x16x32_bf16 v[68:71], a[88:91], v[124:127], v[68:71]
    ds_read_b64_tr_b16 a[100:101], v20 offset:40960
    s_waitcnt lgkmcnt(11)
    v_mfma_f32_16x16x32_bf16 v[80:83], a[88:91], v[128:131], v[80:83]
    ds_read_b128 v[124:127], v16 offset:38912
    ds_read_b64_tr_b16 a[102:103], v20 offset:41472
    v_mfma_f32_16x16x32_bf16 v[88:91], a[92:95], v[128:131], v[88:91]
    buffer_load_dwordx4 v13, s[12:15], s46 offen offset:1024 lds
    v_mfma_f32_16x16x32_bf16 v[92:95], a[92:95], v[132:135], v[92:95]
    ds_read_b128 v[128:131], v16 offset:40960
    v_readlane_b32 s47, v22, 8
    v_mfma_f32_16x16x32_bf16 v[84:87], a[88:91], v[132:135], v[84:87]
    ds_read_b64_tr_b16 a[104:105], v20 offset:36864
    s_waitcnt lgkmcnt(11)
    v_mfma_f32_16x16x32_bf16 v[96:99], a[88:91], v[136:139], v[96:99]
    ds_read_b128 v[132:135], v16 offset:43008
    v_mfma_f32_16x16x32_bf16 v[104:107], a[92:95], v[136:139], v[104:107]
    buffer_load_dwordx4 v14, s[12:15], s46 offen offset:2048 lds
    v_mfma_f32_16x16x32_bf16 v[108:111], a[92:95], v[140:143], v[108:111]
    ds_read_b128 v[136:139], v16 offset:45056
    v_mfma_f32_16x16x32_bf16 v[100:103], a[88:91], v[140:143], v[100:103]
    ds_read_b64_tr_b16 a[106:107], v20 offset:37376
    s_waitcnt lgkmcnt(5)
    v_mfma_f32_16x16x32_bf16 v[32:35], a[96:99], v[112:115], v[32:35]
    ds_read_b128 v[140:143], v16 offset:47104
    ds_read_b64_tr_b16 a[108:109], v20 offset:45056
    v_mfma_f32_16x16x32_bf16 v[40:43], a[100:103], v[112:115], v[40:43]
    buffer_load_dwordx4 v15, s[12:15], s46 offen offset:3072 lds
    v_mfma_f32_16x16x32_bf16 v[44:47], a[100:103], v[116:119], v[44:47]
    ds_read_b128 v[112:115], v17 offset:32768
    s_add_u32 m0, s45, 81920
    v_mfma_f32_16x16x32_bf16 v[36:39], a[96:99], v[116:119], v[36:39]
    buffer_load_dwordx4 v234, s[20:23], s3 offen offset:2048 lds
    v_mfma_f32_16x16x32_bf16 v[64:67], a[96:99], v[120:123], v[64:67]
    ds_read_b128 v[116:119], v17 offset:34816
    s_add_u32 m0, s44, 0
    v_mfma_f32_16x16x32_bf16 v[72:75], a[100:103], v[120:123], v[72:75]
    buffer_load_dwordx4 v8, s[8:11], s47 offen offset:0 lds
    v_mfma_f32_16x16x32_bf16 v[76:79], a[100:103], v[124:127], v[76:79]
    ds_read_b128 v[120:123], v17 offset:36864
    v_mfma_f32_16x16x32_bf16 v[68:71], a[96:99], v[124:127], v[68:71]
    ds_read_b64_tr_b16 a[110:111], v20 offset:45568
    s_waitcnt lgkmcnt(8)
    v_mfma_f32_16x16x32_bf16 v[80:83], a[96:99], v[128:131], v[80:83]
    ds_read_b128 v[124:127], v17 offset:38912
    v_mfma_f32_16x16x32_bf16 v[88:91], a[100:103], v[128:131], v[88:91]
    buffer_load_dwordx4 v9, s[8:11], s47 offen offset:1024 lds
    v_mfma_f32_16x16x32_bf16 v[92:95], a[100:103], v[132:135], v[92:95]
    ds_read_b128 v[128:131], v17 offset:40960
    v_readlane_b32 s46, v23, 9
    v_mfma_f32_16x16x32_bf16 v[84:87], a[96:99], v[132:135], v[84:87]
    ds_read_b64_tr_b16 a[168:169], v238 offset:0
    s_waitcnt lgkmcnt(8)
    v_mfma_f32_16x16x32_bf16 v[96:99], a[96:99], v[136:139], v[96:99]
    ds_read_b128 v[132:135], v17 offset:43008
    ds_read_b64_tr_b16 a[170:171], v238 offset:512
    v_mfma_f32_16x16x32_bf16 v[104:107], a[100:103], v[136:139], v[104:107]
    buffer_load_dwordx4 v10, s[8:11], s47 offen offset:2048 lds
    v_mfma_f32_16x16x32_bf16 v[108:111], a[100:103], v[140:143], v[108:111]
    ds_read_b128 v[136:139], v17 offset:45056
    v_mfma_f32_16x16x32_bf16 v[100:103], a[96:99], v[140:143], v[100:103]
    ds_read_b64_tr_b16 a[172:173], v239 offset:0
    s_waitcnt lgkmcnt(7)
L_tc1:
    s_cbranch_execz L_base
    v_mfma_f32_16x16x32_bf16 v[32:35], a[104:107], v[112:115], v[32:35]
    ds_read_b128 v[140:143], v17 offset:47104
    ds_read_b64_tr_b16 a[174:175], v239 offset:512
    v_mfma_f32_16x16x32_bf16 v[40:43], a[108:111], v[112:115], v[40:43]
    buffer_load_dwordx4 v11, s[8:11], s47 offen offset:3072 lds
    v_mfma_f32_16x16x32_bf16 v[44:47], a[108:111], v[116:119], v[44:47]
    s_waitcnt vmcnt(9)
    s_barrier
    ds_read_b128 v[112:115], v16 offset:49152
    v_mfma_f32_16x16x32_bf16 v[36:39], a[104:107], v[116:119], v[36:39]
    ds_read_b64_tr_b16 a[112:113], v20 offset:49152
    s_add_u32 m0, s45, 16384
    s_waitcnt lgkmcnt(10)
    v_mfma_f32_16x16x32_bf16 v[64:67], a[104:107], v[120:123], v[64:67]
    ds_read_b128 v[116:119], v16 offset:51200
    ds_read_b64_tr_b16 a[114:115], v20 offset:49664
    v_mfma_f32_16x16x32_bf16 v[72:75], a[108:111], v[120:123], v[72:75]
    buffer_load_dwordx4 v12, s[12:15], s46 offen offset:0 lds
    v_mfma_f32_16x16x32_bf16 v[76:79], a[108:111], v[124:127], v[76:79]
    ds_read_b128 v[120:123], v16 offset:53248
    v_mfma_f32_16x16x32_bf16 v[68:71], a[104:107], v[124:127], v[68:71]
    ds_read_b64_tr_b16 a[116:117], v20 offset:57344
    s_waitcnt lgkmcnt(11)
    v_mfma_f32_16x16x32_bf16 v[80:83], a[104:107], v[128:131], v[80:83]
    ds_read_b128 v[124:127], v16 offset:55296
    ds_read_b64_tr_b16 a[118:119], v20 offset:57856
    v_mfma_f32_16x16x32_bf16 v[88:91], a[108:111], v[128:131], v[88:91]
    buffer_load_dwordx4 v13, s[12:15], s46 offen offset:1024 lds
    v_mfma_f32_16x16x32_bf16 v[92:95], a[108:111], v[132:135], v[92:95]
    ds_read_b128 v[128:131], v16 offset:57344
    v_readlane_b32 s47, v22, 9
    v_mfma_f32_16x16x32_bf16 v[84:87], a[104:107], v[132:135], v[84:87]
    ds_read_b64_tr_b16 a[120:121], v20 offset:53248
    s_waitcnt lgkmcnt(11)
    v_mfma_f32_16x16x32_bf16 v[96:99], a[104:107], v[136:139], v[96:99]
    ds_read_b128 v[132:135], v16 offset:59392
    v_mfma_f32_16x16x32_bf16 v[104:107], a[108:111], v[136:139], v[104:107]
    buffer_load_dwordx4 v14, s[12:15], s46 offen offset:2048 lds
    v_mfma_f32_16x16x32_bf16 v[108:111], a[108:111], v[140:143], v[108:111]
    ds_read_b128 v[136:139], v16 offset:61440
    v_mfma_f32_16x16x32_bf16 v[100:103], a[104:107], v[140:143], v[100:103]
    ds_read_b64_tr_b16 a[122:123], v20 offset:53760
    s_waitcnt lgkmcnt(5)
    v_mfma_f32_16x16x32_bf16 v[32:35], a[112:115], v[112:115], v[32:35]
    ds_read_b128 v[140:143], v16 offset:63488
    ds_read_b64_tr_b16 a[124:125], v20 offset:61440
    v_mfma_f32_16x16x32_bf16 v[40:43], a[116:119], v[112:115], v[40:43]
    buffer_load_dwordx4 v15, s[12:15], s46 offen offset:3072 lds
    v_mfma_f32_16x16x32_bf16 v[44:47], a[116:119], v[116:119], v[44:47]
    ds_read_b128 v[112:115], v17 offset:49152
    s_add_u32 m0, s45, 81920
    v_mfma_f32_16x16x32_bf16 v[36:39], a[112:115], v[116:119], v[36:39]
    buffer_load_dwordx4 v235, s[20:23], s3 offen offset:3072 lds
    v_mfma_f32_16x16x32_bf16 v[64:67], a[112:115], v[120:123], v[64:67]
    ds_read_b128 v[116:119], v17 offset:51200
    s_add_u32 m0, s44, 16384
    v_mfma_f32_16x16x32_bf16 v[72:75], a[116:119], v[120:123], v[72:75]
    buffer_load_dwordx4 v8, s[8:11], s47 offen offset:0 lds
    v_mfma_f32_16x16x32_bf16 v[76:79], a[116:119], v[124:127], v[76:79]
    ds_read_b128 v[120:123], v17 offset:53248
    v_mfma_f32_16x16x32_bf16 v[68:71], a[112:115], v[124:127], v[68:71]
    ds_read_b64_tr_b16 a[126:127], v20 offset:61952
    s_waitcnt lgkmcnt(8)
    v_mfma_f32_16x16x32_bf16 v[80:83], a[112:115], v[128:131], v[80:83]
    ds_read_b128 v[124:127], v17 offset:55296
    v_mfma_f32_16x16x32_bf16 v[88:91], a[116:119], v[128:131], v[88:91]
    buffer_load_dwordx4 v9, s[8:11], s47 offen offset:1024 lds
    v_mfma_f32_16x16x32_bf16 v[92:95], a[116:119], v[132:135], v[92:95]
    ds_read_b128 v[128:131], v17 offset:57344
    v_readlane_b32 s46, v22, 10
    v_mfma_f32_16x16x32_bf16 v[84:87], a[112:115], v[132:135], v[84:87]
    s_waitcnt lgkmcnt(7)
    v_mfma_f32_16x16x32_bf16 v[96:99], a[112:115], v[136:139], v[96:99]
    ds_read_b128 v[132:135], v17 offset:59392
    v_mfma_f32_16x16x32_bf16 v[104:107], a[116:119], v[136:139], v[104:107]
    buffer_load_dwordx4 v10, s[8:11], s47 offen offset:2048 lds
    v_mfma_f32_16x16x32_bf16 v[108:111], a[116:119], v[140:143], v[108:111]
    ds_read_b128 v[136:139], v17 offset:61440
    v_mfma_f32_16x16x32_bf16 v[100:103], a[112:115], v[140:143], v[100:103]
    s_waitcnt lgkmcnt(4)
    v_mfma_f32_16x16x32_bf16 v[32:35], a[120:123], v[112:115], v[32:35]
    ds_read_b128 v[140:143], v17 offset:63488
    v_mfma_f32_16x16x32_bf16 v[40:43], a[124:127], v[112:115], v[40:43]
    buffer_load_dwordx4 v11, s[8:11], s47 offen offset:3072 lds
    v_mfma_f32_16x16x32_bf16 v[44:47], a[124:127], v[116:119], v[44:47]
    s_waitcnt vmcnt(9)
    s_barrier
    ds_read_b128 v[112:115], v16 offset:0
    v_mfma_f32_16x16x32_bf16 v[36:39], a[120:123], v[116:119], v[36:39]
    ds_read_b64_tr_b16 a[128:129], v20 offset:0
    s_add_u32 m0, s44, 32768
    s_waitcnt lgkmcnt(6)
    v_mfma_f32_16x16x32_bf16 v[64:67], a[120:123], v[120:123], v[64:67]
    ds_read_b128 v[116:119], v16 offset:2048
    ds_read_b64_tr_b16 a[130:131], v20 offset:512
    v_mfma_f32_16x16x32_bf16 v[72:75], a[124:127], v[120:123], v[72:75]
    buffer_load_dwordx4 v8, s[8:11], s46 offen offset:0 lds
    v_mfma_f32_16x16x32_bf16 v[76:79], a[124:127], v[124:127], v[76:79]
    ds_read_b128 v[120:123], v16 offset:4096
    v_mfma_f32_16x16x32_bf16 v[68:71], a[120:123], v[124:127], v[68:71]
    ds_read_b64_tr_b16 a[132:133], v20 offset:8192
    s_waitcnt lgkmcnt(8)
    v_mfma_f32_16x16x32_bf16 v[80:83], a[120:123], v[128:131], v[80:83]
    ds_read_b128 v[124:127], v16 offset:6144
    ds_read_b64_tr_b16 a[134:135], v20 offset:8704
    v_mfma_f32_16x16x32_bf16 v[88:91], a[124:127], v[128:131], v[88:91]
    buffer_load_dwordx4 v9, s[8:11], s46 offen offset:1024 lds
    v_mfma_f32_16x16x32_bf16 v[92:95], a[124:127], v[132:135], v[92:95]
    ds_read_b128 v[128:131], v16 offset:8192
    s_mov_b32 s47, s54
    s_add_u32 s54, s54, s55
    v_mfma_f32_16x16x32_bf16 v[84:87], a[120:123], v[132:135], v[84:87]
    ds_read_b64_tr_b16 a[136:137], v20 offset:4096
    s_waitcnt lgkmcnt(10)
    v_mfma_f32_16x16x32_bf16 v[96:99], a[120:123], v[136:139], v[96:99]
    ds_read_b128 v[132:135], v16 offset:10240
    v_mfma_f32_16x16x32_bf16 v[104:107], a[124:127], v[136:139], v[104:107]
    buffer_load_dwordx4 v10, s[8:11], s46 offen offset:2048 lds
    v_mfma_f32_16x16x32_bf16 v[108:111], a[124:127], v[140:143], v[108:111]
    ds_read_b128 v[136:139], v16 offset:12288
    v_mfma_f32_16x16x32_bf16 v[100:103], a[120:123], v[140:143], v[100:103]
    ds_read_b64_tr_b16 a[138:139], v20 offset:4608
    s_waitcnt lgkmcnt(5)
    v_mfma_f32_16x16x32_bf16 v[32:35], a[128:131], v[112:115], v[32:35]
    ds_read_b128 v[140:143], v16 offset:14336
    ds_read_b64_tr_b16 a[140:141], v20 offset:12288
    v_mfma_f32_16x16x32_bf16 v[40:43], a[132:135], v[112:115], v[40:43]
    buffer_load_dwordx4 v11, s[8:11], s46 offen offset:3072 lds
    v_mfma_f32_16x16x32_bf16 v[44:47], a[132:135], v[116:119], v[44:47]
    ds_read_b128 v[112:115], v17 offset:0
    s_add_u32 m0, s45, 32768
    v_mfma_f32_16x16x32_bf16 v[36:39], a[128:131], v[116:119], v[36:39]
    v_mfma_f32_16x16x32_bf16 v[64:67], a[128:131], v[120:123], v[64:67]
    ds_read_b128 v[116:119], v17 offset:2048
    v_mfma_f32_16x16x32_bf16 v[72:75], a[132:135], v[120:123], v[72:75]
    buffer_load_dwordx4 v232, s[20:23], s47 offen offset:0 lds
    v_mfma_f32_16x16x32_bf16 v[76:79], a[132:135], v[124:127], v[76:79]
    ds_read_b128 v[120:123], v17 offset:4096
    v_mfma_f32_16x16x32_bf16 v[68:71], a[128:131], v[124:127], v[68:71]
    ds_read_b64_tr_b16 a[142:143], v20 offset:12800
    s_waitcnt lgkmcnt(8)
    v_mfma_f32_16x16x32_bf16 v[80:83], a[128:131], v[128:131], v[80:83]
    ds_read_b128 v[124:127], v17 offset:6144
    v_mfma_f32_16x16x32_bf16 v[88:91], a[132:135], v[128:131], v[88:91]
    buffer_load_dwordx4 v233, s[20:23], s47 offen offset:1024 lds
    v_mfma_f32_16x16x32_bf16 v[92:95], a[132:135], v[132:135], v[92:95]
    ds_read_b128 v[128:131], v17 offset:8192
    v_readlane_b32 s46, v22, 11
    v_mfma_f32_16x16x32_bf16 v[84:87], a[128:131], v[132:135], v[84:87]
    s_waitcnt lgkmcnt(7)
    v_mfma_f32_16x16x32_bf16 v[96:99], a[128:131], v[136:139], v[96:99]
    ds_read_b128 v[132:135], v17 offset:10240
    v_mfma_f32_16x16x32_bf16 v[104:107], a[132:135], v[136:139], v[104:107]
    buffer_load_dwordx4 v234, s[20:23], s47 offen offset:2048 lds
    v_mfma_f32_16x16x32_bf16 v[108:111], a[132:135], v[140:143], v[108:111]
    ds_read_b128 v[136:139], v17 offset:12288
    v_mfma_f32_16x16x32_bf16 v[100:103], a[128:131], v[140:143], v[100:103]
    s_waitcnt lgkmcnt(4)
    v_mfma_f32_16x16x32_bf16 v[32:35], a[136:139], v[112:115], v[32:35]
    ds_read_b128 v[140:143], v17 offset:14336
    v_mfma_f32_16x16x32_bf16 v[40:43], a[140:143], v[112:115], v[40:43]
    buffer_load_dwordx4 v235, s[20:23], s47 offen offset:3072 lds
    v_mfma_f32_16x16x32_bf16 v[44:47], a[140:143], v[116:119], v[44:47]
    s_waitcnt vmcnt(8)
    s_barrier
    ds_read_b128 v[112:115], v16 offset:16384
    v_mfma_f32_16x16x32_bf16 v[36:39], a[136:139], v[116:119], v[36:39]
    ds_read_b64_tr_b16 a[144:145], v20 offset:16384
    s_add_u32 m0, s44, 49152
    s_waitcnt lgkmcnt(6)
    v_mfma_f32_16x16x32_bf16 v[64:67], a[136:139], v[120:123], v[64:67]
    ds_read_b128 v[116:119], v16 offset:18432
    ds_read_b64_tr_b16 a[146:147], v20 offset:16896
    v_mfma_f32_16x16x32_bf16 v[72:75], a[140:143], v[120:123], v[72:75]
    buffer_load_dwordx4 v8, s[8:11], s46 offen offset:0 lds
    v_mfma_f32_16x16x32_bf16 v[76:79], a[140:143], v[124:127], v[76:79]
    ds_read_b128 v[120:123], v16 offset:20480
    v_mfma_f32_16x16x32_bf16 v[68:71], a[136:139], v[124:127], v[68:71]
    ds_read_b64_tr_b16 a[148:149], v20 offset:24576
    s_waitcnt lgkmcnt(8)
    v_mfma_f32_16x16x32_bf16 v[80:83], a[136:139], v[128:131], v[80:83]
    ds_read_b128 v[124:127], v16 offset:22528
    ds_read_b64_tr_b16 a[150:151], v20 offset:25088
    v_mfma_f32_16x16x32_bf16 v[88:91], a[140:143], v[128:131], v[88:91]
    buffer_load_dwordx4 v9, s[8:11], s46 offen offset:1024 lds
    v_mfma_f32_16x16x32_bf16 v[92:95], a[140:143], v[132:135], v[92:95]
    ds_read_b128 v[128:131], v16 offset:24576
    s_mov_b32 s47, s54
    s_add_u32 s54, s54, s55
    v_mfma_f32_16x16x32_bf16 v[84:87], a[136:139], v[132:135], v[84:87]
    ds_read_b64_tr_b16 a[152:153], v20 offset:20480
    s_waitcnt lgkmcnt(10)
    v_mfma_f32_16x16x32_bf16 v[96:99], a[136:139], v[136:139], v[96:99]
    ds_read_b128 v[132:135], v16 offset:26624
    v_mfma_f32_16x16x32_bf16 v[104:107], a[140:143], v[136:139], v[104:107]
    buffer_load_dwordx4 v10, s[8:11], s46 offen offset:2048 lds
    v_mfma_f32_16x16x32_bf16 v[108:111], a[140:143], v[140:143], v[108:111]
    ds_read_b128 v[136:139], v16 offset:28672
    v_mfma_f32_16x16x32_bf16 v[100:103], a[136:139], v[140:143], v[100:103]
    ds_read_b64_tr_b16 a[154:155], v20 offset:20992
    s_waitcnt lgkmcnt(5)
    v_mfma_f32_16x16x32_bf16 v[32:35], a[144:147], v[112:115], v[32:35]
    ds_read_b128 v[140:143], v16 offset:30720
    ds_read_b64_tr_b16 a[156:157], v20 offset:28672
    v_mfma_f32_16x16x32_bf16 v[40:43], a[148:151], v[112:115], v[40:43]
    buffer_load_dwordx4 v11, s[8:11], s46 offen offset:3072 lds
    v_mfma_f32_16x16x32_bf16 v[44:47], a[148:151], v[116:119], v[44:47]
    ds_read_b128 v[112:115], v17 offset:16384
    s_add_u32 m0, s45, 49152
    v_mfma_f32_16x16x32_bf16 v[36:39], a[144:147], v[116:119], v[36:39]
    v_mfma_f32_16x16x32_bf16 v[64:67], a[144:147], v[120:123], v[64:67]
    ds_read_b128 v[116:119], v17 offset:18432
    v_mfma_f32_16x16x32_bf16 v[72:75], a[148:151], v[120:123], v[72:75]
    buffer_load_dwordx4 v232, s[20:23], s47 offen offset:0 lds
    v_mfma_f32_16x16x32_bf16 v[76:79], a[148:151], v[124:127], v[76:79]
    ds_read_b128 v[120:123], v17 offset:20480
    v_mfma_f32_16x16x32_bf16 v[68:71], a[144:147], v[124:127], v[68:71]
    ds_read_b64_tr_b16 a[158:159], v20 offset:29184
    s_waitcnt lgkmcnt(8)
    v_mfma_f32_16x16x32_bf16 v[80:83], a[144:147], v[128:131], v[80:83]
    ds_read_b128 v[124:127], v17 offset:22528
    v_mfma_f32_16x16x32_bf16 v[88:91], a[148:151], v[128:131], v[88:91]
    buffer_load_dwordx4 v233, s[20:23], s47 offen offset:1024 lds
    v_mfma_f32_16x16x32_bf16 v[92:95], a[148:151], v[132:135], v[92:95]
    ds_read_b128 v[128:131], v17 offset:24576
    v_readlane_b32 s46, v22, 12
    v_mfma_f32_16x16x32_bf16 v[84:87], a[144:147], v[132:135], v[84:87]
    ds_read_b64_tr_b16 a[176:177], v236 offset:16384
    s_waitcnt lgkmcnt(8)
    v_mfma_f32_16x16x32_bf16 v[96:99], a[144:147], v[136:139], v[96:99]
    ds_read_b128 v[132:135], v17 offset:26624
    ds_read_b64_tr_b16 a[178:179], v236 offset:16896
    v_mfma_f32_16x16x32_bf16 v[104:107], a[148:151], v[136:139], v[104:107]
    buffer_load_dwordx4 v234, s[20:23], s47 offen offset:2048 lds
    v_mfma_f32_16x16x32_bf16 v[108:111], a[148:151], v[140:143], v[108:111]
    ds_read_b128 v[136:139], v17 offset:28672
    v_mfma_f32_16x16x32_bf16 v[100:103], a[144:147], v[140:143], v[100:103]
    ds_read_b64_tr_b16 a[180:181], v237 offset:16384
    s_waitcnt lgkmcnt(7)
    v_mfma_f32_16x16x32_bf16 v[32:35], a[152:155], v[112:115], v[32:35]
    ds_read_b128 v[140:143], v17 offset:30720
    ds_read_b64_tr_b16 a[182:183], v237 offset:16896
    v_mfma_f32_16x16x32_bf16 v[40:43], a[156:159], v[112:115], v[40:43]
    buffer_load_dwordx4 v235, s[20:23], s47 offen offset:3072 lds
    v_mfma_f32_16x16x32_bf16 v[44:47], a[156:159], v[116:119], v[44:47]
    s_waitcnt vmcnt(8)
    s_barrier
    ds_read_b128 v[112:115], v16 offset:32768
    v_mfma_f32_16x16x32_bf16 v[36:39], a[152:155], v[116:119], v[36:39]
    ds_read_b64_tr_b16 a[192:193], v4 offset:32768
    s_add_u32 m0, s44, 0
    s_waitcnt lgkmcnt(10)
    v_mfma_f32_16x16x32_bf16 v[64:67], a[152:155], v[120:123], v[64:67]
    ds_read_b128 v[116:119], v17 offset:32768
    v_mfma_f32_16x16x32_bf16 v[72:75], a[156:159], v[120:123], v[72:75]
    buffer_load_dwordx4 v8, s[8:11], s46 offen offset:0 lds
    v_mfma_f32_16x16x32_bf16 v[76:79], a[156:159], v[124:127], v[76:79]
    ds_read_b128 v[120:123], v16 offset:36864
    v_readlane_b32 s82, v24, 0
    v_mfma_f32_16x16x32_bf16 v[68:71], a[152:155], v[124:127], v[68:71]
    ds_read_b64_tr_b16 a[194:195], v4 offset:33280
    v_mul_f32 v32, v32, v40
    s_waitcnt lgkmcnt(10)
    v_mfma_f32_16x16x32_bf16 v[80:83], a[152:155], v[128:131], v[80:83]
    ds_read_b128 v[124:127], v17 offset:36864
    v_mul_f32 v33, v33, v41
    v_mfma_f32_16x16x32_bf16 v[88:91], a[156:159], v[128:131], v[88:91]
    buffer_load_dwordx4 v9, s[8:11], s46 offen offset:1024 lds
    v_mul_f32 v34, v34, v42
    v_mfma_f32_16x16x32_bf16 v[92:95], a[156:159], v[132:135], v[92:95]
    ds_read_b128 v[128:131], v16 offset:40960
    s_mov_b32 s47, s54
    s_add_u32 s54, s54, s55
    v_mul_f32 v35, v35, v43
    v_mfma_f32_16x16x32_bf16 v[84:87], a[152:155], v[132:135], v[84:87]
    ds_read_b64_tr_b16 a[196:197], v5 offset:32768
    v_mul_f32 v36, v36, v44
    s_waitcnt lgkmcnt(9)
    v_mfma_f32_16x16x32_bf16 v[96:99], a[152:155], v[136:139], v[96:99]
    ds_read_b128 v[132:135], v17 offset:40960
    v_mul_f32 v37, v37, v45
    v_mfma_f32_16x16x32_bf16 v[104:107], a[156:159], v[136:139], v[104:107]
    buffer_load_dwordx4 v10, s[8:11], s46 offen offset:2048 lds
    v_mul_f32 v38, v38, v46
    v_mfma_f32_16x16x32_bf16 v[108:111], a[156:159], v[140:143], v[108:111]
    ds_read_b128 v[136:139], v16 offset:45056
    v_mul_f32 v39, v39, v47
    v_mfma_f32_16x16x32_bf16 v[100:103], a[152:155], v[140:143], v[100:103]
    ds_read_b64_tr_b16 a[198:199], v5 offset:33280
    v_cvt_pk_bf16_f32 v248, v32, v33
    v_cvt_pk_bf16_f32 v250, v36, v37
    s_waitcnt lgkmcnt(8)
    v_mfma_f32_16x16x32_bf16 v[48:51], a[0:3], v[112:115], 0
    ds_read_b128 v[140:143], v17 offset:45056
    v_cvt_pk_bf16_f32 v249, v34, v35
    v_mfma_f32_16x16x32_bf16 v[48:51], a[8:11], v[116:119], v[48:51]
    buffer_load_dwordx4 v11, s[8:11], s46 offen offset:3072 lds
    v_cvt_pk_bf16_f32 v251, v38, v39
    v_mfma_f32_16x16x32_bf16 v[56:59], a[4:7], v[112:115], 0
    ds_read_b128 v[112:115], v16 offset:34816
    s_add_u32 m0, s45, 0
    v_permlane16_swap_b32 v248, v250
    v_mfma_f32_16x16x32_bf16 v[56:59], a[12:15], v[116:119], v[56:59]
    ds_read_b64_tr_b16 a[200:201], v6 offset:32768
    v_permlane16_swap_b32 v249, v251
    s_waitcnt lgkmcnt(8)
    v_mfma_f32_16x16x32_bf16 v[56:59], a[20:23], v[120:123], v[56:59]
    ds_read_b128 v[116:119], v17 offset:34816
    v_readlane_b32 s83, v24, 1
    v_mfma_f32_16x16x32_bf16 v[56:59], a[28:31], v[124:127], v[56:59]
    buffer_load_dwordx4 v232, s[20:23], s47 offen offset:0 lds
    v_mul_f32 v64, v64, v72
    v_mfma_f32_16x16x32_bf16 v[48:51], a[16:19], v[120:123], v[48:51]
    ds_read_b128 v[120:123], v16 offset:38912
    v_mul_f32 v65, v65, v73
    v_mfma_f32_16x16x32_bf16 v[48:51], a[24:27], v[124:127], v[48:51]
    ds_read_b64_tr_b16 a[202:203], v6 offset:33280
    v_mul_f32 v66, v66, v74
    s_waitcnt lgkmcnt(8)
    v_mfma_f32_16x16x32_bf16 v[48:51], a[32:35], v[128:131], v[48:51]
    ds_read_b128 v[124:127], v17 offset:38912
    v_mul_f32 v67, v67, v75
    v_mfma_f32_16x16x32_bf16 v[48:51], a[40:43], v[132:135], v[48:51]
    buffer_load_dwordx4 v233, s[20:23], s47 offen offset:1024 lds
    v_mul_f32 v68, v68, v76
    v_mul_f32 v69, v69, v77
    v_mfma_f32_16x16x32_bf16 v[56:59], a[36:39], v[128:131], v[56:59]
    ds_read_b128 v[128:131], v16 offset:43008
    v_readlane_b32 s46, v22, 13
    v_mul_f32 v70, v70, v78
    v_mfma_f32_16x16x32_bf16 v[56:59], a[44:47], v[132:135], v[56:59]
    ds_read_b64_tr_b16 a[204:205], v7 offset:32768
    ds_read_b64_tr_b16 a[184:185], v238 offset:16384
    s_waitcnt lgkmcnt(9)
    v_mfma_f32_16x16x32_bf16 v[56:59], a[52:55], v[136:139], v[56:59]
    ds_read_b128 v[132:135], v17 offset:43008
    ds_read_b64_tr_b16 a[186:187], v238 offset:16896
    v_mul_f32 v71, v71, v79
    v_cvt_pk_bf16_f32 v72, v64, v65
    v_mfma_f32_16x16x32_bf16 v[56:59], a[60:63], v[140:143], v[56:59]
    buffer_load_dwordx4 v234, s[20:23], s47 offen offset:2048 lds
    v_cvt_pk_bf16_f32 v74, v68, v69
    v_mfma_f32_16x16x32_bf16 v[48:51], a[48:51], v[136:139], v[48:51]
    ds_read_b128 v[136:139], v16 offset:47104
    v_cvt_pk_bf16_f32 v73, v66, v67
    v_mfma_f32_16x16x32_bf16 v[48:51], a[56:59], v[140:143], v[48:51]
    ds_read_b64_tr_b16 a[206:207], v7 offset:33280
    ds_read_b64_tr_b16 a[188:189], v239 offset:16384
    s_waitcnt lgkmcnt(11)
    v_mfma_f32_16x16x32_bf16 v[52:55], a[0:3], v[112:115], 0
    ds_read_b128 v[140:143], v17 offset:47104
    ds_read_b64_tr_b16 a[190:191], v239 offset:16896
    v_cvt_pk_bf16_f32 v75, v70, v71
    s_nop 1
    v_permlane16_swap_b32 v72, v74
    v_mfma_f32_16x16x32_bf16 v[52:55], a[8:11], v[116:119], v[52:55]
    buffer_load_dwordx4 v235, s[20:23], s47 offen offset:3072 lds
    v_permlane16_swap_b32 v73, v75
    buffer_store_dwordx4 v[248:251], v21, s[16:19], s82 offen sc1
    buffer_store_dwordx4 v[72:75], v21, s[16:19], s83 offen sc1
    v_mfma_f32_16x16x32_bf16 v[60:63], a[4:7], v[112:115], 0
    s_waitcnt vmcnt(10)
    s_barrier
    ds_read_b128 v[112:115], v16 offset:51200
    v_mfma_f32_16x16x32_bf16 v[60:63], a[12:15], v[116:119], v[60:63]
    ds_read_b64_tr_b16 a[208:209], v4 offset:49152
    s_add_u32 m0, s44, 16384
    s_waitcnt lgkmcnt(12)
    v_mfma_f32_16x16x32_bf16 v[60:63], a[20:23], v[120:123], v[60:63]
    ds_read_b128 v[116:119], v17 offset:51200
    v_readlane_b32 s84, v24, 2
    v_mul_f32 v80, v80, v88
    v_mul_f32 v81, v81, v89
    v_mul_f32 v82, v82, v90
    v_mfma_f32_16x16x32_bf16 v[60:63], a[28:31], v[124:127], v[60:63]
    buffer_load_dwordx4 v8, s[8:11], s46 offen offset:0 lds
    v_mul_f32 v83, v83, v91
    v_mfma_f32_16x16x32_bf16 v[52:55], a[16:19], v[120:123], v[52:55]
    ds_read_b128 v[120:123], v16 offset:55296
    v_mul_f32 v84, v84, v92
    v_mfma_f32_16x16x32_bf16 v[52:55], a[24:27], v[124:127], v[52:55]
    ds_read_b64_tr_b16 a[210:211], v4 offset:49664
    v_mul_f32 v85, v85, v93
    s_waitcnt lgkmcnt(11)
    v_mfma_f32_16x16x32_bf16 v[52:55], a[32:35], v[128:131], v[52:55]
    ds_read_b128 v[124:127], v17 offset:55296
    v_mul_f32 v86, v86, v94
    v_mfma_f32_16x16x32_bf16 v[52:55], a[40:43], v[132:135], v[52:55]
    buffer_load_dwordx4 v9, s[8:11], s46 offen offset:1024 lds
    v_mul_f32 v87, v87, v95
    v_mfma_f32_16x16x32_bf16 v[60:63], a[36:39], v[128:131], v[60:63]
    ds_read_b128 v[128:131], v16 offset:59392
    s_mov_b32 s47, s54
    s_add_u32 s54, s54, s55
    v_cvt_pk_bf16_f32 v88, v80, v81
    v_mfma_f32_16x16x32_bf16 v[60:63], a[44:47], v[132:135], v[60:63]
    ds_read_b64_tr_b16 a[212:213], v5 offset:49152
    v_cvt_pk_bf16_f32 v90, v84, v85
    s_waitcnt lgkmcnt(9)
    v_mfma_f32_16x16x32_bf16 v[60:63], a[52:55], v[136:139], v[60:63]
    ds_read_b128 v[132:135], v17 offset:59392
    v_cvt_pk_bf16_f32 v89, v82, v83
    v_mfma_f32_16x16x32_bf16 v[60:63], a[60:63], v[140:143], v[60:63]
    buffer_load_dwordx4 v10, s[8:11], s46 offen offset:2048 lds
    v_cvt_pk_bf16_f32 v91, v86, v87
    s_nop 1
    v_permlane16_swap_b32 v88, v90
    v_mfma_f32_16x16x32_bf16 v[52:55], a[48:51], v[136:139], v[52:55]
    ds_read_b128 v[136:139], v16 offset:63488
    v_permlane16_swap_b32 v89, v91
    v_mfma_f32_16x16x32_bf16 v[52:55], a[56:59], v[140:143], v[52:55]
    ds_read_b64_tr_b16 a[214:215], v5 offset:49664
    v_readlane_b32 s85, v24, 3
    s_waitcnt lgkmcnt(8)
    v_mfma_f32_16x16x32_bf16 v[52:55], a[64:67], v[112:115], v[52:55]
    ds_read_b128 v[140:143], v17 offset:63488
    v_mul_f32 v96, v96, v104
    v_mfma_f32_16x16x32_bf16 v[52:55], a[72:75], v[116:119], v[52:55]
    buffer_load_dwordx4 v11, s[8:11], s46 offen offset:3072 lds
    v_mul_f32 v97, v97, v105
    v_mfma_f32_16x16x32_bf16 v[60:63], a[68:71], v[112:115], v[60:63]
    ds_read_b128 v[112:115], v16 offset:49152
    s_add_u32 m0, s45, 16384
    v_mul_f32 v98, v98, v106
    v_mfma_f32_16x16x32_bf16 v[60:63], a[76:79], v[116:119], v[60:63]
    ds_read_b64_tr_b16 a[216:217], v6 offset:49152
    v_mul_f32 v99, v99, v107
    s_waitcnt lgkmcnt(8)
    v_mfma_f32_16x16x32_bf16 v[60:63], a[84:87], v[120:123], v[60:63]
    ds_read_b128 v[116:119], v17 offset:49152
    v_mul_f32 v100, v100, v108
    v_mfma_f32_16x16x32_bf16 v[60:63], a[92:95], v[124:127], v[60:63]
    buffer_load_dwordx4 v232, s[20:23], s47 offen offset:0 lds
    v_mul_f32 v101, v101, v109
    v_mfma_f32_16x16x32_bf16 v[52:55], a[80:83], v[120:123], v[52:55]
    ds_read_b128 v[120:123], v16 offset:53248
    v_mul_f32 v102, v102, v110
    v_mfma_f32_16x16x32_bf16 v[52:55], a[88:91], v[124:127], v[52:55]
    ds_read_b64_tr_b16 a[218:219], v6 offset:49664
    v_mul_f32 v103, v103, v111
    v_cvt_pk_bf16_f32 v104, v96, v97
    s_waitcnt lgkmcnt(8)
    v_mfma_f32_16x16x32_bf16 v[52:55], a[96:99], v[128:131], v[52:55]
    ds_read_b128 v[124:127], v17 offset:53248
    v_cvt_pk_bf16_f32 v106, v100, v101
    v_mfma_f32_16x16x32_bf16 v[52:55], a[104:107], v[132:135], v[52:55]
    buffer_load_dwordx4 v233, s[20:23], s47 offen offset:1024 lds
    v_cvt_pk_bf16_f32 v105, v98, v99
    v_mfma_f32_16x16x32_bf16 v[60:63], a[100:103], v[128:131], v[60:63]
    ds_read_b128 v[128:131], v16 offset:57344
    v_readlane_b32 s46, v22, 14
    v_cvt_pk_bf16_f32 v107, v102, v103
    v_mfma_f32_16x16x32_bf16 v[60:63], a[108:111], v[132:135], v[60:63]
    ds_read_b64_tr_b16 a[220:221], v7 offset:49152
    v_permlane16_swap_b32 v104, v106
    s_waitcnt lgkmcnt(8)
    v_mfma_f32_16x16x32_bf16 v[60:63], a[116:119], v[136:139], v[60:63]
    ds_read_b128 v[132:135], v17 offset:57344
    v_permlane16_swap_b32 v105, v107
    v_mfma_f32_16x16x32_bf16 v[60:63], a[124:127], v[140:143], v[60:63]
    buffer_load_dwordx4 v234, s[20:23], s47 offen offset:2048 lds
    buffer_store_dwordx4 v[88:91], v21, s[16:19], s84 offen sc1
    buffer_store_dwordx4 v[104:107], v21, s[16:19], s85 offen sc1
    v_mfma_f32_16x16x32_bf16 v[52:55], a[112:115], v[136:139], v[52:55]
    ds_read_b128 v[136:139], v16 offset:61440
    v_mfma_f32_16x16x32_bf16 v[52:55], a[120:123], v[140:143], v[52:55]
    ds_read_b64_tr_b16 a[222:223], v7 offset:49664
    s_waitcnt lgkmcnt(8)
    v_mfma_f32_16x16x32_bf16 v[48:51], a[64:67], v[112:115], v[48:51]
    ds_read_b128 v[140:143], v17 offset:61440
    v_mfma_f32_16x16x32_bf16 v[48:51], a[72:75], v[116:119], v[48:51]
    buffer_load_dwordx4 v235, s[20:23], s47 offen offset:3072 lds
    v_mfma_f32_16x16x32_bf16 v[56:59], a[68:71], v[112:115], v[56:59]
    s_waitcnt vmcnt(12)
    s_barrier
    ds_read_b128 v[112:115], v16 offset:0
    v_mfma_f32_16x16x32_bf16 v[56:59], a[76:79], v[116:119], v[56:59]
    ds_read_b64_tr_b16 a[224:225], v4 offset:0
    s_add_u32 m0, s44, 32768
    s_waitcnt lgkmcnt(8)
    v_mfma_f32_16x16x32_bf16 v[56:59], a[84:87], v[120:123], v[56:59]
    ds_read_b128 v[116:119], v17 offset:0
    v_mfma_f32_16x16x32_bf16 v[56:59], a[92:95], v[124:127], v[56:59]
    buffer_load_dwordx4 v8, s[8:11], s46 offen offset:0 lds
    v_mfma_f32_16x16x32_bf16 v[48:51], a[80:83], v[120:123], v[48:51]
    ds_read_b128 v[120:123], v16 offset:4096
    v_mfma_f32_16x16x32_bf16 v[48:51], a[88:91], v[124:127], v[48:51]
    ds_read_b64_tr_b16 a[226:227], v4 offset:512
    s_waitcnt lgkmcnt(8)
    v_mfma_f32_16x16x32_bf16 v[48:51], a[96:99], v[128:131], v[48:51]
    ds_read_b128 v[124:127], v17 offset:4096
    v_mfma_f32_16x16x32_bf16 v[48:51], a[104:107], v[132:135], v[48:51]
    buffer_load_dwordx4 v9, s[8:11], s46 offen offset:1024 lds
    v_mfma_f32_16x16x32_bf16 v[56:59], a[100:103], v[128:131], v[56:59]
    ds_read_b128 v[128:131], v16 offset:2048
    s_mov_b32 s47, s54
    s_add_u32 s54, s54, s55
    v_mfma_f32_16x16x32_bf16 v[56:59], a[108:111], v[132:135], v[56:59]
    ds_read_b64_tr_b16 a[228:229], v5 offset:0
    s_waitcnt lgkmcnt(8)
    v_mfma_f32_16x16x32_bf16 v[56:59], a[116:119], v[136:139], v[56:59]
    ds_read_b128 v[132:135], v17 offset:2048
    v_mfma_f32_16x16x32_bf16 v[56:59], a[124:127], v[140:143], v[56:59]
    buffer_load_dwordx4 v10, s[8:11], s46 offen offset:2048 lds
    v_mfma_f32_16x16x32_bf16 v[48:51], a[112:115], v[136:139], v[48:51]
    ds_read_b128 v[136:139], v16 offset:6144
    v_mfma_f32_16x16x32_bf16 v[48:51], a[120:123], v[140:143], v[48:51]
    ds_read_b64_tr_b16 a[230:231], v5 offset:512
    s_waitcnt lgkmcnt(8)
    v_mfma_f32_16x16x32_bf16 v[48:51], a[128:131], v[112:115], v[48:51]
    ds_read_b128 v[140:143], v17 offset:6144
    v_mfma_f32_16x16x32_bf16 v[48:51], a[136:139], v[116:119], v[48:51]
    buffer_load_dwordx4 v11, s[8:11], s46 offen offset:3072 lds
    v_mfma_f32_16x16x32_bf16 v[56:59], a[132:135], v[112:115], v[56:59]
    ds_read_b128 v[112:115], v16 offset:8192
    s_add_u32 m0, s45, 32768
    v_mfma_f32_16x16x32_bf16 v[56:59], a[140:143], v[116:119], v[56:59]
    ds_read_b64_tr_b16 a[232:233], v6 offset:0
    s_waitcnt lgkmcnt(8)
    v_mfma_f32_16x16x32_bf16 v[56:59], a[148:151], v[120:123], v[56:59]
    ds_read_b128 v[116:119], v17 offset:8192
    v_mfma_f32_16x16x32_bf16 v[56:59], a[156:159], v[124:127], v[56:59]
    buffer_load_dwordx4 v232, s[20:23], s47 offen offset:0 lds
    v_mfma_f32_16x16x32_bf16 v[48:51], a[144:147], v[120:123], v[48:51]
    ds_read_b128 v[120:123], v16 offset:12288
    v_mfma_f32_16x16x32_bf16 v[48:51], a[152:155], v[124:127], v[48:51]
    ds_read_b64_tr_b16 a[234:235], v6 offset:512
    s_waitcnt lgkmcnt(8)
    v_mfma_f32_16x16x32_bf16 v[52:55], a[128:131], v[128:131], v[52:55]
    ds_read_b128 v[124:127], v17 offset:12288
    v_mfma_f32_16x16x32_bf16 v[52:55], a[136:139], v[132:135], v[52:55]
    buffer_load_dwordx4 v233, s[20:23], s47 offen offset:1024 lds
    v_mfma_f32_16x16x32_bf16 v[60:63], a[132:135], v[128:131], v[60:63]
    ds_read_b128 v[128:131], v16 offset:10240
    v_readlane_b32 s46, v22, 15
    v_mfma_f32_16x16x32_bf16 v[60:63], a[140:143], v[132:135], v[60:63]
    ds_read_b64_tr_b16 a[236:237], v7 offset:0
    s_waitcnt lgkmcnt(8)
    v_mfma_f32_16x16x32_bf16 v[60:63], a[148:151], v[136:139], v[60:63]
    ds_read_b128 v[132:135], v17 offset:10240
    v_mfma_f32_16x16x32_bf16 v[60:63], a[156:159], v[140:143], v[60:63]
    buffer_load_dwordx4 v234, s[20:23], s47 offen offset:2048 lds
    v_mfma_f32_16x16x32_bf16 v[52:55], a[144:147], v[136:139], v[52:55]
    ds_read_b128 v[136:139], v16 offset:14336
    v_mfma_f32_16x16x32_bf16 v[52:55], a[152:155], v[140:143], v[52:55]
    ds_read_b64_tr_b16 a[238:239], v7 offset:512
    s_waitcnt lgkmcnt(8)
    v_mfma_f32_16x16x32_bf16 v[32:35], a[0:3], v[112:115], 0
    ds_read_b128 v[140:143], v17 offset:14336
    v_mfma_f32_16x16x32_bf16 v[32:35], a[8:11], v[116:119], v[32:35]
    buffer_load_dwordx4 v235, s[20:23], s47 offen offset:3072 lds
    v_mfma_f32_16x16x32_bf16 v[40:43], a[4:7], v[112:115], 0
    s_waitcnt vmcnt(8)
    s_barrier
    s_cmp_lg_u32 s36, 0
    s_cbranch_scc1 L_pub_n0
    s_atomic_swap s50, s[64:65], 0
L_pub_n0:
    ds_read_b128 v[112:115], v16 offset:18432
    v_mfma_f32_16x16x32_bf16 v[40:43], a[12:15], v[116:119], v[40:43]
    ds_read_b64_tr_b16 a[240:241], v4 offset:16384
    s_add_u32 m0, s44, 49152
    s_waitcnt lgkmcnt(8)
    v_mfma_f32_16x16x32_bf16 v[40:43], a[20:23], v[120:123], v[40:43]
    ds_read_b128 v[116:119], v17 offset:18432
    v_readlane_b32 s86, v24, 4
    v_mul_f32 v48, v48, v56
    v_mul_f32 v49, v49, v57
    v_mfma_f32_16x16x32_bf16 v[40:43], a[28:31], v[124:127], v[40:43]
    buffer_load_dwordx4 v8, s[8:11], s46 offen offset:0 lds
    v_mul_f32 v50, v50, v58
L_tc2:
    s_cbranch_execz L_base
    v_mfma_f32_16x16x32_bf16 v[32:35], a[16:19], v[120:123], v[32:35]
    ds_read_b128 v[120:123], v16 offset:22528
    v_mul_f32 v51, v51, v59
    v_mfma_f32_16x16x32_bf16 v[32:35], a[24:27], v[124:127], v[32:35]
    ds_read_b64_tr_b16 a[242:243], v4 offset:16896
    v_mul_f32 v52, v52, v60
    s_waitcnt lgkmcnt(8)
    v_mfma_f32_16x16x32_bf16 v[36:39], a[0:3], v[128:131], 0
    ds_read_b128 v[124:127], v17 offset:22528
    v_mul_f32 v53, v53, v61
    v_mfma_f32_16x16x32_bf16 v[36:39], a[8:11], v[132:135], v[36:39]
    buffer_load_dwordx4 v9, s[8:11], s46 offen offset:1024 lds
    v_mul_f32 v54, v54, v62
    v_mfma_f32_16x16x32_bf16 v[44:47], a[4:7], v[128:131], 0
    ds_read_b128 v[128:131], v16 offset:26624
    s_mov_b32 s47, s54
    s_add_u32 s54, s54, s55
    v_mul_f32 v55, v55, v63
    v_mfma_f32_16x16x32_bf16 v[44:47], a[12:15], v[132:135], v[44:47]
    ds_read_b64_tr_b16 a[244:245], v5 offset:16384
    v_cvt_pk_bf16_f32 v64, v48, v49
    v_cvt_pk_bf16_f32 v66, v52, v53
    s_waitcnt lgkmcnt(8)
    v_mfma_f32_16x16x32_bf16 v[44:47], a[20:23], v[136:139], v[44:47]
    ds_read_b128 v[132:135], v17 offset:26624
    v_cvt_pk_bf16_f32 v65, v50, v51
    v_mfma_f32_16x16x32_bf16 v[44:47], a[28:31], v[140:143], v[44:47]
    buffer_load_dwordx4 v10, s[8:11], s46 offen offset:2048 lds
    v_cvt_pk_bf16_f32 v67, v54, v55
    v_mfma_f32_16x16x32_bf16 v[36:39], a[16:19], v[136:139], v[36:39]
    ds_read_b128 v[136:139], v16 offset:30720
    v_permlane16_swap_b32 v64, v66
    v_mfma_f32_16x16x32_bf16 v[36:39], a[24:27], v[140:143], v[36:39]
    ds_read_b64_tr_b16 a[246:247], v5 offset:16896
    v_permlane16_swap_b32 v65, v67
    s_waitcnt lgkmcnt(8)
    v_mfma_f32_16x16x32_bf16 v[36:39], a[32:35], v[112:115], v[36:39]
    ds_read_b128 v[140:143], v17 offset:30720
    v_mfma_f32_16x16x32_bf16 v[36:39], a[40:43], v[116:119], v[36:39]
    buffer_load_dwordx4 v11, s[8:11], s46 offen offset:3072 lds
    v_mfma_f32_16x16x32_bf16 v[44:47], a[36:39], v[112:115], v[44:47]
    ds_read_b128 v[112:115], v16 offset:16384
    s_add_u32 m0, s45, 49152
    v_mfma_f32_16x16x32_bf16 v[44:47], a[44:47], v[116:119], v[44:47]
    ds_read_b64_tr_b16 a[248:249], v6 offset:16384
    s_waitcnt lgkmcnt(8)
    v_mfma_f32_16x16x32_bf16 v[44:47], a[52:55], v[120:123], v[44:47]
    ds_read_b128 v[116:119], v17 offset:16384
    v_mfma_f32_16x16x32_bf16 v[44:47], a[60:63], v[124:127], v[44:47]
    buffer_load_dwordx4 v232, s[20:23], s47 offen offset:0 lds
    v_mfma_f32_16x16x32_bf16 v[36:39], a[48:51], v[120:123], v[36:39]
    ds_read_b128 v[120:123], v16 offset:20480
    v_mfma_f32_16x16x32_bf16 v[36:39], a[56:59], v[124:127], v[36:39]
    ds_read_b64_tr_b16 a[250:251], v6 offset:16896
    s_waitcnt lgkmcnt(8)
    v_mfma_f32_16x16x32_bf16 v[36:39], a[64:67], v[128:131], v[36:39]
    ds_read_b128 v[124:127], v17 offset:20480
    v_mfma_f32_16x16x32_bf16 v[36:39], a[72:75], v[132:135], v[36:39]
    buffer_load_dwordx4 v233, s[20:23], s47 offen offset:1024 lds
    v_mfma_f32_16x16x32_bf16 v[44:47], a[68:71], v[128:131], v[44:47]
    ds_read_b128 v[128:131], v16 offset:24576
    v_readlane_b32 s46, v22, 16
    v_mfma_f32_16x16x32_bf16 v[44:47], a[76:79], v[132:135], v[44:47]
    ds_read_b64_tr_b16 a[252:253], v7 offset:16384
    s_waitcnt lgkmcnt(8)
    v_mfma_f32_16x16x32_bf16 v[44:47], a[84:87], v[136:139], v[44:47]
    ds_read_b128 v[132:135], v17 offset:24576
    v_mfma_f32_16x16x32_bf16 v[44:47], a[92:95], v[140:143], v[44:47]
    buffer_load_dwordx4 v234, s[20:23], s47 offen offset:2048 lds
    v_mfma_f32_16x16x32_bf16 v[36:39], a[80:83], v[136:139], v[36:39]
    ds_read_b128 v[136:139], v16 offset:28672
    v_mfma_f32_16x16x32_bf16 v[36:39], a[88:91], v[140:143], v[36:39]
    ds_read_b64_tr_b16 a[254:255], v7 offset:16896
    s_waitcnt lgkmcnt(8)
    v_mfma_f32_16x16x32_bf16 v[32:35], a[32:35], v[112:115], v[32:35]
    ds_read_b128 v[140:143], v17 offset:28672
    v_mfma_f32_16x16x32_bf16 v[32:35], a[40:43], v[116:119], v[32:35]
    buffer_load_dwordx4 v235, s[20:23], s47 offen offset:3072 lds
    v_mfma_f32_16x16x32_bf16 v[40:43], a[36:39], v[112:115], v[40:43]
    s_waitcnt vmcnt(8)
    s_barrier
    ds_read_b128 v[112:115], v16 offset:32768
    v_mfma_f32_16x16x32_bf16 v[40:43], a[44:47], v[116:119], v[40:43]
    ds_read_b64_tr_b16 v[144:145], v4 offset:32768
    s_add_u32 m0, s44, 0
    s_waitcnt lgkmcnt(8)
    v_mfma_f32_16x16x32_bf16 v[40:43], a[52:55], v[120:123], v[40:43]
    ds_read_b128 v[116:119], v17 offset:32768
    v_mfma_f32_16x16x32_bf16 v[40:43], a[60:63], v[124:127], v[40:43]
    buffer_load_dwordx4 v8, s[8:11], s46 offen offset:0 lds
    v_mfma_f32_16x16x32_bf16 v[32:35], a[48:51], v[120:123], v[32:35]
    ds_read_b128 v[120:123], v16 offset:36864
    v_mfma_f32_16x16x32_bf16 v[32:35], a[56:59], v[124:127], v[32:35]
    ds_read_b64_tr_b16 v[146:147], v4 offset:33280
    s_waitcnt lgkmcnt(8)
    v_mfma_f32_16x16x32_bf16 v[32:35], a[64:67], v[128:131], v[32:35]
    ds_read_b128 v[124:127], v17 offset:36864
    v_mfma_f32_16x16x32_bf16 v[32:35], a[72:75], v[132:135], v[32:35]
    buffer_load_dwordx4 v9, s[8:11], s46 offen offset:1024 lds
    v_mfma_f32_16x16x32_bf16 v[40:43], a[68:71], v[128:131], v[40:43]
    ds_read_b128 v[128:131], v16 offset:40960
    s_mov_b32 s47, s54
    s_add_u32 s54, s54, s55
    v_mfma_f32_16x16x32_bf16 v[40:43], a[76:79], v[132:135], v[40:43]
    ds_read_b64_tr_b16 v[148:149], v5 offset:32768
    s_waitcnt lgkmcnt(8)
    v_mfma_f32_16x16x32_bf16 v[40:43], a[84:87], v[136:139], v[40:43]
    ds_read_b128 v[132:135], v17 offset:40960
    v_mfma_f32_16x16x32_bf16 v[40:43], a[92:95], v[140:143], v[40:43]
    buffer_load_dwordx4 v10, s[8:11], s46 offen offset:2048 lds
    v_mfma_f32_16x16x32_bf16 v[32:35], a[80:83], v[136:139], v[32:35]
    ds_read_b128 v[136:139], v16 offset:45056
    v_mfma_f32_16x16x32_bf16 v[32:35], a[88:91], v[140:143], v[32:35]
    ds_read_b64_tr_b16 v[150:151], v5 offset:33280
    s_waitcnt lgkmcnt(8)
    v_mfma_f32_16x16x32_bf16 v[32:35], a[96:99], v[112:115], v[32:35]
    ds_read_b128 v[140:143], v17 offset:45056
    v_mfma_f32_16x16x32_bf16 v[32:35], a[104:107], v[116:119], v[32:35]
    buffer_load_dwordx4 v11, s[8:11], s46 offen offset:3072 lds
    v_mfma_f32_16x16x32_bf16 v[40:43], a[100:103], v[112:115], v[40:43]
    ds_read_b128 v[112:115], v16 offset:34816
    s_add_u32 m0, s45, 0
    v_mfma_f32_16x16x32_bf16 v[40:43], a[108:111], v[116:119], v[40:43]
    ds_read_b64_tr_b16 v[152:153], v6 offset:32768
    s_waitcnt lgkmcnt(8)
    v_mfma_f32_16x16x32_bf16 v[40:43], a[116:119], v[120:123], v[40:43]
    ds_read_b128 v[116:119], v17 offset:34816
    v_mfma_f32_16x16x32_bf16 v[40:43], a[124:127], v[124:127], v[40:43]
    buffer_load_dwordx4 v232, s[20:23], s47 offen offset:0 lds
    v_mfma_f32_16x16x32_bf16 v[32:35], a[112:115], v[120:123], v[32:35]
    ds_read_b128 v[120:123], v16 offset:38912
    v_mfma_f32_16x16x32_bf16 v[32:35], a[120:123], v[124:127], v[32:35]
    ds_read_b64_tr_b16 v[154:155], v6 offset:33280
    s_waitcnt lgkmcnt(8)
    v_mfma_f32_16x16x32_bf16 v[32:35], a[128:131], v[128:131], v[32:35]
    ds_read_b128 v[124:127], v17 offset:38912
    v_mfma_f32_16x16x32_bf16 v[32:35], a[136:139], v[132:135], v[32:35]
    buffer_load_dwordx4 v233, s[20:23], s47 offen offset:1024 lds
    v_mfma_f32_16x16x32_bf16 v[40:43], a[132:135], v[128:131], v[40:43]
    ds_read_b128 v[128:131], v16 offset:43008
    v_readlane_b32 s46, v22, 17
    v_mfma_f32_16x16x32_bf16 v[40:43], a[140:143], v[132:135], v[40:43]
    ds_read_b64_tr_b16 v[156:157], v7 offset:32768
    s_waitcnt lgkmcnt(8)
    v_mfma_f32_16x16x32_bf16 v[40:43], a[148:151], v[136:139], v[40:43]
    ds_read_b128 v[132:135], v17 offset:43008
    v_mfma_f32_16x16x32_bf16 v[40:43], a[156:159], v[140:143], v[40:43]
    buffer_load_dwordx4 v234, s[20:23], s47 offen offset:2048 lds
    v_mfma_f32_16x16x32_bf16 v[32:35], a[144:147], v[136:139], v[32:35]
    ds_read_b128 v[136:139], v16 offset:47104
    v_mfma_f32_16x16x32_bf16 v[32:35], a[152:155], v[140:143], v[32:35]
    ds_read_b64_tr_b16 v[158:159], v7 offset:33280
    s_waitcnt lgkmcnt(8)
    v_mfma_f32_16x16x32_bf16 v[36:39], a[96:99], v[112:115], v[36:39]
    ds_read_b128 v[140:143], v17 offset:47104
    v_mfma_f32_16x16x32_bf16 v[36:39], a[104:107], v[116:119], v[36:39]
    buffer_load_dwordx4 v235, s[20:23], s47 offen offset:3072 lds
    v_mfma_f32_16x16x32_bf16 v[44:47], a[100:103], v[112:115], v[44:47]
    s_waitcnt vmcnt(8)
    s_barrier
    ds_read_b128 v[112:115], v16 offset:51200
    v_mfma_f32_16x16x32_bf16 v[44:47], a[108:111], v[116:119], v[44:47]
    ds_read_b64_tr_b16 v[160:161], v4 offset:49152
    s_add_u32 m0, s44, 16384
    s_waitcnt lgkmcnt(8)
    v_mfma_f32_16x16x32_bf16 v[44:47], a[116:119], v[120:123], v[44:47]
    ds_read_b128 v[116:119], v17 offset:51200
    v_mfma_f32_16x16x32_bf16 v[44:47], a[124:127], v[124:127], v[44:47]
    buffer_load_dwordx4 v8, s[8:11], s46 offen offset:0 lds
    v_mfma_f32_16x16x32_bf16 v[36:39], a[112:115], v[120:123], v[36:39]
    ds_read_b128 v[120:123], v16 offset:55296
    v_mfma_f32_16x16x32_bf16 v[36:39], a[120:123], v[124:127], v[36:39]
    ds_read_b64_tr_b16 v[162:163], v4 offset:49664
    s_waitcnt lgkmcnt(8)
    v_mfma_f32_16x16x32_bf16 v[36:39], a[128:131], v[128:131], v[36:39]
    ds_read_b128 v[124:127], v17 offset:55296
    v_mfma_f32_16x16x32_bf16 v[36:39], a[136:139], v[132:135], v[36:39]
    buffer_load_dwordx4 v9, s[8:11], s46 offen offset:1024 lds
    v_mfma_f32_16x16x32_bf16 v[44:47], a[132:135], v[128:131], v[44:47]
    ds_read_b128 v[128:131], v16 offset:59392
    s_mov_b32 s47, s54
    s_add_u32 s54, s54, s55
    v_mfma_f32_16x16x32_bf16 v[44:47], a[140:143], v[132:135], v[44:47]
    ds_read_b64_tr_b16 v[164:165], v5 offset:49152
    s_waitcnt lgkmcnt(8)
    v_mfma_f32_16x16x32_bf16 v[44:47], a[148:151], v[136:139], v[44:47]
    ds_read_b128 v[132:135], v17 offset:59392
    v_mfma_f32_16x16x32_bf16 v[44:47], a[156:159], v[140:143], v[44:47]
    buffer_load_dwordx4 v10, s[8:11], s46 offen offset:2048 lds
    v_mfma_f32_16x16x32_bf16 v[36:39], a[144:147], v[136:139], v[36:39]
    ds_read_b128 v[136:139], v16 offset:63488
    v_mfma_f32_16x16x32_bf16 v[36:39], a[152:155], v[140:143], v[36:39]
    ds_read_b64_tr_b16 v[166:167], v5 offset:49664
    s_waitcnt lgkmcnt(8)
    v_mfma_f32_16x16x32_bf16 v[52:55], a[0:3], v[112:115], 0
    ds_read_b128 v[140:143], v17 offset:63488
    v_mfma_f32_16x16x32_bf16 v[52:55], a[8:11], v[116:119], v[52:55]
    buffer_load_dwordx4 v11, s[8:11], s46 offen offset:3072 lds
    v_mfma_f32_16x16x32_bf16 v[60:63], a[4:7], v[112:115], 0
    ds_read_b128 v[112:115], v16 offset:49152
    s_add_u32 m0, s45, 16384
    v_readlane_b32 s87, v24, 5
    v_mfma_f32_16x16x32_bf16 v[60:63], a[12:15], v[116:119], v[60:63]
    ds_read_b64_tr_b16 v[168:169], v6 offset:49152
    v_mul_f32 v32, v32, v40
    s_waitcnt lgkmcnt(8)
    v_mfma_f32_16x16x32_bf16 v[60:63], a[20:23], v[120:123], v[60:63]
    ds_read_b128 v[116:119], v17 offset:49152
    v_mul_f32 v33, v33, v41
    v_mfma_f32_16x16x32_bf16 v[60:63], a[28:31], v[124:127], v[60:63]
    buffer_load_dwordx4 v232, s[20:23], s47 offen offset:0 lds
    v_mul_f32 v34, v34, v42
    v_mfma_f32_16x16x32_bf16 v[52:55], a[16:19], v[120:123], v[52:55]
    ds_read_b128 v[120:123], v16 offset:53248
    v_mul_f32 v35, v35, v43
    v_mfma_f32_16x16x32_bf16 v[52:55], a[24:27], v[124:127], v[52:55]
    ds_read_b64_tr_b16 v[170:171], v6 offset:49664
    v_mul_f32 v36, v36, v44
    s_waitcnt lgkmcnt(8)
    v_mfma_f32_16x16x32_bf16 v[52:55], a[32:35], v[128:131], v[52:55]
    ds_read_b128 v[124:127], v17 offset:53248
    v_mul_f32 v37, v37, v45
    v_mfma_f32_16x16x32_bf16 v[52:55], a[40:43], v[132:135], v[52:55]
    buffer_load_dwordx4 v233, s[20:23], s47 offen offset:1024 lds
    v_mul_f32 v38, v38, v46
    v_mfma_f32_16x16x32_bf16 v[60:63], a[36:39], v[128:131], v[60:63]
    ds_read_b128 v[128:131], v16 offset:57344
    v_readlane_b32 s46, v22, 18
    v_mul_f32 v39, v39, v47
    v_mfma_f32_16x16x32_bf16 v[60:63], a[44:47], v[132:135], v[60:63]
    ds_read_b64_tr_b16 v[172:173], v7 offset:49152
    v_cvt_pk_bf16_f32 v40, v32, v33
    v_cvt_pk_bf16_f32 v42, v36, v37
    s_waitcnt lgkmcnt(8)
    v_mfma_f32_16x16x32_bf16 v[60:63], a[52:55], v[136:139], v[60:63]
    ds_read_b128 v[132:135], v17 offset:57344
    v_cvt_pk_bf16_f32 v41, v34, v35
    v_mfma_f32_16x16x32_bf16 v[60:63], a[60:63], v[140:143], v[60:63]
    buffer_load_dwordx4 v234, s[20:23], s47 offen offset:2048 lds
    v_cvt_pk_bf16_f32 v43, v38, v39
    v_mfma_f32_16x16x32_bf16 v[52:55], a[48:51], v[136:139], v[52:55]
    ds_read_b128 v[136:139], v16 offset:61440
    v_permlane16_swap_b32 v40, v42
    v_mfma_f32_16x16x32_bf16 v[52:55], a[56:59], v[140:143], v[52:55]
    ds_read_b64_tr_b16 v[174:175], v7 offset:49664
    v_permlane16_swap_b32 v41, v43
    buffer_store_dwordx4 v[64:67], v21, s[16:19], s86 offen sc1
    buffer_store_dwordx4 v[40:43], v21, s[16:19], s87 offen sc1
    s_waitcnt lgkmcnt(8)
    v_mfma_f32_16x16x32_bf16 v[48:51], a[0:3], v[112:115], 0
    ds_read_b128 v[140:143], v17 offset:61440
    v_mfma_f32_16x16x32_bf16 v[48:51], a[8:11], v[116:119], v[48:51]
    buffer_load_dwordx4 v235, s[20:23], s47 offen offset:3072 lds
    v_mfma_f32_16x16x32_bf16 v[56:59], a[4:7], v[112:115], 0
    s_waitcnt vmcnt(10)
    s_barrier
    ds_read_b128 v[112:115], v16 offset:0
    v_mfma_f32_16x16x32_bf16 v[56:59], a[12:15], v[116:119], v[56:59]
    ds_read_b64_tr_b16 v[176:177], v4 offset:0
    s_add_u32 m0, s44, 32768
    s_waitcnt lgkmcnt(8)
    v_mfma_f32_16x16x32_bf16 v[56:59], a[20:23], v[120:123], v[56:59]
    ds_read_b128 v[116:119], v17 offset:0
    v_mfma_f32_16x16x32_bf16 v[56:59], a[28:31], v[124:127], v[56:59]
    buffer_load_dwordx4 v8, s[8:11], s46 offen offset:0 lds
    v_mfma_f32_16x16x32_bf16 v[48:51], a[16:19], v[120:123], v[48:51]
    ds_read_b128 v[120:123], v16 offset:4096
    v_mfma_f32_16x16x32_bf16 v[48:51], a[24:27], v[124:127], v[48:51]
    ds_read_b64_tr_b16 v[178:179], v4 offset:512
    s_waitcnt lgkmcnt(8)
    v_mfma_f32_16x16x32_bf16 v[48:51], a[32:35], v[128:131], v[48:51]
    ds_read_b128 v[124:127], v17 offset:4096
    v_mfma_f32_16x16x32_bf16 v[48:51], a[40:43], v[132:135], v[48:51]
    buffer_load_dwordx4 v9, s[8:11], s46 offen offset:1024 lds
    v_mfma_f32_16x16x32_bf16 v[56:59], a[36:39], v[128:131], v[56:59]
    ds_read_b128 v[128:131], v16 offset:8192
    s_mov_b32 s47, s54
    s_add_u32 s54, s54, s55
    v_mfma_f32_16x16x32_bf16 v[56:59], a[44:47], v[132:135], v[56:59]
    ds_read_b64_tr_b16 v[180:181], v5 offset:0
    s_waitcnt lgkmcnt(8)
    v_mfma_f32_16x16x32_bf16 v[56:59], a[52:55], v[136:139], v[56:59]
    ds_read_b128 v[132:135], v17 offset:8192
    v_mfma_f32_16x16x32_bf16 v[56:59], a[60:63], v[140:143], v[56:59]
    buffer_load_dwordx4 v10, s[8:11], s46 offen offset:2048 lds
    v_mfma_f32_16x16x32_bf16 v[48:51], a[48:51], v[136:139], v[48:51]
    ds_read_b128 v[136:139], v16 offset:12288
    v_mfma_f32_16x16x32_bf16 v[48:51], a[56:59], v[140:143], v[48:51]
    ds_read_b64_tr_b16 v[182:183], v5 offset:512
    s_waitcnt lgkmcnt(8)
    v_mfma_f32_16x16x32_bf16 v[48:51], a[64:67], v[112:115], v[48:51]
    ds_read_b128 v[140:143], v17 offset:12288
    v_mfma_f32_16x16x32_bf16 v[48:51], a[72:75], v[116:119], v[48:51]
    buffer_load_dwordx4 v11, s[8:11], s46 offen offset:3072 lds
    v_mfma_f32_16x16x32_bf16 v[56:59], a[68:71], v[112:115], v[56:59]
    ds_read_b128 v[112:115], v16 offset:2048
    s_add_u32 m0, s45, 32768
    v_mfma_f32_16x16x32_bf16 v[56:59], a[76:79], v[116:119], v[56:59]
    ds_read_b64_tr_b16 v[184:185], v6 offset:0
    s_waitcnt lgkmcnt(8)
    v_mfma_f32_16x16x32_bf16 v[56:59], a[84:87], v[120:123], v[56:59]
    ds_read_b128 v[116:119], v17 offset:2048
    v_mfma_f32_16x16x32_bf16 v[56:59], a[92:95], v[124:127], v[56:59]
    buffer_load_dwordx4 v232, s[20:23], s47 offen offset:0 lds
    v_mfma_f32_16x16x32_bf16 v[48:51], a[80:83], v[120:123], v[48:51]
    ds_read_b128 v[120:123], v16 offset:6144
    v_mfma_f32_16x16x32_bf16 v[48:51], a[88:91], v[124:127], v[48:51]
    ds_read_b64_tr_b16 v[186:187], v6 offset:512
    s_waitcnt lgkmcnt(8)
    v_mfma_f32_16x16x32_bf16 v[48:51], a[96:99], v[128:131], v[48:51]
    ds_read_b128 v[124:127], v17 offset:6144
    v_mfma_f32_16x16x32_bf16 v[48:51], a[104:107], v[132:135], v[48:51]
    buffer_load_dwordx4 v233, s[20:23], s47 offen offset:1024 lds
    v_mfma_f32_16x16x32_bf16 v[56:59], a[100:103], v[128:131], v[56:59]
    ds_read_b128 v[128:131], v16 offset:10240
    v_readlane_b32 s46, v22, 19
    v_mfma_f32_16x16x32_bf16 v[56:59], a[108:111], v[132:135], v[56:59]
    ds_read_b64_tr_b16 v[188:189], v7 offset:0
    s_waitcnt lgkmcnt(8)
    v_mfma_f32_16x16x32_bf16 v[56:59], a[116:119], v[136:139], v[56:59]
    ds_read_b128 v[132:135], v17 offset:10240
    v_mfma_f32_16x16x32_bf16 v[56:59], a[124:127], v[140:143], v[56:59]
    buffer_load_dwordx4 v234, s[20:23], s47 offen offset:2048 lds
    s_cmp_eq_u32 s48, 1
    s_cbranch_scc1 L_var1
    s_cmp_eq_u32 s48, 2
    s_cbranch_scc1 L_var2
    s_cmp_eq_u32 s48, 3
    s_cbranch_scc1 L_var3
    s_cmp_eq_u32 s48, 4
    s_cbranch_scc1 L_var4
    s_cmp_eq_u32 s48, 5
    s_cbranch_scc1 L_var5
    s_branch L_var0
.p2align 12
L_var0:
L_tv0_0:
    s_cbranch_execz L_base
    v_mfma_f32_16x16x32_bf16 v[48:51], a[112:115], v[136:139], v[48:51]
    ds_read_b128 v[136:139], v16 offset:14336
    s_load_dword s74, s[70:71], 0
    s_load_dword s75, s[70:71], 1280
    v_mfma_f32_16x16x32_bf16 v[48:51], a[120:123], v[140:143], v[48:51]
    ds_read_b64_tr_b16 v[190:191], v7 offset:512
    s_load_dword s76, s[70:71], 2560
    s_waitcnt lgkmcnt(8)
    v_mfma_f32_16x16x32_bf16 v[52:55], a[64:67], v[112:115], v[52:55]
    ds_read_b128 v[140:143], v17 offset:14336
    s_load_dword s77, s[70:71], 14080
    v_mfma_f32_16x16x32_bf16 v[52:55], a[72:75], v[116:119], v[52:55]
    buffer_load_dwordx4 v235, s[20:23], s47 offen offset:3072 lds
    v_mfma_f32_16x16x32_bf16 v[60:63], a[68:71], v[112:115], v[60:63]
    s_waitcnt vmcnt(8)
    s_barrier
    s_cmp_lg_u32 s36, 0
    s_cbranch_scc1 L_pub_n01
    s_atomic_swap s50, s[64:65], 128
L_pub_n01:
    ds_read_b128 v[112:115], v16 offset:18432
    v_mfma_f32_16x16x32_bf16 v[60:63], a[76:79], v[116:119], v[60:63]
    ds_read_b64_tr_b16 v[192:193], v4 offset:16384
    s_add_u32 m0, s44, 49152
    s_waitcnt lgkmcnt(8)
    v_mfma_f32_16x16x32_bf16 v[60:63], a[84:87], v[120:123], v[60:63]
    ds_read_b128 v[116:119], v17 offset:18432
    v_mfma_f32_16x16x32_bf16 v[60:63], a[92:95], v[124:127], v[60:63]
    buffer_load_dwordx4 v8, s[8:11], s46 offen offset:0 lds
    v_mfma_f32_16x16x32_bf16 v[52:55], a[80:83], v[120:123], v[52:55]
    ds_read_b128 v[120:123], v16 offset:22528
    v_mfma_f32_16x16x32_bf16 v[52:55], a[88:91], v[124:127], v[52:55]
    ds_read_b64_tr_b16 v[194:195], v4 offset:16896
    s_waitcnt lgkmcnt(8)
    v_mfma_f32_16x16x32_bf16 v[52:55], a[96:99], v[128:131], v[52:55]
    ds_read_b128 v[124:127], v17 offset:22528
    v_mfma_f32_16x16x32_bf16 v[52:55], a[104:107], v[132:135], v[52:55]
    buffer_load_dwordx4 v9, s[8:11], s46 offen offset:1024 lds
    v_mfma_f32_16x16x32_bf16 v[60:63], a[100:103], v[128:131], v[60:63]
    ds_read_b128 v[128:131], v16 offset:16384
    s_mov_b32 s47, s54
    s_add_u32 s54, s54, s55
    v_mfma_f32_16x16x32_bf16 v[60:63], a[108:111], v[132:135], v[60:63]
    ds_read_b64_tr_b16 v[196:197], v5 offset:16384
    s_waitcnt lgkmcnt(8)
    v_mfma_f32_16x16x32_bf16 v[60:63], a[116:119], v[136:139], v[60:63]
    ds_read_b128 v[132:135], v17 offset:16384
    v_mfma_f32_16x16x32_bf16 v[60:63], a[124:127], v[140:143], v[60:63]
    buffer_load_dwordx4 v10, s[8:11], s46 offen offset:2048 lds
    v_mfma_f32_16x16x32_bf16 v[52:55], a[112:115], v[136:139], v[52:55]
    ds_read_b128 v[136:139], v16 offset:20480
    v_mfma_f32_16x16x32_bf16 v[52:55], a[120:123], v[140:143], v[52:55]
    ds_read_b64_tr_b16 v[198:199], v5 offset:16896
    s_waitcnt lgkmcnt(8)
    v_mfma_f32_16x16x32_bf16 v[52:55], a[128:131], v[112:115], v[52:55]
    ds_read_b128 v[140:143], v17 offset:20480
    v_mfma_f32_16x16x32_bf16 v[52:55], a[136:139], v[116:119], v[52:55]
    buffer_load_dwordx4 v11, s[8:11], s46 offen offset:3072 lds
    v_mfma_f32_16x16x32_bf16 v[60:63], a[132:135], v[112:115], v[60:63]
    ds_read_b128 v[112:115], v16 offset:26624
    s_add_u32 m0, s45, 49152
    s_load_dword s78, s[70:71], 3840
    v_mfma_f32_16x16x32_bf16 v[60:63], a[140:143], v[116:119], v[60:63]
    ds_read_b64_tr_b16 v[200:201], v6 offset:16384
    s_load_dword s79, s[70:71], 15360
    s_waitcnt lgkmcnt(8)
    v_mfma_f32_16x16x32_bf16 v[60:63], a[148:151], v[120:123], v[60:63]
    ds_read_b128 v[116:119], v17 offset:26624
    s_load_dword s80, s[72:73], 16640
    s_load_dword s81, s[70:71], 5120
    v_mfma_f32_16x16x32_bf16 v[60:63], a[156:159], v[124:127], v[60:63]
    buffer_load_dwordx4 v232, s[20:23], s47 offen offset:0 lds
    v_mfma_f32_16x16x32_bf16 v[52:55], a[144:147], v[120:123], v[52:55]
    ds_read_b128 v[120:123], v16 offset:30720
    v_mfma_f32_16x16x32_bf16 v[52:55], a[152:155], v[124:127], v[52:55]
    ds_read_b64_tr_b16 v[202:203], v6 offset:16896
    s_waitcnt lgkmcnt(8)
    v_mfma_f32_16x16x32_bf16 v[48:51], a[128:131], v[128:131], v[48:51]
    ds_read_b128 v[124:127], v17 offset:30720
    v_mfma_f32_16x16x32_bf16 v[48:51], a[136:139], v[132:135], v[48:51]
    buffer_load_dwordx4 v233, s[20:23], s47 offen offset:1024 lds
    v_mfma_f32_16x16x32_bf16 v[56:59], a[132:135], v[128:131], v[56:59]
    ds_read_b128 v[128:131], v16 offset:24576
    s_mov_b32 s46, s54
    s_add_u32 s54, s54, s55
    v_mfma_f32_16x16x32_bf16 v[56:59], a[140:143], v[132:135], v[56:59]
    ds_read_b64_tr_b16 v[204:205], v7 offset:16384
    s_waitcnt lgkmcnt(8)
    v_mfma_f32_16x16x32_bf16 v[56:59], a[148:151], v[136:139], v[56:59]
    ds_read_b128 v[132:135], v17 offset:24576
    v_mfma_f32_16x16x32_bf16 v[56:59], a[156:159], v[140:143], v[56:59]
    buffer_load_dwordx4 v234, s[20:23], s47 offen offset:2048 lds
    v_mfma_f32_16x16x32_bf16 v[48:51], a[144:147], v[136:139], v[48:51]
    ds_read_b128 v[136:139], v16 offset:28672
    v_mfma_f32_16x16x32_bf16 v[48:51], a[152:155], v[140:143], v[48:51]
    ds_read_b64_tr_b16 v[206:207], v7 offset:16896
    s_waitcnt lgkmcnt(8)
    v_mfma_f32_16x16x32_bf16 v[36:39], a[0:3], v[112:115], 0
    ds_read_b128 v[140:143], v17 offset:28672
    v_mfma_f32_16x16x32_bf16 v[36:39], a[8:11], v[116:119], v[36:39]
    buffer_load_dwordx4 v235, s[20:23], s47 offen offset:3072 lds
    v_mfma_f32_16x16x32_bf16 v[44:47], a[4:7], v[112:115], 0
    s_waitcnt vmcnt(8)
    s_barrier
    ds_read_b128 v[112:115], v16 offset:32768
    v_mfma_f32_16x16x32_bf16 v[44:47], a[12:15], v[116:119], v[44:47]
    ds_read_b64_tr_b16 v[208:209], v4 offset:32768
    s_add_u32 m0, s45, 0
    s_waitcnt lgkmcnt(8)
    v_mfma_f32_16x16x32_bf16 v[44:47], a[20:23], v[120:123], v[44:47]
    ds_read_b128 v[116:119], v17 offset:32768
    v_readlane_b32 s88, v24, 6
    v_mul_f32 v48, v48, v56
    v_mul_f32 v49, v49, v57
    v_mfma_f32_16x16x32_bf16 v[44:47], a[28:31], v[124:127], v[44:47]
    buffer_load_dwordx4 v232, s[20:23], s46 offen offset:0 lds
    v_mul_f32 v50, v50, v58
    v_mfma_f32_16x16x32_bf16 v[36:39], a[16:19], v[120:123], v[36:39]
    ds_read_b128 v[120:123], v16 offset:36864
    s_load_dword s82, s[70:71], 6400
    s_load_dword s83, s[70:71], 7680
    v_mfma_f32_16x16x32_bf16 v[36:39], a[24:27], v[124:127], v[36:39]
    ds_read_b64_tr_b16 v[210:211], v4 offset:33280
    v_mul_f32 v51, v51, v59
    v_mul_f32 v52, v52, v60
    s_waitcnt lgkmcnt(8)
    v_mfma_f32_16x16x32_bf16 v[32:35], a[0:3], v[128:131], 0
    ds_read_b128 v[124:127], v17 offset:36864
    v_mul_f32 v53, v53, v61
    v_mfma_f32_16x16x32_bf16 v[32:35], a[8:11], v[132:135], v[32:35]
    buffer_load_dwordx4 v233, s[20:23], s46 offen offset:1024 lds
    v_mul_f32 v54, v54, v62
    v_mfma_f32_16x16x32_bf16 v[40:43], a[4:7], v[128:131], 0
    ds_read_b128 v[128:131], v16 offset:40960
    s_min_u32 s47, s54, 2211840
    v_mul_f32 v55, v55, v63
    v_mfma_f32_16x16x32_bf16 v[40:43], a[12:15], v[132:135], v[40:43]
    ds_read_b64_tr_b16 v[212:213], v5 offset:32768
    v_cvt_pk_bf16_f32 v56, v48, v49
    v_cvt_pk_bf16_f32 v58, v52, v53
    s_waitcnt lgkmcnt(8)
    v_mfma_f32_16x16x32_bf16 v[40:43], a[20:23], v[136:139], v[40:43]
    ds_read_b128 v[132:135], v17 offset:40960
    v_cvt_pk_bf16_f32 v57, v50, v51
    v_mfma_f32_16x16x32_bf16 v[40:43], a[28:31], v[140:143], v[40:43]
    buffer_load_dwordx4 v234, s[20:23], s46 offen offset:2048 lds
    v_cvt_pk_bf16_f32 v59, v54, v55
    v_mfma_f32_16x16x32_bf16 v[32:35], a[16:19], v[136:139], v[32:35]
    ds_read_b128 v[136:139], v16 offset:45056
    v_permlane16_swap_b32 v56, v58
    v_mfma_f32_16x16x32_bf16 v[32:35], a[24:27], v[140:143], v[32:35]
    ds_read_b64_tr_b16 v[214:215], v5 offset:33280
    v_permlane16_swap_b32 v57, v59
    buffer_store_dwordx4 v[56:59], v21, s[16:19], s88 offen sc1
    s_waitcnt lgkmcnt(8)
    v_mfma_f32_16x16x32_bf16 v[32:35], a[32:35], v[112:115], v[32:35]
    ds_read_b128 v[140:143], v17 offset:45056
    v_mfma_f32_16x16x32_bf16 v[32:35], a[40:43], v[116:119], v[32:35]
    buffer_load_dwordx4 v235, s[20:23], s46 offen offset:3072 lds
    v_mfma_f32_16x16x32_bf16 v[40:43], a[36:39], v[112:115], v[40:43]
    ds_read_b128 v[112:115], v16 offset:34816
    s_add_u32 m0, s45, 16384
    v_mfma_f32_16x16x32_bf16 v[40:43], a[44:47], v[116:119], v[40:43]
    ds_read_b64_tr_b16 v[216:217], v6 offset:32768
    s_waitcnt lgkmcnt(8)
    v_mfma_f32_16x16x32_bf16 v[40:43], a[52:55], v[120:123], v[40:43]
    ds_read_b128 v[116:119], v17 offset:34816
    v_mfma_f32_16x16x32_bf16 v[40:43], a[60:63], v[124:127], v[40:43]
    buffer_load_dwordx4 v232, s[20:23], s47 offen offset:0 lds
    v_mfma_f32_16x16x32_bf16 v[32:35], a[48:51], v[120:123], v[32:35]
    ds_read_b128 v[120:123], v16 offset:38912
    v_mfma_f32_16x16x32_bf16 v[32:35], a[56:59], v[124:127], v[32:35]
    ds_read_b64_tr_b16 v[218:219], v6 offset:33280
    s_waitcnt lgkmcnt(8)
    v_mfma_f32_16x16x32_bf16 v[32:35], a[64:67], v[128:131], v[32:35]
    ds_read_b128 v[124:127], v17 offset:38912
    v_mfma_f32_16x16x32_bf16 v[32:35], a[72:75], v[132:135], v[32:35]
    buffer_load_dwordx4 v233, s[20:23], s47 offen offset:1024 lds
    v_mfma_f32_16x16x32_bf16 v[40:43], a[68:71], v[128:131], v[40:43]
    ds_read_b128 v[128:131], v16 offset:43008
    v_mfma_f32_16x16x32_bf16 v[40:43], a[76:79], v[132:135], v[40:43]
    ds_read_b64_tr_b16 v[220:221], v7 offset:32768
    s_waitcnt lgkmcnt(8)
    v_mfma_f32_16x16x32_bf16 v[40:43], a[84:87], v[136:139], v[40:43]
    ds_read_b128 v[132:135], v17 offset:43008
    v_mfma_f32_16x16x32_bf16 v[40:43], a[92:95], v[140:143], v[40:43]
    buffer_load_dwordx4 v234, s[20:23], s47 offen offset:2048 lds
    v_mfma_f32_16x16x32_bf16 v[32:35], a[80:83], v[136:139], v[32:35]
    ds_read_b128 v[136:139], v16 offset:47104
    v_mfma_f32_16x16x32_bf16 v[32:35], a[88:91], v[140:143], v[32:35]
    ds_read_b64_tr_b16 v[222:223], v7 offset:33280
    s_waitcnt lgkmcnt(8)
    v_mfma_f32_16x16x32_bf16 v[36:39], a[32:35], v[112:115], v[36:39]
    s_waitcnt lgkmcnt(0)
    s_xor_b64 s[74:75], s[74:75], s[50:51]
    s_xor_b64 s[76:77], s[76:77], s[50:51]
    s_xor_b64 s[78:79], s[78:79], s[50:51]
    s_xor_b64 s[80:81], s[80:81], s[50:51]
    s_xor_b64 s[82:83], s[82:83], s[50:51]
    s_or_b64 s[74:75], s[74:75], s[76:77]
    s_or_b64 s[74:75], s[74:75], s[78:79]
    s_or_b64 s[74:75], s[74:75], s[80:81]
    s_or_b64 s[74:75], s[74:75], s[82:83]
    s_cbranch_scc1 L_slow_n0c0
L_ok_n0c0:
    ds_read_b128 v[140:143], v17 offset:47104
    v_mfma_f32_16x16x32_bf16 v[36:39], a[40:43], v[116:119], v[36:39]
    buffer_load_dwordx4 v235, s[20:23], s47 offen offset:3072 lds
    v_mfma_f32_16x16x32_bf16 v[44:47], a[36:39], v[112:115], v[44:47]
    s_waitcnt vmcnt(9)
    s_barrier
    ds_read_b128 v[112:115], v16 offset:51200
    v_mfma_f32_16x16x32_bf16 v[44:47], a[44:47], v[116:119], v[44:47]
    ds_read_b64_tr_b16 v[64:65], v4 offset:49152
    v_mfma_f32_16x16x32_bf16 v[44:47], a[52:55], v[120:123], v[44:47]
    ds_read_b128 v[116:119], v17 offset:51200
    v_mfma_f32_16x16x32_bf16 v[44:47], a[60:63], v[124:127], v[44:47]
    buffer_load_dwordx4 v[224:227], v30, s[16:19], s37 offen offset:0 sc1
    v_mfma_f32_16x16x32_bf16 v[36:39], a[48:51], v[120:123], v[36:39]
    ds_read_b128 v[120:123], v16 offset:55296
    v_mfma_f32_16x16x32_bf16 v[36:39], a[56:59], v[124:127], v[36:39]
    ds_read_b64_tr_b16 v[66:67], v4 offset:49664
    v_mfma_f32_16x16x32_bf16 v[36:39], a[64:67], v[128:131], v[36:39]
    ds_read_b128 v[124:127], v17 offset:55296
    v_mfma_f32_16x16x32_bf16 v[36:39], a[72:75], v[132:135], v[36:39]
    buffer_load_dwordx4 v[228:231], v30, s[16:19], s38 offen offset:0 sc1
    v_mfma_f32_16x16x32_bf16 v[44:47], a[68:71], v[128:131], v[44:47]
    ds_read_b128 v[128:131], v16 offset:59392
    v_mfma_f32_16x16x32_bf16 v[44:47], a[76:79], v[132:135], v[44:47]
    ds_read_b64_tr_b16 v[68:69], v5 offset:49152
    s_waitcnt lgkmcnt(8)
    v_mfma_f32_16x16x32_bf16 v[44:47], a[84:87], v[136:139], v[44:47]
    ds_read_b128 v[132:135], v17 offset:59392
    v_mfma_f32_16x16x32_bf16 v[44:47], a[92:95], v[140:143], v[44:47]
    buffer_load_dwordx4 v[232:235], v30, s[16:19], s37 offen offset:1024 sc1
    v_mfma_f32_16x16x32_bf16 v[36:39], a[80:83], v[136:139], v[36:39]
    ds_read_b128 v[136:139], v16 offset:63488
    v_mfma_f32_16x16x32_bf16 v[36:39], a[88:91], v[140:143], v[36:39]
    ds_read_b64_tr_b16 v[70:71], v5 offset:49664
    s_waitcnt lgkmcnt(8)
    v_mfma_f32_16x16x32_bf16 v[36:39], a[96:99], v[112:115], v[36:39]
    ds_read_b128 v[140:143], v17 offset:63488
    v_mfma_f32_16x16x32_bf16 v[36:39], a[104:107], v[116:119], v[36:39]
    buffer_load_dwordx4 v[236:239], v30, s[16:19], s38 offen offset:1024 sc1
    v_mfma_f32_16x16x32_bf16 v[44:47], a[100:103], v[112:115], v[44:47]
    ds_read_b128 v[112:115], v16 offset:49152
    v_mfma_f32_16x16x32_bf16 v[44:47], a[108:111], v[116:119], v[44:47]
    ds_read_b64_tr_b16 v[72:73], v6 offset:49152
    s_waitcnt lgkmcnt(8)
    v_mfma_f32_16x16x32_bf16 v[44:47], a[116:119], v[120:123], v[44:47]
    ds_read_b128 v[116:119], v17 offset:49152
    v_mfma_f32_16x16x32_bf16 v[44:47], a[124:127], v[124:127], v[44:47]
    buffer_load_dwordx4 v[240:243], v30, s[16:19], s37 offen offset:2048 sc1
    v_mfma_f32_16x16x32_bf16 v[36:39], a[112:115], v[120:123], v[36:39]
    ds_read_b128 v[120:123], v16 offset:53248
    v_mfma_f32_16x16x32_bf16 v[36:39], a[120:123], v[124:127], v[36:39]
    ds_read_b64_tr_b16 v[74:75], v6 offset:49664
    s_waitcnt lgkmcnt(8)
    v_mfma_f32_16x16x32_bf16 v[36:39], a[128:131], v[128:131], v[36:39]
    ds_read_b128 v[124:127], v17 offset:53248
    v_mfma_f32_16x16x32_bf16 v[36:39], a[136:139], v[132:135], v[36:39]
    buffer_load_dwordx4 v[244:247], v30, s[16:19], s38 offen offset:2048 sc1
    v_mfma_f32_16x16x32_bf16 v[44:47], a[132:135], v[128:131], v[44:47]
    ds_read_b128 v[128:131], v16 offset:57344
    v_mfma_f32_16x16x32_bf16 v[44:47], a[140:143], v[132:135], v[44:47]
    ds_read_b64_tr_b16 v[76:77], v7 offset:49152
    s_waitcnt lgkmcnt(8)
    v_mfma_f32_16x16x32_bf16 v[44:47], a[148:151], v[136:139], v[44:47]
    ds_read_b128 v[132:135], v17 offset:57344
    v_mfma_f32_16x16x32_bf16 v[44:47], a[156:159], v[140:143], v[44:47]
    buffer_load_dwordx4 a[0:3], v30, s[16:19], s37 offen offset:3072 sc1
    v_mfma_f32_16x16x32_bf16 v[36:39], a[144:147], v[136:139], v[36:39]
    ds_read_b128 v[136:139], v16 offset:61440
    v_mfma_f32_16x16x32_bf16 v[36:39], a[152:155], v[140:143], v[36:39]
    ds_read_b64_tr_b16 v[78:79], v7 offset:49664
    s_waitcnt lgkmcnt(8)
    v_mfma_f32_16x16x32_bf16 v[32:35], a[96:99], v[112:115], v[32:35]
    ds_read_b128 v[140:143], v17 offset:61440
    v_mfma_f32_16x16x32_bf16 v[32:35], a[104:107], v[116:119], v[32:35]
    buffer_load_dwordx4 a[4:7], v30, s[16:19], s38 offen offset:3072 sc1
    v_mfma_f32_16x16x32_bf16 v[40:43], a[100:103], v[112:115], v[40:43]
    s_waitcnt vmcnt(12)
    v_mfma_f32_16x16x32_bf16 v[40:43], a[108:111], v[116:119], v[40:43]
    ds_read_b64_tr_b16 v[80:81], v4 offset:0
    s_waitcnt lgkmcnt(7)
    v_mfma_f32_16x16x32_bf16 v[40:43], a[116:119], v[120:123], v[40:43]
    v_mfma_f32_16x16x32_bf16 v[40:43], a[124:127], v[124:127], v[40:43]
    ds_read_b64_tr_b16 v[82:83], v4 offset:512
    buffer_load_dwordx4 a[8:11], v31, s[16:19], s37 offen offset:0 sc1
    v_mfma_f32_16x16x32_bf16 v[32:35], a[112:115], v[120:123], v[32:35]
    v_mfma_f32_16x16x32_bf16 v[32:35], a[120:123], v[124:127], v[32:35]
    ds_read_b64_tr_b16 v[84:85], v5 offset:0
    s_waitcnt lgkmcnt(6)
    v_mfma_f32_16x16x32_bf16 v[32:35], a[128:131], v[128:131], v[32:35]
    v_mfma_f32_16x16x32_bf16 v[32:35], a[136:139], v[132:135], v[32:35]
    ds_read_b64_tr_b16 v[86:87], v5 offset:512
    buffer_load_dwordx4 a[12:15], v31, s[16:19], s38 offen offset:0 sc1
    v_mfma_f32_16x16x32_bf16 v[40:43], a[132:135], v[128:131], v[40:43]
    v_mfma_f32_16x16x32_bf16 v[40:43], a[140:143], v[132:135], v[40:43]
    ds_read_b64_tr_b16 v[88:89], v6 offset:0
    s_waitcnt lgkmcnt(5)
    v_mfma_f32_16x16x32_bf16 v[40:43], a[148:151], v[136:139], v[40:43]
    v_mfma_f32_16x16x32_bf16 v[40:43], a[156:159], v[140:143], v[40:43]
    ds_read_b64_tr_b16 v[90:91], v6 offset:512
    v_mfma_f32_16x16x32_bf16 v[32:35], a[144:147], v[136:139], v[32:35]
    v_mfma_f32_16x16x32_bf16 v[32:35], a[152:155], v[140:143], v[32:35]
    ds_read_b64_tr_b16 v[92:93], v7 offset:0
    ds_read_b64_tr_b16 v[94:95], v7 offset:512
    s_cmp_eq_u32 s48, 6
    s_cbranch_scc1 L_idle
    s_waitcnt vmcnt(8)
    v_mfma_f32_16x16x32_bf16 a[40:43], a[160:163], v[224:227], 0
    s_barrier
    s_cmp_lg_u32 s36, 0
    s_cbranch_scc1 L_pub_n02
    s_atomic_swap s50, s[64:65], 256
L_pub_n02:
    v_mfma_f32_16x16x32_bf16 a[40:43], a[176:179], v[228:231], a[40:43]
    buffer_load_dwordx4 a[16:19], v30, s[16:19], s39 offen offset:0 sc1
    v_mfma_f32_16x16x32_bf16 a[44:47], a[164:167], v[224:227], 0
    v_readlane_b32 s89, v24, 7
    v_mul_f32 v32, v32, v40
    v_mfma_f32_16x16x32_bf16 a[44:47], a[180:183], v[228:231], a[44:47]
    v_mul_f32 v33, v33, v41
    v_mul_f32 v34, v34, v42
    v_mfma_f32_16x16x32_bf16 a[48:51], a[168:171], v[224:227], 0
    v_mul_f32 v35, v35, v43
    v_mul_f32 v36, v36, v44
    v_mfma_f32_16x16x32_bf16 a[48:51], a[184:187], v[228:231], a[48:51]
    buffer_load_dwordx4 a[20:23], v30, s[16:19], s67 offen offset:0 sc1
    v_mfma_f32_16x16x32_bf16 a[52:55], a[172:175], v[224:227], 0
    v_mul_f32 v37, v37, v45
    v_mul_f32 v38, v38, v46
    v_mfma_f32_16x16x32_bf16 a[52:55], a[188:191], v[228:231], a[52:55]
    v_mul_f32 v39, v39, v47
    v_cvt_pk_bf16_f32 v40, v32, v33
    s_waitcnt vmcnt(8)
    v_mfma_f32_16x16x32_bf16 a[56:59], a[160:163], v[232:235], 0
    v_cvt_pk_bf16_f32 v42, v36, v37
    v_cvt_pk_bf16_f32 v41, v34, v35
    v_mfma_f32_16x16x32_bf16 a[56:59], a[176:179], v[236:239], a[56:59]
    buffer_load_dwordx4 a[24:27], v30, s[16:19], s39 offen offset:1024 sc1
    v_mfma_f32_16x16x32_bf16 a[60:63], a[164:167], v[232:235], 0
    v_cvt_pk_bf16_f32 v43, v38, v39
    s_nop 1
    v_permlane16_swap_b32 v40, v42
    v_mfma_f32_16x16x32_bf16 a[60:63], a[180:183], v[236:239], a[60:63]
    v_permlane16_swap_b32 v41, v43
    buffer_store_dwordx4 v[40:43], v21, s[16:19], s89 offen sc1
    v_mfma_f32_16x16x32_bf16 a[64:67], a[168:171], v[232:235], 0
    v_mfma_f32_16x16x32_bf16 a[64:67], a[184:187], v[236:239], a[64:67]
    buffer_load_dwordx4 a[28:31], v30, s[16:19], s67 offen offset:1024 sc1
    v_mfma_f32_16x16x32_bf16 a[68:71], a[172:175], v[232:235], 0
    v_mfma_f32_16x16x32_bf16 a[68:71], a[188:191], v[236:239], a[68:71]
    ds_read_b64_tr_b16 v[96:97], v4 offset:16384
    s_waitcnt vmcnt(9)
    v_mfma_f32_16x16x32_bf16 a[72:75], a[160:163], v[240:243], 0
    ds_read_b64_tr_b16 v[98:99], v4 offset:16896
    v_mfma_f32_16x16x32_bf16 a[72:75], a[176:179], v[244:247], a[72:75]
    buffer_load_dwordx4 a[32:35], v30, s[16:19], s39 offen offset:2048 sc1
    v_mfma_f32_16x16x32_bf16 a[76:79], a[164:167], v[240:243], 0
    v_mfma_f32_16x16x32_bf16 a[76:79], a[180:183], v[244:247], a[76:79]
    ds_read_b64_tr_b16 v[100:101], v5 offset:16384
    v_mfma_f32_16x16x32_bf16 a[80:83], a[168:171], v[240:243], 0
    ds_read_b64_tr_b16 v[102:103], v5 offset:16896
    v_mfma_f32_16x16x32_bf16 a[80:83], a[184:187], v[244:247], a[80:83]
    buffer_load_dwordx4 v[224:227], v30, s[16:19], s67 offen offset:2048 sc1
    v_mfma_f32_16x16x32_bf16 a[84:87], a[172:175], v[240:243], 0
    v_mfma_f32_16x16x32_bf16 a[84:87], a[188:191], v[244:247], a[84:87]
    ds_read_b64_tr_b16 v[104:105], v6 offset:16384
    s_waitcnt vmcnt(9)
    v_mfma_f32_16x16x32_bf16 a[88:91], a[160:163], a[0:3], 0
    ds_read_b64_tr_b16 v[106:107], v6 offset:16896
    v_mfma_f32_16x16x32_bf16 a[88:91], a[176:179], a[4:7], a[88:91]
    buffer_load_dwordx4 v[228:231], v30, s[16:19], s39 offen offset:3072 sc1
    v_mfma_f32_16x16x32_bf16 a[92:95], a[164:167], a[0:3], 0
    v_mfma_f32_16x16x32_bf16 a[92:95], a[180:183], a[4:7], a[92:95]
    ds_read_b64_tr_b16 v[108:109], v7 offset:16384
    v_mfma_f32_16x16x32_bf16 a[96:99], a[168:171], a[0:3], 0
    s_load_dword s74, s[70:71], 9088
    s_load_dword s75, s[70:71], 10368
    ds_read_b64_tr_b16 v[110:111], v7 offset:16896
    v_mfma_f32_16x16x32_bf16 a[96:99], a[184:187], a[4:7], a[96:99]
    buffer_load_dwordx4 v[232:235], v30, s[16:19], s67 offen offset:3072 sc1
    v_mfma_f32_16x16x32_bf16 a[100:103], a[172:175], a[0:3], 0
    s_load_dword s76, s[70:71], 11648
    v_mfma_f32_16x16x32_bf16 a[100:103], a[188:191], a[4:7], a[100:103]
    s_load_dword s77, s[70:71], 12928
    s_waitcnt vmcnt(9)
    v_mfma_f32_16x16x32_bf16 a[104:107], a[160:163], a[8:11], 0
    s_load_dword s78, s[70:71], 14208
    s_load_dword s79, s[70:71], 15488
    v_mfma_f32_16x16x32_bf16 a[104:107], a[176:179], a[12:15], a[104:107]
    buffer_load_dwordx4 v[236:239], v31, s[16:19], s39 offen offset:0 sc1
    v_mfma_f32_16x16x32_bf16 a[108:111], a[164:167], a[8:11], 0
    s_load_dword s80, s[72:73], 16768
    v_mfma_f32_16x16x32_bf16 a[108:111], a[180:183], a[12:15], a[108:111]
    s_load_dword s81, s[72:73], 16768
    v_mfma_f32_16x16x32_bf16 a[112:115], a[168:171], a[8:11], 0
    v_mfma_f32_16x16x32_bf16 a[112:115], a[184:187], a[12:15], a[112:115]
    buffer_load_dwordx4 v[240:243], v31, s[16:19], s40 offen offset:0 sc1
    v_mfma_f32_16x16x32_bf16 a[116:119], a[172:175], a[8:11], 0
    v_mfma_f32_16x16x32_bf16 a[116:119], a[188:191], a[12:15], a[116:119]
    s_waitcnt vmcnt(9)
    v_mfma_f32_16x16x32_bf16 a[40:43], a[192:195], a[16:19], a[40:43]
    v_mfma_f32_16x16x32_bf16 a[40:43], v[64:67], a[20:23], a[40:43]
    buffer_load_dwordx4 v[244:247], v30, s[16:19], s68 offen offset:0 sc1
    v_mfma_f32_16x16x32_bf16 a[44:47], a[196:199], a[16:19], a[44:47]
    v_mfma_f32_16x16x32_bf16 a[44:47], v[68:71], a[20:23], a[44:47]
    v_mfma_f32_16x16x32_bf16 a[48:51], a[200:203], a[16:19], a[48:51]
    v_mfma_f32_16x16x32_bf16 a[48:51], v[72:75], a[20:23], a[48:51]
    buffer_load_dwordx4 a[0:3], v30, s[16:19], s68 offen offset:1024 sc1
    v_mfma_f32_16x16x32_bf16 a[52:55], a[204:207], a[16:19], a[52:55]
    v_mfma_f32_16x16x32_bf16 a[52:55], v[76:79], a[20:23], a[52:55]
    s_waitcnt vmcnt(8)
    v_mfma_f32_16x16x32_bf16 a[56:59], a[192:195], a[24:27], a[56:59]
    s_waitcnt lgkmcnt(0)
    s_barrier
    s_cmp_lg_u32 s36, 0
    s_cbranch_scc1 L_pub_n03
    s_atomic_swap s50, s[64:65], 384
L_pub_n03:
    v_mfma_f32_16x16x32_bf16 a[56:59], v[64:67], a[28:31], a[56:59]
    buffer_load_dwordx4 a[4:7], v30, s[16:19], s68 offen offset:2048 sc1
    v_mfma_f32_16x16x32_bf16 a[60:63], a[196:199], a[24:27], a[60:63]
    v_mfma_f32_16x16x32_bf16 a[60:63], v[68:71], a[28:31], a[60:63]
    v_mfma_f32_16x16x32_bf16 a[64:67], a[200:203], a[24:27], a[64:67]
    v_mfma_f32_16x16x32_bf16 a[64:67], v[72:75], a[28:31], a[64:67]
    buffer_load_dwordx4 a[8:11], v30, s[16:19], s69 offen offset:2048 sc1
    v_mfma_f32_16x16x32_bf16 a[68:71], a[204:207], a[24:27], a[68:71]
    v_mfma_f32_16x16x32_bf16 a[68:71], v[76:79], a[28:31], a[68:71]
    s_waitcnt vmcnt(8)
    v_mfma_f32_16x16x32_bf16 a[72:75], a[192:195], a[32:35], a[72:75]
    v_mfma_f32_16x16x32_bf16 a[72:75], v[64:67], v[224:227], a[72:75]
    buffer_load_dwordx4 a[12:15], v30, s[16:19], s68 offen offset:3072 sc1
    v_mfma_f32_16x16x32_bf16 a[76:79], a[196:199], a[32:35], a[76:79]
    v_mfma_f32_16x16x32_bf16 a[76:79], v[68:71], v[224:227], a[76:79]
    v_mfma_f32_16x16x32_bf16 a[80:83], a[200:203], a[32:35], a[80:83]
    v_and_b32 v1, 15, v0
    v_mfma_f32_16x16x32_bf16 a[80:83], v[72:75], v[224:227], a[80:83]
    buffer_load_dwordx4 a[16:19], v30, s[16:19], s69 offen offset:3072 sc1
    v_mfma_f32_16x16x32_bf16 a[84:87], a[204:207], a[32:35], a[84:87]
    v_lshrrev_b32 v2, 4, v0
    v_mfma_f32_16x16x32_bf16 a[84:87], v[76:79], v[224:227], a[84:87]
    v_and_b32 v3, 7, v0
    s_waitcnt vmcnt(8)
    v_mfma_f32_16x16x32_bf16 a[88:91], a[192:195], v[228:231], a[88:91]
    s_waitcnt lgkmcnt(0)
    v_mfma_f32_16x16x32_bf16 a[88:91], v[64:67], v[232:235], a[88:91]
    buffer_load_dwordx4 a[20:23], v31, s[16:19], s41 offen offset:0 sc1
    v_mfma_f32_16x16x32_bf16 a[92:95], a[196:199], v[228:231], a[92:95]
    s_xor_b64 s[74:75], s[74:75], s[50:51]
    v_mfma_f32_16x16x32_bf16 a[92:95], v[68:71], v[232:235], a[92:95]
    s_xor_b64 s[76:77], s[76:77], s[50:51]
    v_mfma_f32_16x16x32_bf16 a[96:99], a[200:203], v[228:231], a[96:99]
    s_xor_b64 s[78:79], s[78:79], s[50:51]
    v_mfma_f32_16x16x32_bf16 a[96:99], v[72:75], v[232:235], a[96:99]
    buffer_load_dwordx4 a[24:27], v31, s[16:19], s42 offen offset:0 sc1
    v_mfma_f32_16x16x32_bf16 a[100:103], a[204:207], v[228:231], a[100:103]
    s_xor_b64 s[80:81], s[80:81], s[50:51]
    v_mfma_f32_16x16x32_bf16 a[100:103], v[76:79], v[232:235], a[100:103]
    s_or_b64 s[74:75], s[74:75], s[76:77]
    s_waitcnt vmcnt(8)
    v_mfma_f32_16x16x32_bf16 a[104:107], a[192:195], v[236:239], a[104:107]
    s_or_b64 s[74:75], s[74:75], s[78:79]
    v_mfma_f32_16x16x32_bf16 a[104:107], a[208:211], v[240:243], a[104:107]
    buffer_load_dwordx4 a[28:31], v31, s[16:19], s49 offen offset:0 sc1
    v_mfma_f32_16x16x32_bf16 a[108:111], a[196:199], v[236:239], a[108:111]
    s_or_b64 s[74:75], s[74:75], s[80:81]
    s_cbranch_scc1 L_slow_n0c1
L_ok_n0c1:
    v_mfma_f32_16x16x32_bf16 a[108:111], a[212:215], v[240:243], a[108:111]
    v_mfma_f32_16x16x32_bf16 a[112:115], a[200:203], v[236:239], a[112:115]
    v_xor_b32 v2, v2, v3
    v_mfma_f32_16x16x32_bf16 a[112:115], a[216:219], v[240:243], a[112:115]
    buffer_load_dwordx4 a[32:35], v30, s[16:19], s57 offen offset:0 sc1
    v_mfma_f32_16x16x32_bf16 a[116:119], a[204:207], v[236:239], a[116:119]
    v_lshlrev_b32 v2, 4, v2
    v_mfma_f32_16x16x32_bf16 a[116:119], a[220:223], v[240:243], a[116:119]
    v_lshl_add_u32 v1, v1, 8, v2
    s_waitcnt vmcnt(9)
    v_mfma_f32_16x16x32_bf16 a[40:43], v[80:83], v[244:247], a[40:43]
    v_add_u32 v16, s43, v1
    v_mfma_f32_16x16x32_bf16 a[44:47], v[84:87], v[244:247], a[44:47]
    buffer_load_dwordx4 v[224:227], v30, s[16:19], s58 offen offset:0 sc1
    v_mfma_f32_16x16x32_bf16 a[48:51], v[88:91], v[244:247], a[48:51]
    v_xor_b32 v17, 64, v16
    v_mfma_f32_16x16x32_bf16 a[52:55], v[92:95], v[244:247], a[52:55]
    v_lshrrev_b32 v1, 3, v0
    s_waitcnt vmcnt(9)
    v_mfma_f32_16x16x32_bf16 a[56:59], v[80:83], a[0:3], a[56:59]
    v_lshlrev_b32 v2, 1, v3
    v_mfma_f32_16x16x32_bf16 a[60:63], v[84:87], a[0:3], a[60:63]
    buffer_load_dwordx4 v[228:231], v30, s[16:19], s57 offen offset:1024 sc1
    v_mfma_f32_16x16x32_bf16 a[64:67], v[88:91], a[0:3], a[64:67]
    v_xor_b32 v2, v2, v1
    v_mfma_f32_16x16x32_bf16 a[68:71], v[92:95], a[0:3], a[68:71]
    v_lshlrev_b32 v2, 4, v2
    s_waitcnt vmcnt(8)
    v_mfma_f32_16x16x32_bf16 a[72:75], v[80:83], a[4:7], a[72:75]
    s_lshl_b32 s61, s36, 3
    v_mfma_f32_16x16x32_bf16 a[72:75], v[96:99], a[8:11], a[72:75]
    buffer_load_dwordx4 v[232:235], v30, s[16:19], s58 offen offset:1024 sc1
    v_mfma_f32_16x16x32_bf16 a[76:79], v[84:87], a[4:7], a[76:79]
    v_add_u32 v1, s61, v1
    v_mfma_f32_16x16x32_bf16 a[76:79], v[100:103], a[8:11], a[76:79]
    v_lshl_add_u32 v8, v1, 8, v2
    v_mfma_f32_16x16x32_bf16 a[80:83], v[88:91], a[4:7], a[80:83]
    v_xor_b32 v9, 16, v8
    v_mfma_f32_16x16x32_bf16 a[80:83], v[104:107], a[8:11], a[80:83]
    buffer_load_dwordx4 v[236:239], v30, s[16:19], s57 offen offset:2048 sc1
    v_mfma_f32_16x16x32_bf16 a[84:87], v[92:95], a[4:7], a[84:87]
    v_add_u32 v10, 40960, v8
    v_mfma_f32_16x16x32_bf16 a[84:87], v[108:111], a[8:11], a[84:87]
    v_add_u32 v11, 40960, v9
    s_waitcnt vmcnt(8)
    v_mfma_f32_16x16x32_bf16 a[88:91], v[80:83], a[12:15], a[88:91]
    v_mul_u32_u24 v1, 1280, v1
    v_mfma_f32_16x16x32_bf16 a[88:91], v[96:99], a[16:19], a[88:91]
    buffer_load_dwordx4 v[240:243], v30, s[16:19], s58 offen offset:2048 sc1
    v_mfma_f32_16x16x32_bf16 a[92:95], v[84:87], a[12:15], a[92:95]
    v_lshl_add_u32 v18, v3, 4, v1
    v_mfma_f32_16x16x32_bf16 a[92:95], v[100:103], a[16:19], a[92:95]
    s_lshl_b32 s61, s36, 2
    v_mfma_f32_16x16x32_bf16 a[96:99], v[88:91], a[12:15], a[96:99]
    s_load_dword s74, s[70:71], 4096
    s_load_dword s75, s[70:71], 5376
    v_mfma_f32_16x16x32_bf16 a[96:99], v[104:107], a[16:19], a[96:99]
    buffer_load_dwordx4 v[244:247], v30, s[16:19], s57 offen offset:3072 sc1
    v_mfma_f32_16x16x32_bf16 a[100:103], v[92:95], a[12:15], a[100:103]
    s_load_dword s76, s[70:71], 9216
    v_mfma_f32_16x16x32_bf16 a[100:103], v[108:111], a[16:19], a[100:103]
    s_load_dword s77, s[70:71], 10496
    s_waitcnt vmcnt(8)
    v_mfma_f32_16x16x32_bf16 a[104:107], a[224:227], a[20:23], a[104:107]
    s_load_dword s78, s[70:71], 6656
    s_load_dword s79, s[70:71], 7936
    v_mfma_f32_16x16x32_bf16 a[104:107], a[240:243], a[24:27], a[104:107]
    buffer_load_dwordx4 a[0:3], v30, s[16:19], s58 offen offset:3072 sc1
    v_mfma_f32_16x16x32_bf16 a[108:111], a[228:231], a[20:23], a[108:111]
    s_load_dword s80, s[70:71], 11776
    v_mfma_f32_16x16x32_bf16 a[108:111], a[244:247], a[24:27], a[108:111]
    s_load_dword s81, s[70:71], 13056
    v_mfma_f32_16x16x32_bf16 a[112:115], a[232:235], a[20:23], a[112:115]
    v_lshrrev_b32 v1, 4, v0
    v_mfma_f32_16x16x32_bf16 a[112:115], a[248:251], a[24:27], a[112:115]
    buffer_load_dwordx4 a[4:7], v30, s[16:19], s59 offen offset:0 sc1
    v_mfma_f32_16x16x32_bf16 a[116:119], a[236:239], a[20:23], a[116:119]
    v_add_u32 v1, s61, v1
    v_mfma_f32_16x16x32_bf16 a[116:119], a[252:255], a[24:27], a[116:119]
    v_and_b32 v2, 15, v0
    s_waitcnt vmcnt(9)
    v_mfma_f32_16x16x32_bf16 a[104:107], v[144:147], a[28:31], a[104:107]
    v_and_b32 v3, 7, v1
    v_mfma_f32_16x16x32_bf16 a[108:111], v[148:151], a[28:31], a[108:111]
    buffer_load_dwordx4 a[8:11], v30, s[16:19], s66 offen offset:0 sc1
    v_mfma_f32_16x16x32_bf16 a[112:115], v[152:155], a[28:31], a[112:115]
    v_xor_b32 v3, v3, v2
    v_mfma_f32_16x16x32_bf16 a[116:119], v[156:159], a[28:31], a[116:119]
    v_lshlrev_b32 v3, 4, v3
    s_waitcnt vmcnt(8)
    v_mfma_f32_16x16x32_bf16 a[40:43], v[160:163], a[32:35], a[40:43]
    v_lshl_add_u32 v12, v1, 8, v3
    v_mfma_f32_16x16x32_bf16 a[40:43], v[176:179], v[224:227], a[40:43]
    buffer_load_dwordx4 a[12:15], v30, s[16:19], s59 offen offset:1024 sc1
    v_mfma_f32_16x16x32_bf16 a[44:47], v[164:167], a[32:35], a[44:47]
    v_add_u32 v13, 40960, v12
    v_mfma_f32_16x16x32_bf16 a[44:47], v[180:183], v[224:227], a[44:47]
    v_mul_u32_u24 v1, 1280, v1
    v_mfma_f32_16x16x32_bf16 a[48:51], v[168:171], a[32:35], a[48:51]
    v_lshl_add_u32 v19, v2, 3, v1
    v_mfma_f32_16x16x32_bf16 a[48:51], v[184:187], v[224:227], a[48:51]
    buffer_load_dwordx4 a[16:19], v30, s[16:19], s66 offen offset:1024 sc1
    v_mfma_f32_16x16x32_bf16 a[52:55], v[172:175], a[32:35], a[52:55]
    v_mfma_f32_16x16x32_bf16 a[52:55], v[188:191], v[224:227], a[52:55]
    s_waitcnt vmcnt(8)
    v_mfma_f32_16x16x32_bf16 a[56:59], v[160:163], v[228:231], a[56:59]
    v_mfma_f32_16x16x32_bf16 a[56:59], v[176:179], v[232:235], a[56:59]
    buffer_load_dwordx4 a[20:23], v30, s[16:19], s59 offen offset:2048 sc1
    v_mfma_f32_16x16x32_bf16 a[60:63], v[164:167], v[228:231], a[60:63]
    v_mfma_f32_16x16x32_bf16 a[60:63], v[180:183], v[232:235], a[60:63]
L_tv0_1:
    s_cbranch_execz L_base
    v_mfma_f32_16x16x32_bf16 a[64:67], v[168:171], v[228:231], a[64:67]
    v_mfma_f32_16x16x32_bf16 a[64:67], v[184:187], v[232:235], a[64:67]
    buffer_load_dwordx4 a[24:27], v30, s[16:19], s66 offen offset:2048 sc1
    v_mfma_f32_16x16x32_bf16 a[68:71], v[172:175], v[228:231], a[68:71]
    v_mfma_f32_16x16x32_bf16 a[68:71], v[188:191], v[232:235], a[68:71]
    s_waitcnt vmcnt(8)
    v_mfma_f32_16x16x32_bf16 a[72:75], v[160:163], v[236:239], a[72:75]
    v_mfma_f32_16x16x32_bf16 a[72:75], v[176:179], v[240:243], a[72:75]
    buffer_load_dwordx4 a[28:31], v30, s[16:19], s59 offen offset:3072 sc1
    v_mfma_f32_16x16x32_bf16 a[76:79], v[164:167], v[236:239], a[76:79]
    v_mfma_f32_16x16x32_bf16 a[76:79], v[180:183], v[240:243], a[76:79]
    v_mfma_f32_16x16x32_bf16 a[80:83], v[168:171], v[236:239], a[80:83]
    s_waitcnt lgkmcnt(0)
    v_mfma_f32_16x16x32_bf16 a[80:83], v[184:187], v[240:243], a[80:83]
    buffer_load_dwordx4 a[32:35], v30, s[16:19], s66 offen offset:3072 sc1
    v_mfma_f32_16x16x32_bf16 a[84:87], v[172:175], v[236:239], a[84:87]
    s_xor_b64 s[74:75], s[74:75], s[50:51]
    v_mfma_f32_16x16x32_bf16 a[84:87], v[188:191], v[240:243], a[84:87]
    s_xor_b64 s[76:77], s[76:77], s[50:51]
    s_waitcnt vmcnt(8)
    v_mfma_f32_16x16x32_bf16 a[88:91], v[160:163], v[244:247], a[88:91]
    s_xor_b64 s[78:79], s[78:79], s[50:51]
    v_mfma_f32_16x16x32_bf16 a[88:91], v[176:179], a[0:3], a[88:91]
    buffer_load_dwordx4 v[224:227], v31, s[16:19], s67 offen offset:0 sc1
    v_mfma_f32_16x16x32_bf16 a[92:95], v[164:167], v[244:247], a[92:95]
    s_xor_b64 s[80:81], s[80:81], s[50:51]
    v_mfma_f32_16x16x32_bf16 a[92:95], v[180:183], a[0:3], a[92:95]
    s_or_b64 s[74:75], s[74:75], s[76:77]
    v_mfma_f32_16x16x32_bf16 a[96:99], v[168:171], v[244:247], a[96:99]
    s_or_b64 s[74:75], s[74:75], s[78:79]
    v_mfma_f32_16x16x32_bf16 a[96:99], v[184:187], a[0:3], a[96:99]
    buffer_load_dwordx4 v[228:231], v31, s[16:19], s68 offen offset:0 sc1
    v_mfma_f32_16x16x32_bf16 a[100:103], v[172:175], v[244:247], a[100:103]
    s_or_b64 s[74:75], s[74:75], s[80:81]
    s_cbranch_scc1 L_slow_n0c2
L_ok_n0c2:
    v_mfma_f32_16x16x32_bf16 a[100:103], v[188:191], a[0:3], a[100:103]
    s_waitcnt vmcnt(8)
    v_mfma_f32_16x16x32_bf16 a[40:43], v[192:195], a[4:7], a[40:43]
    v_mfma_f32_16x16x32_bf16 a[40:43], v[208:211], a[8:11], a[40:43]
    buffer_load_dwordx4 v[232:235], v30, s[16:19], s40 offen offset:0 sc1
    v_mfma_f32_16x16x32_bf16 a[44:47], v[196:199], a[4:7], a[44:47]
    v_mfma_f32_16x16x32_bf16 a[44:47], v[212:215], a[8:11], a[44:47]
    v_mfma_f32_16x16x32_bf16 a[48:51], v[200:203], a[4:7], a[48:51]
    v_mfma_f32_16x16x32_bf16 a[48:51], v[216:219], a[8:11], a[48:51]
    buffer_load_dwordx4 v[236:239], v30, s[16:19], s41 offen offset:0 sc1
    v_mfma_f32_16x16x32_bf16 a[52:55], v[204:207], a[4:7], a[52:55]
    v_mfma_f32_16x16x32_bf16 a[52:55], v[220:223], a[8:11], a[52:55]
    s_waitcnt vmcnt(8)
    v_mfma_f32_16x16x32_bf16 a[56:59], v[192:195], a[12:15], a[56:59]
    v_mfma_f32_16x16x32_bf16 a[56:59], v[208:211], a[16:19], a[56:59]
    buffer_load_dwordx4 v[240:243], v30, s[16:19], s40 offen offset:1024 sc1
    v_mfma_f32_16x16x32_bf16 a[60:63], v[196:199], a[12:15], a[60:63]
    v_mfma_f32_16x16x32_bf16 a[60:63], v[212:215], a[16:19], a[60:63]
    v_mfma_f32_16x16x32_bf16 a[64:67], v[200:203], a[12:15], a[64:67]
    v_mfma_f32_16x16x32_bf16 a[64:67], v[216:219], a[16:19], a[64:67]
    buffer_load_dwordx4 v[244:247], v30, s[16:19], s41 offen offset:1024 sc1
    v_mfma_f32_16x16x32_bf16 a[68:71], v[204:207], a[12:15], a[68:71]
    v_mfma_f32_16x16x32_bf16 a[68:71], v[220:223], a[16:19], a[68:71]
    s_waitcnt vmcnt(8)
    v_mfma_f32_16x16x32_bf16 a[72:75], v[192:195], a[20:23], a[72:75]
    s_load_dword s74, s[70:71], 4224
    s_load_dword s75, s[70:71], 5504
    v_mfma_f32_16x16x32_bf16 a[72:75], v[208:211], a[24:27], a[72:75]
    buffer_load_dwordx4 a[0:3], v31, s[16:19], s57 offen offset:0 sc1
    v_mfma_f32_16x16x32_bf16 a[76:79], v[196:199], a[20:23], a[76:79]
    s_load_dword s76, s[70:71], 6784
    v_mfma_f32_16x16x32_bf16 a[76:79], v[212:215], a[24:27], a[76:79]
    s_load_dword s77, s[70:71], 8064
    v_mfma_f32_16x16x32_bf16 a[80:83], v[200:203], a[20:23], a[80:83]
    v_mfma_f32_16x16x32_bf16 a[80:83], v[216:219], a[24:27], a[80:83]
    buffer_load_dwordx4 a[4:7], v31, s[16:19], s58 offen offset:0 sc1
    v_mfma_f32_16x16x32_bf16 a[84:87], v[204:207], a[20:23], a[84:87]
    v_mfma_f32_16x16x32_bf16 a[84:87], v[220:223], a[24:27], a[84:87]
    s_waitcnt vmcnt(8)
    v_mfma_f32_16x16x32_bf16 a[88:91], v[192:195], a[28:31], a[88:91]
    v_mfma_f32_16x16x32_bf16 a[88:91], v[208:211], a[32:35], a[88:91]
    buffer_load_dwordx4 a[8:11], v30, s[16:19], s69 offen offset:0 sc1
    v_mfma_f32_16x16x32_bf16 a[92:95], v[196:199], a[28:31], a[92:95]
    v_mfma_f32_16x16x32_bf16 a[92:95], v[212:215], a[32:35], a[92:95]
    v_mfma_f32_16x16x32_bf16 a[96:99], v[200:203], a[28:31], a[96:99]
    v_mfma_f32_16x16x32_bf16 a[96:99], v[216:219], a[32:35], a[96:99]
    buffer_load_dwordx4 a[12:15], v30, s[16:19], s42 offen offset:0 sc1
    v_mfma_f32_16x16x32_bf16 a[100:103], v[204:207], a[28:31], a[100:103]
    v_mfma_f32_16x16x32_bf16 a[100:103], v[220:223], a[32:35], a[100:103]
    s_waitcnt vmcnt(8)
    v_mfma_f32_16x16x32_bf16 a[104:107], v[64:67], v[224:227], a[104:107]
    v_mfma_f32_16x16x32_bf16 a[104:107], v[80:83], v[228:231], a[104:107]
    buffer_load_dwordx4 a[16:19], v30, s[16:19], s49 offen offset:0 sc1
    v_mfma_f32_16x16x32_bf16 a[108:111], v[68:71], v[224:227], a[108:111]
    v_mfma_f32_16x16x32_bf16 a[108:111], v[84:87], v[228:231], a[108:111]
    v_mfma_f32_16x16x32_bf16 a[112:115], v[72:75], v[224:227], a[112:115]
    v_mfma_f32_16x16x32_bf16 a[112:115], v[88:91], v[228:231], a[112:115]
    buffer_load_dwordx4 a[20:23], v30, s[16:19], s69 offen offset:1024 sc1
    v_mfma_f32_16x16x32_bf16 a[116:119], v[76:79], v[224:227], a[116:119]
    v_mfma_f32_16x16x32_bf16 a[116:119], v[92:95], v[228:231], a[116:119]
    s_waitcnt vmcnt(8)
    v_mfma_f32_16x16x32_bf16 a[40:43], a[208:211], v[232:235], a[40:43]
    v_mfma_f32_16x16x32_bf16 a[40:43], a[224:227], v[236:239], a[40:43]
    buffer_load_dwordx4 a[24:27], v30, s[16:19], s42 offen offset:1024 sc1
    v_mfma_f32_16x16x32_bf16 a[44:47], a[212:215], v[232:235], a[44:47]
    v_mfma_f32_16x16x32_bf16 a[44:47], a[228:231], v[236:239], a[44:47]
    v_mfma_f32_16x16x32_bf16 a[48:51], a[216:219], v[232:235], a[48:51]
    v_mfma_f32_16x16x32_bf16 a[48:51], a[232:235], v[236:239], a[48:51]
    buffer_load_dwordx4 a[28:31], v30, s[16:19], s49 offen offset:1024 sc1
    v_mfma_f32_16x16x32_bf16 a[52:55], a[220:223], v[232:235], a[52:55]
    v_mfma_f32_16x16x32_bf16 a[52:55], a[236:239], v[236:239], a[52:55]
    s_waitcnt vmcnt(8)
    v_mfma_f32_16x16x32_bf16 a[56:59], a[208:211], v[240:243], a[56:59]
    v_mfma_f32_16x16x32_bf16 a[56:59], a[224:227], v[244:247], a[56:59]
    buffer_load_dwordx4 a[32:35], v31, s[16:19], s69 offen offset:0 sc1
    v_mfma_f32_16x16x32_bf16 a[60:63], a[212:215], v[240:243], a[60:63]
    v_mfma_f32_16x16x32_bf16 a[60:63], a[228:231], v[244:247], a[60:63]
    v_mfma_f32_16x16x32_bf16 a[64:67], a[216:219], v[240:243], a[64:67]
    s_waitcnt lgkmcnt(0)
    v_mfma_f32_16x16x32_bf16 a[64:67], a[232:235], v[244:247], a[64:67]
    buffer_load_dwordx4 v[224:227], v31, s[16:19], s59 offen offset:0 sc1
    v_mfma_f32_16x16x32_bf16 a[68:71], a[220:223], v[240:243], a[68:71]
    s_xor_b64 s[74:75], s[74:75], s[50:51]
    v_mfma_f32_16x16x32_bf16 a[68:71], a[236:239], v[244:247], a[68:71]
    s_xor_b64 s[76:77], s[76:77], s[50:51]
    s_waitcnt vmcnt(8)
    v_mfma_f32_16x16x32_bf16 a[104:107], v[160:163], a[0:3], a[104:107]
    s_or_b64 s[74:75], s[74:75], s[76:77]
    s_cbranch_scc1 L_slow_n0c3
L_ok_n0c3:
    v_mfma_f32_16x16x32_bf16 a[104:107], v[176:179], a[4:7], a[104:107]
    buffer_load_dwordx4 v[228:231], v31, s[16:19], s66 offen offset:0 sc1
    v_mfma_f32_16x16x32_bf16 a[108:111], v[164:167], a[0:3], a[108:111]
    v_mfma_f32_16x16x32_bf16 a[108:111], v[180:183], a[4:7], a[108:111]
    v_mfma_f32_16x16x32_bf16 a[112:115], v[168:171], a[0:3], a[112:115]
    v_mfma_f32_16x16x32_bf16 a[112:115], v[184:187], a[4:7], a[112:115]
    buffer_load_dwordx4 v[232:235], v30, s[16:19], s40 offen offset:2048 sc1
    v_mfma_f32_16x16x32_bf16 a[116:119], v[172:175], a[0:3], a[116:119]
    v_mfma_f32_16x16x32_bf16 a[116:119], v[188:191], a[4:7], a[116:119]
    s_waitcnt vmcnt(7)
    v_mfma_f32_16x16x32_bf16 a[40:43], v[96:99], a[8:11], a[40:43]
    v_mfma_f32_16x16x32_bf16 a[40:43], a[240:243], a[12:15], a[40:43]
    buffer_load_dwordx4 v[236:239], v30, s[16:19], s41 offen offset:2048 sc1
    v_mfma_f32_16x16x32_bf16 a[40:43], v[144:147], a[16:19], a[40:43]
    v_mfma_f32_16x16x32_bf16 a[44:47], v[100:103], a[8:11], a[44:47]
    v_mfma_f32_16x16x32_bf16 a[44:47], a[244:247], a[12:15], a[44:47]
    v_mfma_f32_16x16x32_bf16 a[44:47], v[148:151], a[16:19], a[44:47]
    buffer_load_dwordx4 v[240:243], v30, s[16:19], s42 offen offset:2048 sc1
    v_mfma_f32_16x16x32_bf16 a[48:51], v[104:107], a[8:11], a[48:51]
    v_mfma_f32_16x16x32_bf16 a[48:51], a[248:251], a[12:15], a[48:51]
    s_nop 2
    ds_write_b128 v16, a[40:43] offset:0
    v_mfma_f32_16x16x32_bf16 a[48:51], v[152:155], a[16:19], a[48:51]
    v_mfma_f32_16x16x32_bf16 a[52:55], v[108:111], a[8:11], a[52:55]
    buffer_load_dwordx4 v[244:247], v30, s[16:19], s49 offen offset:2048 sc1
    v_mfma_f32_16x16x32_bf16 a[52:55], a[252:255], a[12:15], a[52:55]
    ds_write_b128 v17, a[44:47] offset:0
    v_mfma_f32_16x16x32_bf16 a[52:55], v[156:159], a[16:19], a[52:55]
    s_waitcnt vmcnt(7)
    v_mfma_f32_16x16x32_bf16 a[56:59], v[96:99], a[20:23], a[56:59]
    v_mfma_f32_16x16x32_bf16 a[56:59], a[240:243], a[24:27], a[56:59]
    buffer_load_dwordx4 a[0:3], v30, s[16:19], s40 offen offset:3072 sc1
    v_mfma_f32_16x16x32_bf16 a[56:59], v[144:147], a[28:31], a[56:59]
    ds_write_b128 v16, a[48:51] offset:128
    v_mfma_f32_16x16x32_bf16 a[60:63], v[100:103], a[20:23], a[60:63]
    v_mfma_f32_16x16x32_bf16 a[60:63], a[244:247], a[24:27], a[60:63]
    s_nop 0
    ds_write_b128 v17, a[52:55] offset:128
    v_mfma_f32_16x16x32_bf16 a[60:63], v[148:151], a[28:31], a[60:63]
    buffer_load_dwordx4 a[4:7], v30, s[16:19], s41 offen offset:3072 sc1
    v_mfma_f32_16x16x32_bf16 a[64:67], v[104:107], a[20:23], a[64:67]
    v_mfma_f32_16x16x32_bf16 a[64:67], a[248:251], a[24:27], a[64:67]
    ds_write_b128 v16, a[56:59] offset:4096
    v_mfma_f32_16x16x32_bf16 a[64:67], v[152:155], a[28:31], a[64:67]
    v_mfma_f32_16x16x32_bf16 a[68:71], v[108:111], a[20:23], a[68:71]
    buffer_load_dwordx4 a[8:11], v30, s[16:19], s42 offen offset:3072 sc1
    v_mfma_f32_16x16x32_bf16 a[68:71], a[252:255], a[24:27], a[68:71]
    s_nop 0
    ds_write_b128 v17, a[60:63] offset:4096
    v_mfma_f32_16x16x32_bf16 a[68:71], v[156:159], a[28:31], a[68:71]
    s_waitcnt vmcnt(7)
    v_mfma_f32_16x16x32_bf16 a[104:107], v[96:99], a[32:35], a[104:107]
    v_mfma_f32_16x16x32_bf16 a[104:107], v[192:195], v[224:227], a[104:107]
    buffer_load_dwordx4 a[12:15], v30, s[16:19], s49 offen offset:3072 sc1
    v_mfma_f32_16x16x32_bf16 a[104:107], v[208:211], v[228:231], a[104:107]
    ds_write_b128 v16, a[64:67] offset:4224
    v_mfma_f32_16x16x32_bf16 a[108:111], v[100:103], a[32:35], a[108:111]
    v_mfma_f32_16x16x32_bf16 a[108:111], v[196:199], v[224:227], a[108:111]
    s_nop 0
    ds_write_b128 v17, a[68:71] offset:4224
    v_mfma_f32_16x16x32_bf16 a[108:111], v[212:215], v[228:231], a[108:111]
    v_mfma_f32_16x16x32_bf16 a[112:115], v[104:107], a[32:35], a[112:115]
    v_mfma_f32_16x16x32_bf16 a[112:115], v[200:203], v[224:227], a[112:115]
    s_nop 0
    ds_write_b128 v16, a[104:107] offset:16384
    v_mfma_f32_16x16x32_bf16 a[112:115], v[216:219], v[228:231], a[112:115]
    v_mfma_f32_16x16x32_bf16 a[116:119], v[108:111], a[32:35], a[116:119]
    v_mfma_f32_16x16x32_bf16 a[116:119], v[204:207], v[224:227], a[116:119]
    s_nop 1
    ds_write_b128 v17, a[108:111] offset:16384
    v_mfma_f32_16x16x32_bf16 a[116:119], v[220:223], v[228:231], a[116:119]
    s_waitcnt vmcnt(6)
    v_mfma_f32_16x16x32_bf16 a[72:75], a[208:211], v[232:235], a[72:75]
    v_mfma_f32_16x16x32_bf16 a[72:75], a[224:227], v[236:239], a[72:75]
    ds_write_b128 v16, a[112:115] offset:16512
    v_mfma_f32_16x16x32_bf16 a[76:79], a[212:215], v[232:235], a[76:79]
    v_mfma_f32_16x16x32_bf16 a[76:79], a[228:231], v[236:239], a[76:79]
    v_mfma_f32_16x16x32_bf16 a[80:83], a[216:219], v[232:235], a[80:83]
    s_nop 1
    ds_write_b128 v17, a[116:119] offset:16512
    v_mfma_f32_16x16x32_bf16 a[80:83], a[232:235], v[236:239], a[80:83]
    v_mfma_f32_16x16x32_bf16 a[84:87], a[220:223], v[232:235], a[84:87]
    v_mfma_f32_16x16x32_bf16 a[84:87], a[236:239], v[236:239], a[84:87]
    s_waitcnt vmcnt(4)
    v_mfma_f32_16x16x32_bf16 a[72:75], a[240:243], v[240:243], a[72:75]
    v_mfma_f32_16x16x32_bf16 a[72:75], v[144:147], v[244:247], a[72:75]
    v_mfma_f32_16x16x32_bf16 a[76:79], a[244:247], v[240:243], a[76:79]
    v_mfma_f32_16x16x32_bf16 a[76:79], v[148:151], v[244:247], a[76:79]
    v_mfma_f32_16x16x32_bf16 a[80:83], a[248:251], v[240:243], a[80:83]
    v_mfma_f32_16x16x32_bf16 a[80:83], v[152:155], v[244:247], a[80:83]
    v_mfma_f32_16x16x32_bf16 a[84:87], a[252:255], v[240:243], a[84:87]
    s_nop 3
    ds_write_b128 v16, a[72:75] offset:8192
    v_mfma_f32_16x16x32_bf16 a[84:87], v[156:159], v[244:247], a[84:87]
    s_waitcnt vmcnt(2)
    v_mfma_f32_16x16x32_bf16 a[88:91], a[208:211], a[0:3], a[88:91]
    ds_write_b128 v17, a[76:79] offset:8192
    v_mfma_f32_16x16x32_bf16 a[88:91], a[224:227], a[4:7], a[88:91]
    v_mfma_f32_16x16x32_bf16 a[92:95], a[212:215], a[0:3], a[92:95]
    ds_write_b128 v16, a[80:83] offset:8320
    v_mfma_f32_16x16x32_bf16 a[92:95], a[228:231], a[4:7], a[92:95]
    v_mfma_f32_16x16x32_bf16 a[96:99], a[216:219], a[0:3], a[96:99]
    s_nop 0
    ds_write_b128 v17, a[84:87] offset:8320
    v_mfma_f32_16x16x32_bf16 a[96:99], a[232:235], a[4:7], a[96:99]
    v_mfma_f32_16x16x32_bf16 a[100:103], a[220:223], a[0:3], a[100:103]
    v_mfma_f32_16x16x32_bf16 a[100:103], a[236:239], a[4:7], a[100:103]
    s_waitcnt vmcnt(0)
    v_mfma_f32_16x16x32_bf16 a[88:91], a[240:243], a[8:11], a[88:91]
    v_mfma_f32_16x16x32_bf16 a[88:91], v[144:147], a[12:15], a[88:91]
    v_mfma_f32_16x16x32_bf16 a[92:95], a[244:247], a[8:11], a[92:95]
    v_mfma_f32_16x16x32_bf16 a[92:95], v[148:151], a[12:15], a[92:95]
    v_mfma_f32_16x16x32_bf16 a[96:99], a[248:251], a[8:11], a[96:99]
    v_mfma_f32_16x16x32_bf16 a[96:99], v[152:155], a[12:15], a[96:99]
    v_mfma_f32_16x16x32_bf16 a[100:103], a[252:255], a[8:11], a[100:103]
    s_nop 3
    ds_write_b128 v16, a[88:91] offset:12288
    v_mfma_f32_16x16x32_bf16 a[100:103], v[156:159], a[12:15], a[100:103]
    ds_write_b128 v17, a[92:95] offset:12288
    s_nop 0
    ds_write_b128 v16, a[96:99] offset:12416
    s_nop 5
    ds_write_b128 v17, a[100:103] offset:12416
    s_waitcnt lgkmcnt(0)
    s_barrier
    ds_read_b128 v[32:35], v8 offset:0
    ds_read_b128 v[36:39], v9 offset:0
    ds_read_b128 v[40:43], v8 offset:20480
    ds_read_b128 v[44:47], v9 offset:20480
    ds_read_b128 v[48:51], v10 offset:0
    ds_read_b128 v[52:55], v11 offset:0
    ds_read_b128 v[56:59], v10 offset:20480
    ds_read_b128 v[60:63], v11 offset:20480
    ds_read_b128 v[64:67], v8 offset:8192
    ds_read_b128 v[68:71], v9 offset:8192
    ds_read_b128 v[72:75], v8 offset:28672
    ds_read_b128 v[76:79], v9 offset:28672
    ds_read_b128 v[80:83], v10 offset:8192
    ds_read_b128 v[84:87], v11 offset:8192
    ds_read_b128 v[88:91], v10 offset:28672
    ds_read_b128 v[92:95], v11 offset:28672
    s_waitcnt lgkmcnt(12)
    v_pk_add_f32 v[32:33], v[32:33], v[40:41]
    v_pk_add_f32 v[34:35], v[34:35], v[42:43]
    v_pk_add_f32 v[36:37], v[36:37], v[44:45]
    v_pk_add_f32 v[38:39], v[38:39], v[46:47]
    s_waitcnt lgkmcnt(8)
    ds_read_b128 v[96:99], v12 offset:16384
    ds_read_b128 v[100:103], v12 offset:36864
    ds_read_b128 v[104:107], v13 offset:16384
    ds_read_b128 v[108:111], v13 offset:36864
    v_pk_add_f32 v[48:49], v[48:49], v[56:57]
    v_pk_add_f32 v[50:51], v[50:51], v[58:59]
    v_pk_add_f32 v[52:53], v[52:53], v[60:61]
    v_pk_add_f32 v[54:55], v[54:55], v[62:63]
    v_pk_add_f32 v[32:33], v[32:33], v[48:49]
    v_pk_add_f32 v[34:35], v[34:35], v[50:51]
    v_pk_add_f32 v[36:37], v[36:37], v[52:53]
    v_pk_add_f32 v[38:39], v[38:39], v[54:55]
    v_cvt_pk_bf16_f32 v40, v32, v33
    v_cvt_pk_bf16_f32 v41, v34, v35
    v_cvt_pk_bf16_f32 v42, v36, v37
    v_cvt_pk_bf16_f32 v43, v38, v39
    buffer_store_dwordx4 v[40:43], v18, s[24:27], s53 offen nt
    s_add_u32 s53, s53, 40960
    s_waitcnt lgkmcnt(8)
    v_pk_add_f32 v[64:65], v[64:65], v[72:73]
    v_pk_add_f32 v[66:67], v[66:67], v[74:75]
    v_pk_add_f32 v[68:69], v[68:69], v[76:77]
    v_pk_add_f32 v[70:71], v[70:71], v[78:79]
    s_waitcnt lgkmcnt(4)
    v_pk_add_f32 v[80:81], v[80:81], v[88:89]
    v_pk_add_f32 v[82:83], v[82:83], v[90:91]
    v_pk_add_f32 v[84:85], v[84:85], v[92:93]
    v_pk_add_f32 v[86:87], v[86:87], v[94:95]
    v_pk_add_f32 v[64:65], v[64:65], v[80:81]
    v_pk_add_f32 v[66:67], v[66:67], v[82:83]
    v_pk_add_f32 v[68:69], v[68:69], v[84:85]
    v_pk_add_f32 v[70:71], v[70:71], v[86:87]
    v_cvt_pk_bf16_f32 v72, v64, v65
    v_cvt_pk_bf16_f32 v73, v66, v67
    v_cvt_pk_bf16_f32 v74, v68, v69
    v_cvt_pk_bf16_f32 v75, v70, v71
    buffer_store_dwordx4 v[72:75], v18, s[24:27], s53 offen nt
    s_add_u32 s53, s53, 40960
    s_waitcnt lgkmcnt(2)
    v_pk_add_f32 v[96:97], v[96:97], v[100:101]
    v_pk_add_f32 v[98:99], v[98:99], v[102:103]
    s_waitcnt lgkmcnt(0)
    v_pk_add_f32 v[104:105], v[104:105], v[108:109]
    v_pk_add_f32 v[106:107], v[106:107], v[110:111]
    v_pk_add_f32 v[96:97], v[96:97], v[104:105]
    v_pk_add_f32 v[98:99], v[98:99], v[106:107]
    v_cvt_pk_bf16_f32 v100, v96, v97
    v_cvt_pk_bf16_f32 v101, v98, v99
    buffer_store_dwordx2 v[100:101], v19, s[24:27], s53 offen nt
    s_endpgm
L_slow_n0c0:
    s_mov_b32 s62, 0x387f
    s_mov_b32 s63, 0x0
    s_mov_b64 exec, s[62:63]
    buffer_load_dword v26, v25, s[28:31], 0 offen offset:0 sc1
    s_mov_b64 exec, -1
    s_waitcnt vmcnt(0)
    v_cmp_eq_u32 vcc, s50, v26
    s_andn2_b64 s[62:63], s[62:63], vcc
    s_cbranch_scc0 L_ok_n0c0
    s_cmp_eq_u32 s52, 0
    s_cbranch_scc1 L_ok_n0c0
    s_sub_u32 s52, s52, 1
    s_sleep 1
    s_branch L_slow_n0c0
L_slow_n0c1:
    s_mov_b32 s62, 0x3f80
    s_mov_b32 s63, 0x0
    s_mov_b64 exec, s[62:63]
    buffer_load_dword v26, v25, s[28:31], 0 offen offset:128 sc1
    s_mov_b64 exec, -1
    s_waitcnt vmcnt(0)
    v_cmp_eq_u32 vcc, s50, v26
    s_andn2_b64 s[62:63], s[62:63], vcc
    s_cbranch_scc0 L_ok_n0c1
    s_cmp_eq_u32 s52, 0
    s_cbranch_scc1 L_ok_n0c1
    s_sub_u32 s52, s52, 1
    s_sleep 1
    s_branch L_slow_n0c1
L_slow_n0c2:
    s_mov_b32 s62, 0x7f8
    s_mov_b32 s63, 0x0
    s_mov_b64 exec, s[62:63]
    buffer_load_dword v26, v25, s[28:31], 0 offen offset:256 sc1
    s_mov_b64 exec, -1
    s_waitcnt vmcnt(0)
    v_cmp_eq_u32 vcc, s50, v26
    s_andn2_b64 s[62:63], s[62:63], vcc
    s_cbranch_scc0 L_ok_n0c2
    s_cmp_eq_u32 s52, 0
    s_cbranch_scc1 L_ok_n0c2
    s_sub_u32 s52, s52, 1
    s_sleep 1
    s_branch L_slow_n0c2
L_slow_n0c3:
    s_mov_b32 s62, 0x78
    s_mov_b32 s63, 0x0
    s_mov_b64 exec, s[62:63]
    buffer_load_dword v26, v25, s[28:31], 0 offen offset:384 sc1
    s_mov_b64 exec, -1
    s_waitcnt vmcnt(0)
    v_cmp_eq_u32 vcc, s50, v26
    s_andn2_b64 s[62:63], s[62:63], vcc
    s_cbranch_scc0 L_ok_n0c3
    s_cmp_eq_u32 s52, 0
    s_cbranch_scc1 L_ok_n0c3
    s_sub_u32 s52, s52, 1
    s_sleep 1
    s_branch L_slow_n0c3
.p2align 12
L_var1:
L_tv1_0:
    s_cbranch_execz L_base
    v_mfma_f32_16x16x32_bf16 v[48:51], a[112:115], v[136:139], v[48:51]
    ds_read_b128 v[136:139], v16 offset:14336
    s_load_dword s74, s[70:71], 5120
    s_load_dword s75, s[70:71], 6400
    v_mfma_f32_16x16x32_bf16 v[48:51], a[120:123], v[140:143], v[48:51]
    ds_read_b64_tr_b16 v[190:191], v7 offset:512
    s_load_dword s76, s[70:71], 7680
    s_waitcnt lgkmcnt(8)
    v_mfma_f32_16x16x32_bf16 v[52:55], a[64:67], v[112:115], v[52:55]
    ds_read_b128 v[140:143], v17 offset:14336
    s_load_dword s77, s[70:71], 0
    v_mfma_f32_16x16x32_bf16 v[52:55], a[72:75], v[116:119], v[52:55]
    buffer_load_dwordx4 v235, s[20:23], s47 offen offset:3072 lds
    v_mfma_f32_16x16x32_bf16 v[60:63], a[68:71], v[112:115], v[60:63]
    s_waitcnt vmcnt(8)
    s_barrier
    s_cmp_lg_u32 s36, 0
    s_cbranch_scc1 L_pub_n11
    s_atomic_swap s50, s[64:65], 128
L_pub_n11:
    ds_read_b128 v[112:115], v16 offset:18432
    v_mfma_f32_16x16x32_bf16 v[60:63], a[76:79], v[116:119], v[60:63]
    ds_read_b64_tr_b16 v[192:193], v4 offset:16384
    s_add_u32 m0, s44, 49152
    s_waitcnt lgkmcnt(8)
    v_mfma_f32_16x16x32_bf16 v[60:63], a[84:87], v[120:123], v[60:63]
    ds_read_b128 v[116:119], v17 offset:18432
    v_mfma_f32_16x16x32_bf16 v[60:63], a[92:95], v[124:127], v[60:63]
    buffer_load_dwordx4 v8, s[8:11], s46 offen offset:0 lds
    v_mfma_f32_16x16x32_bf16 v[52:55], a[80:83], v[120:123], v[52:55]
    ds_read_b128 v[120:123], v16 offset:22528
    v_mfma_f32_16x16x32_bf16 v[52:55], a[88:91], v[124:127], v[52:55]
    ds_read_b64_tr_b16 v[194:195], v4 offset:16896
    s_waitcnt lgkmcnt(8)
    v_mfma_f32_16x16x32_bf16 v[52:55], a[96:99], v[128:131], v[52:55]
    ds_read_b128 v[124:127], v17 offset:22528
    v_mfma_f32_16x16x32_bf16 v[52:55], a[104:107], v[132:135], v[52:55]
    buffer_load_dwordx4 v9, s[8:11], s46 offen offset:1024 lds
    v_mfma_f32_16x16x32_bf16 v[60:63], a[100:103], v[128:131], v[60:63]
    ds_read_b128 v[128:131], v16 offset:16384
    s_mov_b32 s47, s54
    s_add_u32 s54, s54, s55
    v_mfma_f32_16x16x32_bf16 v[60:63], a[108:111], v[132:135], v[60:63]
    ds_read_b64_tr_b16 v[196:197], v5 offset:16384
    s_waitcnt lgkmcnt(8)
    v_mfma_f32_16x16x32_bf16 v[60:63], a[116:119], v[136:139], v[60:63]
    ds_read_b128 v[132:135], v17 offset:16384
    v_mfma_f32_16x16x32_bf16 v[60:63], a[124:127], v[140:143], v[60:63]
    buffer_load_dwordx4 v10, s[8:11], s46 offen offset:2048 lds
    v_mfma_f32_16x16x32_bf16 v[52:55], a[112:115], v[136:139], v[52:55]
    ds_read_b128 v[136:139], v16 offset:20480
    v_mfma_f32_16x16x32_bf16 v[52:55], a[120:123], v[140:143], v[52:55]
    ds_read_b64_tr_b16 v[198:199], v5 offset:16896
    s_waitcnt lgkmcnt(8)
    v_mfma_f32_16x16x32_bf16 v[52:55], a[128:131], v[112:115], v[52:55]
    ds_read_b128 v[140:143], v17 offset:20480
    v_mfma_f32_16x16x32_bf16 v[52:55], a[136:139], v[116:119], v[52:55]
    buffer_load_dwordx4 v11, s[8:11], s46 offen offset:3072 lds
    v_mfma_f32_16x16x32_bf16 v[60:63], a[132:135], v[112:115], v[60:63]
    ds_read_b128 v[112:115], v16 offset:26624
    s_add_u32 m0, s45, 49152
    s_load_dword s78, s[70:71], 8960
    v_mfma_f32_16x16x32_bf16 v[60:63], a[140:143], v[116:119], v[60:63]
    ds_read_b64_tr_b16 v[200:201], v6 offset:16384
    s_load_dword s79, s[70:71], 1280
    s_waitcnt lgkmcnt(8)
    v_mfma_f32_16x16x32_bf16 v[60:63], a[148:151], v[120:123], v[60:63]
    ds_read_b128 v[116:119], v17 offset:26624
    s_load_dword s80, s[70:71], 2560
    s_load_dword s81, s[70:71], 3840
    v_mfma_f32_16x16x32_bf16 v[60:63], a[156:159], v[124:127], v[60:63]
    buffer_load_dwordx4 v232, s[20:23], s47 offen offset:0 lds
    v_mfma_f32_16x16x32_bf16 v[52:55], a[144:147], v[120:123], v[52:55]
    ds_read_b128 v[120:123], v16 offset:30720
    v_mfma_f32_16x16x32_bf16 v[52:55], a[152:155], v[124:127], v[52:55]
    ds_read_b64_tr_b16 v[202:203], v6 offset:16896
    s_waitcnt lgkmcnt(8)
    v_mfma_f32_16x16x32_bf16 v[48:51], a[128:131], v[128:131], v[48:51]
    ds_read_b128 v[124:127], v17 offset:30720
    v_mfma_f32_16x16x32_bf16 v[48:51], a[136:139], v[132:135], v[48:51]
    buffer_load_dwordx4 v233, s[20:23], s47 offen offset:1024 lds
    v_mfma_f32_16x16x32_bf16 v[56:59], a[132:135], v[128:131], v[56:59]
    ds_read_b128 v[128:131], v16 offset:24576
    s_mov_b32 s46, s54
    s_add_u32 s54, s54, s55
    v_mfma_f32_16x16x32_bf16 v[56:59], a[140:143], v[132:135], v[56:59]
    ds_read_b64_tr_b16 v[204:205], v7 offset:16384
    s_waitcnt lgkmcnt(8)
    v_mfma_f32_16x16x32_bf16 v[56:59], a[148:151], v[136:139], v[56:59]
    ds_read_b128 v[132:135], v17 offset:24576
    v_mfma_f32_16x16x32_bf16 v[56:59], a[156:159], v[140:143], v[56:59]
    buffer_load_dwordx4 v234, s[20:23], s47 offen offset:2048 lds
    v_mfma_f32_16x16x32_bf16 v[48:51], a[144:147], v[136:139], v[48:51]
    ds_read_b128 v[136:139], v16 offset:28672
    v_mfma_f32_16x16x32_bf16 v[48:51], a[152:155], v[140:143], v[48:51]
    ds_read_b64_tr_b16 v[206:207], v7 offset:16896
    s_waitcnt lgkmcnt(8)
    v_mfma_f32_16x16x32_bf16 v[36:39], a[0:3], v[112:115], 0
    ds_read_b128 v[140:143], v17 offset:28672
    v_mfma_f32_16x16x32_bf16 v[36:39], a[8:11], v[116:119], v[36:39]
    buffer_load_dwordx4 v235, s[20:23], s47 offen offset:3072 lds
    v_mfma_f32_16x16x32_bf16 v[44:47], a[4:7], v[112:115], 0
    s_waitcnt vmcnt(8)
    s_barrier
    ds_read_b128 v[112:115], v16 offset:32768
    v_mfma_f32_16x16x32_bf16 v[44:47], a[12:15], v[116:119], v[44:47]
    ds_read_b64_tr_b16 v[208:209], v4 offset:32768
    s_add_u32 m0, s45, 0
    s_waitcnt lgkmcnt(8)
    v_mfma_f32_16x16x32_bf16 v[44:47], a[20:23], v[120:123], v[44:47]
    ds_read_b128 v[116:119], v17 offset:32768
    v_readlane_b32 s88, v24, 6
    v_mul_f32 v48, v48, v56
    v_mul_f32 v49, v49, v57
    v_mfma_f32_16x16x32_bf16 v[44:47], a[28:31], v[124:127], v[44:47]
    buffer_load_dwordx4 v232, s[20:23], s46 offen offset:0 lds
    v_mul_f32 v50, v50, v58
    v_mfma_f32_16x16x32_bf16 v[36:39], a[16:19], v[120:123], v[36:39]
    ds_read_b128 v[120:123], v16 offset:36864
    s_load_dword s82, s[70:71], 10240
    s_load_dword s83, s[70:71], 11520
    v_mfma_f32_16x16x32_bf16 v[36:39], a[24:27], v[124:127], v[36:39]
    ds_read_b64_tr_b16 v[210:211], v4 offset:33280
    v_mul_f32 v51, v51, v59
    v_mul_f32 v52, v52, v60
    s_waitcnt lgkmcnt(8)
    v_mfma_f32_16x16x32_bf16 v[32:35], a[0:3], v[128:131], 0
    ds_read_b128 v[124:127], v17 offset:36864
    v_mul_f32 v53, v53, v61
    v_mfma_f32_16x16x32_bf16 v[32:35], a[8:11], v[132:135], v[32:35]
    buffer_load_dwordx4 v233, s[20:23], s46 offen offset:1024 lds
    v_mul_f32 v54, v54, v62
    v_mfma_f32_16x16x32_bf16 v[40:43], a[4:7], v[128:131], 0
    ds_read_b128 v[128:131], v16 offset:40960
    s_min_u32 s47, s54, 2211840
    v_mul_f32 v55, v55, v63
    v_mfma_f32_16x16x32_bf16 v[40:43], a[12:15], v[132:135], v[40:43]
    ds_read_b64_tr_b16 v[212:213], v5 offset:32768
    v_cvt_pk_bf16_f32 v56, v48, v49
    v_cvt_pk_bf16_f32 v58, v52, v53
    s_waitcnt lgkmcnt(8)
    v_mfma_f32_16x16x32_bf16 v[40:43], a[20:23], v[136:139], v[40:43]
    ds_read_b128 v[132:135], v17 offset:40960
    v_cvt_pk_bf16_f32 v57, v50, v51
    v_mfma_f32_16x16x32_bf16 v[40:43], a[28:31], v[140:143], v[40:43]
    buffer_load_dwordx4 v234, s[20:23], s46 offen offset:2048 lds
    v_cvt_pk_bf16_f32 v59, v54, v55
    v_mfma_f32_16x16x32_bf16 v[32:35], a[16:19], v[136:139], v[32:35]
    ds_read_b128 v[136:139], v16 offset:45056
    v_permlane16_swap_b32 v56, v58
    v_mfma_f32_16x16x32_bf16 v[32:35], a[24:27], v[140:143], v[32:35]
    ds_read_b64_tr_b16 v[214:215], v5 offset:33280
    v_permlane16_swap_b32 v57, v59
    buffer_store_dwordx4 v[56:59], v21, s[16:19], s88 offen sc1
    s_waitcnt lgkmcnt(8)
    v_mfma_f32_16x16x32_bf16 v[32:35], a[32:35], v[112:115], v[32:35]
    ds_read_b128 v[140:143], v17 offset:45056
    v_mfma_f32_16x16x32_bf16 v[32:35], a[40:43], v[116:119], v[32:35]
    buffer_load_dwordx4 v235, s[20:23], s46 offen offset:3072 lds
    v_mfma_f32_16x16x32_bf16 v[40:43], a[36:39], v[112:115], v[40:43]
    ds_read_b128 v[112:115], v16 offset:34816
    s_add_u32 m0, s45, 16384
    v_mfma_f32_16x16x32_bf16 v[40:43], a[44:47], v[116:119], v[40:43]
    ds_read_b64_tr_b16 v[216:217], v6 offset:32768
    s_waitcnt lgkmcnt(8)
    v_mfma_f32_16x16x32_bf16 v[40:43], a[52:55], v[120:123], v[40:43]
    ds_read_b128 v[116:119], v17 offset:34816
    v_mfma_f32_16x16x32_bf16 v[40:43], a[60:63], v[124:127], v[40:43]
    buffer_load_dwordx4 v232, s[20:23], s47 offen offset:0 lds
    v_mfma_f32_16x16x32_bf16 v[32:35], a[48:51], v[120:123], v[32:35]
    ds_read_b128 v[120:123], v16 offset:38912
    v_mfma_f32_16x16x32_bf16 v[32:35], a[56:59], v[124:127], v[32:35]
    ds_read_b64_tr_b16 v[218:219], v6 offset:33280
    s_waitcnt lgkmcnt(8)
    v_mfma_f32_16x16x32_bf16 v[32:35], a[64:67], v[128:131], v[32:35]
    ds_read_b128 v[124:127], v17 offset:38912
    v_mfma_f32_16x16x32_bf16 v[32:35], a[72:75], v[132:135], v[32:35]
    buffer_load_dwordx4 v233, s[20:23], s47 offen offset:1024 lds
    v_mfma_f32_16x16x32_bf16 v[40:43], a[68:71], v[128:131], v[40:43]
    ds_read_b128 v[128:131], v16 offset:43008
    v_mfma_f32_16x16x32_bf16 v[40:43], a[76:79], v[132:135], v[40:43]
    ds_read_b64_tr_b16 v[220:221], v7 offset:32768
    s_waitcnt lgkmcnt(8)
    v_mfma_f32_16x16x32_bf16 v[40:43], a[84:87], v[136:139], v[40:43]
    ds_read_b128 v[132:135], v17 offset:43008
    v_mfma_f32_16x16x32_bf16 v[40:43], a[92:95], v[140:143], v[40:43]
    buffer_load_dwordx4 v234, s[20:23], s47 offen offset:2048 lds
    v_mfma_f32_16x16x32_bf16 v[32:35], a[80:83], v[136:139], v[32:35]
    ds_read_b128 v[136:139], v16 offset:47104
    v_mfma_f32_16x16x32_bf16 v[32:35], a[88:91], v[140:143], v[32:35]
    ds_read_b64_tr_b16 v[222:223], v7 offset:33280
    s_waitcnt lgkmcnt(8)
    v_mfma_f32_16x16x32_bf16 v[36:39], a[32:35], v[112:115], v[36:39]
    s_waitcnt lgkmcnt(0)
    s_xor_b64 s[74:75], s[74:75], s[50:51]
    s_xor_b64 s[76:77], s[76:77], s[50:51]
    s_xor_b64 s[78:79], s[78:79], s[50:51]
    s_xor_b64 s[80:81], s[80:81], s[50:51]
    s_xor_b64 s[82:83], s[82:83], s[50:51]
    s_or_b64 s[74:75], s[74:75], s[76:77]
    s_or_b64 s[74:75], s[74:75], s[78:79]
    s_or_b64 s[74:75], s[74:75], s[80:81]
    s_or_b64 s[74:75], s[74:75], s[82:83]
    s_cbranch_scc1 L_slow_n1c0
L_ok_n1c0:
    ds_read_b128 v[140:143], v17 offset:47104
    v_mfma_f32_16x16x32_bf16 v[36:39], a[40:43], v[116:119], v[36:39]
    buffer_load_dwordx4 v235, s[20:23], s47 offen offset:3072 lds
    v_mfma_f32_16x16x32_bf16 v[44:47], a[36:39], v[112:115], v[44:47]
    s_waitcnt vmcnt(9)
    s_barrier
    ds_read_b128 v[112:115], v16 offset:51200
    v_mfma_f32_16x16x32_bf16 v[44:47], a[44:47], v[116:119], v[44:47]
    ds_read_b64_tr_b16 v[64:65], v4 offset:49152
    v_mfma_f32_16x16x32_bf16 v[44:47], a[52:55], v[120:123], v[44:47]
    ds_read_b128 v[116:119], v17 offset:51200
    v_mfma_f32_16x16x32_bf16 v[44:47], a[60:63], v[124:127], v[44:47]
    buffer_load_dwordx4 v[224:227], v30, s[16:19], s41 offen offset:0 sc1
    v_mfma_f32_16x16x32_bf16 v[36:39], a[48:51], v[120:123], v[36:39]
    ds_read_b128 v[120:123], v16 offset:55296
    v_mfma_f32_16x16x32_bf16 v[36:39], a[56:59], v[124:127], v[36:39]
    ds_read_b64_tr_b16 v[66:67], v4 offset:49664
    v_mfma_f32_16x16x32_bf16 v[36:39], a[64:67], v[128:131], v[36:39]
    ds_read_b128 v[124:127], v17 offset:55296
    v_mfma_f32_16x16x32_bf16 v[36:39], a[72:75], v[132:135], v[36:39]
    buffer_load_dwordx4 v[228:231], v30, s[16:19], s42 offen offset:0 sc1
    v_mfma_f32_16x16x32_bf16 v[44:47], a[68:71], v[128:131], v[44:47]
    ds_read_b128 v[128:131], v16 offset:59392
    v_mfma_f32_16x16x32_bf16 v[44:47], a[76:79], v[132:135], v[44:47]
    ds_read_b64_tr_b16 v[68:69], v5 offset:49152
    s_waitcnt lgkmcnt(8)
    v_mfma_f32_16x16x32_bf16 v[44:47], a[84:87], v[136:139], v[44:47]
    ds_read_b128 v[132:135], v17 offset:59392
    v_mfma_f32_16x16x32_bf16 v[44:47], a[92:95], v[140:143], v[44:47]
    buffer_load_dwordx4 v[232:235], v30, s[16:19], s41 offen offset:1024 sc1
    v_mfma_f32_16x16x32_bf16 v[36:39], a[80:83], v[136:139], v[36:39]
    ds_read_b128 v[136:139], v16 offset:63488
    v_mfma_f32_16x16x32_bf16 v[36:39], a[88:91], v[140:143], v[36:39]
    ds_read_b64_tr_b16 v[70:71], v5 offset:49664
    s_waitcnt lgkmcnt(8)
    v_mfma_f32_16x16x32_bf16 v[36:39], a[96:99], v[112:115], v[36:39]
    ds_read_b128 v[140:143], v17 offset:63488
    v_mfma_f32_16x16x32_bf16 v[36:39], a[104:107], v[116:119], v[36:39]
    buffer_load_dwordx4 v[236:239], v30, s[16:19], s42 offen offset:1024 sc1
    v_mfma_f32_16x16x32_bf16 v[44:47], a[100:103], v[112:115], v[44:47]
    ds_read_b128 v[112:115], v16 offset:49152
    v_mfma_f32_16x16x32_bf16 v[44:47], a[108:111], v[116:119], v[44:47]
    ds_read_b64_tr_b16 v[72:73], v6 offset:49152
    s_waitcnt lgkmcnt(8)
    v_mfma_f32_16x16x32_bf16 v[44:47], a[116:119], v[120:123], v[44:47]
    ds_read_b128 v[116:119], v17 offset:49152
    v_mfma_f32_16x16x32_bf16 v[44:47], a[124:127], v[124:127], v[44:47]
    buffer_load_dwordx4 v[240:243], v30, s[16:19], s41 offen offset:2048 sc1
    v_mfma_f32_16x16x32_bf16 v[36:39], a[112:115], v[120:123], v[36:39]
    ds_read_b128 v[120:123], v16 offset:53248
    v_mfma_f32_16x16x32_bf16 v[36:39], a[120:123], v[124:127], v[36:39]
    ds_read_b64_tr_b16 v[74:75], v6 offset:49664
    s_waitcnt lgkmcnt(8)
    v_mfma_f32_16x16x32_bf16 v[36:39], a[128:131], v[128:131], v[36:39]
    ds_read_b128 v[124:127], v17 offset:53248
    v_mfma_f32_16x16x32_bf16 v[36:39], a[136:139], v[132:135], v[36:39]
    buffer_load_dwordx4 v[244:247], v30, s[16:19], s42 offen offset:2048 sc1
    v_mfma_f32_16x16x32_bf16 v[44:47], a[132:135], v[128:131], v[44:47]
    ds_read_b128 v[128:131], v16 offset:57344
    v_mfma_f32_16x16x32_bf16 v[44:47], a[140:143], v[132:135], v[44:47]
    ds_read_b64_tr_b16 v[76:77], v7 offset:49152
    s_waitcnt lgkmcnt(8)
    v_mfma_f32_16x16x32_bf16 v[44:47], a[148:151], v[136:139], v[44:47]
    ds_read_b128 v[132:135], v17 offset:57344
    v_mfma_f32_16x16x32_bf16 v[44:47], a[156:159], v[140:143], v[44:47]
    buffer_load_dwordx4 a[0:3], v30, s[16:19], s41 offen offset:3072 sc1
    v_mfma_f32_16x16x32_bf16 v[36:39], a[144:147], v[136:139], v[36:39]
    ds_read_b128 v[136:139], v16 offset:61440
    v_mfma_f32_16x16x32_bf16 v[36:39], a[152:155], v[140:143], v[36:39]
    ds_read_b64_tr_b16 v[78:79], v7 offset:49664
    s_waitcnt lgkmcnt(8)
    v_mfma_f32_16x16x32_bf16 v[32:35], a[96:99], v[112:115], v[32:35]
    ds_read_b128 v[140:143], v17 offset:61440
    v_mfma_f32_16x16x32_bf16 v[32:35], a[104:107], v[116:119], v[32:35]
    buffer_load_dwordx4 a[4:7], v30, s[16:19], s42 offen offset:3072 sc1
    v_mfma_f32_16x16x32_bf16 v[40:43], a[100:103], v[112:115], v[40:43]
    s_waitcnt vmcnt(12)
    v_mfma_f32_16x16x32_bf16 v[40:43], a[108:111], v[116:119], v[40:43]
    ds_read_b64_tr_b16 v[80:81], v4 offset:0
    s_waitcnt lgkmcnt(7)
    v_mfma_f32_16x16x32_bf16 v[40:43], a[116:119], v[120:123], v[40:43]
    v_mfma_f32_16x16x32_bf16 v[40:43], a[124:127], v[124:127], v[40:43]
    ds_read_b64_tr_b16 v[82:83], v4 offset:512
    buffer_load_dwordx4 a[8:11], v31, s[16:19], s41 offen offset:0 sc1
    v_mfma_f32_16x16x32_bf16 v[32:35], a[112:115], v[120:123], v[32:35]
    v_mfma_f32_16x16x32_bf16 v[32:35], a[120:123], v[124:127], v[32:35]
    ds_read_b64_tr_b16 v[84:85], v5 offset:0
    s_waitcnt lgkmcnt(6)
    v_mfma_f32_16x16x32_bf16 v[32:35], a[128:131], v[128:131], v[32:35]
    v_mfma_f32_16x16x32_bf16 v[32:35], a[136:139], v[132:135], v[32:35]
    ds_read_b64_tr_b16 v[86:87], v5 offset:512
    buffer_load_dwordx4 a[12:15], v31, s[16:19], s42 offen offset:0 sc1
    v_mfma_f32_16x16x32_bf16 v[40:43], a[132:135], v[128:131], v[40:43]
    v_mfma_f32_16x16x32_bf16 v[40:43], a[140:143], v[132:135], v[40:43]
    ds_read_b64_tr_b16 v[88:89], v6 offset:0
    s_waitcnt lgkmcnt(5)
    v_mfma_f32_16x16x32_bf16 v[40:43], a[148:151], v[136:139], v[40:43]
    v_mfma_f32_16x16x32_bf16 v[40:43], a[156:159], v[140:143], v[40:43]
    ds_read_b64_tr_b16 v[90:91], v6 offset:512
    v_mfma_f32_16x16x32_bf16 v[32:35], a[144:147], v[136:139], v[32:35]
    v_mfma_f32_16x16x32_bf16 v[32:35], a[152:155], v[140:143], v[32:35]
    ds_read_b64_tr_b16 v[92:93], v7 offset:0
    ds_read_b64_tr_b16 v[94:95], v7 offset:512
    s_waitcnt vmcnt(8)
    v_mfma_f32_16x16x32_bf16 a[40:43], a[224:227], v[224:227], 0
    s_barrier
    s_cmp_lg_u32 s36, 0
    s_cbranch_scc1 L_pub_n12
    s_atomic_swap s50, s[64:65], 256
L_pub_n12:
    v_mfma_f32_16x16x32_bf16 a[40:43], a[240:243], v[228:231], a[40:43]
    buffer_load_dwordx4 a[16:19], v30, s[16:19], s49 offen offset:0 sc1
    v_mfma_f32_16x16x32_bf16 a[44:47], a[228:231], v[224:227], 0
    v_readlane_b32 s89, v24, 7
    v_mul_f32 v32, v32, v40
    v_mfma_f32_16x16x32_bf16 a[44:47], a[244:247], v[228:231], a[44:47]
    v_mul_f32 v33, v33, v41
    v_mul_f32 v34, v34, v42
    v_mfma_f32_16x16x32_bf16 a[48:51], a[232:235], v[224:227], 0
    v_mul_f32 v35, v35, v43
    v_mul_f32 v36, v36, v44
    v_mfma_f32_16x16x32_bf16 a[48:51], a[248:251], v[228:231], a[48:51]
    buffer_load_dwordx4 a[20:23], v30, s[16:19], s37 offen offset:0 sc1
    v_mfma_f32_16x16x32_bf16 a[52:55], a[236:239], v[224:227], 0
    v_mul_f32 v37, v37, v45
    v_mul_f32 v38, v38, v46
    v_mfma_f32_16x16x32_bf16 a[52:55], a[252:255], v[228:231], a[52:55]
    v_mul_f32 v39, v39, v47
    v_cvt_pk_bf16_f32 v40, v32, v33
    s_waitcnt vmcnt(8)
    v_mfma_f32_16x16x32_bf16 a[56:59], a[224:227], v[232:235], 0
    v_cvt_pk_bf16_f32 v42, v36, v37
    v_cvt_pk_bf16_f32 v41, v34, v35
    v_mfma_f32_16x16x32_bf16 a[56:59], a[240:243], v[236:239], a[56:59]
    buffer_load_dwordx4 a[24:27], v30, s[16:19], s49 offen offset:1024 sc1
    v_mfma_f32_16x16x32_bf16 a[60:63], a[228:231], v[232:235], 0
    v_cvt_pk_bf16_f32 v43, v38, v39
    s_nop 1
    v_permlane16_swap_b32 v40, v42
    v_mfma_f32_16x16x32_bf16 a[60:63], a[244:247], v[236:239], a[60:63]
    v_permlane16_swap_b32 v41, v43
    buffer_store_dwordx4 v[40:43], v21, s[16:19], s89 offen sc1
    v_mfma_f32_16x16x32_bf16 a[64:67], a[232:235], v[232:235], 0
    v_mfma_f32_16x16x32_bf16 a[64:67], a[248:251], v[236:239], a[64:67]
    buffer_load_dwordx4 a[28:31], v30, s[16:19], s37 offen offset:1024 sc1
    v_mfma_f32_16x16x32_bf16 a[68:71], a[236:239], v[232:235], 0
    v_mfma_f32_16x16x32_bf16 a[68:71], a[252:255], v[236:239], a[68:71]
    ds_read_b64_tr_b16 v[96:97], v4 offset:16384
    s_waitcnt vmcnt(9)
    v_mfma_f32_16x16x32_bf16 a[72:75], a[224:227], v[240:243], 0
    ds_read_b64_tr_b16 v[98:99], v4 offset:16896
    v_mfma_f32_16x16x32_bf16 a[72:75], a[240:243], v[244:247], a[72:75]
    buffer_load_dwordx4 a[32:35], v30, s[16:19], s49 offen offset:2048 sc1
    v_mfma_f32_16x16x32_bf16 a[76:79], a[228:231], v[240:243], 0
    v_mfma_f32_16x16x32_bf16 a[76:79], a[244:247], v[244:247], a[76:79]
    ds_read_b64_tr_b16 v[100:101], v5 offset:16384
    v_mfma_f32_16x16x32_bf16 a[80:83], a[232:235], v[240:243], 0
    ds_read_b64_tr_b16 v[102:103], v5 offset:16896
    v_mfma_f32_16x16x32_bf16 a[80:83], a[248:251], v[244:247], a[80:83]
    buffer_load_dwordx4 v[224:227], v30, s[16:19], s37 offen offset:2048 sc1
    v_mfma_f32_16x16x32_bf16 a[84:87], a[236:239], v[240:243], 0
    v_mfma_f32_16x16x32_bf16 a[84:87], a[252:255], v[244:247], a[84:87]
    ds_read_b64_tr_b16 v[104:105], v6 offset:16384
    s_waitcnt vmcnt(9)
    v_mfma_f32_16x16x32_bf16 a[88:91], a[224:227], a[0:3], 0
    ds_read_b64_tr_b16 v[106:107], v6 offset:16896
    v_mfma_f32_16x16x32_bf16 a[88:91], a[240:243], a[4:7], a[88:91]
    buffer_load_dwordx4 v[228:231], v30, s[16:19], s49 offen offset:3072 sc1
    v_mfma_f32_16x16x32_bf16 a[92:95], a[228:231], a[0:3], 0
    v_mfma_f32_16x16x32_bf16 a[92:95], a[244:247], a[4:7], a[92:95]
    ds_read_b64_tr_b16 v[108:109], v7 offset:16384
    v_mfma_f32_16x16x32_bf16 a[96:99], a[232:235], a[0:3], 0
    ds_read_b64_tr_b16 v[110:111], v7 offset:16896
    v_mfma_f32_16x16x32_bf16 a[96:99], a[248:251], a[4:7], a[96:99]
    buffer_load_dwordx4 v[232:235], v30, s[16:19], s57 offen offset:3072 sc1
    v_mfma_f32_16x16x32_bf16 a[100:103], a[236:239], a[0:3], 0
    v_mfma_f32_16x16x32_bf16 a[100:103], a[252:255], a[4:7], a[100:103]
    s_waitcnt vmcnt(9)
    v_mfma_f32_16x16x32_bf16 a[104:107], a[224:227], a[8:11], 0
    v_mfma_f32_16x16x32_bf16 a[104:107], a[240:243], a[12:15], a[104:107]
    buffer_load_dwordx4 v[236:239], v31, s[16:19], s49 offen offset:0 sc1
    v_mfma_f32_16x16x32_bf16 a[108:111], a[228:231], a[8:11], 0
    v_mfma_f32_16x16x32_bf16 a[108:111], a[244:247], a[12:15], a[108:111]
    v_mfma_f32_16x16x32_bf16 a[112:115], a[232:235], a[8:11], 0
    v_mfma_f32_16x16x32_bf16 a[112:115], a[248:251], a[12:15], a[112:115]
    buffer_load_dwordx4 v[240:243], v31, s[16:19], s57 offen offset:0 sc1
    v_mfma_f32_16x16x32_bf16 a[116:119], a[236:239], a[8:11], 0
    v_mfma_f32_16x16x32_bf16 a[116:119], a[252:255], a[12:15], a[116:119]
    s_waitcnt vmcnt(9)
    v_mfma_f32_16x16x32_bf16 a[40:43], v[144:147], a[16:19], a[40:43]
    v_mfma_f32_16x16x32_bf16 a[40:43], a[160:163], a[20:23], a[40:43]
    buffer_load_dwordx4 v[244:247], v30, s[16:19], s38 offen offset:0 sc1
    v_mfma_f32_16x16x32_bf16 a[44:47], v[148:151], a[16:19], a[44:47]
    v_mfma_f32_16x16x32_bf16 a[44:47], a[164:167], a[20:23], a[44:47]
    v_mfma_f32_16x16x32_bf16 a[48:51], v[152:155], a[16:19], a[48:51]
    s_load_dword s74, s[70:71], 14208
    s_load_dword s75, s[70:71], 15488
    v_mfma_f32_16x16x32_bf16 a[48:51], a[168:171], a[20:23], a[48:51]
    buffer_load_dwordx4 a[0:3], v30, s[16:19], s39 offen offset:0 sc1
    v_mfma_f32_16x16x32_bf16 a[52:55], v[156:159], a[16:19], a[52:55]
    s_load_dword s76, s[70:71], 128
    v_mfma_f32_16x16x32_bf16 a[52:55], a[172:175], a[20:23], a[52:55]
    s_load_dword s77, s[70:71], 1408
    s_waitcnt vmcnt(8)
    v_mfma_f32_16x16x32_bf16 a[56:59], v[144:147], a[24:27], a[56:59]
    s_load_dword s78, s[70:71], 2688
    s_load_dword s79, s[70:71], 3968
    s_waitcnt lgkmcnt(0)
    s_barrier
    s_cmp_lg_u32 s36, 0
    s_cbranch_scc1 L_pub_n13
    s_atomic_swap s50, s[64:65], 384
L_pub_n13:
    v_mfma_f32_16x16x32_bf16 a[56:59], a[160:163], a[28:31], a[56:59]
    buffer_load_dwordx4 a[4:7], v30, s[16:19], s38 offen offset:1024 sc1
    v_mfma_f32_16x16x32_bf16 a[60:63], v[148:151], a[24:27], a[60:63]
    s_load_dword s80, s[72:73], 16768
    v_mfma_f32_16x16x32_bf16 a[60:63], a[164:167], a[28:31], a[60:63]
    s_load_dword s81, s[72:73], 16768
    v_mfma_f32_16x16x32_bf16 a[64:67], v[152:155], a[24:27], a[64:67]
    v_mfma_f32_16x16x32_bf16 a[64:67], a[168:171], a[28:31], a[64:67]
    buffer_load_dwordx4 a[8:11], v30, s[16:19], s39 offen offset:1024 sc1
    v_mfma_f32_16x16x32_bf16 a[68:71], v[156:159], a[24:27], a[68:71]
    v_mfma_f32_16x16x32_bf16 a[68:71], a[172:175], a[28:31], a[68:71]
    s_waitcnt vmcnt(8)
    v_mfma_f32_16x16x32_bf16 a[72:75], v[144:147], a[32:35], a[72:75]
    v_mfma_f32_16x16x32_bf16 a[72:75], a[160:163], v[224:227], a[72:75]
    buffer_load_dwordx4 a[12:15], v30, s[16:19], s38 offen offset:2048 sc1
    v_mfma_f32_16x16x32_bf16 a[76:79], v[148:151], a[32:35], a[76:79]
    v_mfma_f32_16x16x32_bf16 a[76:79], a[164:167], v[224:227], a[76:79]
    v_mfma_f32_16x16x32_bf16 a[80:83], v[152:155], a[32:35], a[80:83]
    v_and_b32 v1, 15, v0
    v_mfma_f32_16x16x32_bf16 a[80:83], a[168:171], v[224:227], a[80:83]
    buffer_load_dwordx4 a[16:19], v30, s[16:19], s39 offen offset:2048 sc1
    v_mfma_f32_16x16x32_bf16 a[84:87], v[156:159], a[32:35], a[84:87]
    v_lshrrev_b32 v2, 4, v0
    v_mfma_f32_16x16x32_bf16 a[84:87], a[172:175], v[224:227], a[84:87]
    v_and_b32 v3, 7, v0
    s_waitcnt vmcnt(8)
    v_mfma_f32_16x16x32_bf16 a[88:91], v[144:147], v[228:231], a[88:91]
    v_xor_b32 v2, v2, v3
    v_mfma_f32_16x16x32_bf16 a[88:91], v[160:163], v[232:235], a[88:91]
    buffer_load_dwordx4 a[20:23], v30, s[16:19], s40 offen offset:0 sc1
    v_mfma_f32_16x16x32_bf16 a[92:95], v[148:151], v[228:231], a[92:95]
    v_lshlrev_b32 v2, 4, v2
    v_mfma_f32_16x16x32_bf16 a[92:95], v[164:167], v[232:235], a[92:95]
    v_lshl_add_u32 v1, v1, 8, v2
    v_mfma_f32_16x16x32_bf16 a[96:99], v[152:155], v[228:231], a[96:99]
    v_add_u32 v16, s43, v1
    v_mfma_f32_16x16x32_bf16 a[96:99], v[168:171], v[232:235], a[96:99]
    buffer_load_dwordx4 a[24:27], v30, s[16:19], s40 offen offset:1024 sc1
    v_mfma_f32_16x16x32_bf16 a[100:103], v[156:159], v[228:231], a[100:103]
    v_xor_b32 v17, 64, v16
    v_mfma_f32_16x16x32_bf16 a[100:103], v[172:175], v[232:235], a[100:103]
    v_lshrrev_b32 v1, 3, v0
    s_waitcnt vmcnt(8)
    v_mfma_f32_16x16x32_bf16 a[104:107], v[144:147], v[236:239], a[104:107]
    v_lshlrev_b32 v2, 1, v3
    v_mfma_f32_16x16x32_bf16 a[104:107], v[160:163], v[240:243], a[104:107]
    buffer_load_dwordx4 a[28:31], v30, s[16:19], s40 offen offset:2048 sc1
    v_mfma_f32_16x16x32_bf16 a[108:111], v[148:151], v[236:239], a[108:111]
    v_xor_b32 v2, v2, v1
    v_mfma_f32_16x16x32_bf16 a[108:111], v[164:167], v[240:243], a[108:111]
    v_lshlrev_b32 v2, 4, v2
    v_mfma_f32_16x16x32_bf16 a[112:115], v[152:155], v[236:239], a[112:115]
    s_lshl_b32 s61, s36, 3
    v_mfma_f32_16x16x32_bf16 a[112:115], v[168:171], v[240:243], a[112:115]
    buffer_load_dwordx4 a[32:35], v30, s[16:19], s58 offen offset:3072 sc1
    v_mfma_f32_16x16x32_bf16 a[116:119], v[156:159], v[236:239], a[116:119]
    v_add_u32 v1, s61, v1
    v_mfma_f32_16x16x32_bf16 a[116:119], v[172:175], v[240:243], a[116:119]
    v_lshl_add_u32 v8, v1, 8, v2
    s_waitcnt vmcnt(8)
    v_mfma_f32_16x16x32_bf16 a[40:43], a[176:179], v[244:247], a[40:43]
    s_waitcnt lgkmcnt(0)
    v_mfma_f32_16x16x32_bf16 a[40:43], a[192:195], a[0:3], a[40:43]
    buffer_load_dwordx4 v[224:227], v30, s[16:19], s59 offen offset:3072 sc1
    v_mfma_f32_16x16x32_bf16 a[44:47], a[180:183], v[244:247], a[44:47]
    s_xor_b64 s[74:75], s[74:75], s[50:51]
    v_mfma_f32_16x16x32_bf16 a[44:47], a[196:199], a[0:3], a[44:47]
    s_xor_b64 s[76:77], s[76:77], s[50:51]
    v_mfma_f32_16x16x32_bf16 a[48:51], a[184:187], v[244:247], a[48:51]
    s_xor_b64 s[78:79], s[78:79], s[50:51]
    v_mfma_f32_16x16x32_bf16 a[48:51], a[200:203], a[0:3], a[48:51]
    buffer_load_dwordx4 v[228:231], v31, s[16:19], s58 offen offset:0 sc1
    v_mfma_f32_16x16x32_bf16 a[52:55], a[188:191], v[244:247], a[52:55]
    s_xor_b64 s[80:81], s[80:81], s[50:51]
    v_mfma_f32_16x16x32_bf16 a[52:55], a[204:207], a[0:3], a[52:55]
    s_or_b64 s[74:75], s[74:75], s[76:77]
    s_waitcnt vmcnt(8)
    v_mfma_f32_16x16x32_bf16 a[56:59], a[176:179], a[4:7], a[56:59]
    s_or_b64 s[74:75], s[74:75], s[78:79]
    v_mfma_f32_16x16x32_bf16 a[56:59], a[192:195], a[8:11], a[56:59]
    buffer_load_dwordx4 v[232:235], v31, s[16:19], s59 offen offset:0 sc1
    v_mfma_f32_16x16x32_bf16 a[60:63], a[180:183], a[4:7], a[60:63]
    s_or_b64 s[74:75], s[74:75], s[80:81]
    s_cbranch_scc1 L_slow_n1c1
L_ok_n1c1:
    v_mfma_f32_16x16x32_bf16 a[60:63], a[196:199], a[8:11], a[60:63]
    v_mfma_f32_16x16x32_bf16 a[64:67], a[184:187], a[4:7], a[64:67]
    v_xor_b32 v9, 16, v8
    v_mfma_f32_16x16x32_bf16 a[64:67], a[200:203], a[8:11], a[64:67]
    buffer_load_dwordx4 v[236:239], v30, s[16:19], s67 offen offset:0 sc1
    v_mfma_f32_16x16x32_bf16 a[68:71], a[188:191], a[4:7], a[68:71]
    v_add_u32 v10, 40960, v8
    v_mfma_f32_16x16x32_bf16 a[68:71], a[204:207], a[8:11], a[68:71]
    v_add_u32 v11, 40960, v9
    s_waitcnt vmcnt(8)
    v_mfma_f32_16x16x32_bf16 a[72:75], a[176:179], a[12:15], a[72:75]
    v_mul_u32_u24 v1, 1280, v1
    v_mfma_f32_16x16x32_bf16 a[72:75], a[192:195], a[16:19], a[72:75]
    buffer_load_dwordx4 v[240:243], v30, s[16:19], s68 offen offset:0 sc1
    v_mfma_f32_16x16x32_bf16 a[76:79], a[180:183], a[12:15], a[76:79]
    v_lshl_add_u32 v18, v3, 4, v1
    v_mfma_f32_16x16x32_bf16 a[76:79], a[196:199], a[16:19], a[76:79]
    s_lshl_b32 s61, s36, 2
    v_mfma_f32_16x16x32_bf16 a[80:83], a[184:187], a[12:15], a[80:83]
    v_lshrrev_b32 v1, 4, v0
    v_mfma_f32_16x16x32_bf16 a[80:83], a[200:203], a[16:19], a[80:83]
    buffer_load_dwordx4 v[244:247], v30, s[16:19], s67 offen offset:1024 sc1
    v_mfma_f32_16x16x32_bf16 a[84:87], a[188:191], a[12:15], a[84:87]
    v_add_u32 v1, s61, v1
    v_mfma_f32_16x16x32_bf16 a[84:87], a[204:207], a[16:19], a[84:87]
    v_and_b32 v2, 15, v0
    s_waitcnt vmcnt(9)
    v_mfma_f32_16x16x32_bf16 a[40:43], a[208:211], a[20:23], a[40:43]
    v_and_b32 v3, 7, v1
    v_mfma_f32_16x16x32_bf16 a[44:47], a[212:215], a[20:23], a[44:47]
    buffer_load_dwordx4 a[0:3], v30, s[16:19], s68 offen offset:1024 sc1
    v_mfma_f32_16x16x32_bf16 a[48:51], a[216:219], a[20:23], a[48:51]
    v_xor_b32 v3, v3, v2
    v_mfma_f32_16x16x32_bf16 a[52:55], a[220:223], a[20:23], a[52:55]
    v_lshlrev_b32 v3, 4, v3
    s_waitcnt vmcnt(9)
    v_mfma_f32_16x16x32_bf16 a[56:59], a[208:211], a[24:27], a[56:59]
    s_load_dword s74, s[70:71], 13056
    s_load_dword s75, s[70:71], 9216
    v_mfma_f32_16x16x32_bf16 a[60:63], a[212:215], a[24:27], a[60:63]
    buffer_load_dwordx4 a[4:7], v30, s[16:19], s67 offen offset:2048 sc1
    v_mfma_f32_16x16x32_bf16 a[64:67], a[216:219], a[24:27], a[64:67]
    s_load_dword s76, s[70:71], 10496
    v_mfma_f32_16x16x32_bf16 a[68:71], a[220:223], a[24:27], a[68:71]
    s_load_dword s77, s[70:71], 11776
    s_waitcnt vmcnt(9)
    v_mfma_f32_16x16x32_bf16 a[72:75], a[208:211], a[28:31], a[72:75]
    s_load_dword s78, s[70:71], 14336
    s_load_dword s79, s[70:71], 15616
    v_mfma_f32_16x16x32_bf16 a[76:79], a[212:215], a[28:31], a[76:79]
    buffer_load_dwordx4 a[8:11], v30, s[16:19], s68 offen offset:2048 sc1
    v_mfma_f32_16x16x32_bf16 a[80:83], a[216:219], a[28:31], a[80:83]
    s_load_dword s80, s[72:73], 16896
    v_mfma_f32_16x16x32_bf16 a[84:87], a[220:223], a[28:31], a[84:87]
    s_load_dword s81, s[72:73], 16896
    s_waitcnt vmcnt(8)
    v_mfma_f32_16x16x32_bf16 a[88:91], v[176:179], a[32:35], a[88:91]
    v_lshl_add_u32 v12, v1, 8, v3
    v_mfma_f32_16x16x32_bf16 a[88:91], v[192:195], v[224:227], a[88:91]
    buffer_load_dwordx4 a[12:15], v30, s[16:19], s37 offen offset:3072 sc1
    v_mfma_f32_16x16x32_bf16 a[92:95], v[180:183], a[32:35], a[92:95]
    v_add_u32 v13, 40960, v12
    v_mfma_f32_16x16x32_bf16 a[92:95], v[196:199], v[224:227], a[92:95]
    v_mul_u32_u24 v1, 1280, v1
    v_mfma_f32_16x16x32_bf16 a[96:99], v[184:187], a[32:35], a[96:99]
    v_lshl_add_u32 v19, v2, 3, v1
    v_mfma_f32_16x16x32_bf16 a[96:99], v[200:203], v[224:227], a[96:99]
    buffer_load_dwordx4 a[16:19], v30, s[16:19], s38 offen offset:3072 sc1
    v_mfma_f32_16x16x32_bf16 a[100:103], v[188:191], a[32:35], a[100:103]
    v_mfma_f32_16x16x32_bf16 a[100:103], v[204:207], v[224:227], a[100:103]
    s_waitcnt vmcnt(8)
    v_mfma_f32_16x16x32_bf16 a[104:107], v[176:179], v[228:231], a[104:107]
    v_mfma_f32_16x16x32_bf16 a[104:107], v[192:195], v[232:235], a[104:107]
    buffer_load_dwordx4 a[20:23], v31, s[16:19], s37 offen offset:0 sc1
    v_mfma_f32_16x16x32_bf16 a[108:111], v[180:183], v[228:231], a[108:111]
    v_mfma_f32_16x16x32_bf16 a[108:111], v[196:199], v[232:235], a[108:111]
    v_mfma_f32_16x16x32_bf16 a[112:115], v[184:187], v[228:231], a[112:115]
L_tv1_1:
    s_cbranch_execz L_base
    v_mfma_f32_16x16x32_bf16 a[112:115], v[200:203], v[232:235], a[112:115]
    buffer_load_dwordx4 a[24:27], v31, s[16:19], s38 offen offset:0 sc1
    v_mfma_f32_16x16x32_bf16 a[116:119], v[188:191], v[228:231], a[116:119]
    v_mfma_f32_16x16x32_bf16 a[116:119], v[204:207], v[232:235], a[116:119]
    s_waitcnt vmcnt(8)
    v_mfma_f32_16x16x32_bf16 a[40:43], v[64:67], v[236:239], a[40:43]
    v_mfma_f32_16x16x32_bf16 a[40:43], v[80:83], v[240:243], a[40:43]
    buffer_load_dwordx4 a[28:31], v30, s[16:19], s39 offen offset:3072 sc1
    v_mfma_f32_16x16x32_bf16 a[44:47], v[68:71], v[236:239], a[44:47]
    v_mfma_f32_16x16x32_bf16 a[44:47], v[84:87], v[240:243], a[44:47]
    v_mfma_f32_16x16x32_bf16 a[48:51], v[72:75], v[236:239], a[48:51]
    v_mfma_f32_16x16x32_bf16 a[48:51], v[88:91], v[240:243], a[48:51]
    buffer_load_dwordx4 a[32:35], v30, s[16:19], s40 offen offset:3072 sc1
    v_mfma_f32_16x16x32_bf16 a[52:55], v[76:79], v[236:239], a[52:55]
    v_mfma_f32_16x16x32_bf16 a[52:55], v[92:95], v[240:243], a[52:55]
    s_waitcnt vmcnt(8)
    v_mfma_f32_16x16x32_bf16 a[56:59], v[64:67], v[244:247], a[56:59]
    v_mfma_f32_16x16x32_bf16 a[56:59], v[80:83], a[0:3], a[56:59]
    buffer_load_dwordx4 v[224:227], v31, s[16:19], s39 offen offset:0 sc1
    v_mfma_f32_16x16x32_bf16 a[60:63], v[68:71], v[244:247], a[60:63]
    v_mfma_f32_16x16x32_bf16 a[60:63], v[84:87], a[0:3], a[60:63]
    v_mfma_f32_16x16x32_bf16 a[64:67], v[72:75], v[244:247], a[64:67]
    s_waitcnt lgkmcnt(0)
    v_mfma_f32_16x16x32_bf16 a[64:67], v[88:91], a[0:3], a[64:67]
    buffer_load_dwordx4 v[228:231], v31, s[16:19], s40 offen offset:0 sc1
    v_mfma_f32_16x16x32_bf16 a[68:71], v[76:79], v[244:247], a[68:71]
    s_xor_b64 s[74:75], s[74:75], s[50:51]
    v_mfma_f32_16x16x32_bf16 a[68:71], v[92:95], a[0:3], a[68:71]
    s_xor_b64 s[76:77], s[76:77], s[50:51]
    s_waitcnt vmcnt(8)
    v_mfma_f32_16x16x32_bf16 a[72:75], v[64:67], a[4:7], a[72:75]
    s_xor_b64 s[78:79], s[78:79], s[50:51]
    v_mfma_f32_16x16x32_bf16 a[72:75], v[80:83], a[8:11], a[72:75]
    buffer_load_dwordx4 v[232:235], v30, s[16:19], s69 offen offset:1024 sc1
    v_mfma_f32_16x16x32_bf16 a[76:79], v[68:71], a[4:7], a[76:79]
    s_xor_b64 s[80:81], s[80:81], s[50:51]
    v_mfma_f32_16x16x32_bf16 a[76:79], v[84:87], a[8:11], a[76:79]
    s_or_b64 s[74:75], s[74:75], s[76:77]
    v_mfma_f32_16x16x32_bf16 a[80:83], v[72:75], a[4:7], a[80:83]
    s_or_b64 s[74:75], s[74:75], s[78:79]
    v_mfma_f32_16x16x32_bf16 a[80:83], v[88:91], a[8:11], a[80:83]
    buffer_load_dwordx4 v[236:239], v30, s[16:19], s69 offen offset:2048 sc1
    v_mfma_f32_16x16x32_bf16 a[84:87], v[76:79], a[4:7], a[84:87]
    s_or_b64 s[74:75], s[74:75], s[80:81]
    s_cbranch_scc1 L_slow_n1c2
L_ok_n1c2:
    v_mfma_f32_16x16x32_bf16 a[84:87], v[92:95], a[8:11], a[84:87]
    s_waitcnt vmcnt(8)
    v_mfma_f32_16x16x32_bf16 a[88:91], a[160:163], a[12:15], a[88:91]
    v_mfma_f32_16x16x32_bf16 a[88:91], a[176:179], a[16:19], a[88:91]
    buffer_load_dwordx4 v[240:243], v30, s[16:19], s66 offen offset:3072 sc1
    v_mfma_f32_16x16x32_bf16 a[92:95], a[164:167], a[12:15], a[92:95]
    v_mfma_f32_16x16x32_bf16 a[92:95], a[180:183], a[16:19], a[92:95]
    v_mfma_f32_16x16x32_bf16 a[96:99], a[168:171], a[12:15], a[96:99]
    v_mfma_f32_16x16x32_bf16 a[96:99], a[184:187], a[16:19], a[96:99]
    buffer_load_dwordx4 v[244:247], v31, s[16:19], s66 offen offset:0 sc1
    v_mfma_f32_16x16x32_bf16 a[100:103], a[172:175], a[12:15], a[100:103]
    v_mfma_f32_16x16x32_bf16 a[100:103], a[188:191], a[16:19], a[100:103]
    s_waitcnt vmcnt(8)
    v_mfma_f32_16x16x32_bf16 a[104:107], a[160:163], a[20:23], a[104:107]
    s_load_dword s74, s[70:71], 9344
    s_load_dword s75, s[70:71], 10624
    v_mfma_f32_16x16x32_bf16 a[104:107], a[176:179], a[24:27], a[104:107]
    buffer_load_dwordx4 a[0:3], v30, s[16:19], s57 offen offset:0 sc1
    v_mfma_f32_16x16x32_bf16 a[108:111], a[164:167], a[20:23], a[108:111]
    s_load_dword s76, s[70:71], 11904
    v_mfma_f32_16x16x32_bf16 a[108:111], a[180:183], a[24:27], a[108:111]
    s_load_dword s77, s[70:71], 13184
    v_mfma_f32_16x16x32_bf16 a[112:115], a[168:171], a[20:23], a[112:115]
    v_mfma_f32_16x16x32_bf16 a[112:115], a[184:187], a[24:27], a[112:115]
    buffer_load_dwordx4 a[4:7], v30, s[16:19], s58 offen offset:0 sc1
    v_mfma_f32_16x16x32_bf16 a[116:119], a[172:175], a[20:23], a[116:119]
    v_mfma_f32_16x16x32_bf16 a[116:119], a[188:191], a[24:27], a[116:119]
    s_waitcnt vmcnt(8)
    v_mfma_f32_16x16x32_bf16 a[88:91], a[192:195], a[28:31], a[88:91]
    v_mfma_f32_16x16x32_bf16 a[88:91], a[208:211], a[32:35], a[88:91]
    buffer_load_dwordx4 a[8:11], v30, s[16:19], s69 offen offset:0 sc1
    v_mfma_f32_16x16x32_bf16 a[92:95], a[196:199], a[28:31], a[92:95]
    v_mfma_f32_16x16x32_bf16 a[92:95], a[212:215], a[32:35], a[92:95]
    v_mfma_f32_16x16x32_bf16 a[96:99], a[200:203], a[28:31], a[96:99]
    v_mfma_f32_16x16x32_bf16 a[96:99], a[216:219], a[32:35], a[96:99]
    buffer_load_dwordx4 a[12:15], v30, s[16:19], s59 offen offset:0 sc1
    v_mfma_f32_16x16x32_bf16 a[100:103], a[204:207], a[28:31], a[100:103]
    v_mfma_f32_16x16x32_bf16 a[100:103], a[220:223], a[32:35], a[100:103]
    s_waitcnt vmcnt(8)
    v_mfma_f32_16x16x32_bf16 a[104:107], a[192:195], v[224:227], a[104:107]
    v_mfma_f32_16x16x32_bf16 a[104:107], a[208:211], v[228:231], a[104:107]
    buffer_load_dwordx4 a[16:19], v30, s[16:19], s66 offen offset:0 sc1
    v_mfma_f32_16x16x32_bf16 a[108:111], a[196:199], v[224:227], a[108:111]
    v_mfma_f32_16x16x32_bf16 a[108:111], a[212:215], v[228:231], a[108:111]
    v_mfma_f32_16x16x32_bf16 a[112:115], a[200:203], v[224:227], a[112:115]
    v_mfma_f32_16x16x32_bf16 a[112:115], a[216:219], v[228:231], a[112:115]
    buffer_load_dwordx4 a[20:23], v30, s[16:19], s67 offen offset:3072 sc1
    v_mfma_f32_16x16x32_bf16 a[116:119], a[204:207], v[224:227], a[116:119]
    v_mfma_f32_16x16x32_bf16 a[116:119], a[220:223], v[228:231], a[116:119]
    s_waitcnt vmcnt(9)
    v_mfma_f32_16x16x32_bf16 a[56:59], v[96:99], v[232:235], a[56:59]
    v_mfma_f32_16x16x32_bf16 a[60:63], v[100:103], v[232:235], a[60:63]
    buffer_load_dwordx4 a[24:27], v30, s[16:19], s68 offen offset:3072 sc1
    v_mfma_f32_16x16x32_bf16 a[64:67], v[104:107], v[232:235], a[64:67]
    v_mfma_f32_16x16x32_bf16 a[68:71], v[108:111], v[232:235], a[68:71]
    s_waitcnt vmcnt(9)
    v_mfma_f32_16x16x32_bf16 a[72:75], v[96:99], v[236:239], a[72:75]
    v_mfma_f32_16x16x32_bf16 a[76:79], v[100:103], v[236:239], a[76:79]
    buffer_load_dwordx4 a[28:31], v30, s[16:19], s69 offen offset:3072 sc1
    v_mfma_f32_16x16x32_bf16 a[80:83], v[104:107], v[236:239], a[80:83]
    v_mfma_f32_16x16x32_bf16 a[84:87], v[108:111], v[236:239], a[84:87]
    s_waitcnt vmcnt(9)
    v_mfma_f32_16x16x32_bf16 a[88:91], v[208:211], v[240:243], a[88:91]
    v_mfma_f32_16x16x32_bf16 a[92:95], v[212:215], v[240:243], a[92:95]
    buffer_load_dwordx4 a[32:35], v31, s[16:19], s67 offen offset:0 sc1
    v_mfma_f32_16x16x32_bf16 a[96:99], v[216:219], v[240:243], a[96:99]
    v_mfma_f32_16x16x32_bf16 a[100:103], v[220:223], v[240:243], a[100:103]
    s_waitcnt vmcnt(9)
    v_mfma_f32_16x16x32_bf16 a[104:107], v[208:211], v[244:247], a[104:107]
    s_waitcnt lgkmcnt(0)
    v_mfma_f32_16x16x32_bf16 a[108:111], v[212:215], v[244:247], a[108:111]
    buffer_load_dwordx4 v[224:227], v31, s[16:19], s68 offen offset:0 sc1
    v_mfma_f32_16x16x32_bf16 a[112:115], v[216:219], v[244:247], a[112:115]
    s_xor_b64 s[74:75], s[74:75], s[50:51]
    v_mfma_f32_16x16x32_bf16 a[116:119], v[220:223], v[244:247], a[116:119]
    s_xor_b64 s[76:77], s[76:77], s[50:51]
    s_waitcnt vmcnt(8)
    v_mfma_f32_16x16x32_bf16 a[40:43], v[160:163], a[0:3], a[40:43]
    s_or_b64 s[74:75], s[74:75], s[76:77]
    s_cbranch_scc1 L_slow_n1c3
L_ok_n1c3:
    v_mfma_f32_16x16x32_bf16 a[40:43], v[176:179], a[4:7], a[40:43]
    buffer_load_dwordx4 v[228:231], v31, s[16:19], s69 offen offset:0 sc1
    v_mfma_f32_16x16x32_bf16 a[44:47], v[164:167], a[0:3], a[44:47]
    v_mfma_f32_16x16x32_bf16 a[44:47], v[180:183], a[4:7], a[44:47]
    v_mfma_f32_16x16x32_bf16 a[48:51], v[168:171], a[0:3], a[48:51]
    v_mfma_f32_16x16x32_bf16 a[48:51], v[184:187], a[4:7], a[48:51]
    buffer_load_dwordx4 v[232:235], v30, s[16:19], s57 offen offset:1024 sc1
    v_mfma_f32_16x16x32_bf16 a[52:55], v[172:175], a[0:3], a[52:55]
    v_mfma_f32_16x16x32_bf16 a[52:55], v[188:191], a[4:7], a[52:55]
    s_waitcnt vmcnt(7)
    v_mfma_f32_16x16x32_bf16 a[40:43], v[96:99], a[8:11], a[40:43]
    v_mfma_f32_16x16x32_bf16 a[40:43], v[192:195], a[12:15], a[40:43]
    buffer_load_dwordx4 v[236:239], v30, s[16:19], s58 offen offset:1024 sc1
    v_mfma_f32_16x16x32_bf16 a[40:43], v[208:211], a[16:19], a[40:43]
    v_mfma_f32_16x16x32_bf16 a[44:47], v[100:103], a[8:11], a[44:47]
    v_mfma_f32_16x16x32_bf16 a[44:47], v[196:199], a[12:15], a[44:47]
    v_mfma_f32_16x16x32_bf16 a[44:47], v[212:215], a[16:19], a[44:47]
    buffer_load_dwordx4 v[240:243], v30, s[16:19], s59 offen offset:1024 sc1
    v_mfma_f32_16x16x32_bf16 a[48:51], v[104:107], a[8:11], a[48:51]
    v_mfma_f32_16x16x32_bf16 a[48:51], v[200:203], a[12:15], a[48:51]
    s_nop 2
    ds_write_b128 v16, a[40:43] offset:0
    v_mfma_f32_16x16x32_bf16 a[48:51], v[216:219], a[16:19], a[48:51]
    v_mfma_f32_16x16x32_bf16 a[52:55], v[108:111], a[8:11], a[52:55]
    buffer_load_dwordx4 v[244:247], v30, s[16:19], s66 offen offset:1024 sc1
    v_mfma_f32_16x16x32_bf16 a[52:55], v[204:207], a[12:15], a[52:55]
    ds_write_b128 v17, a[44:47] offset:0
    v_mfma_f32_16x16x32_bf16 a[52:55], v[220:223], a[16:19], a[52:55]
    s_waitcnt vmcnt(7)
    v_mfma_f32_16x16x32_bf16 a[88:91], v[64:67], a[20:23], a[88:91]
    v_mfma_f32_16x16x32_bf16 a[88:91], v[80:83], a[24:27], a[88:91]
    buffer_load_dwordx4 a[0:3], v30, s[16:19], s57 offen offset:2048 sc1
    v_mfma_f32_16x16x32_bf16 a[88:91], v[96:99], a[28:31], a[88:91]
    ds_write_b128 v16, a[48:51] offset:128
    v_mfma_f32_16x16x32_bf16 a[92:95], v[68:71], a[20:23], a[92:95]
    v_mfma_f32_16x16x32_bf16 a[92:95], v[84:87], a[24:27], a[92:95]
    s_nop 0
    ds_write_b128 v17, a[52:55] offset:128
    v_mfma_f32_16x16x32_bf16 a[92:95], v[100:103], a[28:31], a[92:95]
    buffer_load_dwordx4 a[4:7], v30, s[16:19], s58 offen offset:2048 sc1
    v_mfma_f32_16x16x32_bf16 a[96:99], v[72:75], a[20:23], a[96:99]
    v_mfma_f32_16x16x32_bf16 a[96:99], v[88:91], a[24:27], a[96:99]
    ds_write_b128 v16, a[88:91] offset:12288
    v_mfma_f32_16x16x32_bf16 a[96:99], v[104:107], a[28:31], a[96:99]
    v_mfma_f32_16x16x32_bf16 a[100:103], v[76:79], a[20:23], a[100:103]
    buffer_load_dwordx4 a[8:11], v30, s[16:19], s59 offen offset:2048 sc1
    v_mfma_f32_16x16x32_bf16 a[100:103], v[92:95], a[24:27], a[100:103]
    s_nop 0
    ds_write_b128 v17, a[92:95] offset:12288
    v_mfma_f32_16x16x32_bf16 a[100:103], v[108:111], a[28:31], a[100:103]
    s_waitcnt vmcnt(7)
    v_mfma_f32_16x16x32_bf16 a[104:107], v[64:67], a[32:35], a[104:107]
    v_mfma_f32_16x16x32_bf16 a[104:107], v[80:83], v[224:227], a[104:107]
    buffer_load_dwordx4 a[12:15], v30, s[16:19], s66 offen offset:2048 sc1
    v_mfma_f32_16x16x32_bf16 a[104:107], v[96:99], v[228:231], a[104:107]
    ds_write_b128 v16, a[96:99] offset:12416
    v_mfma_f32_16x16x32_bf16 a[108:111], v[68:71], a[32:35], a[108:111]
    v_mfma_f32_16x16x32_bf16 a[108:111], v[84:87], v[224:227], a[108:111]
    s_nop 0
    ds_write_b128 v17, a[100:103] offset:12416
    v_mfma_f32_16x16x32_bf16 a[108:111], v[100:103], v[228:231], a[108:111]
    v_mfma_f32_16x16x32_bf16 a[112:115], v[72:75], a[32:35], a[112:115]
    v_mfma_f32_16x16x32_bf16 a[112:115], v[88:91], v[224:227], a[112:115]
    s_nop 0
    ds_write_b128 v16, a[104:107] offset:16384
    v_mfma_f32_16x16x32_bf16 a[112:115], v[104:107], v[228:231], a[112:115]
    v_mfma_f32_16x16x32_bf16 a[116:119], v[76:79], a[32:35], a[116:119]
    v_mfma_f32_16x16x32_bf16 a[116:119], v[92:95], v[224:227], a[116:119]
    s_nop 1
    ds_write_b128 v17, a[108:111] offset:16384
    v_mfma_f32_16x16x32_bf16 a[116:119], v[108:111], v[228:231], a[116:119]
    s_waitcnt vmcnt(6)
    v_mfma_f32_16x16x32_bf16 a[56:59], v[160:163], v[232:235], a[56:59]
    v_mfma_f32_16x16x32_bf16 a[56:59], v[176:179], v[236:239], a[56:59]
    ds_write_b128 v16, a[112:115] offset:16512
    v_mfma_f32_16x16x32_bf16 a[60:63], v[164:167], v[232:235], a[60:63]
    v_mfma_f32_16x16x32_bf16 a[60:63], v[180:183], v[236:239], a[60:63]
    v_mfma_f32_16x16x32_bf16 a[64:67], v[168:171], v[232:235], a[64:67]
    s_nop 1
    ds_write_b128 v17, a[116:119] offset:16512
    v_mfma_f32_16x16x32_bf16 a[64:67], v[184:187], v[236:239], a[64:67]
    v_mfma_f32_16x16x32_bf16 a[68:71], v[172:175], v[232:235], a[68:71]
    v_mfma_f32_16x16x32_bf16 a[68:71], v[188:191], v[236:239], a[68:71]
    s_waitcnt vmcnt(4)
    v_mfma_f32_16x16x32_bf16 a[56:59], v[192:195], v[240:243], a[56:59]
    v_mfma_f32_16x16x32_bf16 a[56:59], v[208:211], v[244:247], a[56:59]
    v_mfma_f32_16x16x32_bf16 a[60:63], v[196:199], v[240:243], a[60:63]
    v_mfma_f32_16x16x32_bf16 a[60:63], v[212:215], v[244:247], a[60:63]
    v_mfma_f32_16x16x32_bf16 a[64:67], v[200:203], v[240:243], a[64:67]
    v_mfma_f32_16x16x32_bf16 a[64:67], v[216:219], v[244:247], a[64:67]
    v_mfma_f32_16x16x32_bf16 a[68:71], v[204:207], v[240:243], a[68:71]
    s_nop 3
    ds_write_b128 v16, a[56:59] offset:4096
    v_mfma_f32_16x16x32_bf16 a[68:71], v[220:223], v[244:247], a[68:71]
    s_waitcnt vmcnt(2)
    v_mfma_f32_16x16x32_bf16 a[72:75], v[160:163], a[0:3], a[72:75]
    ds_write_b128 v17, a[60:63] offset:4096
    v_mfma_f32_16x16x32_bf16 a[72:75], v[176:179], a[4:7], a[72:75]
    v_mfma_f32_16x16x32_bf16 a[76:79], v[164:167], a[0:3], a[76:79]
    ds_write_b128 v16, a[64:67] offset:4224
    v_mfma_f32_16x16x32_bf16 a[76:79], v[180:183], a[4:7], a[76:79]
    v_mfma_f32_16x16x32_bf16 a[80:83], v[168:171], a[0:3], a[80:83]
    s_nop 0
    ds_write_b128 v17, a[68:71] offset:4224
    v_mfma_f32_16x16x32_bf16 a[80:83], v[184:187], a[4:7], a[80:83]
    v_mfma_f32_16x16x32_bf16 a[84:87], v[172:175], a[0:3], a[84:87]
    v_mfma_f32_16x16x32_bf16 a[84:87], v[188:191], a[4:7], a[84:87]
    s_waitcnt vmcnt(0)
    v_mfma_f32_16x16x32_bf16 a[72:75], v[192:195], a[8:11], a[72:75]
    v_mfma_f32_16x16x32_bf16 a[72:75], v[208:211], a[12:15], a[72:75]
    v_mfma_f32_16x16x32_bf16 a[76:79], v[196:199], a[8:11], a[76:79]
    v_mfma_f32_16x16x32_bf16 a[76:79], v[212:215], a[12:15], a[76:79]
    v_mfma_f32_16x16x32_bf16 a[80:83], v[200:203], a[8:11], a[80:83]
    v_mfma_f32_16x16x32_bf16 a[80:83], v[216:219], a[12:15], a[80:83]
    v_mfma_f32_16x16x32_bf16 a[84:87], v[204:207], a[8:11], a[84:87]
    s_nop 3
    ds_write_b128 v16, a[72:75] offset:8192
    v_mfma_f32_16x16x32_bf16 a[84:87], v[220:223], a[12:15], a[84:87]
    ds_write_b128 v17, a[76:79] offset:8192
    s_nop 0
    ds_write_b128 v16, a[80:83] offset:8320
    s_nop 5
    ds_write_b128 v17, a[84:87] offset:8320
    s_waitcnt lgkmcnt(0)
    s_barrier
    ds_read_b128 v[32:35], v8 offset:0
    ds_read_b128 v[36:39], v9 offset:0
    ds_read_b128 v[40:43], v8 offset:20480
    ds_read_b128 v[44:47], v9 offset:20480
    ds_read_b128 v[48:51], v10 offset:0
    ds_read_b128 v[52:55], v11 offset:0
    ds_read_b128 v[56:59], v10 offset:20480
    ds_read_b128 v[60:63], v11 offset:20480
    ds_read_b128 v[64:67], v8 offset:8192
    ds_read_b128 v[68:71], v9 offset:8192
    ds_read_b128 v[72:75], v8 offset:28672
    ds_read_b128 v[76:79], v9 offset:28672
    ds_read_b128 v[80:83], v10 offset:8192
    ds_read_b128 v[84:87], v11 offset:8192
    ds_read_b128 v[88:91], v10 offset:28672
    ds_read_b128 v[92:95], v11 offset:28672
    s_waitcnt lgkmcnt(12)
    v_pk_add_f32 v[32:33], v[32:33], v[40:41]
    v_pk_add_f32 v[34:35], v[34:35], v[42:43]
    v_pk_add_f32 v[36:37], v[36:37], v[44:45]
    v_pk_add_f32 v[38:39], v[38:39], v[46:47]
    s_waitcnt lgkmcnt(8)
    ds_read_b128 v[96:99], v12 offset:16384
    ds_read_b128 v[100:103], v12 offset:36864
    ds_read_b128 v[104:107], v13 offset:16384
    ds_read_b128 v[108:111], v13 offset:36864
    v_pk_add_f32 v[48:49], v[48:49], v[56:57]
    v_pk_add_f32 v[50:51], v[50:51], v[58:59]
    v_pk_add_f32 v[52:53], v[52:53], v[60:61]
    v_pk_add_f32 v[54:55], v[54:55], v[62:63]
    v_pk_add_f32 v[32:33], v[32:33], v[48:49]
    v_pk_add_f32 v[34:35], v[34:35], v[50:51]
    v_pk_add_f32 v[36:37], v[36:37], v[52:53]
    v_pk_add_f32 v[38:39], v[38:39], v[54:55]
    v_cvt_pk_bf16_f32 v40, v32, v33
    v_cvt_pk_bf16_f32 v41, v34, v35
    v_cvt_pk_bf16_f32 v42, v36, v37
    v_cvt_pk_bf16_f32 v43, v38, v39
    buffer_store_dwordx4 v[40:43], v18, s[24:27], s53 offen nt
    s_add_u32 s53, s53, 40960
    s_waitcnt lgkmcnt(8)
    v_pk_add_f32 v[64:65], v[64:65], v[72:73]
    v_pk_add_f32 v[66:67], v[66:67], v[74:75]
    v_pk_add_f32 v[68:69], v[68:69], v[76:77]
    v_pk_add_f32 v[70:71], v[70:71], v[78:79]
    s_waitcnt lgkmcnt(4)
    v_pk_add_f32 v[80:81], v[80:81], v[88:89]
    v_pk_add_f32 v[82:83], v[82:83], v[90:91]
    v_pk_add_f32 v[84:85], v[84:85], v[92:93]
    v_pk_add_f32 v[86:87], v[86:87], v[94:95]
    v_pk_add_f32 v[64:65], v[64:65], v[80:81]
    v_pk_add_f32 v[66:67], v[66:67], v[82:83]
    v_pk_add_f32 v[68:69], v[68:69], v[84:85]
    v_pk_add_f32 v[70:71], v[70:71], v[86:87]
    v_cvt_pk_bf16_f32 v72, v64, v65
    v_cvt_pk_bf16_f32 v73, v66, v67
    v_cvt_pk_bf16_f32 v74, v68, v69
    v_cvt_pk_bf16_f32 v75, v70, v71
    buffer_store_dwordx4 v[72:75], v18, s[24:27], s53 offen nt
    s_add_u32 s53, s53, 40960
    s_waitcnt lgkmcnt(2)
    v_pk_add_f32 v[96:97], v[96:97], v[100:101]
    v_pk_add_f32 v[98:99], v[98:99], v[102:103]
    s_waitcnt lgkmcnt(0)
    v_pk_add_f32 v[104:105], v[104:105], v[108:109]
    v_pk_add_f32 v[106:107], v[106:107], v[110:111]
    v_pk_add_f32 v[96:97], v[96:97], v[104:105]
    v_pk_add_f32 v[98:99], v[98:99], v[106:107]
    v_cvt_pk_bf16_f32 v100, v96, v97
    v_cvt_pk_bf16_f32 v101, v98, v99
    buffer_store_dwordx2 v[100:101], v19, s[24:27], s53 offen nt
    s_endpgm
L_slow_n1c0:
    s_mov_b32 s62, 0x3ff
    s_mov_b32 s63, 0x0
    s_mov_b64 exec, s[62:63]
    buffer_load_dword v26, v25, s[28:31], 0 offen offset:0 sc1
    s_mov_b64 exec, -1
    s_waitcnt vmcnt(0)
    v_cmp_eq_u32 vcc, s50, v26
    s_andn2_b64 s[62:63], s[62:63], vcc
    s_cbranch_scc0 L_ok_n1c0
    s_cmp_eq_u32 s52, 0
    s_cbranch_scc1 L_ok_n1c0
    s_sub_u32 s52, s52, 1
    s_sleep 1
    s_branch L_slow_n1c0
L_slow_n1c1:
    s_mov_b32 s62, 0x380f
    s_mov_b32 s63, 0x0
    s_mov_b64 exec, s[62:63]
    buffer_load_dword v26, v25, s[28:31], 0 offen offset:128 sc1
    s_mov_b64 exec, -1
    s_waitcnt vmcnt(0)
    v_cmp_eq_u32 vcc, s50, v26
    s_andn2_b64 s[62:63], s[62:63], vcc
    s_cbranch_scc0 L_ok_n1c1
    s_cmp_eq_u32 s52, 0
    s_cbranch_scc1 L_ok_n1c1
    s_sub_u32 s52, s52, 1
    s_sleep 1
    s_branch L_slow_n1c1
L_slow_n1c2:
    s_mov_b32 s62, 0x3f80
    s_mov_b32 s63, 0x0
    s_mov_b64 exec, s[62:63]
    buffer_load_dword v26, v25, s[28:31], 0 offen offset:256 sc1
    s_mov_b64 exec, -1
    s_waitcnt vmcnt(0)
    v_cmp_eq_u32 vcc, s50, v26
    s_andn2_b64 s[62:63], s[62:63], vcc
    s_cbranch_scc0 L_ok_n1c2
    s_cmp_eq_u32 s52, 0
    s_cbranch_scc1 L_ok_n1c2
    s_sub_u32 s52, s52, 1
    s_sleep 1
    s_branch L_slow_n1c2
L_slow_n1c3:
    s_mov_b32 s62, 0x780
    s_mov_b32 s63, 0x0
    s_mov_b64 exec, s[62:63]
    buffer_load_dword v26, v25, s[28:31], 0 offen offset:384 sc1
    s_mov_b64 exec, -1
    s_waitcnt vmcnt(0)
    v_cmp_eq_u32 vcc, s50, v26
    s_andn2_b64 s[62:63], s[62:63], vcc
    s_cbranch_scc0 L_ok_n1c3
    s_cmp_eq_u32 s52, 0
    s_cbranch_scc1 L_ok_n1c3
    s_sub_u32 s52, s52, 1
    s_sleep 1
    s_branch L_slow_n1c3
.p2align 12
L_var2:
L_tv2_0:
    s_cbranch_execz L_base
    v_mfma_f32_16x16x32_bf16 v[48:51], a[112:115], v[136:139], v[48:51]
    ds_read_b128 v[136:139], v16 offset:14336
    s_load_dword s74, s[70:71], 8960
    s_load_dword s75, s[70:71], 10240
    v_mfma_f32_16x16x32_bf16 v[48:51], a[120:123], v[140:143], v[48:51]
    ds_read_b64_tr_b16 v[190:191], v7 offset:512
    s_load_dword s76, s[70:71], 11520
    s_waitcnt lgkmcnt(8)
    v_mfma_f32_16x16x32_bf16 v[52:55], a[64:67], v[112:115], v[52:55]
    ds_read_b128 v[140:143], v17 offset:14336
    s_load_dword s77, s[70:71], 5120
    v_mfma_f32_16x16x32_bf16 v[52:55], a[72:75], v[116:119], v[52:55]
    buffer_load_dwordx4 v235, s[20:23], s47 offen offset:3072 lds
    v_mfma_f32_16x16x32_bf16 v[60:63], a[68:71], v[112:115], v[60:63]
    s_waitcnt vmcnt(8)
    s_barrier
    s_cmp_lg_u32 s36, 0
    s_cbranch_scc1 L_pub_n21
    s_atomic_swap s50, s[64:65], 128
L_pub_n21:
    ds_read_b128 v[112:115], v16 offset:18432
    v_mfma_f32_16x16x32_bf16 v[60:63], a[76:79], v[116:119], v[60:63]
    ds_read_b64_tr_b16 v[192:193], v4 offset:16384
    s_add_u32 m0, s44, 49152
    s_waitcnt lgkmcnt(8)
    v_mfma_f32_16x16x32_bf16 v[60:63], a[84:87], v[120:123], v[60:63]
    ds_read_b128 v[116:119], v17 offset:18432
    v_mfma_f32_16x16x32_bf16 v[60:63], a[92:95], v[124:127], v[60:63]
    buffer_load_dwordx4 v8, s[8:11], s46 offen offset:0 lds
    v_mfma_f32_16x16x32_bf16 v[52:55], a[80:83], v[120:123], v[52:55]
    ds_read_b128 v[120:123], v16 offset:22528
    v_mfma_f32_16x16x32_bf16 v[52:55], a[88:91], v[124:127], v[52:55]
    ds_read_b64_tr_b16 v[194:195], v4 offset:16896
    s_waitcnt lgkmcnt(8)
    v_mfma_f32_16x16x32_bf16 v[52:55], a[96:99], v[128:131], v[52:55]
    ds_read_b128 v[124:127], v17 offset:22528
    v_mfma_f32_16x16x32_bf16 v[52:55], a[104:107], v[132:135], v[52:55]
    buffer_load_dwordx4 v9, s[8:11], s46 offen offset:1024 lds
    v_mfma_f32_16x16x32_bf16 v[60:63], a[100:103], v[128:131], v[60:63]
    ds_read_b128 v[128:131], v16 offset:16384
    s_mov_b32 s47, s54
    s_add_u32 s54, s54, s55
    v_mfma_f32_16x16x32_bf16 v[60:63], a[108:111], v[132:135], v[60:63]
    ds_read_b64_tr_b16 v[196:197], v5 offset:16384
    s_waitcnt lgkmcnt(8)
    v_mfma_f32_16x16x32_bf16 v[60:63], a[116:119], v[136:139], v[60:63]
    ds_read_b128 v[132:135], v17 offset:16384
    v_mfma_f32_16x16x32_bf16 v[60:63], a[124:127], v[140:143], v[60:63]
    buffer_load_dwordx4 v10, s[8:11], s46 offen offset:2048 lds
    v_mfma_f32_16x16x32_bf16 v[52:55], a[112:115], v[136:139], v[52:55]
    ds_read_b128 v[136:139], v16 offset:20480
    v_mfma_f32_16x16x32_bf16 v[52:55], a[120:123], v[140:143], v[52:55]
    ds_read_b64_tr_b16 v[198:199], v5 offset:16896
    s_waitcnt lgkmcnt(8)
    v_mfma_f32_16x16x32_bf16 v[52:55], a[128:131], v[112:115], v[52:55]
    ds_read_b128 v[140:143], v17 offset:20480
    v_mfma_f32_16x16x32_bf16 v[52:55], a[136:139], v[116:119], v[52:55]
    buffer_load_dwordx4 v11, s[8:11], s46 offen offset:3072 lds
    v_mfma_f32_16x16x32_bf16 v[60:63], a[132:135], v[112:115], v[60:63]
    ds_read_b128 v[112:115], v16 offset:26624
    s_add_u32 m0, s45, 49152
    s_load_dword s78, s[70:71], 12800
    v_mfma_f32_16x16x32_bf16 v[60:63], a[140:143], v[116:119], v[60:63]
    ds_read_b64_tr_b16 v[200:201], v6 offset:16384
    s_load_dword s79, s[70:71], 14080
    s_waitcnt lgkmcnt(8)
    v_mfma_f32_16x16x32_bf16 v[60:63], a[148:151], v[120:123], v[60:63]
    ds_read_b128 v[116:119], v17 offset:26624
    s_load_dword s80, s[70:71], 15360
    s_load_dword s81, s[70:71], 6400
    v_mfma_f32_16x16x32_bf16 v[60:63], a[156:159], v[124:127], v[60:63]
    buffer_load_dwordx4 v232, s[20:23], s47 offen offset:0 lds
    v_mfma_f32_16x16x32_bf16 v[52:55], a[144:147], v[120:123], v[52:55]
    ds_read_b128 v[120:123], v16 offset:30720
    v_mfma_f32_16x16x32_bf16 v[52:55], a[152:155], v[124:127], v[52:55]
    ds_read_b64_tr_b16 v[202:203], v6 offset:16896
    s_waitcnt lgkmcnt(8)
    v_mfma_f32_16x16x32_bf16 v[48:51], a[128:131], v[128:131], v[48:51]
    ds_read_b128 v[124:127], v17 offset:30720
    v_mfma_f32_16x16x32_bf16 v[48:51], a[136:139], v[132:135], v[48:51]
    buffer_load_dwordx4 v233, s[20:23], s47 offen offset:1024 lds
    v_mfma_f32_16x16x32_bf16 v[56:59], a[132:135], v[128:131], v[56:59]
    ds_read_b128 v[128:131], v16 offset:24576
    s_mov_b32 s46, s54
    s_add_u32 s54, s54, s55
    v_mfma_f32_16x16x32_bf16 v[56:59], a[140:143], v[132:135], v[56:59]
    ds_read_b64_tr_b16 v[204:205], v7 offset:16384
    s_waitcnt lgkmcnt(8)
    v_mfma_f32_16x16x32_bf16 v[56:59], a[148:151], v[136:139], v[56:59]
    ds_read_b128 v[132:135], v17 offset:24576
    v_mfma_f32_16x16x32_bf16 v[56:59], a[156:159], v[140:143], v[56:59]
    buffer_load_dwordx4 v234, s[20:23], s47 offen offset:2048 lds
    v_mfma_f32_16x16x32_bf16 v[48:51], a[144:147], v[136:139], v[48:51]
    ds_read_b128 v[136:139], v16 offset:28672
    v_mfma_f32_16x16x32_bf16 v[48:51], a[152:155], v[140:143], v[48:51]
    ds_read_b64_tr_b16 v[206:207], v7 offset:16896
    s_waitcnt lgkmcnt(8)
    v_mfma_f32_16x16x32_bf16 v[36:39], a[0:3], v[112:115], 0
    ds_read_b128 v[140:143], v17 offset:28672
    v_mfma_f32_16x16x32_bf16 v[36:39], a[8:11], v[116:119], v[36:39]
    buffer_load_dwordx4 v235, s[20:23], s47 offen offset:3072 lds
    v_mfma_f32_16x16x32_bf16 v[44:47], a[4:7], v[112:115], 0
    s_waitcnt vmcnt(8)
    s_barrier
    ds_read_b128 v[112:115], v16 offset:32768
    v_mfma_f32_16x16x32_bf16 v[44:47], a[12:15], v[116:119], v[44:47]
    ds_read_b64_tr_b16 v[208:209], v4 offset:32768
    s_add_u32 m0, s45, 0
    s_waitcnt lgkmcnt(8)
    v_mfma_f32_16x16x32_bf16 v[44:47], a[20:23], v[120:123], v[44:47]
    ds_read_b128 v[116:119], v17 offset:32768
    v_readlane_b32 s88, v24, 6
    v_mul_f32 v48, v48, v56
    v_mul_f32 v49, v49, v57
    v_mfma_f32_16x16x32_bf16 v[44:47], a[28:31], v[124:127], v[44:47]
    buffer_load_dwordx4 v232, s[20:23], s46 offen offset:0 lds
    v_mul_f32 v50, v50, v58
    v_mfma_f32_16x16x32_bf16 v[36:39], a[16:19], v[120:123], v[36:39]
    ds_read_b128 v[120:123], v16 offset:36864
    s_load_dword s82, s[70:71], 7680
    s_load_dword s83, s[72:73], 16640
    v_mfma_f32_16x16x32_bf16 v[36:39], a[24:27], v[124:127], v[36:39]
    ds_read_b64_tr_b16 v[210:211], v4 offset:33280
    v_mul_f32 v51, v51, v59
    v_mul_f32 v52, v52, v60
    s_waitcnt lgkmcnt(8)
    v_mfma_f32_16x16x32_bf16 v[32:35], a[0:3], v[128:131], 0
    ds_read_b128 v[124:127], v17 offset:36864
    v_mul_f32 v53, v53, v61
    v_mfma_f32_16x16x32_bf16 v[32:35], a[8:11], v[132:135], v[32:35]
    buffer_load_dwordx4 v233, s[20:23], s46 offen offset:1024 lds
    v_mul_f32 v54, v54, v62
    v_mfma_f32_16x16x32_bf16 v[40:43], a[4:7], v[128:131], 0
    ds_read_b128 v[128:131], v16 offset:40960
    s_min_u32 s47, s54, 2211840
    v_mul_f32 v55, v55, v63
    v_mfma_f32_16x16x32_bf16 v[40:43], a[12:15], v[132:135], v[40:43]
    ds_read_b64_tr_b16 v[212:213], v5 offset:32768
    v_cvt_pk_bf16_f32 v56, v48, v49
    v_cvt_pk_bf16_f32 v58, v52, v53
    s_waitcnt lgkmcnt(8)
    v_mfma_f32_16x16x32_bf16 v[40:43], a[20:23], v[136:139], v[40:43]
    ds_read_b128 v[132:135], v17 offset:40960
    v_cvt_pk_bf16_f32 v57, v50, v51
    v_mfma_f32_16x16x32_bf16 v[40:43], a[28:31], v[140:143], v[40:43]
    buffer_load_dwordx4 v234, s[20:23], s46 offen offset:2048 lds
    v_cvt_pk_bf16_f32 v59, v54, v55
    v_mfma_f32_16x16x32_bf16 v[32:35], a[16:19], v[136:139], v[32:35]
    ds_read_b128 v[136:139], v16 offset:45056
    v_permlane16_swap_b32 v56, v58
    v_mfma_f32_16x16x32_bf16 v[32:35], a[24:27], v[140:143], v[32:35]
    ds_read_b64_tr_b16 v[214:215], v5 offset:33280
    v_permlane16_swap_b32 v57, v59
    buffer_store_dwordx4 v[56:59], v21, s[16:19], s88 offen sc1
    s_waitcnt lgkmcnt(8)
    v_mfma_f32_16x16x32_bf16 v[32:35], a[32:35], v[112:115], v[32:35]
    ds_read_b128 v[140:143], v17 offset:45056
    v_mfma_f32_16x16x32_bf16 v[32:35], a[40:43], v[116:119], v[32:35]
    buffer_load_dwordx4 v235, s[20:23], s46 offen offset:3072 lds
    v_mfma_f32_16x16x32_bf16 v[40:43], a[36:39], v[112:115], v[40:43]
    ds_read_b128 v[112:115], v16 offset:34816
    s_add_u32 m0, s45, 16384
    v_mfma_f32_16x16x32_bf16 v[40:43], a[44:47], v[116:119], v[40:43]
    ds_read_b64_tr_b16 v[216:217], v6 offset:32768
    s_waitcnt lgkmcnt(8)
    v_mfma_f32_16x16x32_bf16 v[40:43], a[52:55], v[120:123], v[40:43]
    ds_read_b128 v[116:119], v17 offset:34816
    v_mfma_f32_16x16x32_bf16 v[40:43], a[60:63], v[124:127], v[40:43]
    buffer_load_dwordx4 v232, s[20:23], s47 offen offset:0 lds
    v_mfma_f32_16x16x32_bf16 v[32:35], a[48:51], v[120:123], v[32:35]
    ds_read_b128 v[120:123], v16 offset:38912
    v_mfma_f32_16x16x32_bf16 v[32:35], a[56:59], v[124:127], v[32:35]
    ds_read_b64_tr_b16 v[218:219], v6 offset:33280
    s_waitcnt lgkmcnt(8)
    v_mfma_f32_16x16x32_bf16 v[32:35], a[64:67], v[128:131], v[32:35]
    ds_read_b128 v[124:127], v17 offset:38912
    v_mfma_f32_16x16x32_bf16 v[32:35], a[72:75], v[132:135], v[32:35]
    buffer_load_dwordx4 v233, s[20:23], s47 offen offset:1024 lds
    v_mfma_f32_16x16x32_bf16 v[40:43], a[68:71], v[128:131], v[40:43]
    ds_read_b128 v[128:131], v16 offset:43008
    v_mfma_f32_16x16x32_bf16 v[40:43], a[76:79], v[132:135], v[40:43]
    ds_read_b64_tr_b16 v[220:221], v7 offset:32768
    s_waitcnt lgkmcnt(8)
    v_mfma_f32_16x16x32_bf16 v[40:43], a[84:87], v[136:139], v[40:43]
    ds_read_b128 v[132:135], v17 offset:43008
    v_mfma_f32_16x16x32_bf16 v[40:43], a[92:95], v[140:143], v[40:43]
    buffer_load_dwordx4 v234, s[20:23], s47 offen offset:2048 lds
    v_mfma_f32_16x16x32_bf16 v[32:35], a[80:83], v[136:139], v[32:35]
    ds_read_b128 v[136:139], v16 offset:47104
    v_mfma_f32_16x16x32_bf16 v[32:35], a[88:91], v[140:143], v[32:35]
    ds_read_b64_tr_b16 v[222:223], v7 offset:33280
    s_waitcnt lgkmcnt(8)
    v_mfma_f32_16x16x32_bf16 v[36:39], a[32:35], v[112:115], v[36:39]
    s_waitcnt lgkmcnt(0)
    s_xor_b64 s[74:75], s[74:75], s[50:51]
    s_xor_b64 s[76:77], s[76:77], s[50:51]
    s_xor_b64 s[78:79], s[78:79], s[50:51]
    s_xor_b64 s[80:81], s[80:81], s[50:51]
    s_xor_b64 s[82:83], s[82:83], s[50:51]
    s_or_b64 s[74:75], s[74:75], s[76:77]
    s_or_b64 s[74:75], s[74:75], s[78:79]
    s_or_b64 s[74:75], s[74:75], s[80:81]
    s_or_b64 s[74:75], s[74:75], s[82:83]
    s_cbranch_scc1 L_slow_n2c0
L_ok_n2c0:
    ds_read_b128 v[140:143], v17 offset:47104
    v_mfma_f32_16x16x32_bf16 v[36:39], a[40:43], v[116:119], v[36:39]
    buffer_load_dwordx4 v235, s[20:23], s47 offen offset:3072 lds
    v_mfma_f32_16x16x32_bf16 v[44:47], a[36:39], v[112:115], v[44:47]
    s_waitcnt vmcnt(9)
    s_barrier
    ds_read_b128 v[112:115], v16 offset:51200
    v_mfma_f32_16x16x32_bf16 v[44:47], a[44:47], v[116:119], v[44:47]
    ds_read_b64_tr_b16 v[64:65], v4 offset:49152
    v_mfma_f32_16x16x32_bf16 v[44:47], a[52:55], v[120:123], v[44:47]
    ds_read_b128 v[116:119], v17 offset:51200
    v_mfma_f32_16x16x32_bf16 v[44:47], a[60:63], v[124:127], v[44:47]
    buffer_load_dwordx4 v[224:227], v30, s[16:19], s57 offen offset:0 sc1
    v_mfma_f32_16x16x32_bf16 v[36:39], a[48:51], v[120:123], v[36:39]
    ds_read_b128 v[120:123], v16 offset:55296
    v_mfma_f32_16x16x32_bf16 v[36:39], a[56:59], v[124:127], v[36:39]
    ds_read_b64_tr_b16 v[66:67], v4 offset:49664
    v_mfma_f32_16x16x32_bf16 v[36:39], a[64:67], v[128:131], v[36:39]
    ds_read_b128 v[124:127], v17 offset:55296
    v_mfma_f32_16x16x32_bf16 v[36:39], a[72:75], v[132:135], v[36:39]
    buffer_load_dwordx4 v[228:231], v30, s[16:19], s58 offen offset:0 sc1
    v_mfma_f32_16x16x32_bf16 v[44:47], a[68:71], v[128:131], v[44:47]
    ds_read_b128 v[128:131], v16 offset:59392
    v_mfma_f32_16x16x32_bf16 v[44:47], a[76:79], v[132:135], v[44:47]
    ds_read_b64_tr_b16 v[68:69], v5 offset:49152
    s_waitcnt lgkmcnt(8)
    v_mfma_f32_16x16x32_bf16 v[44:47], a[84:87], v[136:139], v[44:47]
    ds_read_b128 v[132:135], v17 offset:59392
    v_mfma_f32_16x16x32_bf16 v[44:47], a[92:95], v[140:143], v[44:47]
    buffer_load_dwordx4 v[232:235], v30, s[16:19], s57 offen offset:1024 sc1
    v_mfma_f32_16x16x32_bf16 v[36:39], a[80:83], v[136:139], v[36:39]
    ds_read_b128 v[136:139], v16 offset:63488
    v_mfma_f32_16x16x32_bf16 v[36:39], a[88:91], v[140:143], v[36:39]
    ds_read_b64_tr_b16 v[70:71], v5 offset:49664
    s_waitcnt lgkmcnt(8)
    v_mfma_f32_16x16x32_bf16 v[36:39], a[96:99], v[112:115], v[36:39]
    ds_read_b128 v[140:143], v17 offset:63488
    v_mfma_f32_16x16x32_bf16 v[36:39], a[104:107], v[116:119], v[36:39]
    buffer_load_dwordx4 v[236:239], v30, s[16:19], s58 offen offset:1024 sc1
    v_mfma_f32_16x16x32_bf16 v[44:47], a[100:103], v[112:115], v[44:47]
    ds_read_b128 v[112:115], v16 offset:49152
    v_mfma_f32_16x16x32_bf16 v[44:47], a[108:111], v[116:119], v[44:47]
    ds_read_b64_tr_b16 v[72:73], v6 offset:49152
    s_waitcnt lgkmcnt(8)
    v_mfma_f32_16x16x32_bf16 v[44:47], a[116:119], v[120:123], v[44:47]
    ds_read_b128 v[116:119], v17 offset:49152
    v_mfma_f32_16x16x32_bf16 v[44:47], a[124:127], v[124:127], v[44:47]
    buffer_load_dwordx4 v[240:243], v30, s[16:19], s57 offen offset:2048 sc1
    v_mfma_f32_16x16x32_bf16 v[36:39], a[112:115], v[120:123], v[36:39]
    ds_read_b128 v[120:123], v16 offset:53248
    v_mfma_f32_16x16x32_bf16 v[36:39], a[120:123], v[124:127], v[36:39]
    ds_read_b64_tr_b16 v[74:75], v6 offset:49664
    s_waitcnt lgkmcnt(8)
    v_mfma_f32_16x16x32_bf16 v[36:39], a[128:131], v[128:131], v[36:39]
    ds_read_b128 v[124:127], v17 offset:53248
    v_mfma_f32_16x16x32_bf16 v[36:39], a[136:139], v[132:135], v[36:39]
    buffer_load_dwordx4 v[244:247], v30, s[16:19], s58 offen offset:2048 sc1
    v_mfma_f32_16x16x32_bf16 v[44:47], a[132:135], v[128:131], v[44:47]
    ds_read_b128 v[128:131], v16 offset:57344
    v_mfma_f32_16x16x32_bf16 v[44:47], a[140:143], v[132:135], v[44:47]
    ds_read_b64_tr_b16 v[76:77], v7 offset:49152
    s_waitcnt lgkmcnt(8)
    v_mfma_f32_16x16x32_bf16 v[44:47], a[148:151], v[136:139], v[44:47]
    ds_read_b128 v[132:135], v17 offset:57344
    v_mfma_f32_16x16x32_bf16 v[44:47], a[156:159], v[140:143], v[44:47]
    buffer_load_dwordx4 a[0:3], v30, s[16:19], s57 offen offset:3072 sc1
    v_mfma_f32_16x16x32_bf16 v[36:39], a[144:147], v[136:139], v[36:39]
    ds_read_b128 v[136:139], v16 offset:61440
    v_mfma_f32_16x16x32_bf16 v[36:39], a[152:155], v[140:143], v[36:39]
    ds_read_b64_tr_b16 v[78:79], v7 offset:49664
    s_waitcnt lgkmcnt(8)
    v_mfma_f32_16x16x32_bf16 v[32:35], a[96:99], v[112:115], v[32:35]
    ds_read_b128 v[140:143], v17 offset:61440
    v_mfma_f32_16x16x32_bf16 v[32:35], a[104:107], v[116:119], v[32:35]
    buffer_load_dwordx4 a[4:7], v30, s[16:19], s58 offen offset:3072 sc1
    v_mfma_f32_16x16x32_bf16 v[40:43], a[100:103], v[112:115], v[40:43]
    s_waitcnt vmcnt(12)
    v_mfma_f32_16x16x32_bf16 v[40:43], a[108:111], v[116:119], v[40:43]
    ds_read_b64_tr_b16 v[80:81], v4 offset:0
    s_waitcnt lgkmcnt(7)
    v_mfma_f32_16x16x32_bf16 v[40:43], a[116:119], v[120:123], v[40:43]
    v_mfma_f32_16x16x32_bf16 v[40:43], a[124:127], v[124:127], v[40:43]
    ds_read_b64_tr_b16 v[82:83], v4 offset:512
    buffer_load_dwordx4 a[8:11], v31, s[16:19], s57 offen offset:0 sc1
    v_mfma_f32_16x16x32_bf16 v[32:35], a[112:115], v[120:123], v[32:35]
    v_mfma_f32_16x16x32_bf16 v[32:35], a[120:123], v[124:127], v[32:35]
    ds_read_b64_tr_b16 v[84:85], v5 offset:0
    s_waitcnt lgkmcnt(6)
    v_mfma_f32_16x16x32_bf16 v[32:35], a[128:131], v[128:131], v[32:35]
    v_mfma_f32_16x16x32_bf16 v[32:35], a[136:139], v[132:135], v[32:35]
    ds_read_b64_tr_b16 v[86:87], v5 offset:512
    buffer_load_dwordx4 a[12:15], v31, s[16:19], s58 offen offset:0 sc1
    v_mfma_f32_16x16x32_bf16 v[40:43], a[132:135], v[128:131], v[40:43]
    v_mfma_f32_16x16x32_bf16 v[40:43], a[140:143], v[132:135], v[40:43]
    ds_read_b64_tr_b16 v[88:89], v6 offset:0
    s_waitcnt lgkmcnt(5)
    v_mfma_f32_16x16x32_bf16 v[40:43], a[148:151], v[136:139], v[40:43]
    v_mfma_f32_16x16x32_bf16 v[40:43], a[156:159], v[140:143], v[40:43]
    ds_read_b64_tr_b16 v[90:91], v6 offset:512
    v_mfma_f32_16x16x32_bf16 v[32:35], a[144:147], v[136:139], v[32:35]
    v_mfma_f32_16x16x32_bf16 v[32:35], a[152:155], v[140:143], v[32:35]
    ds_read_b64_tr_b16 v[92:93], v7 offset:0
    ds_read_b64_tr_b16 v[94:95], v7 offset:512
    s_waitcnt vmcnt(8)
    v_mfma_f32_16x16x32_bf16 a[40:43], v[160:163], v[224:227], 0
    s_barrier
    s_cmp_lg_u32 s36, 0
    s_cbranch_scc1 L_pub_n22
    s_atomic_swap s50, s[64:65], 256
L_pub_n22:
    v_mfma_f32_16x16x32_bf16 a[40:43], v[176:179], v[228:231], a[40:43]
    buffer_load_dwordx4 a[16:19], v30, s[16:19], s59 offen offset:0 sc1
    v_mfma_f32_16x16x32_bf16 a[44:47], v[164:167], v[224:227], 0
    v_readlane_b32 s89, v24, 7
    v_mul_f32 v32, v32, v40
    v_mfma_f32_16x16x32_bf16 a[44:47], v[180:183], v[228:231], a[44:47]
    v_mul_f32 v33, v33, v41
    v_mul_f32 v34, v34, v42
    v_mfma_f32_16x16x32_bf16 a[48:51], v[168:171], v[224:227], 0
    v_mul_f32 v35, v35, v43
    v_mul_f32 v36, v36, v44
    v_mfma_f32_16x16x32_bf16 a[48:51], v[184:187], v[228:231], a[48:51]
    buffer_load_dwordx4 a[20:23], v30, s[16:19], s41 offen offset:0 sc1
    v_mfma_f32_16x16x32_bf16 a[52:55], v[172:175], v[224:227], 0
    v_mul_f32 v37, v37, v45
    v_mul_f32 v38, v38, v46
    v_mfma_f32_16x16x32_bf16 a[52:55], v[188:191], v[228:231], a[52:55]
    v_mul_f32 v39, v39, v47
    v_cvt_pk_bf16_f32 v40, v32, v33
    s_waitcnt vmcnt(8)
    v_mfma_f32_16x16x32_bf16 a[56:59], v[160:163], v[232:235], 0
    v_cvt_pk_bf16_f32 v42, v36, v37
    v_cvt_pk_bf16_f32 v41, v34, v35
    v_mfma_f32_16x16x32_bf16 a[56:59], v[176:179], v[236:239], a[56:59]
    buffer_load_dwordx4 a[24:27], v30, s[16:19], s59 offen offset:1024 sc1
    v_mfma_f32_16x16x32_bf16 a[60:63], v[164:167], v[232:235], 0
    v_cvt_pk_bf16_f32 v43, v38, v39
    s_nop 1
    v_permlane16_swap_b32 v40, v42
    v_mfma_f32_16x16x32_bf16 a[60:63], v[180:183], v[236:239], a[60:63]
    v_permlane16_swap_b32 v41, v43
    buffer_store_dwordx4 v[40:43], v21, s[16:19], s89 offen sc1
    v_mfma_f32_16x16x32_bf16 a[64:67], v[168:171], v[232:235], 0
    v_mfma_f32_16x16x32_bf16 a[64:67], v[184:187], v[236:239], a[64:67]
    buffer_load_dwordx4 a[28:31], v30, s[16:19], s41 offen offset:1024 sc1
    v_mfma_f32_16x16x32_bf16 a[68:71], v[172:175], v[232:235], 0
    v_mfma_f32_16x16x32_bf16 a[68:71], v[188:191], v[236:239], a[68:71]
    ds_read_b64_tr_b16 v[96:97], v4 offset:16384
    s_waitcnt vmcnt(9)
    v_mfma_f32_16x16x32_bf16 a[72:75], v[160:163], v[240:243], 0
    ds_read_b64_tr_b16 v[98:99], v4 offset:16896
    v_mfma_f32_16x16x32_bf16 a[72:75], v[176:179], v[244:247], a[72:75]
    buffer_load_dwordx4 a[32:35], v30, s[16:19], s59 offen offset:2048 sc1
    v_mfma_f32_16x16x32_bf16 a[76:79], v[164:167], v[240:243], 0
    v_mfma_f32_16x16x32_bf16 a[76:79], v[180:183], v[244:247], a[76:79]
    ds_read_b64_tr_b16 v[100:101], v5 offset:16384
    v_mfma_f32_16x16x32_bf16 a[80:83], v[168:171], v[240:243], 0
    ds_read_b64_tr_b16 v[102:103], v5 offset:16896
    v_mfma_f32_16x16x32_bf16 a[80:83], v[184:187], v[244:247], a[80:83]
    buffer_load_dwordx4 v[224:227], v30, s[16:19], s66 offen offset:2048 sc1
    v_mfma_f32_16x16x32_bf16 a[84:87], v[172:175], v[240:243], 0
    v_mfma_f32_16x16x32_bf16 a[84:87], v[188:191], v[244:247], a[84:87]
    ds_read_b64_tr_b16 v[104:105], v6 offset:16384
    s_waitcnt vmcnt(9)
    v_mfma_f32_16x16x32_bf16 a[88:91], v[160:163], a[0:3], 0
    ds_read_b64_tr_b16 v[106:107], v6 offset:16896
    v_mfma_f32_16x16x32_bf16 a[88:91], v[176:179], a[4:7], a[88:91]
    buffer_load_dwordx4 v[228:231], v30, s[16:19], s59 offen offset:3072 sc1
    v_mfma_f32_16x16x32_bf16 a[92:95], v[164:167], a[0:3], 0
    v_mfma_f32_16x16x32_bf16 a[92:95], v[180:183], a[4:7], a[92:95]
    ds_read_b64_tr_b16 v[108:109], v7 offset:16384
    v_mfma_f32_16x16x32_bf16 a[96:99], v[168:171], a[0:3], 0
    ds_read_b64_tr_b16 v[110:111], v7 offset:16896
    v_mfma_f32_16x16x32_bf16 a[96:99], v[184:187], a[4:7], a[96:99]
    buffer_load_dwordx4 v[232:235], v30, s[16:19], s66 offen offset:3072 sc1
    v_mfma_f32_16x16x32_bf16 a[100:103], v[172:175], a[0:3], 0
    v_mfma_f32_16x16x32_bf16 a[100:103], v[188:191], a[4:7], a[100:103]
    s_waitcnt vmcnt(9)
    v_mfma_f32_16x16x32_bf16 a[104:107], v[160:163], a[8:11], 0
    v_mfma_f32_16x16x32_bf16 a[104:107], v[176:179], a[12:15], a[104:107]
    buffer_load_dwordx4 v[236:239], v31, s[16:19], s59 offen offset:0 sc1
    v_mfma_f32_16x16x32_bf16 a[108:111], v[164:167], a[8:11], 0
    v_mfma_f32_16x16x32_bf16 a[108:111], v[180:183], a[12:15], a[108:111]
    v_mfma_f32_16x16x32_bf16 a[112:115], v[168:171], a[8:11], 0
    s_load_dword s74, s[70:71], 5248
    s_load_dword s75, s[70:71], 6528
    v_mfma_f32_16x16x32_bf16 a[112:115], v[184:187], a[12:15], a[112:115]
    buffer_load_dwordx4 v[240:243], v31, s[16:19], s66 offen offset:0 sc1
    v_mfma_f32_16x16x32_bf16 a[116:119], v[172:175], a[8:11], 0
    s_load_dword s76, s[70:71], 7808
    v_mfma_f32_16x16x32_bf16 a[116:119], v[188:191], a[12:15], a[116:119]
    s_load_dword s77, s[70:71], 128
    s_waitcnt vmcnt(9)
    v_mfma_f32_16x16x32_bf16 a[40:43], v[192:195], a[16:19], a[40:43]
    s_load_dword s78, s[70:71], 1408
    s_load_dword s79, s[70:71], 2688
    v_mfma_f32_16x16x32_bf16 a[40:43], a[224:227], a[20:23], a[40:43]
    buffer_load_dwordx4 v[244:247], v30, s[16:19], s67 offen offset:2048 sc1
    v_mfma_f32_16x16x32_bf16 a[44:47], v[196:199], a[16:19], a[44:47]
    s_load_dword s80, s[70:71], 3968
    v_mfma_f32_16x16x32_bf16 a[44:47], a[228:231], a[20:23], a[44:47]
    s_load_dword s81, s[70:71], 3968
    v_mfma_f32_16x16x32_bf16 a[48:51], v[200:203], a[16:19], a[48:51]
    v_mfma_f32_16x16x32_bf16 a[48:51], a[232:235], a[20:23], a[48:51]
    buffer_load_dwordx4 a[0:3], v30, s[16:19], s68 offen offset:2048 sc1
    v_mfma_f32_16x16x32_bf16 a[52:55], v[204:207], a[16:19], a[52:55]
    v_mfma_f32_16x16x32_bf16 a[52:55], a[236:239], a[20:23], a[52:55]
    s_waitcnt vmcnt(8)
    v_mfma_f32_16x16x32_bf16 a[56:59], v[192:195], a[24:27], a[56:59]
    s_waitcnt lgkmcnt(0)
    s_barrier
    s_cmp_lg_u32 s36, 0
    s_cbranch_scc1 L_pub_n23
    s_atomic_swap s50, s[64:65], 384
L_pub_n23:
    v_mfma_f32_16x16x32_bf16 a[56:59], a[224:227], a[28:31], a[56:59]
    buffer_load_dwordx4 a[4:7], v30, s[16:19], s67 offen offset:3072 sc1
    v_mfma_f32_16x16x32_bf16 a[60:63], v[196:199], a[24:27], a[60:63]
    v_mfma_f32_16x16x32_bf16 a[60:63], a[228:231], a[28:31], a[60:63]
    v_mfma_f32_16x16x32_bf16 a[64:67], v[200:203], a[24:27], a[64:67]
    v_mfma_f32_16x16x32_bf16 a[64:67], a[232:235], a[28:31], a[64:67]
    buffer_load_dwordx4 a[8:11], v30, s[16:19], s68 offen offset:3072 sc1
    v_mfma_f32_16x16x32_bf16 a[68:71], v[204:207], a[24:27], a[68:71]
    v_mfma_f32_16x16x32_bf16 a[68:71], a[236:239], a[28:31], a[68:71]
    s_waitcnt vmcnt(8)
    v_mfma_f32_16x16x32_bf16 a[72:75], v[192:195], a[32:35], a[72:75]
    v_and_b32 v1, 15, v0
    v_mfma_f32_16x16x32_bf16 a[72:75], v[208:211], v[224:227], a[72:75]
    buffer_load_dwordx4 a[12:15], v31, s[16:19], s67 offen offset:0 sc1
    v_mfma_f32_16x16x32_bf16 a[76:79], v[196:199], a[32:35], a[76:79]
    v_lshrrev_b32 v2, 4, v0
    v_mfma_f32_16x16x32_bf16 a[76:79], v[212:215], v[224:227], a[76:79]
    v_and_b32 v3, 7, v0
    v_mfma_f32_16x16x32_bf16 a[80:83], v[200:203], a[32:35], a[80:83]
    v_xor_b32 v2, v2, v3
    v_mfma_f32_16x16x32_bf16 a[80:83], v[216:219], v[224:227], a[80:83]
    buffer_load_dwordx4 a[16:19], v31, s[16:19], s68 offen offset:0 sc1
    v_mfma_f32_16x16x32_bf16 a[84:87], v[204:207], a[32:35], a[84:87]
    v_lshlrev_b32 v2, 4, v2
    v_mfma_f32_16x16x32_bf16 a[84:87], v[220:223], v[224:227], a[84:87]
    v_lshl_add_u32 v1, v1, 8, v2
    s_waitcnt vmcnt(8)
    v_mfma_f32_16x16x32_bf16 a[88:91], v[192:195], v[228:231], a[88:91]
    v_add_u32 v16, s43, v1
    v_mfma_f32_16x16x32_bf16 a[88:91], v[208:211], v[232:235], a[88:91]
    buffer_load_dwordx4 a[20:23], v30, s[16:19], s42 offen offset:0 sc1
    v_mfma_f32_16x16x32_bf16 a[92:95], v[196:199], v[228:231], a[92:95]
    v_xor_b32 v17, 64, v16
    v_mfma_f32_16x16x32_bf16 a[92:95], v[212:215], v[232:235], a[92:95]
    v_lshrrev_b32 v1, 3, v0
    v_mfma_f32_16x16x32_bf16 a[96:99], v[200:203], v[228:231], a[96:99]
    v_lshlrev_b32 v2, 1, v3
    v_mfma_f32_16x16x32_bf16 a[96:99], v[216:219], v[232:235], a[96:99]
    buffer_load_dwordx4 a[24:27], v30, s[16:19], s49 offen offset:0 sc1
    v_mfma_f32_16x16x32_bf16 a[100:103], v[204:207], v[228:231], a[100:103]
    v_xor_b32 v2, v2, v1
    v_mfma_f32_16x16x32_bf16 a[100:103], v[220:223], v[232:235], a[100:103]
    v_lshlrev_b32 v2, 4, v2
    s_waitcnt vmcnt(8)
    v_mfma_f32_16x16x32_bf16 a[104:107], v[192:195], v[236:239], a[104:107]
    s_waitcnt lgkmcnt(0)
    v_mfma_f32_16x16x32_bf16 a[104:107], v[208:211], v[240:243], a[104:107]
    buffer_load_dwordx4 a[28:31], v30, s[16:19], s42 offen offset:1024 sc1
    v_mfma_f32_16x16x32_bf16 a[108:111], v[196:199], v[236:239], a[108:111]
    s_xor_b64 s[74:75], s[74:75], s[50:51]
    v_mfma_f32_16x16x32_bf16 a[108:111], v[212:215], v[240:243], a[108:111]
    s_xor_b64 s[76:77], s[76:77], s[50:51]
    v_mfma_f32_16x16x32_bf16 a[112:115], v[200:203], v[236:239], a[112:115]
    s_xor_b64 s[78:79], s[78:79], s[50:51]
    v_mfma_f32_16x16x32_bf16 a[112:115], v[216:219], v[240:243], a[112:115]
    buffer_load_dwordx4 a[32:35], v30, s[16:19], s49 offen offset:1024 sc1
    v_mfma_f32_16x16x32_bf16 a[116:119], v[204:207], v[236:239], a[116:119]
    s_xor_b64 s[80:81], s[80:81], s[50:51]
    v_mfma_f32_16x16x32_bf16 a[116:119], v[220:223], v[240:243], a[116:119]
    s_or_b64 s[74:75], s[74:75], s[76:77]
    s_waitcnt vmcnt(8)
    v_mfma_f32_16x16x32_bf16 a[72:75], v[64:67], v[244:247], a[72:75]
    s_or_b64 s[74:75], s[74:75], s[78:79]
    v_mfma_f32_16x16x32_bf16 a[72:75], v[80:83], a[0:3], a[72:75]
    buffer_load_dwordx4 v[224:227], v31, s[16:19], s69 offen offset:0 sc1
    v_mfma_f32_16x16x32_bf16 a[76:79], v[68:71], v[244:247], a[76:79]
    s_or_b64 s[74:75], s[74:75], s[80:81]
    s_cbranch_scc1 L_slow_n2c1
L_ok_n2c1:
    v_mfma_f32_16x16x32_bf16 a[76:79], v[84:87], a[0:3], a[76:79]
    v_mfma_f32_16x16x32_bf16 a[80:83], v[72:75], v[244:247], a[80:83]
    s_lshl_b32 s61, s36, 3
    v_mfma_f32_16x16x32_bf16 a[80:83], v[88:91], a[0:3], a[80:83]
    buffer_load_dwordx4 v[228:231], v30, s[16:19], s41 offen offset:2048 sc1
    v_mfma_f32_16x16x32_bf16 a[84:87], v[76:79], v[244:247], a[84:87]
    v_add_u32 v1, s61, v1
    v_mfma_f32_16x16x32_bf16 a[84:87], v[92:95], a[0:3], a[84:87]
    v_lshl_add_u32 v8, v1, 8, v2
    s_waitcnt vmcnt(8)
    v_mfma_f32_16x16x32_bf16 a[88:91], v[64:67], a[4:7], a[88:91]
    v_xor_b32 v9, 16, v8
    v_mfma_f32_16x16x32_bf16 a[88:91], v[80:83], a[8:11], a[88:91]
    buffer_load_dwordx4 v[232:235], v30, s[16:19], s42 offen offset:2048 sc1
    v_mfma_f32_16x16x32_bf16 a[92:95], v[68:71], a[4:7], a[92:95]
    v_add_u32 v10, 40960, v8
    v_mfma_f32_16x16x32_bf16 a[92:95], v[84:87], a[8:11], a[92:95]
    v_add_u32 v11, 40960, v9
    v_mfma_f32_16x16x32_bf16 a[96:99], v[72:75], a[4:7], a[96:99]
    v_mul_u32_u24 v1, 1280, v1
    v_mfma_f32_16x16x32_bf16 a[96:99], v[88:91], a[8:11], a[96:99]
    buffer_load_dwordx4 v[236:239], v30, s[16:19], s41 offen offset:3072 sc1
    v_mfma_f32_16x16x32_bf16 a[100:103], v[76:79], a[4:7], a[100:103]
    v_lshl_add_u32 v18, v3, 4, v1
    v_mfma_f32_16x16x32_bf16 a[100:103], v[92:95], a[8:11], a[100:103]
    s_lshl_b32 s61, s36, 2
    s_waitcnt vmcnt(8)
    v_mfma_f32_16x16x32_bf16 a[104:107], v[64:67], a[12:15], a[104:107]
    v_lshrrev_b32 v1, 4, v0
    v_mfma_f32_16x16x32_bf16 a[104:107], v[80:83], a[16:19], a[104:107]
    buffer_load_dwordx4 v[240:243], v30, s[16:19], s42 offen offset:3072 sc1
    v_mfma_f32_16x16x32_bf16 a[108:111], v[68:71], a[12:15], a[108:111]
    v_add_u32 v1, s61, v1
    v_mfma_f32_16x16x32_bf16 a[108:111], v[84:87], a[16:19], a[108:111]
    v_and_b32 v2, 15, v0
    v_mfma_f32_16x16x32_bf16 a[112:115], v[72:75], a[12:15], a[112:115]
    s_load_dword s74, s[70:71], 256
    s_load_dword s75, s[70:71], 1536
    v_mfma_f32_16x16x32_bf16 a[112:115], v[88:91], a[16:19], a[112:115]
    buffer_load_dwordx4 v[244:247], v31, s[16:19], s41 offen offset:0 sc1
    v_mfma_f32_16x16x32_bf16 a[116:119], v[76:79], a[12:15], a[116:119]
    s_load_dword s76, s[70:71], 2816
    v_mfma_f32_16x16x32_bf16 a[116:119], v[92:95], a[16:19], a[116:119]
    s_load_dword s77, s[70:71], 4096
    s_waitcnt vmcnt(8)
    v_mfma_f32_16x16x32_bf16 a[40:43], a[240:243], a[20:23], a[40:43]
    v_and_b32 v3, 7, v1
    v_mfma_f32_16x16x32_bf16 a[40:43], v[144:147], a[24:27], a[40:43]
    buffer_load_dwordx4 a[0:3], v31, s[16:19], s42 offen offset:0 sc1
    v_mfma_f32_16x16x32_bf16 a[44:47], a[244:247], a[20:23], a[44:47]
    v_xor_b32 v3, v3, v2
    v_mfma_f32_16x16x32_bf16 a[44:47], v[148:151], a[24:27], a[44:47]
    v_lshlrev_b32 v3, 4, v3
    v_mfma_f32_16x16x32_bf16 a[48:51], a[248:251], a[20:23], a[48:51]
    v_lshl_add_u32 v12, v1, 8, v3
    v_mfma_f32_16x16x32_bf16 a[48:51], v[152:155], a[24:27], a[48:51]
    buffer_load_dwordx4 a[4:7], v30, s[16:19], s49 offen offset:2048 sc1
    v_mfma_f32_16x16x32_bf16 a[52:55], a[252:255], a[20:23], a[52:55]
    v_add_u32 v13, 40960, v12
    v_mfma_f32_16x16x32_bf16 a[52:55], v[156:159], a[24:27], a[52:55]
    v_mul_u32_u24 v1, 1280, v1
    s_waitcnt vmcnt(8)
    v_mfma_f32_16x16x32_bf16 a[56:59], a[240:243], a[28:31], a[56:59]
    v_lshl_add_u32 v19, v2, 3, v1
    v_mfma_f32_16x16x32_bf16 a[56:59], v[144:147], a[32:35], a[56:59]
    buffer_load_dwordx4 a[8:11], v30, s[16:19], s49 offen offset:3072 sc1
    v_mfma_f32_16x16x32_bf16 a[60:63], a[244:247], a[28:31], a[60:63]
    v_mfma_f32_16x16x32_bf16 a[60:63], v[148:151], a[32:35], a[60:63]
    v_mfma_f32_16x16x32_bf16 a[64:67], a[248:251], a[28:31], a[64:67]
    v_mfma_f32_16x16x32_bf16 a[64:67], v[152:155], a[32:35], a[64:67]
    buffer_load_dwordx4 a[12:15], v31, s[16:19], s49 offen offset:0 sc1
    v_mfma_f32_16x16x32_bf16 a[68:71], a[252:255], a[28:31], a[68:71]
    v_mfma_f32_16x16x32_bf16 a[68:71], v[156:159], a[32:35], a[68:71]
    s_waitcnt vmcnt(9)
    v_mfma_f32_16x16x32_bf16 a[104:107], v[96:99], v[224:227], a[104:107]
    v_mfma_f32_16x16x32_bf16 a[108:111], v[100:103], v[224:227], a[108:111]
    buffer_load_dwordx4 a[16:19], v30, s[16:19], s37 offen offset:0 sc1
    v_mfma_f32_16x16x32_bf16 a[112:115], v[104:107], v[224:227], a[112:115]
    v_mfma_f32_16x16x32_bf16 a[116:119], v[108:111], v[224:227], a[116:119]
    s_waitcnt vmcnt(8)
    v_mfma_f32_16x16x32_bf16 a[72:75], a[224:227], v[228:231], a[72:75]
    v_mfma_f32_16x16x32_bf16 a[72:75], a[240:243], v[232:235], a[72:75]
    buffer_load_dwordx4 a[20:23], v30, s[16:19], s38 offen offset:0 sc1
    v_mfma_f32_16x16x32_bf16 a[76:79], a[228:231], v[228:231], a[76:79]
    v_mfma_f32_16x16x32_bf16 a[76:79], a[244:247], v[232:235], a[76:79]
    v_mfma_f32_16x16x32_bf16 a[80:83], a[232:235], v[228:231], a[80:83]
    v_mfma_f32_16x16x32_bf16 a[80:83], a[248:251], v[232:235], a[80:83]
    buffer_load_dwordx4 a[24:27], v30, s[16:19], s37 offen offset:1024 sc1
    v_mfma_f32_16x16x32_bf16 a[84:87], a[236:239], v[228:231], a[84:87]
    v_mfma_f32_16x16x32_bf16 a[84:87], a[252:255], v[232:235], a[84:87]
    s_waitcnt vmcnt(8)
L_tv2_1:
    s_cbranch_execz L_base
    v_mfma_f32_16x16x32_bf16 a[88:91], a[224:227], v[236:239], a[88:91]
    v_mfma_f32_16x16x32_bf16 a[88:91], a[240:243], v[240:243], a[88:91]
    buffer_load_dwordx4 a[28:31], v30, s[16:19], s38 offen offset:1024 sc1
    v_mfma_f32_16x16x32_bf16 a[92:95], a[228:231], v[236:239], a[92:95]
    v_mfma_f32_16x16x32_bf16 a[92:95], a[244:247], v[240:243], a[92:95]
    v_mfma_f32_16x16x32_bf16 a[96:99], a[232:235], v[236:239], a[96:99]
    s_waitcnt lgkmcnt(0)
    v_mfma_f32_16x16x32_bf16 a[96:99], a[248:251], v[240:243], a[96:99]
    buffer_load_dwordx4 a[32:35], v30, s[16:19], s39 offen offset:0 sc1
    v_mfma_f32_16x16x32_bf16 a[100:103], a[236:239], v[236:239], a[100:103]
    s_xor_b64 s[74:75], s[74:75], s[50:51]
    v_mfma_f32_16x16x32_bf16 a[100:103], a[252:255], v[240:243], a[100:103]
    s_xor_b64 s[76:77], s[76:77], s[50:51]
    s_waitcnt vmcnt(8)
    v_mfma_f32_16x16x32_bf16 a[104:107], a[224:227], v[244:247], a[104:107]
    s_or_b64 s[74:75], s[74:75], s[76:77]
    s_cbranch_scc1 L_slow_n2c2
L_ok_n2c2:
    v_mfma_f32_16x16x32_bf16 a[104:107], a[240:243], a[0:3], a[104:107]
    buffer_load_dwordx4 v[224:227], v30, s[16:19], s40 offen offset:0 sc1
    v_mfma_f32_16x16x32_bf16 a[108:111], a[228:231], v[244:247], a[108:111]
    v_mfma_f32_16x16x32_bf16 a[108:111], a[244:247], a[0:3], a[108:111]
    v_mfma_f32_16x16x32_bf16 a[112:115], a[232:235], v[244:247], a[112:115]
    s_load_dword s74, s[70:71], 13184
    s_load_dword s75, s[70:71], 14464
    v_mfma_f32_16x16x32_bf16 a[112:115], a[248:251], a[0:3], a[112:115]
    buffer_load_dwordx4 v[228:231], v30, s[16:19], s39 offen offset:1024 sc1
    v_mfma_f32_16x16x32_bf16 a[116:119], a[236:239], v[244:247], a[116:119]
    s_load_dword s76, s[70:71], 15744
    v_mfma_f32_16x16x32_bf16 a[116:119], a[252:255], a[0:3], a[116:119]
    s_load_dword s77, s[72:73], 17024
    s_waitcnt vmcnt(9)
    v_mfma_f32_16x16x32_bf16 a[72:75], v[144:147], a[4:7], a[72:75]
    s_load_dword s78, s[70:71], 384
    s_load_dword s79, s[70:71], 1664
    v_mfma_f32_16x16x32_bf16 a[76:79], v[148:151], a[4:7], a[76:79]
    buffer_load_dwordx4 v[232:235], v30, s[16:19], s40 offen offset:1024 sc1
    v_mfma_f32_16x16x32_bf16 a[80:83], v[152:155], a[4:7], a[80:83]
    s_load_dword s80, s[70:71], 2944
    v_mfma_f32_16x16x32_bf16 a[84:87], v[156:159], a[4:7], a[84:87]
    s_load_dword s81, s[70:71], 4224
    s_waitcnt vmcnt(9)
    v_mfma_f32_16x16x32_bf16 a[88:91], v[144:147], a[8:11], a[88:91]
    v_mfma_f32_16x16x32_bf16 a[92:95], v[148:151], a[8:11], a[92:95]
    buffer_load_dwordx4 v[236:239], v30, s[16:19], s37 offen offset:2048 sc1
    v_mfma_f32_16x16x32_bf16 a[96:99], v[152:155], a[8:11], a[96:99]
    v_mfma_f32_16x16x32_bf16 a[100:103], v[156:159], a[8:11], a[100:103]
    s_waitcnt vmcnt(9)
    v_mfma_f32_16x16x32_bf16 a[104:107], v[144:147], a[12:15], a[104:107]
    v_mfma_f32_16x16x32_bf16 a[108:111], v[148:151], a[12:15], a[108:111]
    buffer_load_dwordx4 v[240:243], v30, s[16:19], s38 offen offset:2048 sc1
    v_mfma_f32_16x16x32_bf16 a[112:115], v[152:155], a[12:15], a[112:115]
    v_mfma_f32_16x16x32_bf16 a[116:119], v[156:159], a[12:15], a[116:119]
    s_waitcnt vmcnt(8)
    v_mfma_f32_16x16x32_bf16 a[40:43], a[160:163], a[16:19], a[40:43]
    v_mfma_f32_16x16x32_bf16 a[40:43], a[176:179], a[20:23], a[40:43]
    buffer_load_dwordx4 v[244:247], v30, s[16:19], s37 offen offset:3072 sc1
    v_mfma_f32_16x16x32_bf16 a[44:47], a[164:167], a[16:19], a[44:47]
    v_mfma_f32_16x16x32_bf16 a[44:47], a[180:183], a[20:23], a[44:47]
    v_mfma_f32_16x16x32_bf16 a[48:51], a[168:171], a[16:19], a[48:51]
    v_mfma_f32_16x16x32_bf16 a[48:51], a[184:187], a[20:23], a[48:51]
    buffer_load_dwordx4 a[0:3], v30, s[16:19], s38 offen offset:3072 sc1
    v_mfma_f32_16x16x32_bf16 a[52:55], a[172:175], a[16:19], a[52:55]
    v_mfma_f32_16x16x32_bf16 a[52:55], a[188:191], a[20:23], a[52:55]
    s_waitcnt vmcnt(8)
    v_mfma_f32_16x16x32_bf16 a[56:59], a[160:163], a[24:27], a[56:59]
    v_mfma_f32_16x16x32_bf16 a[56:59], a[176:179], a[28:31], a[56:59]
    buffer_load_dwordx4 a[4:7], v30, s[16:19], s69 offen offset:2048 sc1
    v_mfma_f32_16x16x32_bf16 a[60:63], a[164:167], a[24:27], a[60:63]
    v_mfma_f32_16x16x32_bf16 a[60:63], a[180:183], a[28:31], a[60:63]
    v_mfma_f32_16x16x32_bf16 a[64:67], a[168:171], a[24:27], a[64:67]
    v_mfma_f32_16x16x32_bf16 a[64:67], a[184:187], a[28:31], a[64:67]
    buffer_load_dwordx4 a[8:11], v30, s[16:19], s39 offen offset:2048 sc1
    v_mfma_f32_16x16x32_bf16 a[68:71], a[172:175], a[24:27], a[68:71]
    v_mfma_f32_16x16x32_bf16 a[68:71], a[188:191], a[28:31], a[68:71]
    s_waitcnt vmcnt(8)
    v_mfma_f32_16x16x32_bf16 a[40:43], a[192:195], a[32:35], a[40:43]
    v_mfma_f32_16x16x32_bf16 a[40:43], a[208:211], v[224:227], a[40:43]
    buffer_load_dwordx4 a[12:15], v30, s[16:19], s40 offen offset:2048 sc1
    v_mfma_f32_16x16x32_bf16 a[44:47], a[196:199], a[32:35], a[44:47]
    v_mfma_f32_16x16x32_bf16 a[44:47], a[212:215], v[224:227], a[44:47]
    v_mfma_f32_16x16x32_bf16 a[48:51], a[200:203], a[32:35], a[48:51]
    s_waitcnt lgkmcnt(0)
    v_mfma_f32_16x16x32_bf16 a[48:51], a[216:219], v[224:227], a[48:51]
    buffer_load_dwordx4 a[16:19], v30, s[16:19], s69 offen offset:3072 sc1
    v_mfma_f32_16x16x32_bf16 a[52:55], a[204:207], a[32:35], a[52:55]
    s_xor_b64 s[74:75], s[74:75], s[50:51]
    v_mfma_f32_16x16x32_bf16 a[52:55], a[220:223], v[224:227], a[52:55]
    s_xor_b64 s[76:77], s[76:77], s[50:51]
    s_waitcnt vmcnt(8)
    v_mfma_f32_16x16x32_bf16 a[56:59], a[192:195], v[228:231], a[56:59]
    s_xor_b64 s[78:79], s[78:79], s[50:51]
    v_mfma_f32_16x16x32_bf16 a[56:59], a[208:211], v[232:235], a[56:59]
    buffer_load_dwordx4 a[20:23], v30, s[16:19], s39 offen offset:3072 sc1
    v_mfma_f32_16x16x32_bf16 a[60:63], a[196:199], v[228:231], a[60:63]
    s_xor_b64 s[80:81], s[80:81], s[50:51]
    v_mfma_f32_16x16x32_bf16 a[60:63], a[212:215], v[232:235], a[60:63]
    s_or_b64 s[74:75], s[74:75], s[76:77]
    v_mfma_f32_16x16x32_bf16 a[64:67], a[200:203], v[228:231], a[64:67]
    s_or_b64 s[74:75], s[74:75], s[78:79]
    v_mfma_f32_16x16x32_bf16 a[64:67], a[216:219], v[232:235], a[64:67]
    buffer_load_dwordx4 a[24:27], v30, s[16:19], s40 offen offset:3072 sc1
    v_mfma_f32_16x16x32_bf16 a[68:71], a[204:207], v[228:231], a[68:71]
    s_or_b64 s[74:75], s[74:75], s[80:81]
    s_cbranch_scc1 L_slow_n2c3
L_ok_n2c3:
    v_mfma_f32_16x16x32_bf16 a[68:71], a[220:223], v[232:235], a[68:71]
    s_waitcnt vmcnt(8)
    v_mfma_f32_16x16x32_bf16 a[72:75], a[160:163], v[236:239], a[72:75]
    v_mfma_f32_16x16x32_bf16 a[72:75], a[176:179], v[240:243], a[72:75]
    buffer_load_dwordx4 a[28:31], v30, s[16:19], s66 offen offset:0 sc1
    v_mfma_f32_16x16x32_bf16 a[76:79], a[164:167], v[236:239], a[76:79]
    v_mfma_f32_16x16x32_bf16 a[76:79], a[180:183], v[240:243], a[76:79]
    v_mfma_f32_16x16x32_bf16 a[80:83], a[168:171], v[236:239], a[80:83]
    v_mfma_f32_16x16x32_bf16 a[80:83], a[184:187], v[240:243], a[80:83]
    buffer_load_dwordx4 a[32:35], v30, s[16:19], s67 offen offset:0 sc1
    v_mfma_f32_16x16x32_bf16 a[84:87], a[172:175], v[236:239], a[84:87]
    v_mfma_f32_16x16x32_bf16 a[84:87], a[188:191], v[240:243], a[84:87]
    s_waitcnt vmcnt(8)
    v_mfma_f32_16x16x32_bf16 a[88:91], a[160:163], v[244:247], a[88:91]
    v_mfma_f32_16x16x32_bf16 a[88:91], a[176:179], a[0:3], a[88:91]
    buffer_load_dwordx4 v[224:227], v30, s[16:19], s68 offen offset:0 sc1
    v_mfma_f32_16x16x32_bf16 a[92:95], a[164:167], v[244:247], a[92:95]
    v_mfma_f32_16x16x32_bf16 a[92:95], a[180:183], a[0:3], a[92:95]
    v_mfma_f32_16x16x32_bf16 a[96:99], a[168:171], v[244:247], a[96:99]
    v_mfma_f32_16x16x32_bf16 a[96:99], a[184:187], a[0:3], a[96:99]
    buffer_load_dwordx4 v[228:231], v30, s[16:19], s69 offen offset:0 sc1
    v_mfma_f32_16x16x32_bf16 a[100:103], a[172:175], v[244:247], a[100:103]
    v_mfma_f32_16x16x32_bf16 a[100:103], a[188:191], a[0:3], a[100:103]
    s_waitcnt vmcnt(7)
    v_mfma_f32_16x16x32_bf16 a[72:75], v[96:99], a[4:7], a[72:75]
    v_mfma_f32_16x16x32_bf16 a[72:75], a[192:195], a[8:11], a[72:75]
    buffer_load_dwordx4 v[232:235], v30, s[16:19], s66 offen offset:1024 sc1
    v_mfma_f32_16x16x32_bf16 a[72:75], a[208:211], a[12:15], a[72:75]
    v_mfma_f32_16x16x32_bf16 a[76:79], v[100:103], a[4:7], a[76:79]
    v_mfma_f32_16x16x32_bf16 a[76:79], a[196:199], a[8:11], a[76:79]
    v_mfma_f32_16x16x32_bf16 a[76:79], a[212:215], a[12:15], a[76:79]
    buffer_load_dwordx4 v[236:239], v30, s[16:19], s67 offen offset:1024 sc1
    v_mfma_f32_16x16x32_bf16 a[80:83], v[104:107], a[4:7], a[80:83]
    v_mfma_f32_16x16x32_bf16 a[80:83], a[200:203], a[8:11], a[80:83]
    s_nop 2
    ds_write_b128 v16, a[72:75] offset:8192
    v_mfma_f32_16x16x32_bf16 a[80:83], a[216:219], a[12:15], a[80:83]
    v_mfma_f32_16x16x32_bf16 a[84:87], v[108:111], a[4:7], a[84:87]
    buffer_load_dwordx4 v[240:243], v30, s[16:19], s68 offen offset:1024 sc1
    v_mfma_f32_16x16x32_bf16 a[84:87], a[204:207], a[8:11], a[84:87]
    ds_write_b128 v17, a[76:79] offset:8192
    v_mfma_f32_16x16x32_bf16 a[84:87], a[220:223], a[12:15], a[84:87]
    s_waitcnt vmcnt(7)
    v_mfma_f32_16x16x32_bf16 a[88:91], v[96:99], a[16:19], a[88:91]
    v_mfma_f32_16x16x32_bf16 a[88:91], a[192:195], a[20:23], a[88:91]
    buffer_load_dwordx4 v[244:247], v30, s[16:19], s69 offen offset:1024 sc1
    v_mfma_f32_16x16x32_bf16 a[88:91], a[208:211], a[24:27], a[88:91]
    ds_write_b128 v16, a[80:83] offset:8320
    v_mfma_f32_16x16x32_bf16 a[92:95], v[100:103], a[16:19], a[92:95]
    v_mfma_f32_16x16x32_bf16 a[92:95], a[196:199], a[20:23], a[92:95]
    s_nop 0
    ds_write_b128 v17, a[84:87] offset:8320
    v_mfma_f32_16x16x32_bf16 a[92:95], a[212:215], a[24:27], a[92:95]
    buffer_load_dwordx4 a[0:3], v31, s[16:19], s37 offen offset:0 sc1
    v_mfma_f32_16x16x32_bf16 a[96:99], v[104:107], a[16:19], a[96:99]
    v_mfma_f32_16x16x32_bf16 a[96:99], a[200:203], a[20:23], a[96:99]
    ds_write_b128 v16, a[88:91] offset:12288
    v_mfma_f32_16x16x32_bf16 a[96:99], a[216:219], a[24:27], a[96:99]
    v_mfma_f32_16x16x32_bf16 a[100:103], v[108:111], a[16:19], a[100:103]
    buffer_load_dwordx4 a[4:7], v31, s[16:19], s38 offen offset:0 sc1
    v_mfma_f32_16x16x32_bf16 a[100:103], a[204:207], a[20:23], a[100:103]
    s_nop 0
    ds_write_b128 v17, a[92:95] offset:12288
    v_mfma_f32_16x16x32_bf16 a[100:103], a[220:223], a[24:27], a[100:103]
    s_waitcnt vmcnt(8)
    v_mfma_f32_16x16x32_bf16 a[40:43], v[208:211], a[28:31], a[40:43]
    v_mfma_f32_16x16x32_bf16 a[40:43], v[64:67], a[32:35], a[40:43]
    buffer_load_dwordx4 a[8:11], v31, s[16:19], s39 offen offset:0 sc1
    v_mfma_f32_16x16x32_bf16 a[44:47], v[212:215], a[28:31], a[44:47]
    ds_write_b128 v16, a[96:99] offset:12416
    v_mfma_f32_16x16x32_bf16 a[44:47], v[68:71], a[32:35], a[44:47]
    v_mfma_f32_16x16x32_bf16 a[48:51], v[216:219], a[28:31], a[48:51]
    s_nop 0
    ds_write_b128 v17, a[100:103] offset:12416
    v_mfma_f32_16x16x32_bf16 a[48:51], v[72:75], a[32:35], a[48:51]
    buffer_load_dwordx4 a[12:15], v31, s[16:19], s40 offen offset:0 sc1
    v_mfma_f32_16x16x32_bf16 a[52:55], v[220:223], a[28:31], a[52:55]
    v_mfma_f32_16x16x32_bf16 a[52:55], v[76:79], a[32:35], a[52:55]
    s_waitcnt vmcnt(8)
    v_mfma_f32_16x16x32_bf16 a[40:43], v[80:83], v[224:227], a[40:43]
    v_mfma_f32_16x16x32_bf16 a[40:43], v[96:99], v[228:231], a[40:43]
    v_mfma_f32_16x16x32_bf16 a[44:47], v[84:87], v[224:227], a[44:47]
    v_mfma_f32_16x16x32_bf16 a[44:47], v[100:103], v[228:231], a[44:47]
    v_mfma_f32_16x16x32_bf16 a[48:51], v[88:91], v[224:227], a[48:51]
    v_mfma_f32_16x16x32_bf16 a[48:51], v[104:107], v[228:231], a[48:51]
    v_mfma_f32_16x16x32_bf16 a[52:55], v[92:95], v[224:227], a[52:55]
    s_nop 3
    ds_write_b128 v16, a[40:43] offset:0
    v_mfma_f32_16x16x32_bf16 a[52:55], v[108:111], v[228:231], a[52:55]
    s_waitcnt vmcnt(6)
    v_mfma_f32_16x16x32_bf16 a[56:59], v[208:211], v[232:235], a[56:59]
    ds_write_b128 v17, a[44:47] offset:0
    v_mfma_f32_16x16x32_bf16 a[56:59], v[64:67], v[236:239], a[56:59]
    v_mfma_f32_16x16x32_bf16 a[60:63], v[212:215], v[232:235], a[60:63]
    ds_write_b128 v16, a[48:51] offset:128
    v_mfma_f32_16x16x32_bf16 a[60:63], v[68:71], v[236:239], a[60:63]
    v_mfma_f32_16x16x32_bf16 a[64:67], v[216:219], v[232:235], a[64:67]
    s_nop 0
    ds_write_b128 v17, a[52:55] offset:128
    v_mfma_f32_16x16x32_bf16 a[64:67], v[72:75], v[236:239], a[64:67]
    v_mfma_f32_16x16x32_bf16 a[68:71], v[220:223], v[232:235], a[68:71]
    v_mfma_f32_16x16x32_bf16 a[68:71], v[76:79], v[236:239], a[68:71]
    s_waitcnt vmcnt(4)
    v_mfma_f32_16x16x32_bf16 a[56:59], v[80:83], v[240:243], a[56:59]
    v_mfma_f32_16x16x32_bf16 a[56:59], v[96:99], v[244:247], a[56:59]
    v_mfma_f32_16x16x32_bf16 a[60:63], v[84:87], v[240:243], a[60:63]
    v_mfma_f32_16x16x32_bf16 a[60:63], v[100:103], v[244:247], a[60:63]
    v_mfma_f32_16x16x32_bf16 a[64:67], v[88:91], v[240:243], a[64:67]
    v_mfma_f32_16x16x32_bf16 a[64:67], v[104:107], v[244:247], a[64:67]
    v_mfma_f32_16x16x32_bf16 a[68:71], v[92:95], v[240:243], a[68:71]
    s_nop 3
    ds_write_b128 v16, a[56:59] offset:4096
    v_mfma_f32_16x16x32_bf16 a[68:71], v[108:111], v[244:247], a[68:71]
    s_waitcnt vmcnt(2)
    v_mfma_f32_16x16x32_bf16 a[104:107], a[160:163], a[0:3], a[104:107]
    ds_write_b128 v17, a[60:63] offset:4096
    v_mfma_f32_16x16x32_bf16 a[104:107], a[176:179], a[4:7], a[104:107]
    v_mfma_f32_16x16x32_bf16 a[108:111], a[164:167], a[0:3], a[108:111]
    ds_write_b128 v16, a[64:67] offset:4224
    v_mfma_f32_16x16x32_bf16 a[108:111], a[180:183], a[4:7], a[108:111]
    v_mfma_f32_16x16x32_bf16 a[112:115], a[168:171], a[0:3], a[112:115]
    s_nop 0
    ds_write_b128 v17, a[68:71] offset:4224
    v_mfma_f32_16x16x32_bf16 a[112:115], a[184:187], a[4:7], a[112:115]
    v_mfma_f32_16x16x32_bf16 a[116:119], a[172:175], a[0:3], a[116:119]
    v_mfma_f32_16x16x32_bf16 a[116:119], a[188:191], a[4:7], a[116:119]
    s_waitcnt vmcnt(0)
    v_mfma_f32_16x16x32_bf16 a[104:107], a[192:195], a[8:11], a[104:107]
    v_mfma_f32_16x16x32_bf16 a[104:107], a[208:211], a[12:15], a[104:107]
    v_mfma_f32_16x16x32_bf16 a[108:111], a[196:199], a[8:11], a[108:111]
    v_mfma_f32_16x16x32_bf16 a[108:111], a[212:215], a[12:15], a[108:111]
    v_mfma_f32_16x16x32_bf16 a[112:115], a[200:203], a[8:11], a[112:115]
    v_mfma_f32_16x16x32_bf16 a[112:115], a[216:219], a[12:15], a[112:115]
    v_mfma_f32_16x16x32_bf16 a[116:119], a[204:207], a[8:11], a[116:119]
    s_nop 3
    ds_write_b128 v16, a[104:107] offset:16384
    v_mfma_f32_16x16x32_bf16 a[116:119], a[220:223], a[12:15], a[116:119]
    ds_write_b128 v17, a[108:111] offset:16384
    s_nop 0
    ds_write_b128 v16, a[112:115] offset:16512
    s_nop 5
    ds_write_b128 v17, a[116:119] offset:16512
    s_waitcnt lgkmcnt(0)
    s_barrier
    ds_read_b128 v[32:35], v8 offset:0
    ds_read_b128 v[36:39], v9 offset:0
    ds_read_b128 v[40:43], v8 offset:20480
    ds_read_b128 v[44:47], v9 offset:20480
    ds_read_b128 v[48:51], v10 offset:0
    ds_read_b128 v[52:55], v11 offset:0
    ds_read_b128 v[56:59], v10 offset:20480
    ds_read_b128 v[60:63], v11 offset:20480
    ds_read_b128 v[64:67], v8 offset:8192
    ds_read_b128 v[68:71], v9 offset:8192
    ds_read_b128 v[72:75], v8 offset:28672
    ds_read_b128 v[76:79], v9 offset:28672
    ds_read_b128 v[80:83], v10 offset:8192
    ds_read_b128 v[84:87], v11 offset:8192
    ds_read_b128 v[88:91], v10 offset:28672
    ds_read_b128 v[92:95], v11 offset:28672
    s_waitcnt lgkmcnt(12)
    v_pk_add_f32 v[32:33], v[32:33], v[40:41]
    v_pk_add_f32 v[34:35], v[34:35], v[42:43]
    v_pk_add_f32 v[36:37], v[36:37], v[44:45]
    v_pk_add_f32 v[38:39], v[38:39], v[46:47]
    s_waitcnt lgkmcnt(8)
    ds_read_b128 v[96:99], v12 offset:16384
    ds_read_b128 v[100:103], v12 offset:36864
    ds_read_b128 v[104:107], v13 offset:16384
    ds_read_b128 v[108:111], v13 offset:36864
    v_pk_add_f32 v[48:49], v[48:49], v[56:57]
    v_pk_add_f32 v[50:51], v[50:51], v[58:59]
    v_pk_add_f32 v[52:53], v[52:53], v[60:61]
    v_pk_add_f32 v[54:55], v[54:55], v[62:63]
    v_pk_add_f32 v[32:33], v[32:33], v[48:49]
    v_pk_add_f32 v[34:35], v[34:35], v[50:51]
    v_pk_add_f32 v[36:37], v[36:37], v[52:53]
    v_pk_add_f32 v[38:39], v[38:39], v[54:55]
    v_cvt_pk_bf16_f32 v40, v32, v33
    v_cvt_pk_bf16_f32 v41, v34, v35
    v_cvt_pk_bf16_f32 v42, v36, v37
    v_cvt_pk_bf16_f32 v43, v38, v39
    buffer_store_dwordx4 v[40:43], v18, s[24:27], s53 offen nt
    s_add_u32 s53, s53, 40960
    s_waitcnt lgkmcnt(8)
    v_pk_add_f32 v[64:65], v[64:65], v[72:73]
    v_pk_add_f32 v[66:67], v[66:67], v[74:75]
    v_pk_add_f32 v[68:69], v[68:69], v[76:77]
    v_pk_add_f32 v[70:71], v[70:71], v[78:79]
    s_waitcnt lgkmcnt(4)
    v_pk_add_f32 v[80:81], v[80:81], v[88:89]
    v_pk_add_f32 v[82:83], v[82:83], v[90:91]
    v_pk_add_f32 v[84:85], v[84:85], v[92:93]
    v_pk_add_f32 v[86:87], v[86:87], v[94:95]
    v_pk_add_f32 v[64:65], v[64:65], v[80:81]
    v_pk_add_f32 v[66:67], v[66:67], v[82:83]
    v_pk_add_f32 v[68:69], v[68:69], v[84:85]
    v_pk_add_f32 v[70:71], v[70:71], v[86:87]
    v_cvt_pk_bf16_f32 v72, v64, v65
    v_cvt_pk_bf16_f32 v73, v66, v67
    v_cvt_pk_bf16_f32 v74, v68, v69
    v_cvt_pk_bf16_f32 v75, v70, v71
    buffer_store_dwordx4 v[72:75], v18, s[24:27], s53 offen nt
    s_add_u32 s53, s53, 40960
    s_waitcnt lgkmcnt(2)
    v_pk_add_f32 v[96:97], v[96:97], v[100:101]
    v_pk_add_f32 v[98:99], v[98:99], v[102:103]
    s_waitcnt lgkmcnt(0)
    v_pk_add_f32 v[104:105], v[104:105], v[108:109]
    v_pk_add_f32 v[106:107], v[106:107], v[110:111]
    v_pk_add_f32 v[96:97], v[96:97], v[104:105]
    v_pk_add_f32 v[98:99], v[98:99], v[106:107]
    v_cvt_pk_bf16_f32 v100, v96, v97
    v_cvt_pk_bf16_f32 v101, v98, v99
    buffer_store_dwordx2 v[100:101], v19, s[24:27], s53 offen nt
    s_endpgm
L_slow_n2c0:
    s_mov_b32 s62, 0x3ff0
    s_mov_b32 s63, 0x0
    s_mov_b64 exec, s[62:63]
    buffer_load_dword v26, v25, s[28:31], 0 offen offset:0 sc1
    s_mov_b64 exec, -1
    s_waitcnt vmcnt(0)
    v_cmp_eq_u32 vcc, s50, v26
    s_andn2_b64 s[62:63], s[62:63], vcc
    s_cbranch_scc0 L_ok_n2c0
    s_cmp_eq_u32 s52, 0
    s_cbranch_scc1 L_ok_n2c0
    s_sub_u32 s52, s52, 1
    s_sleep 1
    s_branch L_slow_n2c0
L_slow_n2c1:
    s_mov_b32 s62, 0x7f
    s_mov_b32 s63, 0x0
    s_mov_b64 exec, s[62:63]
    buffer_load_dword v26, v25, s[28:31], 0 offen offset:128 sc1
    s_mov_b64 exec, -1
    s_waitcnt vmcnt(0)
    v_cmp_eq_u32 vcc, s50, v26
    s_andn2_b64 s[62:63], s[62:63], vcc
    s_cbranch_scc0 L_ok_n2c1
    s_cmp_eq_u32 s52, 0
    s_cbranch_scc1 L_ok_n2c1
    s_sub_u32 s52, s52, 1
    s_sleep 1
    s_branch L_slow_n2c1
L_slow_n2c2:
    s_mov_b32 s62, 0xf
    s_mov_b32 s63, 0x0
    s_mov_b64 exec, s[62:63]
    buffer_load_dword v26, v25, s[28:31], 0 offen offset:256 sc1
    s_mov_b64 exec, -1
    s_waitcnt vmcnt(0)
    v_cmp_eq_u32 vcc, s50, v26
    s_andn2_b64 s[62:63], s[62:63], vcc
    s_cbranch_scc0 L_ok_n2c2
    s_cmp_eq_u32 s52, 0
    s_cbranch_scc1 L_ok_n2c2
    s_sub_u32 s52, s52, 1
    s_sleep 1
    s_branch L_slow_n2c2
L_slow_n2c3:
    s_mov_b32 s62, 0x3c0f
    s_mov_b32 s63, 0x0
    s_mov_b64 exec, s[62:63]
    buffer_load_dword v26, v25, s[28:31], 0 offen offset:384 sc1
    s_mov_b64 exec, -1
    s_waitcnt vmcnt(0)
    v_cmp_eq_u32 vcc, s50, v26
    s_andn2_b64 s[62:63], s[62:63], vcc
    s_cbranch_scc0 L_ok_n2c3
    s_cmp_eq_u32 s52, 0
    s_cbranch_scc1 L_ok_n2c3
    s_sub_u32 s52, s52, 1
    s_sleep 1
    s_branch L_slow_n2c3
.p2align 12
L_var3:
L_tv3_0:
    s_cbranch_execz L_base
    v_mfma_f32_16x16x32_bf16 v[48:51], a[112:115], v[136:139], v[48:51]
    ds_read_b128 v[136:139], v16 offset:14336
    s_load_dword s74, s[70:71], 22400
    s_load_dword s75, s[70:71], 23680
    v_mfma_f32_16x16x32_bf16 v[48:51], a[120:123], v[140:143], v[48:51]
    ds_read_b64_tr_b16 v[190:191], v7 offset:512
    s_load_dword s76, s[70:71], 24960
    s_waitcnt lgkmcnt(8)
    v_mfma_f32_16x16x32_bf16 v[52:55], a[64:67], v[112:115], v[52:55]
    ds_read_b128 v[140:143], v17 offset:14336
    s_load_dword s77, s[70:71], 17280
    v_mfma_f32_16x16x32_bf16 v[52:55], a[72:75], v[116:119], v[52:55]
    buffer_load_dwordx4 v235, s[20:23], s47 offen offset:3072 lds
    v_mfma_f32_16x16x32_bf16 v[60:63], a[68:71], v[112:115], v[60:63]
    s_waitcnt vmcnt(8)
    s_barrier
    s_cmp_lg_u32 s36, 0
    s_cbranch_scc1 L_pub_n31
    s_atomic_swap s50, s[64:65], 128
L_pub_n31:
    ds_read_b128 v[112:115], v16 offset:18432
    v_mfma_f32_16x16x32_bf16 v[60:63], a[76:79], v[116:119], v[60:63]
    ds_read_b64_tr_b16 v[192:193], v4 offset:16384
    s_add_u32 m0, s44, 49152
    s_waitcnt lgkmcnt(8)
    v_mfma_f32_16x16x32_bf16 v[60:63], a[84:87], v[120:123], v[60:63]
    ds_read_b128 v[116:119], v17 offset:18432
    v_mfma_f32_16x16x32_bf16 v[60:63], a[92:95], v[124:127], v[60:63]
    buffer_load_dwordx4 v8, s[8:11], s46 offen offset:0 lds
    v_mfma_f32_16x16x32_bf16 v[52:55], a[80:83], v[120:123], v[52:55]
    ds_read_b128 v[120:123], v16 offset:22528
    v_mfma_f32_16x16x32_bf16 v[52:55], a[88:91], v[124:127], v[52:55]
    ds_read_b64_tr_b16 v[194:195], v4 offset:16896
    s_waitcnt lgkmcnt(8)
    v_mfma_f32_16x16x32_bf16 v[52:55], a[96:99], v[128:131], v[52:55]
    ds_read_b128 v[124:127], v17 offset:22528
    v_mfma_f32_16x16x32_bf16 v[52:55], a[104:107], v[132:135], v[52:55]
    buffer_load_dwordx4 v9, s[8:11], s46 offen offset:1024 lds
    v_mfma_f32_16x16x32_bf16 v[60:63], a[100:103], v[128:131], v[60:63]
    ds_read_b128 v[128:131], v16 offset:16384
    s_mov_b32 s47, s54
    s_add_u32 s54, s54, s55
    v_mfma_f32_16x16x32_bf16 v[60:63], a[108:111], v[132:135], v[60:63]
    ds_read_b64_tr_b16 v[196:197], v5 offset:16384
    s_waitcnt lgkmcnt(8)
    v_mfma_f32_16x16x32_bf16 v[60:63], a[116:119], v[136:139], v[60:63]
    ds_read_b128 v[132:135], v17 offset:16384
    v_mfma_f32_16x16x32_bf16 v[60:63], a[124:127], v[140:143], v[60:63]
    buffer_load_dwordx4 v10, s[8:11], s46 offen offset:2048 lds
    v_mfma_f32_16x16x32_bf16 v[52:55], a[112:115], v[136:139], v[52:55]
    ds_read_b128 v[136:139], v16 offset:20480
    v_mfma_f32_16x16x32_bf16 v[52:55], a[120:123], v[140:143], v[52:55]
    ds_read_b64_tr_b16 v[198:199], v5 offset:16896
    s_waitcnt lgkmcnt(8)
    v_mfma_f32_16x16x32_bf16 v[52:55], a[128:131], v[112:115], v[52:55]
    ds_read_b128 v[140:143], v17 offset:20480
    v_mfma_f32_16x16x32_bf16 v[52:55], a[136:139], v[116:119], v[52:55]
    buffer_load_dwordx4 v11, s[8:11], s46 offen offset:3072 lds
    v_mfma_f32_16x16x32_bf16 v[60:63], a[132:135], v[112:115], v[60:63]
    ds_read_b128 v[112:115], v16 offset:26624
    s_add_u32 m0, s45, 49152
    s_load_dword s78, s[70:71], 26240
    v_mfma_f32_16x16x32_bf16 v[60:63], a[140:143], v[116:119], v[60:63]
    ds_read_b64_tr_b16 v[200:201], v6 offset:16384
    s_load_dword s79, s[70:71], 27520
    s_waitcnt lgkmcnt(8)
    v_mfma_f32_16x16x32_bf16 v[60:63], a[148:151], v[120:123], v[60:63]
    ds_read_b128 v[116:119], v17 offset:26624
    s_load_dword s80, s[70:71], 28800
    s_load_dword s81, s[70:71], 18560
    v_mfma_f32_16x16x32_bf16 v[60:63], a[156:159], v[124:127], v[60:63]
    buffer_load_dwordx4 v232, s[20:23], s47 offen offset:0 lds
    v_mfma_f32_16x16x32_bf16 v[52:55], a[144:147], v[120:123], v[52:55]
    ds_read_b128 v[120:123], v16 offset:30720
    v_mfma_f32_16x16x32_bf16 v[52:55], a[152:155], v[124:127], v[52:55]
    ds_read_b64_tr_b16 v[202:203], v6 offset:16896
    s_waitcnt lgkmcnt(8)
    v_mfma_f32_16x16x32_bf16 v[48:51], a[128:131], v[128:131], v[48:51]
    ds_read_b128 v[124:127], v17 offset:30720
    v_mfma_f32_16x16x32_bf16 v[48:51], a[136:139], v[132:135], v[48:51]
    buffer_load_dwordx4 v233, s[20:23], s47 offen offset:1024 lds
    v_mfma_f32_16x16x32_bf16 v[56:59], a[132:135], v[128:131], v[56:59]
    ds_read_b128 v[128:131], v16 offset:24576
    s_mov_b32 s46, s54
    s_add_u32 s54, s54, s55
    v_mfma_f32_16x16x32_bf16 v[56:59], a[140:143], v[132:135], v[56:59]
    ds_read_b64_tr_b16 v[204:205], v7 offset:16384
    s_waitcnt lgkmcnt(8)
    v_mfma_f32_16x16x32_bf16 v[56:59], a[148:151], v[136:139], v[56:59]
    ds_read_b128 v[132:135], v17 offset:24576
    v_mfma_f32_16x16x32_bf16 v[56:59], a[156:159], v[140:143], v[56:59]
    buffer_load_dwordx4 v234, s[20:23], s47 offen offset:2048 lds
    v_mfma_f32_16x16x32_bf16 v[48:51], a[144:147], v[136:139], v[48:51]
    ds_read_b128 v[136:139], v16 offset:28672
    v_mfma_f32_16x16x32_bf16 v[48:51], a[152:155], v[140:143], v[48:51]
    ds_read_b64_tr_b16 v[206:207], v7 offset:16896
    s_waitcnt lgkmcnt(8)
    v_mfma_f32_16x16x32_bf16 v[36:39], a[0:3], v[112:115], 0
    ds_read_b128 v[140:143], v17 offset:28672
    v_mfma_f32_16x16x32_bf16 v[36:39], a[8:11], v[116:119], v[36:39]
    buffer_load_dwordx4 v235, s[20:23], s47 offen offset:3072 lds
    v_mfma_f32_16x16x32_bf16 v[44:47], a[4:7], v[112:115], 0
    s_waitcnt vmcnt(8)
    s_barrier
    ds_read_b128 v[112:115], v16 offset:32768
    v_mfma_f32_16x16x32_bf16 v[44:47], a[12:15], v[116:119], v[44:47]
    ds_read_b64_tr_b16 v[208:209], v4 offset:32768
    s_add_u32 m0, s45, 0
    s_waitcnt lgkmcnt(8)
    v_mfma_f32_16x16x32_bf16 v[44:47], a[20:23], v[120:123], v[44:47]
    ds_read_b128 v[116:119], v17 offset:32768
    v_readlane_b32 s88, v24, 6
    v_mul_f32 v48, v48, v56
    v_mul_f32 v49, v49, v57
    v_mfma_f32_16x16x32_bf16 v[44:47], a[28:31], v[124:127], v[44:47]
    buffer_load_dwordx4 v232, s[20:23], s46 offen offset:0 lds
    v_mul_f32 v50, v50, v58
    v_mfma_f32_16x16x32_bf16 v[36:39], a[16:19], v[120:123], v[36:39]
    ds_read_b128 v[120:123], v16 offset:36864
    s_load_dword s82, s[70:71], 19840
    s_load_dword s83, s[70:71], 21120
    v_mfma_f32_16x16x32_bf16 v[36:39], a[24:27], v[124:127], v[36:39]
    ds_read_b64_tr_b16 v[210:211], v4 offset:33280
    v_mul_f32 v51, v51, v59
    v_mul_f32 v52, v52, v60
    s_waitcnt lgkmcnt(8)
    v_mfma_f32_16x16x32_bf16 v[32:35], a[0:3], v[128:131], 0
    ds_read_b128 v[124:127], v17 offset:36864
    v_mul_f32 v53, v53, v61
    v_mfma_f32_16x16x32_bf16 v[32:35], a[8:11], v[132:135], v[32:35]
    buffer_load_dwordx4 v233, s[20:23], s46 offen offset:1024 lds
    v_mul_f32 v54, v54, v62
    v_mfma_f32_16x16x32_bf16 v[40:43], a[4:7], v[128:131], 0
    ds_read_b128 v[128:131], v16 offset:40960
    s_min_u32 s47, s54, 2211840
    v_mul_f32 v55, v55, v63
    v_mfma_f32_16x16x32_bf16 v[40:43], a[12:15], v[132:135], v[40:43]
    ds_read_b64_tr_b16 v[212:213], v5 offset:32768
    v_cvt_pk_bf16_f32 v56, v48, v49
    v_cvt_pk_bf16_f32 v58, v52, v53
    s_waitcnt lgkmcnt(8)
    v_mfma_f32_16x16x32_bf16 v[40:43], a[20:23], v[136:139], v[40:43]
    ds_read_b128 v[132:135], v17 offset:40960
    v_cvt_pk_bf16_f32 v57, v50, v51
    v_mfma_f32_16x16x32_bf16 v[40:43], a[28:31], v[140:143], v[40:43]
    buffer_load_dwordx4 v234, s[20:23], s46 offen offset:2048 lds
    v_cvt_pk_bf16_f32 v59, v54, v55
    v_mfma_f32_16x16x32_bf16 v[32:35], a[16:19], v[136:139], v[32:35]
    ds_read_b128 v[136:139], v16 offset:45056
    v_permlane16_swap_b32 v56, v58
    v_mfma_f32_16x16x32_bf16 v[32:35], a[24:27], v[140:143], v[32:35]
    ds_read_b64_tr_b16 v[214:215], v5 offset:33280
    v_permlane16_swap_b32 v57, v59
    buffer_store_dwordx4 v[56:59], v21, s[16:19], s88 offen sc1
    s_waitcnt lgkmcnt(8)
    v_mfma_f32_16x16x32_bf16 v[32:35], a[32:35], v[112:115], v[32:35]
    ds_read_b128 v[140:143], v17 offset:45056
    v_mfma_f32_16x16x32_bf16 v[32:35], a[40:43], v[116:119], v[32:35]
    buffer_load_dwordx4 v235, s[20:23], s46 offen offset:3072 lds
    v_mfma_f32_16x16x32_bf16 v[40:43], a[36:39], v[112:115], v[40:43]
    ds_read_b128 v[112:115], v16 offset:34816
    s_add_u32 m0, s45, 16384
    v_mfma_f32_16x16x32_bf16 v[40:43], a[44:47], v[116:119], v[40:43]
    ds_read_b64_tr_b16 v[216:217], v6 offset:32768
    s_waitcnt lgkmcnt(8)
    v_mfma_f32_16x16x32_bf16 v[40:43], a[52:55], v[120:123], v[40:43]
    ds_read_b128 v[116:119], v17 offset:34816
    v_mfma_f32_16x16x32_bf16 v[40:43], a[60:63], v[124:127], v[40:43]
    buffer_load_dwordx4 v232, s[20:23], s47 offen offset:0 lds
    v_mfma_f32_16x16x32_bf16 v[32:35], a[48:51], v[120:123], v[32:35]
    ds_read_b128 v[120:123], v16 offset:38912
    v_mfma_f32_16x16x32_bf16 v[32:35], a[56:59], v[124:127], v[32:35]
    ds_read_b64_tr_b16 v[218:219], v6 offset:33280
    s_waitcnt lgkmcnt(8)
    v_mfma_f32_16x16x32_bf16 v[32:35], a[64:67], v[128:131], v[32:35]
    ds_read_b128 v[124:127], v17 offset:38912
    v_mfma_f32_16x16x32_bf16 v[32:35], a[72:75], v[132:135], v[32:35]
    buffer_load_dwordx4 v233, s[20:23], s47 offen offset:1024 lds
    v_mfma_f32_16x16x32_bf16 v[40:43], a[68:71], v[128:131], v[40:43]
    ds_read_b128 v[128:131], v16 offset:43008
    v_mfma_f32_16x16x32_bf16 v[40:43], a[76:79], v[132:135], v[40:43]
    ds_read_b64_tr_b16 v[220:221], v7 offset:32768
    s_waitcnt lgkmcnt(8)
    v_mfma_f32_16x16x32_bf16 v[40:43], a[84:87], v[136:139], v[40:43]
    ds_read_b128 v[132:135], v17 offset:43008
    v_mfma_f32_16x16x32_bf16 v[40:43], a[92:95], v[140:143], v[40:43]
    buffer_load_dwordx4 v234, s[20:23], s47 offen offset:2048 lds
    v_mfma_f32_16x16x32_bf16 v[32:35], a[80:83], v[136:139], v[32:35]
    ds_read_b128 v[136:139], v16 offset:47104
    v_mfma_f32_16x16x32_bf16 v[32:35], a[88:91], v[140:143], v[32:35]
    ds_read_b64_tr_b16 v[222:223], v7 offset:33280
    s_waitcnt lgkmcnt(8)
    v_mfma_f32_16x16x32_bf16 v[36:39], a[32:35], v[112:115], v[36:39]
    s_waitcnt lgkmcnt(0)
    s_xor_b64 s[74:75], s[74:75], s[50:51]
    s_xor_b64 s[76:77], s[76:77], s[50:51]
    s_xor_b64 s[78:79], s[78:79], s[50:51]
    s_xor_b64 s[80:81], s[80:81], s[50:51]
    s_xor_b64 s[82:83], s[82:83], s[50:51]
    s_or_b64 s[74:75], s[74:75], s[76:77]
    s_or_b64 s[74:75], s[74:75], s[78:79]
    s_or_b64 s[74:75], s[74:75], s[80:81]
    s_or_b64 s[74:75], s[74:75], s[82:83]
    s_cbranch_scc1 L_slow_n3c0
L_ok_n3c0:
    ds_read_b128 v[140:143], v17 offset:47104
    v_mfma_f32_16x16x32_bf16 v[36:39], a[40:43], v[116:119], v[36:39]
    buffer_load_dwordx4 v235, s[20:23], s47 offen offset:3072 lds
    v_mfma_f32_16x16x32_bf16 v[44:47], a[36:39], v[112:115], v[44:47]
    s_waitcnt vmcnt(9)
    s_barrier
    ds_read_b128 v[112:115], v16 offset:51200
    v_mfma_f32_16x16x32_bf16 v[44:47], a[44:47], v[116:119], v[44:47]
    ds_read_b64_tr_b16 v[64:65], v4 offset:49152
    v_mfma_f32_16x16x32_bf16 v[44:47], a[52:55], v[120:123], v[44:47]
    ds_read_b128 v[116:119], v17 offset:51200
    v_mfma_f32_16x16x32_bf16 v[44:47], a[60:63], v[124:127], v[44:47]
    buffer_load_dwordx4 v[224:227], v30, s[16:19], s41 offen offset:0 sc1
    v_mfma_f32_16x16x32_bf16 v[36:39], a[48:51], v[120:123], v[36:39]
    ds_read_b128 v[120:123], v16 offset:55296
    v_mfma_f32_16x16x32_bf16 v[36:39], a[56:59], v[124:127], v[36:39]
    ds_read_b64_tr_b16 v[66:67], v4 offset:49664
    v_mfma_f32_16x16x32_bf16 v[36:39], a[64:67], v[128:131], v[36:39]
    ds_read_b128 v[124:127], v17 offset:55296
    v_mfma_f32_16x16x32_bf16 v[36:39], a[72:75], v[132:135], v[36:39]
    buffer_load_dwordx4 v[228:231], v30, s[16:19], s42 offen offset:0 sc1
    v_mfma_f32_16x16x32_bf16 v[44:47], a[68:71], v[128:131], v[44:47]
    ds_read_b128 v[128:131], v16 offset:59392
    v_mfma_f32_16x16x32_bf16 v[44:47], a[76:79], v[132:135], v[44:47]
    ds_read_b64_tr_b16 v[68:69], v5 offset:49152
    s_waitcnt lgkmcnt(8)
    v_mfma_f32_16x16x32_bf16 v[44:47], a[84:87], v[136:139], v[44:47]
    ds_read_b128 v[132:135], v17 offset:59392
    v_mfma_f32_16x16x32_bf16 v[44:47], a[92:95], v[140:143], v[44:47]
    buffer_load_dwordx4 v[232:235], v30, s[16:19], s41 offen offset:1024 sc1
    v_mfma_f32_16x16x32_bf16 v[36:39], a[80:83], v[136:139], v[36:39]
    ds_read_b128 v[136:139], v16 offset:63488
    v_mfma_f32_16x16x32_bf16 v[36:39], a[88:91], v[140:143], v[36:39]
    ds_read_b64_tr_b16 v[70:71], v5 offset:49664
    s_waitcnt lgkmcnt(8)
    v_mfma_f32_16x16x32_bf16 v[36:39], a[96:99], v[112:115], v[36:39]
    ds_read_b128 v[140:143], v17 offset:63488
    v_mfma_f32_16x16x32_bf16 v[36:39], a[104:107], v[116:119], v[36:39]
    buffer_load_dwordx4 v[236:239], v30, s[16:19], s42 offen offset:1024 sc1
    v_mfma_f32_16x16x32_bf16 v[44:47], a[100:103], v[112:115], v[44:47]
    ds_read_b128 v[112:115], v16 offset:49152
    v_mfma_f32_16x16x32_bf16 v[44:47], a[108:111], v[116:119], v[44:47]
    ds_read_b64_tr_b16 v[72:73], v6 offset:49152
    s_waitcnt lgkmcnt(8)
    v_mfma_f32_16x16x32_bf16 v[44:47], a[116:119], v[120:123], v[44:47]
    ds_read_b128 v[116:119], v17 offset:49152
    v_mfma_f32_16x16x32_bf16 v[44:47], a[124:127], v[124:127], v[44:47]
    buffer_load_dwordx4 v[240:243], v30, s[16:19], s41 offen offset:2048 sc1
    v_mfma_f32_16x16x32_bf16 v[36:39], a[112:115], v[120:123], v[36:39]
    ds_read_b128 v[120:123], v16 offset:53248
    v_mfma_f32_16x16x32_bf16 v[36:39], a[120:123], v[124:127], v[36:39]
    ds_read_b64_tr_b16 v[74:75], v6 offset:49664
    s_waitcnt lgkmcnt(8)
    v_mfma_f32_16x16x32_bf16 v[36:39], a[128:131], v[128:131], v[36:39]
    ds_read_b128 v[124:127], v17 offset:53248
    v_mfma_f32_16x16x32_bf16 v[36:39], a[136:139], v[132:135], v[36:39]
    buffer_load_dwordx4 v[244:247], v30, s[16:19], s42 offen offset:2048 sc1
    v_mfma_f32_16x16x32_bf16 v[44:47], a[132:135], v[128:131], v[44:47]
    ds_read_b128 v[128:131], v16 offset:57344
    v_mfma_f32_16x16x32_bf16 v[44:47], a[140:143], v[132:135], v[44:47]
    ds_read_b64_tr_b16 v[76:77], v7 offset:49152
    s_waitcnt lgkmcnt(8)
    v_mfma_f32_16x16x32_bf16 v[44:47], a[148:151], v[136:139], v[44:47]
    ds_read_b128 v[132:135], v17 offset:57344
    v_mfma_f32_16x16x32_bf16 v[44:47], a[156:159], v[140:143], v[44:47]
    buffer_load_dwordx4 a[0:3], v30, s[16:19], s41 offen offset:3072 sc1
    v_mfma_f32_16x16x32_bf16 v[36:39], a[144:147], v[136:139], v[36:39]
    ds_read_b128 v[136:139], v16 offset:61440
    v_mfma_f32_16x16x32_bf16 v[36:39], a[152:155], v[140:143], v[36:39]
    ds_read_b64_tr_b16 v[78:79], v7 offset:49664
    s_waitcnt lgkmcnt(8)
    v_mfma_f32_16x16x32_bf16 v[32:35], a[96:99], v[112:115], v[32:35]
    ds_read_b128 v[140:143], v17 offset:61440
    v_mfma_f32_16x16x32_bf16 v[32:35], a[104:107], v[116:119], v[32:35]
    buffer_load_dwordx4 a[4:7], v30, s[16:19], s42 offen offset:3072 sc1
    v_mfma_f32_16x16x32_bf16 v[40:43], a[100:103], v[112:115], v[40:43]
    s_waitcnt vmcnt(12)
    v_mfma_f32_16x16x32_bf16 v[40:43], a[108:111], v[116:119], v[40:43]
    ds_read_b64_tr_b16 v[80:81], v4 offset:0
    s_waitcnt lgkmcnt(7)
    v_mfma_f32_16x16x32_bf16 v[40:43], a[116:119], v[120:123], v[40:43]
    v_mfma_f32_16x16x32_bf16 v[40:43], a[124:127], v[124:127], v[40:43]
    ds_read_b64_tr_b16 v[82:83], v4 offset:512
    buffer_load_dwordx4 a[8:11], v31, s[16:19], s41 offen offset:0 sc1
    v_mfma_f32_16x16x32_bf16 v[32:35], a[112:115], v[120:123], v[32:35]
    v_mfma_f32_16x16x32_bf16 v[32:35], a[120:123], v[124:127], v[32:35]
    ds_read_b64_tr_b16 v[84:85], v5 offset:0
    s_waitcnt lgkmcnt(6)
    v_mfma_f32_16x16x32_bf16 v[32:35], a[128:131], v[128:131], v[32:35]
    v_mfma_f32_16x16x32_bf16 v[32:35], a[136:139], v[132:135], v[32:35]
    ds_read_b64_tr_b16 v[86:87], v5 offset:512
    buffer_load_dwordx4 a[12:15], v31, s[16:19], s42 offen offset:0 sc1
    v_mfma_f32_16x16x32_bf16 v[40:43], a[132:135], v[128:131], v[40:43]
    v_mfma_f32_16x16x32_bf16 v[40:43], a[140:143], v[132:135], v[40:43]
    ds_read_b64_tr_b16 v[88:89], v6 offset:0
    s_waitcnt lgkmcnt(5)
    v_mfma_f32_16x16x32_bf16 v[40:43], a[148:151], v[136:139], v[40:43]
    v_mfma_f32_16x16x32_bf16 v[40:43], a[156:159], v[140:143], v[40:43]
    ds_read_b64_tr_b16 v[90:91], v6 offset:512
    v_mfma_f32_16x16x32_bf16 v[32:35], a[144:147], v[136:139], v[32:35]
    v_mfma_f32_16x16x32_bf16 v[32:35], a[152:155], v[140:143], v[32:35]
    ds_read_b64_tr_b16 v[92:93], v7 offset:0
    ds_read_b64_tr_b16 v[94:95], v7 offset:512
    s_waitcnt vmcnt(8)
    v_mfma_f32_16x16x32_bf16 a[40:43], a[224:227], v[224:227], 0
    s_barrier
    s_cmp_lg_u32 s36, 0
    s_cbranch_scc1 L_pub_n32
    s_atomic_swap s50, s[64:65], 256
L_pub_n32:
    v_mfma_f32_16x16x32_bf16 a[40:43], a[240:243], v[228:231], a[40:43]
    buffer_load_dwordx4 a[16:19], v30, s[16:19], s49 offen offset:0 sc1
    v_mfma_f32_16x16x32_bf16 a[44:47], a[228:231], v[224:227], 0
    v_readlane_b32 s89, v24, 7
    v_mul_f32 v32, v32, v40
    v_mfma_f32_16x16x32_bf16 a[44:47], a[244:247], v[228:231], a[44:47]
    v_mul_f32 v33, v33, v41
    v_mul_f32 v34, v34, v42
    v_mfma_f32_16x16x32_bf16 a[48:51], a[232:235], v[224:227], 0
    v_mul_f32 v35, v35, v43
    v_mul_f32 v36, v36, v44
    v_mfma_f32_16x16x32_bf16 a[48:51], a[248:251], v[228:231], a[48:51]
    buffer_load_dwordx4 a[20:23], v30, s[16:19], s37 offen offset:0 sc1
    v_mfma_f32_16x16x32_bf16 a[52:55], a[236:239], v[224:227], 0
    v_mul_f32 v37, v37, v45
    v_mul_f32 v38, v38, v46
    v_mfma_f32_16x16x32_bf16 a[52:55], a[252:255], v[228:231], a[52:55]
    v_mul_f32 v39, v39, v47
    v_cvt_pk_bf16_f32 v40, v32, v33
    s_waitcnt vmcnt(8)
    v_mfma_f32_16x16x32_bf16 a[56:59], a[224:227], v[232:235], 0
    v_cvt_pk_bf16_f32 v42, v36, v37
    v_cvt_pk_bf16_f32 v41, v34, v35
    v_mfma_f32_16x16x32_bf16 a[56:59], a[240:243], v[236:239], a[56:59]
    buffer_load_dwordx4 a[24:27], v30, s[16:19], s49 offen offset:1024 sc1
    v_mfma_f32_16x16x32_bf16 a[60:63], a[228:231], v[232:235], 0
    v_cvt_pk_bf16_f32 v43, v38, v39
    s_nop 1
    v_permlane16_swap_b32 v40, v42
    v_mfma_f32_16x16x32_bf16 a[60:63], a[244:247], v[236:239], a[60:63]
    v_permlane16_swap_b32 v41, v43
    buffer_store_dwordx4 v[40:43], v21, s[16:19], s89 offen sc1
    v_mfma_f32_16x16x32_bf16 a[64:67], a[232:235], v[232:235], 0
    v_mfma_f32_16x16x32_bf16 a[64:67], a[248:251], v[236:239], a[64:67]
    buffer_load_dwordx4 a[28:31], v30, s[16:19], s37 offen offset:1024 sc1
    v_mfma_f32_16x16x32_bf16 a[68:71], a[236:239], v[232:235], 0
    v_mfma_f32_16x16x32_bf16 a[68:71], a[252:255], v[236:239], a[68:71]
    ds_read_b64_tr_b16 v[96:97], v4 offset:16384
    s_waitcnt vmcnt(9)
    v_mfma_f32_16x16x32_bf16 a[72:75], a[224:227], v[240:243], 0
    ds_read_b64_tr_b16 v[98:99], v4 offset:16896
    v_mfma_f32_16x16x32_bf16 a[72:75], a[240:243], v[244:247], a[72:75]
    buffer_load_dwordx4 a[32:35], v30, s[16:19], s49 offen offset:2048 sc1
    v_mfma_f32_16x16x32_bf16 a[76:79], a[228:231], v[240:243], 0
    v_mfma_f32_16x16x32_bf16 a[76:79], a[244:247], v[244:247], a[76:79]
    ds_read_b64_tr_b16 v[100:101], v5 offset:16384
    v_mfma_f32_16x16x32_bf16 a[80:83], a[232:235], v[240:243], 0
    ds_read_b64_tr_b16 v[102:103], v5 offset:16896
    v_mfma_f32_16x16x32_bf16 a[80:83], a[248:251], v[244:247], a[80:83]
    buffer_load_dwordx4 v[224:227], v30, s[16:19], s57 offen offset:2048 sc1
    v_mfma_f32_16x16x32_bf16 a[84:87], a[236:239], v[240:243], 0
    v_mfma_f32_16x16x32_bf16 a[84:87], a[252:255], v[244:247], a[84:87]
    ds_read_b64_tr_b16 v[104:105], v6 offset:16384
    s_waitcnt vmcnt(9)
    v_mfma_f32_16x16x32_bf16 a[88:91], a[224:227], a[0:3], 0
    ds_read_b64_tr_b16 v[106:107], v6 offset:16896
    v_mfma_f32_16x16x32_bf16 a[88:91], a[240:243], a[4:7], a[88:91]
    buffer_load_dwordx4 v[228:231], v30, s[16:19], s49 offen offset:3072 sc1
    v_mfma_f32_16x16x32_bf16 a[92:95], a[228:231], a[0:3], 0
    v_mfma_f32_16x16x32_bf16 a[92:95], a[244:247], a[4:7], a[92:95]
    ds_read_b64_tr_b16 v[108:109], v7 offset:16384
    v_mfma_f32_16x16x32_bf16 a[96:99], a[232:235], a[0:3], 0
    ds_read_b64_tr_b16 v[110:111], v7 offset:16896
    v_mfma_f32_16x16x32_bf16 a[96:99], a[248:251], a[4:7], a[96:99]
    buffer_load_dwordx4 v[232:235], v30, s[16:19], s57 offen offset:3072 sc1
    v_mfma_f32_16x16x32_bf16 a[100:103], a[236:239], a[0:3], 0
    v_mfma_f32_16x16x32_bf16 a[100:103], a[252:255], a[4:7], a[100:103]
    s_waitcnt vmcnt(9)
    v_mfma_f32_16x16x32_bf16 a[104:107], a[224:227], a[8:11], 0
    v_mfma_f32_16x16x32_bf16 a[104:107], a[240:243], a[12:15], a[104:107]
    buffer_load_dwordx4 v[236:239], v31, s[16:19], s49 offen offset:0 sc1
    v_mfma_f32_16x16x32_bf16 a[108:111], a[228:231], a[8:11], 0
    v_mfma_f32_16x16x32_bf16 a[108:111], a[244:247], a[12:15], a[108:111]
    v_mfma_f32_16x16x32_bf16 a[112:115], a[232:235], a[8:11], 0
    v_mfma_f32_16x16x32_bf16 a[112:115], a[248:251], a[12:15], a[112:115]
    buffer_load_dwordx4 v[240:243], v31, s[16:19], s57 offen offset:0 sc1
    v_mfma_f32_16x16x32_bf16 a[116:119], a[236:239], a[8:11], 0
    v_mfma_f32_16x16x32_bf16 a[116:119], a[252:255], a[12:15], a[116:119]
    s_waitcnt vmcnt(9)
    v_mfma_f32_16x16x32_bf16 a[40:43], v[144:147], a[16:19], a[40:43]
    s_load_dword s74, s[70:71], 17408
    s_load_dword s75, s[70:71], 18688
    v_mfma_f32_16x16x32_bf16 a[40:43], a[160:163], a[20:23], a[40:43]
    buffer_load_dwordx4 v[244:247], v30, s[16:19], s58 offen offset:2048 sc1
    v_mfma_f32_16x16x32_bf16 a[44:47], v[148:151], a[16:19], a[44:47]
    s_load_dword s76, s[70:71], 19968
    v_mfma_f32_16x16x32_bf16 a[44:47], a[164:167], a[20:23], a[44:47]
    s_load_dword s77, s[70:71], 21248
    v_mfma_f32_16x16x32_bf16 a[48:51], v[152:155], a[16:19], a[48:51]
    s_load_dword s78, s[70:71], 31488
    s_load_dword s79, s[70:71], 32768
    v_mfma_f32_16x16x32_bf16 a[48:51], a[168:171], a[20:23], a[48:51]
    buffer_load_dwordx4 a[0:3], v30, s[16:19], s59 offen offset:2048 sc1
    v_mfma_f32_16x16x32_bf16 a[52:55], v[156:159], a[16:19], a[52:55]
    s_load_dword s80, s[72:73], 34048
    v_mfma_f32_16x16x32_bf16 a[52:55], a[172:175], a[20:23], a[52:55]
    s_load_dword s81, s[72:73], 34048
    s_waitcnt vmcnt(8)
    v_mfma_f32_16x16x32_bf16 a[56:59], v[144:147], a[24:27], a[56:59]
    s_waitcnt lgkmcnt(0)
    s_barrier
    s_cmp_lg_u32 s36, 0
    s_cbranch_scc1 L_pub_n33
    s_atomic_swap s50, s[64:65], 384
L_pub_n33:
    v_mfma_f32_16x16x32_bf16 a[56:59], a[160:163], a[28:31], a[56:59]
    buffer_load_dwordx4 a[4:7], v30, s[16:19], s58 offen offset:3072 sc1
    v_mfma_f32_16x16x32_bf16 a[60:63], v[148:151], a[24:27], a[60:63]
    v_mfma_f32_16x16x32_bf16 a[60:63], a[164:167], a[28:31], a[60:63]
    v_mfma_f32_16x16x32_bf16 a[64:67], v[152:155], a[24:27], a[64:67]
    v_mfma_f32_16x16x32_bf16 a[64:67], a[168:171], a[28:31], a[64:67]
    buffer_load_dwordx4 a[8:11], v30, s[16:19], s59 offen offset:3072 sc1
    v_mfma_f32_16x16x32_bf16 a[68:71], v[156:159], a[24:27], a[68:71]
    v_mfma_f32_16x16x32_bf16 a[68:71], a[172:175], a[28:31], a[68:71]
    s_waitcnt vmcnt(8)
    v_mfma_f32_16x16x32_bf16 a[72:75], v[144:147], a[32:35], a[72:75]
    v_and_b32 v1, 15, v0
    v_mfma_f32_16x16x32_bf16 a[72:75], v[160:163], v[224:227], a[72:75]
    buffer_load_dwordx4 a[12:15], v31, s[16:19], s58 offen offset:0 sc1
    v_mfma_f32_16x16x32_bf16 a[76:79], v[148:151], a[32:35], a[76:79]
    v_lshrrev_b32 v2, 4, v0
    v_mfma_f32_16x16x32_bf16 a[76:79], v[164:167], v[224:227], a[76:79]
    v_and_b32 v3, 7, v0
    v_mfma_f32_16x16x32_bf16 a[80:83], v[152:155], a[32:35], a[80:83]
    v_xor_b32 v2, v2, v3
    v_mfma_f32_16x16x32_bf16 a[80:83], v[168:171], v[224:227], a[80:83]
    buffer_load_dwordx4 a[16:19], v31, s[16:19], s59 offen offset:0 sc1
    v_mfma_f32_16x16x32_bf16 a[84:87], v[156:159], a[32:35], a[84:87]
    v_lshlrev_b32 v2, 4, v2
    v_mfma_f32_16x16x32_bf16 a[84:87], v[172:175], v[224:227], a[84:87]
    v_lshl_add_u32 v1, v1, 8, v2
    s_waitcnt vmcnt(8)
    v_mfma_f32_16x16x32_bf16 a[88:91], v[144:147], v[228:231], a[88:91]
    v_add_u32 v16, s43, v1
    v_mfma_f32_16x16x32_bf16 a[88:91], v[160:163], v[232:235], a[88:91]
    buffer_load_dwordx4 a[20:23], v30, s[16:19], s38 offen offset:0 sc1
    v_mfma_f32_16x16x32_bf16 a[92:95], v[148:151], v[228:231], a[92:95]
    v_xor_b32 v17, 64, v16
    v_mfma_f32_16x16x32_bf16 a[92:95], v[164:167], v[232:235], a[92:95]
    v_lshrrev_b32 v1, 3, v0
    v_mfma_f32_16x16x32_bf16 a[96:99], v[152:155], v[228:231], a[96:99]
    v_lshlrev_b32 v2, 1, v3
    v_mfma_f32_16x16x32_bf16 a[96:99], v[168:171], v[232:235], a[96:99]
    buffer_load_dwordx4 a[24:27], v30, s[16:19], s39 offen offset:0 sc1
    v_mfma_f32_16x16x32_bf16 a[100:103], v[156:159], v[228:231], a[100:103]
    v_xor_b32 v2, v2, v1
    v_mfma_f32_16x16x32_bf16 a[100:103], v[172:175], v[232:235], a[100:103]
    v_lshlrev_b32 v2, 4, v2
    s_waitcnt vmcnt(8)
    v_mfma_f32_16x16x32_bf16 a[104:107], v[144:147], v[236:239], a[104:107]
    s_lshl_b32 s61, s36, 3
    v_mfma_f32_16x16x32_bf16 a[104:107], v[160:163], v[240:243], a[104:107]
    buffer_load_dwordx4 a[28:31], v30, s[16:19], s38 offen offset:1024 sc1
    v_mfma_f32_16x16x32_bf16 a[108:111], v[148:151], v[236:239], a[108:111]
    v_add_u32 v1, s61, v1
    v_mfma_f32_16x16x32_bf16 a[108:111], v[164:167], v[240:243], a[108:111]
    v_lshl_add_u32 v8, v1, 8, v2
    v_mfma_f32_16x16x32_bf16 a[112:115], v[152:155], v[236:239], a[112:115]
    s_waitcnt lgkmcnt(0)
    v_mfma_f32_16x16x32_bf16 a[112:115], v[168:171], v[240:243], a[112:115]
    buffer_load_dwordx4 a[32:35], v30, s[16:19], s39 offen offset:1024 sc1
    v_mfma_f32_16x16x32_bf16 a[116:119], v[156:159], v[236:239], a[116:119]
    s_xor_b64 s[74:75], s[74:75], s[50:51]
    v_mfma_f32_16x16x32_bf16 a[116:119], v[172:175], v[240:243], a[116:119]
    s_xor_b64 s[76:77], s[76:77], s[50:51]
    s_waitcnt vmcnt(8)
    v_mfma_f32_16x16x32_bf16 a[72:75], v[176:179], v[244:247], a[72:75]
    s_xor_b64 s[78:79], s[78:79], s[50:51]
    v_mfma_f32_16x16x32_bf16 a[72:75], v[192:195], a[0:3], a[72:75]
    buffer_load_dwordx4 v[224:227], v30, s[16:19], s40 offen offset:0 sc1
    v_mfma_f32_16x16x32_bf16 a[76:79], v[180:183], v[244:247], a[76:79]
    s_xor_b64 s[80:81], s[80:81], s[50:51]
    v_mfma_f32_16x16x32_bf16 a[76:79], v[196:199], a[0:3], a[76:79]
    s_or_b64 s[74:75], s[74:75], s[76:77]
    v_mfma_f32_16x16x32_bf16 a[80:83], v[184:187], v[244:247], a[80:83]
    s_or_b64 s[74:75], s[74:75], s[78:79]
    v_mfma_f32_16x16x32_bf16 a[80:83], v[200:203], a[0:3], a[80:83]
    buffer_load_dwordx4 v[228:231], v30, s[16:19], s40 offen offset:1024 sc1
    v_mfma_f32_16x16x32_bf16 a[84:87], v[188:191], v[244:247], a[84:87]
    s_or_b64 s[74:75], s[74:75], s[80:81]
    s_cbranch_scc1 L_slow_n3c1
L_ok_n3c1:
    v_mfma_f32_16x16x32_bf16 a[84:87], v[204:207], a[0:3], a[84:87]
    s_waitcnt vmcnt(8)
    v_mfma_f32_16x16x32_bf16 a[88:91], v[176:179], a[4:7], a[88:91]
    v_xor_b32 v9, 16, v8
    v_mfma_f32_16x16x32_bf16 a[88:91], v[192:195], a[8:11], a[88:91]
    buffer_load_dwordx4 v[232:235], v30, s[16:19], s37 offen offset:2048 sc1
    v_mfma_f32_16x16x32_bf16 a[92:95], v[180:183], a[4:7], a[92:95]
    v_add_u32 v10, 40960, v8
    v_mfma_f32_16x16x32_bf16 a[92:95], v[196:199], a[8:11], a[92:95]
    v_add_u32 v11, 40960, v9
    v_mfma_f32_16x16x32_bf16 a[96:99], v[184:187], a[4:7], a[96:99]
    v_mul_u32_u24 v1, 1280, v1
    v_mfma_f32_16x16x32_bf16 a[96:99], v[200:203], a[8:11], a[96:99]
    buffer_load_dwordx4 v[236:239], v30, s[16:19], s38 offen offset:2048 sc1
    v_mfma_f32_16x16x32_bf16 a[100:103], v[188:191], a[4:7], a[100:103]
    v_lshl_add_u32 v18, v3, 4, v1
    v_mfma_f32_16x16x32_bf16 a[100:103], v[204:207], a[8:11], a[100:103]
    s_lshl_b32 s61, s36, 2
    s_waitcnt vmcnt(8)
    v_mfma_f32_16x16x32_bf16 a[104:107], v[176:179], a[12:15], a[104:107]
    v_lshrrev_b32 v1, 4, v0
    v_mfma_f32_16x16x32_bf16 a[104:107], v[192:195], a[16:19], a[104:107]
    buffer_load_dwordx4 v[240:243], v30, s[16:19], s37 offen offset:3072 sc1
    v_mfma_f32_16x16x32_bf16 a[108:111], v[180:183], a[12:15], a[108:111]
    v_add_u32 v1, s61, v1
    v_mfma_f32_16x16x32_bf16 a[108:111], v[196:199], a[16:19], a[108:111]
    v_and_b32 v2, 15, v0
    v_mfma_f32_16x16x32_bf16 a[112:115], v[184:187], a[12:15], a[112:115]
    s_load_dword s74, s[70:71], 30336
    s_load_dword s75, s[70:71], 31616
    v_mfma_f32_16x16x32_bf16 a[112:115], v[200:203], a[16:19], a[112:115]
    buffer_load_dwordx4 v[244:247], v30, s[16:19], s38 offen offset:3072 sc1
    v_mfma_f32_16x16x32_bf16 a[116:119], v[188:191], a[12:15], a[116:119]
    s_load_dword s76, s[70:71], 32896
    v_mfma_f32_16x16x32_bf16 a[116:119], v[204:207], a[16:19], a[116:119]
    s_load_dword s77, s[72:73], 34176
    s_waitcnt vmcnt(8)
    v_mfma_f32_16x16x32_bf16 a[40:43], a[176:179], a[20:23], a[40:43]
    v_and_b32 v3, 7, v1
    v_mfma_f32_16x16x32_bf16 a[40:43], a[192:195], a[24:27], a[40:43]
    buffer_load_dwordx4 a[0:3], v31, s[16:19], s37 offen offset:0 sc1
    v_mfma_f32_16x16x32_bf16 a[44:47], a[180:183], a[20:23], a[44:47]
    v_xor_b32 v3, v3, v2
    v_mfma_f32_16x16x32_bf16 a[44:47], a[196:199], a[24:27], a[44:47]
    v_lshlrev_b32 v3, 4, v3
    v_mfma_f32_16x16x32_bf16 a[48:51], a[184:187], a[20:23], a[48:51]
    v_lshl_add_u32 v12, v1, 8, v3
    v_mfma_f32_16x16x32_bf16 a[48:51], a[200:203], a[24:27], a[48:51]
    buffer_load_dwordx4 a[4:7], v31, s[16:19], s38 offen offset:0 sc1
    v_mfma_f32_16x16x32_bf16 a[52:55], a[188:191], a[20:23], a[52:55]
    v_add_u32 v13, 40960, v12
    v_mfma_f32_16x16x32_bf16 a[52:55], a[204:207], a[24:27], a[52:55]
    v_mul_u32_u24 v1, 1280, v1
    s_waitcnt vmcnt(8)
    v_mfma_f32_16x16x32_bf16 a[56:59], a[176:179], a[28:31], a[56:59]
    v_lshl_add_u32 v19, v2, 3, v1
    v_mfma_f32_16x16x32_bf16 a[56:59], a[192:195], a[32:35], a[56:59]
    buffer_load_dwordx4 a[8:11], v30, s[16:19], s39 offen offset:2048 sc1
    v_mfma_f32_16x16x32_bf16 a[60:63], a[180:183], a[28:31], a[60:63]
    v_mfma_f32_16x16x32_bf16 a[60:63], a[196:199], a[32:35], a[60:63]
    v_mfma_f32_16x16x32_bf16 a[64:67], a[184:187], a[28:31], a[64:67]
    v_mfma_f32_16x16x32_bf16 a[64:67], a[200:203], a[32:35], a[64:67]
    buffer_load_dwordx4 a[12:15], v30, s[16:19], s40 offen offset:2048 sc1
    v_mfma_f32_16x16x32_bf16 a[68:71], a[188:191], a[28:31], a[68:71]
    v_mfma_f32_16x16x32_bf16 a[68:71], a[204:207], a[32:35], a[68:71]
    s_waitcnt vmcnt(9)
    v_mfma_f32_16x16x32_bf16 a[40:43], a[208:211], v[224:227], a[40:43]
    v_mfma_f32_16x16x32_bf16 a[44:47], a[212:215], v[224:227], a[44:47]
    buffer_load_dwordx4 a[16:19], v30, s[16:19], s39 offen offset:3072 sc1
    v_mfma_f32_16x16x32_bf16 a[48:51], a[216:219], v[224:227], a[48:51]
    v_mfma_f32_16x16x32_bf16 a[52:55], a[220:223], v[224:227], a[52:55]
    s_waitcnt vmcnt(9)
    v_mfma_f32_16x16x32_bf16 a[56:59], a[208:211], v[228:231], a[56:59]
    v_mfma_f32_16x16x32_bf16 a[60:63], a[212:215], v[228:231], a[60:63]
    buffer_load_dwordx4 a[20:23], v30, s[16:19], s40 offen offset:3072 sc1
    v_mfma_f32_16x16x32_bf16 a[64:67], a[216:219], v[228:231], a[64:67]
    v_mfma_f32_16x16x32_bf16 a[68:71], a[220:223], v[228:231], a[68:71]
    s_waitcnt vmcnt(8)
    v_mfma_f32_16x16x32_bf16 a[72:75], a[160:163], v[232:235], a[72:75]
    v_mfma_f32_16x16x32_bf16 a[72:75], a[176:179], v[236:239], a[72:75]
    buffer_load_dwordx4 a[24:27], v31, s[16:19], s39 offen offset:0 sc1
    v_mfma_f32_16x16x32_bf16 a[76:79], a[164:167], v[232:235], a[76:79]
    v_mfma_f32_16x16x32_bf16 a[76:79], a[180:183], v[236:239], a[76:79]
L_tv3_1:
    s_cbranch_execz L_base
    v_mfma_f32_16x16x32_bf16 a[80:83], a[168:171], v[232:235], a[80:83]
    v_mfma_f32_16x16x32_bf16 a[80:83], a[184:187], v[236:239], a[80:83]
    buffer_load_dwordx4 a[28:31], v31, s[16:19], s40 offen offset:0 sc1
    v_mfma_f32_16x16x32_bf16 a[84:87], a[172:175], v[232:235], a[84:87]
    v_mfma_f32_16x16x32_bf16 a[84:87], a[188:191], v[236:239], a[84:87]
    s_waitcnt vmcnt(8)
    v_mfma_f32_16x16x32_bf16 a[88:91], a[160:163], v[240:243], a[88:91]
    s_waitcnt lgkmcnt(0)
    v_mfma_f32_16x16x32_bf16 a[88:91], a[176:179], v[244:247], a[88:91]
    buffer_load_dwordx4 a[32:35], v30, s[16:19], s67 offen offset:0 sc1
    v_mfma_f32_16x16x32_bf16 a[92:95], a[164:167], v[240:243], a[92:95]
    s_xor_b64 s[74:75], s[74:75], s[50:51]
    v_mfma_f32_16x16x32_bf16 a[92:95], a[180:183], v[244:247], a[92:95]
    s_xor_b64 s[76:77], s[76:77], s[50:51]
    v_mfma_f32_16x16x32_bf16 a[96:99], a[168:171], v[240:243], a[96:99]
    s_or_b64 s[74:75], s[74:75], s[76:77]
    s_cbranch_scc1 L_slow_n3c2
L_ok_n3c2:
    v_mfma_f32_16x16x32_bf16 a[96:99], a[184:187], v[244:247], a[96:99]
    buffer_load_dwordx4 v[224:227], v30, s[16:19], s68 offen offset:0 sc1
    v_mfma_f32_16x16x32_bf16 a[100:103], a[172:175], v[240:243], a[100:103]
    v_mfma_f32_16x16x32_bf16 a[100:103], a[188:191], v[244:247], a[100:103]
    s_waitcnt vmcnt(8)
    v_mfma_f32_16x16x32_bf16 a[104:107], a[160:163], a[0:3], a[104:107]
    s_load_dword s74, s[70:71], 26624
    s_load_dword s75, s[70:71], 27904
    v_mfma_f32_16x16x32_bf16 a[104:107], a[176:179], a[4:7], a[104:107]
    buffer_load_dwordx4 v[228:231], v30, s[16:19], s67 offen offset:1024 sc1
    v_mfma_f32_16x16x32_bf16 a[108:111], a[164:167], a[0:3], a[108:111]
    s_load_dword s76, s[70:71], 29184
    v_mfma_f32_16x16x32_bf16 a[108:111], a[180:183], a[4:7], a[108:111]
    s_load_dword s77, s[70:71], 30464
    v_mfma_f32_16x16x32_bf16 a[112:115], a[168:171], a[0:3], a[112:115]
    s_load_dword s78, s[70:71], 31744
    s_load_dword s79, s[70:71], 33024
    v_mfma_f32_16x16x32_bf16 a[112:115], a[184:187], a[4:7], a[112:115]
    buffer_load_dwordx4 v[232:235], v30, s[16:19], s68 offen offset:1024 sc1
    v_mfma_f32_16x16x32_bf16 a[116:119], a[172:175], a[0:3], a[116:119]
    s_load_dword s80, s[72:73], 34304
    v_mfma_f32_16x16x32_bf16 a[116:119], a[188:191], a[4:7], a[116:119]
    s_load_dword s81, s[72:73], 34304
    s_waitcnt vmcnt(8)
    v_mfma_f32_16x16x32_bf16 a[72:75], a[192:195], a[8:11], a[72:75]
    v_mfma_f32_16x16x32_bf16 a[72:75], a[208:211], a[12:15], a[72:75]
    buffer_load_dwordx4 v[236:239], v30, s[16:19], s69 offen offset:0 sc1
    v_mfma_f32_16x16x32_bf16 a[76:79], a[196:199], a[8:11], a[76:79]
    v_mfma_f32_16x16x32_bf16 a[76:79], a[212:215], a[12:15], a[76:79]
    v_mfma_f32_16x16x32_bf16 a[80:83], a[200:203], a[8:11], a[80:83]
    v_mfma_f32_16x16x32_bf16 a[80:83], a[216:219], a[12:15], a[80:83]
    buffer_load_dwordx4 v[240:243], v30, s[16:19], s69 offen offset:1024 sc1
    v_mfma_f32_16x16x32_bf16 a[84:87], a[204:207], a[8:11], a[84:87]
    v_mfma_f32_16x16x32_bf16 a[84:87], a[220:223], a[12:15], a[84:87]
    s_waitcnt vmcnt(8)
    v_mfma_f32_16x16x32_bf16 a[88:91], a[192:195], a[16:19], a[88:91]
    v_mfma_f32_16x16x32_bf16 a[88:91], a[208:211], a[20:23], a[88:91]
    buffer_load_dwordx4 v[244:247], v30, s[16:19], s66 offen offset:2048 sc1
    v_mfma_f32_16x16x32_bf16 a[92:95], a[196:199], a[16:19], a[92:95]
    v_mfma_f32_16x16x32_bf16 a[92:95], a[212:215], a[20:23], a[92:95]
    v_mfma_f32_16x16x32_bf16 a[96:99], a[200:203], a[16:19], a[96:99]
    v_mfma_f32_16x16x32_bf16 a[96:99], a[216:219], a[20:23], a[96:99]
    buffer_load_dwordx4 a[0:3], v30, s[16:19], s66 offen offset:3072 sc1
    v_mfma_f32_16x16x32_bf16 a[100:103], a[204:207], a[16:19], a[100:103]
    v_mfma_f32_16x16x32_bf16 a[100:103], a[220:223], a[20:23], a[100:103]
    s_waitcnt vmcnt(8)
    v_mfma_f32_16x16x32_bf16 a[104:107], a[192:195], a[24:27], a[104:107]
    v_mfma_f32_16x16x32_bf16 a[104:107], a[208:211], a[28:31], a[104:107]
    buffer_load_dwordx4 a[4:7], v30, s[16:19], s67 offen offset:2048 sc1
    v_mfma_f32_16x16x32_bf16 a[108:111], a[196:199], a[24:27], a[108:111]
    v_mfma_f32_16x16x32_bf16 a[108:111], a[212:215], a[28:31], a[108:111]
    v_mfma_f32_16x16x32_bf16 a[112:115], a[200:203], a[24:27], a[112:115]
    v_mfma_f32_16x16x32_bf16 a[112:115], a[216:219], a[28:31], a[112:115]
    buffer_load_dwordx4 a[8:11], v30, s[16:19], s68 offen offset:2048 sc1
    v_mfma_f32_16x16x32_bf16 a[116:119], a[204:207], a[24:27], a[116:119]
    v_mfma_f32_16x16x32_bf16 a[116:119], a[220:223], a[28:31], a[116:119]
    s_waitcnt vmcnt(8)
    v_mfma_f32_16x16x32_bf16 a[40:43], v[64:67], a[32:35], a[40:43]
    v_mfma_f32_16x16x32_bf16 a[40:43], v[80:83], v[224:227], a[40:43]
    buffer_load_dwordx4 a[12:15], v30, s[16:19], s69 offen offset:2048 sc1
    v_mfma_f32_16x16x32_bf16 a[44:47], v[68:71], a[32:35], a[44:47]
    v_mfma_f32_16x16x32_bf16 a[44:47], v[84:87], v[224:227], a[44:47]
    v_mfma_f32_16x16x32_bf16 a[48:51], v[72:75], a[32:35], a[48:51]
    s_waitcnt lgkmcnt(0)
    v_mfma_f32_16x16x32_bf16 a[48:51], v[88:91], v[224:227], a[48:51]
    buffer_load_dwordx4 a[16:19], v30, s[16:19], s67 offen offset:3072 sc1
    v_mfma_f32_16x16x32_bf16 a[52:55], v[76:79], a[32:35], a[52:55]
    s_xor_b64 s[74:75], s[74:75], s[50:51]
    v_mfma_f32_16x16x32_bf16 a[52:55], v[92:95], v[224:227], a[52:55]
    s_xor_b64 s[76:77], s[76:77], s[50:51]
    s_waitcnt vmcnt(8)
    v_mfma_f32_16x16x32_bf16 a[56:59], v[64:67], v[228:231], a[56:59]
    s_xor_b64 s[78:79], s[78:79], s[50:51]
    v_mfma_f32_16x16x32_bf16 a[56:59], v[80:83], v[232:235], a[56:59]
    buffer_load_dwordx4 a[20:23], v30, s[16:19], s68 offen offset:3072 sc1
    v_mfma_f32_16x16x32_bf16 a[60:63], v[68:71], v[228:231], a[60:63]
    s_xor_b64 s[80:81], s[80:81], s[50:51]
    v_mfma_f32_16x16x32_bf16 a[60:63], v[84:87], v[232:235], a[60:63]
    s_or_b64 s[74:75], s[74:75], s[76:77]
    v_mfma_f32_16x16x32_bf16 a[64:67], v[72:75], v[228:231], a[64:67]
    s_or_b64 s[74:75], s[74:75], s[78:79]
    v_mfma_f32_16x16x32_bf16 a[64:67], v[88:91], v[232:235], a[64:67]
    buffer_load_dwordx4 a[24:27], v30, s[16:19], s69 offen offset:3072 sc1
    v_mfma_f32_16x16x32_bf16 a[68:71], v[76:79], v[228:231], a[68:71]
    s_or_b64 s[74:75], s[74:75], s[80:81]
    s_cbranch_scc1 L_slow_n3c3
L_ok_n3c3:
    v_mfma_f32_16x16x32_bf16 a[68:71], v[92:95], v[232:235], a[68:71]
    s_waitcnt vmcnt(9)
    v_mfma_f32_16x16x32_bf16 a[40:43], v[96:99], v[236:239], a[40:43]
    v_mfma_f32_16x16x32_bf16 a[44:47], v[100:103], v[236:239], a[44:47]
    buffer_load_dwordx4 a[28:31], v30, s[16:19], s57 offen offset:0 sc1
    v_mfma_f32_16x16x32_bf16 a[48:51], v[104:107], v[236:239], a[48:51]
    v_mfma_f32_16x16x32_bf16 a[52:55], v[108:111], v[236:239], a[52:55]
    s_waitcnt vmcnt(9)
    v_mfma_f32_16x16x32_bf16 a[56:59], v[96:99], v[240:243], a[56:59]
    v_mfma_f32_16x16x32_bf16 a[60:63], v[100:103], v[240:243], a[60:63]
    buffer_load_dwordx4 a[32:35], v30, s[16:19], s58 offen offset:0 sc1
    v_mfma_f32_16x16x32_bf16 a[64:67], v[104:107], v[240:243], a[64:67]
    v_mfma_f32_16x16x32_bf16 a[68:71], v[108:111], v[240:243], a[68:71]
    s_waitcnt vmcnt(9)
    v_mfma_f32_16x16x32_bf16 a[72:75], v[208:211], v[244:247], a[72:75]
    v_mfma_f32_16x16x32_bf16 a[76:79], v[212:215], v[244:247], a[76:79]
    buffer_load_dwordx4 v[224:227], v30, s[16:19], s59 offen offset:0 sc1
    v_mfma_f32_16x16x32_bf16 a[80:83], v[216:219], v[244:247], a[80:83]
    v_mfma_f32_16x16x32_bf16 a[84:87], v[220:223], v[244:247], a[84:87]
    s_waitcnt vmcnt(9)
    v_mfma_f32_16x16x32_bf16 a[88:91], v[208:211], a[0:3], a[88:91]
    v_mfma_f32_16x16x32_bf16 a[92:95], v[212:215], a[0:3], a[92:95]
    buffer_load_dwordx4 v[228:231], v30, s[16:19], s66 offen offset:0 sc1
    v_mfma_f32_16x16x32_bf16 a[96:99], v[216:219], a[0:3], a[96:99]
    v_mfma_f32_16x16x32_bf16 a[100:103], v[220:223], a[0:3], a[100:103]
    s_waitcnt vmcnt(7)
    v_mfma_f32_16x16x32_bf16 a[72:75], v[64:67], a[4:7], a[72:75]
    v_mfma_f32_16x16x32_bf16 a[72:75], v[80:83], a[8:11], a[72:75]
    buffer_load_dwordx4 v[232:235], v30, s[16:19], s57 offen offset:1024 sc1
    v_mfma_f32_16x16x32_bf16 a[72:75], v[96:99], a[12:15], a[72:75]
    v_mfma_f32_16x16x32_bf16 a[76:79], v[68:71], a[4:7], a[76:79]
    v_mfma_f32_16x16x32_bf16 a[76:79], v[84:87], a[8:11], a[76:79]
    v_mfma_f32_16x16x32_bf16 a[76:79], v[100:103], a[12:15], a[76:79]
    buffer_load_dwordx4 v[236:239], v30, s[16:19], s58 offen offset:1024 sc1
    v_mfma_f32_16x16x32_bf16 a[80:83], v[72:75], a[4:7], a[80:83]
    v_mfma_f32_16x16x32_bf16 a[80:83], v[88:91], a[8:11], a[80:83]
    s_nop 2
    ds_write_b128 v16, a[72:75] offset:8192
    v_mfma_f32_16x16x32_bf16 a[80:83], v[104:107], a[12:15], a[80:83]
    v_mfma_f32_16x16x32_bf16 a[84:87], v[76:79], a[4:7], a[84:87]
    buffer_load_dwordx4 v[240:243], v30, s[16:19], s59 offen offset:1024 sc1
    v_mfma_f32_16x16x32_bf16 a[84:87], v[92:95], a[8:11], a[84:87]
    ds_write_b128 v17, a[76:79] offset:8192
    v_mfma_f32_16x16x32_bf16 a[84:87], v[108:111], a[12:15], a[84:87]
    s_waitcnt vmcnt(7)
    v_mfma_f32_16x16x32_bf16 a[88:91], v[64:67], a[16:19], a[88:91]
    v_mfma_f32_16x16x32_bf16 a[88:91], v[80:83], a[20:23], a[88:91]
    buffer_load_dwordx4 v[244:247], v30, s[16:19], s66 offen offset:1024 sc1
    v_mfma_f32_16x16x32_bf16 a[88:91], v[96:99], a[24:27], a[88:91]
    ds_write_b128 v16, a[80:83] offset:8320
    v_mfma_f32_16x16x32_bf16 a[92:95], v[68:71], a[16:19], a[92:95]
    v_mfma_f32_16x16x32_bf16 a[92:95], v[84:87], a[20:23], a[92:95]
    s_nop 0
    ds_write_b128 v17, a[84:87] offset:8320
    v_mfma_f32_16x16x32_bf16 a[92:95], v[100:103], a[24:27], a[92:95]
    buffer_load_dwordx4 a[0:3], v31, s[16:19], s66 offen offset:0 sc1
    v_mfma_f32_16x16x32_bf16 a[96:99], v[72:75], a[16:19], a[96:99]
    v_mfma_f32_16x16x32_bf16 a[96:99], v[88:91], a[20:23], a[96:99]
    ds_write_b128 v16, a[88:91] offset:12288
    v_mfma_f32_16x16x32_bf16 a[96:99], v[104:107], a[24:27], a[96:99]
    v_mfma_f32_16x16x32_bf16 a[100:103], v[76:79], a[16:19], a[100:103]
    buffer_load_dwordx4 a[4:7], v31, s[16:19], s67 offen offset:0 sc1
    v_mfma_f32_16x16x32_bf16 a[100:103], v[92:95], a[20:23], a[100:103]
    s_nop 0
    ds_write_b128 v17, a[92:95] offset:12288
    v_mfma_f32_16x16x32_bf16 a[100:103], v[108:111], a[24:27], a[100:103]
    s_waitcnt vmcnt(8)
    v_mfma_f32_16x16x32_bf16 a[40:43], v[160:163], a[28:31], a[40:43]
    v_mfma_f32_16x16x32_bf16 a[40:43], v[176:179], a[32:35], a[40:43]
    buffer_load_dwordx4 a[8:11], v31, s[16:19], s68 offen offset:0 sc1
    v_mfma_f32_16x16x32_bf16 a[44:47], v[164:167], a[28:31], a[44:47]
    ds_write_b128 v16, a[96:99] offset:12416
    v_mfma_f32_16x16x32_bf16 a[44:47], v[180:183], a[32:35], a[44:47]
    v_mfma_f32_16x16x32_bf16 a[48:51], v[168:171], a[28:31], a[48:51]
    s_nop 0
    ds_write_b128 v17, a[100:103] offset:12416
    v_mfma_f32_16x16x32_bf16 a[48:51], v[184:187], a[32:35], a[48:51]
    buffer_load_dwordx4 a[12:15], v31, s[16:19], s69 offen offset:0 sc1
    v_mfma_f32_16x16x32_bf16 a[52:55], v[172:175], a[28:31], a[52:55]
    v_mfma_f32_16x16x32_bf16 a[52:55], v[188:191], a[32:35], a[52:55]
    s_waitcnt vmcnt(8)
    v_mfma_f32_16x16x32_bf16 a[40:43], v[192:195], v[224:227], a[40:43]
    v_mfma_f32_16x16x32_bf16 a[40:43], v[208:211], v[228:231], a[40:43]
    v_mfma_f32_16x16x32_bf16 a[44:47], v[196:199], v[224:227], a[44:47]
    v_mfma_f32_16x16x32_bf16 a[44:47], v[212:215], v[228:231], a[44:47]
    v_mfma_f32_16x16x32_bf16 a[48:51], v[200:203], v[224:227], a[48:51]
    v_mfma_f32_16x16x32_bf16 a[48:51], v[216:219], v[228:231], a[48:51]
    v_mfma_f32_16x16x32_bf16 a[52:55], v[204:207], v[224:227], a[52:55]
    s_nop 3
    ds_write_b128 v16, a[40:43] offset:0
    v_mfma_f32_16x16x32_bf16 a[52:55], v[220:223], v[228:231], a[52:55]
    s_waitcnt vmcnt(6)
    v_mfma_f32_16x16x32_bf16 a[56:59], v[160:163], v[232:235], a[56:59]
    ds_write_b128 v17, a[44:47] offset:0
    v_mfma_f32_16x16x32_bf16 a[56:59], v[176:179], v[236:239], a[56:59]
    v_mfma_f32_16x16x32_bf16 a[60:63], v[164:167], v[232:235], a[60:63]
    ds_write_b128 v16, a[48:51] offset:128
    v_mfma_f32_16x16x32_bf16 a[60:63], v[180:183], v[236:239], a[60:63]
    v_mfma_f32_16x16x32_bf16 a[64:67], v[168:171], v[232:235], a[64:67]
    s_nop 0
    ds_write_b128 v17, a[52:55] offset:128
    v_mfma_f32_16x16x32_bf16 a[64:67], v[184:187], v[236:239], a[64:67]
    v_mfma_f32_16x16x32_bf16 a[68:71], v[172:175], v[232:235], a[68:71]
    v_mfma_f32_16x16x32_bf16 a[68:71], v[188:191], v[236:239], a[68:71]
    s_waitcnt vmcnt(4)
    v_mfma_f32_16x16x32_bf16 a[56:59], v[192:195], v[240:243], a[56:59]
    v_mfma_f32_16x16x32_bf16 a[56:59], v[208:211], v[244:247], a[56:59]
    v_mfma_f32_16x16x32_bf16 a[60:63], v[196:199], v[240:243], a[60:63]
    v_mfma_f32_16x16x32_bf16 a[60:63], v[212:215], v[244:247], a[60:63]
    v_mfma_f32_16x16x32_bf16 a[64:67], v[200:203], v[240:243], a[64:67]
    v_mfma_f32_16x16x32_bf16 a[64:67], v[216:219], v[244:247], a[64:67]
    v_mfma_f32_16x16x32_bf16 a[68:71], v[204:207], v[240:243], a[68:71]
    s_nop 3
    ds_write_b128 v16, a[56:59] offset:4096
    v_mfma_f32_16x16x32_bf16 a[68:71], v[220:223], v[244:247], a[68:71]
    s_waitcnt vmcnt(2)
    v_mfma_f32_16x16x32_bf16 a[104:107], v[208:211], a[0:3], a[104:107]
    ds_write_b128 v17, a[60:63] offset:4096
    v_mfma_f32_16x16x32_bf16 a[104:107], v[64:67], a[4:7], a[104:107]
    v_mfma_f32_16x16x32_bf16 a[108:111], v[212:215], a[0:3], a[108:111]
    ds_write_b128 v16, a[64:67] offset:4224
    v_mfma_f32_16x16x32_bf16 a[108:111], v[68:71], a[4:7], a[108:111]
    v_mfma_f32_16x16x32_bf16 a[112:115], v[216:219], a[0:3], a[112:115]
    s_nop 0
    ds_write_b128 v17, a[68:71] offset:4224
    v_mfma_f32_16x16x32_bf16 a[112:115], v[72:75], a[4:7], a[112:115]
    v_mfma_f32_16x16x32_bf16 a[116:119], v[220:223], a[0:3], a[116:119]
    v_mfma_f32_16x16x32_bf16 a[116:119], v[76:79], a[4:7], a[116:119]
    s_waitcnt vmcnt(0)
    v_mfma_f32_16x16x32_bf16 a[104:107], v[80:83], a[8:11], a[104:107]
    v_mfma_f32_16x16x32_bf16 a[104:107], v[96:99], a[12:15], a[104:107]
    v_mfma_f32_16x16x32_bf16 a[108:111], v[84:87], a[8:11], a[108:111]
    v_mfma_f32_16x16x32_bf16 a[108:111], v[100:103], a[12:15], a[108:111]
    v_mfma_f32_16x16x32_bf16 a[112:115], v[88:91], a[8:11], a[112:115]
    v_mfma_f32_16x16x32_bf16 a[112:115], v[104:107], a[12:15], a[112:115]
    v_mfma_f32_16x16x32_bf16 a[116:119], v[92:95], a[8:11], a[116:119]
    s_nop 3
    ds_write_b128 v16, a[104:107] offset:16384
    v_mfma_f32_16x16x32_bf16 a[116:119], v[108:111], a[12:15], a[116:119]
    ds_write_b128 v17, a[108:111] offset:16384
    s_nop 0
    ds_write_b128 v16, a[112:115] offset:16512
    s_nop 5
    ds_write_b128 v17, a[116:119] offset:16512
    s_waitcnt lgkmcnt(0)
    s_barrier
    ds_read_b128 v[32:35], v8 offset:0
    ds_read_b128 v[36:39], v9 offset:0
    ds_read_b128 v[40:43], v8 offset:20480
    ds_read_b128 v[44:47], v9 offset:20480
    ds_read_b128 v[48:51], v10 offset:0
    ds_read_b128 v[52:55], v11 offset:0
    ds_read_b128 v[56:59], v10 offset:20480
    ds_read_b128 v[60:63], v11 offset:20480
    ds_read_b128 v[64:67], v8 offset:8192
    ds_read_b128 v[68:71], v9 offset:8192
    ds_read_b128 v[72:75], v8 offset:28672
    ds_read_b128 v[76:79], v9 offset:28672
    ds_read_b128 v[80:83], v10 offset:8192
    ds_read_b128 v[84:87], v11 offset:8192
    ds_read_b128 v[88:91], v10 offset:28672
    ds_read_b128 v[92:95], v11 offset:28672
    s_waitcnt lgkmcnt(12)
    v_pk_add_f32 v[32:33], v[32:33], v[40:41]
    v_pk_add_f32 v[34:35], v[34:35], v[42:43]
    v_pk_add_f32 v[36:37], v[36:37], v[44:45]
    v_pk_add_f32 v[38:39], v[38:39], v[46:47]
    s_waitcnt lgkmcnt(8)
    ds_read_b128 v[96:99], v12 offset:16384
    ds_read_b128 v[100:103], v12 offset:36864
    ds_read_b128 v[104:107], v13 offset:16384
    ds_read_b128 v[108:111], v13 offset:36864
    v_pk_add_f32 v[48:49], v[48:49], v[56:57]
    v_pk_add_f32 v[50:51], v[50:51], v[58:59]
    v_pk_add_f32 v[52:53], v[52:53], v[60:61]
    v_pk_add_f32 v[54:55], v[54:55], v[62:63]
    v_pk_add_f32 v[32:33], v[32:33], v[48:49]
    v_pk_add_f32 v[34:35], v[34:35], v[50:51]
    v_pk_add_f32 v[36:37], v[36:37], v[52:53]
    v_pk_add_f32 v[38:39], v[38:39], v[54:55]
    v_cvt_pk_bf16_f32 v40, v32, v33
    v_cvt_pk_bf16_f32 v41, v34, v35
    v_cvt_pk_bf16_f32 v42, v36, v37
    v_cvt_pk_bf16_f32 v43, v38, v39
    buffer_store_dwordx4 v[40:43], v18, s[24:27], s53 offen nt
    s_add_u32 s53, s53, 40960
    s_waitcnt lgkmcnt(8)
    v_pk_add_f32 v[64:65], v[64:65], v[72:73]
    v_pk_add_f32 v[66:67], v[66:67], v[74:75]
    v_pk_add_f32 v[68:69], v[68:69], v[76:77]
    v_pk_add_f32 v[70:71], v[70:71], v[78:79]
    s_waitcnt lgkmcnt(4)
    v_pk_add_f32 v[80:81], v[80:81], v[88:89]
    v_pk_add_f32 v[82:83], v[82:83], v[90:91]
    v_pk_add_f32 v[84:85], v[84:85], v[92:93]
    v_pk_add_f32 v[86:87], v[86:87], v[94:95]
    v_pk_add_f32 v[64:65], v[64:65], v[80:81]
    v_pk_add_f32 v[66:67], v[66:67], v[82:83]
    v_pk_add_f32 v[68:69], v[68:69], v[84:85]
    v_pk_add_f32 v[70:71], v[70:71], v[86:87]
    v_cvt_pk_bf16_f32 v72, v64, v65
    v_cvt_pk_bf16_f32 v73, v66, v67
    v_cvt_pk_bf16_f32 v74, v68, v69
    v_cvt_pk_bf16_f32 v75, v70, v71
    buffer_store_dwordx4 v[72:75], v18, s[24:27], s53 offen nt
    s_add_u32 s53, s53, 40960
    s_waitcnt lgkmcnt(2)
    v_pk_add_f32 v[96:97], v[96:97], v[100:101]
    v_pk_add_f32 v[98:99], v[98:99], v[102:103]
    s_waitcnt lgkmcnt(0)
    v_pk_add_f32 v[104:105], v[104:105], v[108:109]
    v_pk_add_f32 v[106:107], v[106:107], v[110:111]
    v_pk_add_f32 v[96:97], v[96:97], v[104:105]
    v_pk_add_f32 v[98:99], v[98:99], v[106:107]
    v_cvt_pk_bf16_f32 v100, v96, v97
    v_cvt_pk_bf16_f32 v101, v98, v99
    buffer_store_dwordx2 v[100:101], v19, s[24:27], s53 offen nt
    s_endpgm
L_slow_n3c0:
    s_mov_b32 s62, 0x3ff0000
    s_mov_b32 s63, 0x0
    s_mov_b64 exec, s[62:63]
    buffer_load_dword v26, v25, s[28:31], 0 offen offset:0 sc1
    s_mov_b64 exec, -1
    s_waitcnt vmcnt(0)
    v_cmp_eq_u32 vcc, s50, v26
    s_andn2_b64 s[62:63], s[62:63], vcc
    s_cbranch_scc0 L_ok_n3c0
    s_cmp_eq_u32 s52, 0
    s_cbranch_scc1 L_ok_n3c0
    s_sub_u32 s52, s52, 1
    s_sleep 1
    s_branch L_slow_n3c0
L_slow_n3c1:
    s_mov_b32 s62, 0x380f0000
    s_mov_b32 s63, 0x0
    s_mov_b64 exec, s[62:63]
    buffer_load_dword v26, v25, s[28:31], 0 offen offset:128 sc1
    s_mov_b64 exec, -1
    s_waitcnt vmcnt(0)
    v_cmp_eq_u32 vcc, s50, v26
    s_andn2_b64 s[62:63], s[62:63], vcc
    s_cbranch_scc0 L_ok_n3c1
    s_cmp_eq_u32 s52, 0
    s_cbranch_scc1 L_ok_n3c1
    s_sub_u32 s52, s52, 1
    s_sleep 1
    s_branch L_slow_n3c1
L_slow_n3c2:
    s_mov_b32 s62, 0x3c000000
    s_mov_b32 s63, 0x0
    s_mov_b64 exec, s[62:63]
    buffer_load_dword v26, v25, s[28:31], 0 offen offset:256 sc1
    s_mov_b64 exec, -1
    s_waitcnt vmcnt(0)
    v_cmp_eq_u32 vcc, s50, v26
    s_andn2_b64 s[62:63], s[62:63], vcc
    s_cbranch_scc0 L_ok_n3c2
    s_cmp_eq_u32 s52, 0
    s_cbranch_scc1 L_ok_n3c2
    s_sub_u32 s52, s52, 1
    s_sleep 1
    s_branch L_slow_n3c2
L_slow_n3c3:
    s_mov_b32 s62, 0x3f800000
    s_mov_b32 s63, 0x0
    s_mov_b64 exec, s[62:63]
    buffer_load_dword v26, v25, s[28:31], 0 offen offset:384 sc1
    s_mov_b64 exec, -1
    s_waitcnt vmcnt(0)
    v_cmp_eq_u32 vcc, s50, v26
    s_andn2_b64 s[62:63], s[62:63], vcc
    s_cbranch_scc0 L_ok_n3c3
    s_cmp_eq_u32 s52, 0
    s_cbranch_scc1 L_ok_n3c3
    s_sub_u32 s52, s52, 1
    s_sleep 1
    s_branch L_slow_n3c3
.p2align 12
L_var4:
L_tv4_0:
    s_cbranch_execz L_base
    v_mfma_f32_16x16x32_bf16 v[48:51], a[112:115], v[136:139], v[48:51]
    ds_read_b128 v[136:139], v16 offset:14336
    s_load_dword s74, s[70:71], 26240
    s_load_dword s75, s[70:71], 27520
    v_mfma_f32_16x16x32_bf16 v[48:51], a[120:123], v[140:143], v[48:51]
    ds_read_b64_tr_b16 v[190:191], v7 offset:512
    s_load_dword s76, s[70:71], 28800
    s_waitcnt lgkmcnt(8)
    v_mfma_f32_16x16x32_bf16 v[52:55], a[64:67], v[112:115], v[52:55]
    ds_read_b128 v[140:143], v17 offset:14336
    s_load_dword s77, s[70:71], 22400
    v_mfma_f32_16x16x32_bf16 v[52:55], a[72:75], v[116:119], v[52:55]
    buffer_load_dwordx4 v235, s[20:23], s47 offen offset:3072 lds
    v_mfma_f32_16x16x32_bf16 v[60:63], a[68:71], v[112:115], v[60:63]
    s_waitcnt vmcnt(8)
    s_barrier
    s_cmp_lg_u32 s36, 0
    s_cbranch_scc1 L_pub_n41
    s_atomic_swap s50, s[64:65], 128
L_pub_n41:
    ds_read_b128 v[112:115], v16 offset:18432
    v_mfma_f32_16x16x32_bf16 v[60:63], a[76:79], v[116:119], v[60:63]
    ds_read_b64_tr_b16 v[192:193], v4 offset:16384
    s_add_u32 m0, s44, 49152
    s_waitcnt lgkmcnt(8)
    v_mfma_f32_16x16x32_bf16 v[60:63], a[84:87], v[120:123], v[60:63]
    ds_read_b128 v[116:119], v17 offset:18432
    v_mfma_f32_16x16x32_bf16 v[60:63], a[92:95], v[124:127], v[60:63]
    buffer_load_dwordx4 v8, s[8:11], s46 offen offset:0 lds
    v_mfma_f32_16x16x32_bf16 v[52:55], a[80:83], v[120:123], v[52:55]
    ds_read_b128 v[120:123], v16 offset:22528
    v_mfma_f32_16x16x32_bf16 v[52:55], a[88:91], v[124:127], v[52:55]
    ds_read_b64_tr_b16 v[194:195], v4 offset:16896
    s_waitcnt lgkmcnt(8)
    v_mfma_f32_16x16x32_bf16 v[52:55], a[96:99], v[128:131], v[52:55]
    ds_read_b128 v[124:127], v17 offset:22528
    v_mfma_f32_16x16x32_bf16 v[52:55], a[104:107], v[132:135], v[52:55]
    buffer_load_dwordx4 v9, s[8:11], s46 offen offset:1024 lds
    v_mfma_f32_16x16x32_bf16 v[60:63], a[100:103], v[128:131], v[60:63]
    ds_read_b128 v[128:131], v16 offset:16384
    s_mov_b32 s47, s54
    s_add_u32 s54, s54, s55
    v_mfma_f32_16x16x32_bf16 v[60:63], a[108:111], v[132:135], v[60:63]
    ds_read_b64_tr_b16 v[196:197], v5 offset:16384
    s_waitcnt lgkmcnt(8)
    v_mfma_f32_16x16x32_bf16 v[60:63], a[116:119], v[136:139], v[60:63]
    ds_read_b128 v[132:135], v17 offset:16384
    v_mfma_f32_16x16x32_bf16 v[60:63], a[124:127], v[140:143], v[60:63]
    buffer_load_dwordx4 v10, s[8:11], s46 offen offset:2048 lds
    v_mfma_f32_16x16x32_bf16 v[52:55], a[112:115], v[136:139], v[52:55]
    ds_read_b128 v[136:139], v16 offset:20480
    v_mfma_f32_16x16x32_bf16 v[52:55], a[120:123], v[140:143], v[52:55]
    ds_read_b64_tr_b16 v[198:199], v5 offset:16896
    s_waitcnt lgkmcnt(8)
    v_mfma_f32_16x16x32_bf16 v[52:55], a[128:131], v[112:115], v[52:55]
    ds_read_b128 v[140:143], v17 offset:20480
    v_mfma_f32_16x16x32_bf16 v[52:55], a[136:139], v[116:119], v[52:55]
    buffer_load_dwordx4 v11, s[8:11], s46 offen offset:3072 lds
    v_mfma_f32_16x16x32_bf16 v[60:63], a[132:135], v[112:115], v[60:63]
    ds_read_b128 v[112:115], v16 offset:26624
    s_add_u32 m0, s45, 49152
    s_load_dword s78, s[70:71], 30080
    v_mfma_f32_16x16x32_bf16 v[60:63], a[140:143], v[116:119], v[60:63]
    ds_read_b64_tr_b16 v[200:201], v6 offset:16384
    s_load_dword s79, s[70:71], 31360
    s_waitcnt lgkmcnt(8)
    v_mfma_f32_16x16x32_bf16 v[60:63], a[148:151], v[120:123], v[60:63]
    ds_read_b128 v[116:119], v17 offset:26624
    s_load_dword s80, s[70:71], 32640
    s_load_dword s81, s[72:73], 33920
    v_mfma_f32_16x16x32_bf16 v[60:63], a[156:159], v[124:127], v[60:63]
    buffer_load_dwordx4 v232, s[20:23], s47 offen offset:0 lds
    v_mfma_f32_16x16x32_bf16 v[52:55], a[144:147], v[120:123], v[52:55]
    ds_read_b128 v[120:123], v16 offset:30720
    v_mfma_f32_16x16x32_bf16 v[52:55], a[152:155], v[124:127], v[52:55]
    ds_read_b64_tr_b16 v[202:203], v6 offset:16896
    s_waitcnt lgkmcnt(8)
    v_mfma_f32_16x16x32_bf16 v[48:51], a[128:131], v[128:131], v[48:51]
    ds_read_b128 v[124:127], v17 offset:30720
    v_mfma_f32_16x16x32_bf16 v[48:51], a[136:139], v[132:135], v[48:51]
    buffer_load_dwordx4 v233, s[20:23], s47 offen offset:1024 lds
    v_mfma_f32_16x16x32_bf16 v[56:59], a[132:135], v[128:131], v[56:59]
    ds_read_b128 v[128:131], v16 offset:24576
    s_mov_b32 s46, s54
    s_add_u32 s54, s54, s55
    v_mfma_f32_16x16x32_bf16 v[56:59], a[140:143], v[132:135], v[56:59]
    ds_read_b64_tr_b16 v[204:205], v7 offset:16384
    s_waitcnt lgkmcnt(8)
    v_mfma_f32_16x16x32_bf16 v[56:59], a[148:151], v[136:139], v[56:59]
    ds_read_b128 v[132:135], v17 offset:24576
    v_mfma_f32_16x16x32_bf16 v[56:59], a[156:159], v[140:143], v[56:59]
    buffer_load_dwordx4 v234, s[20:23], s47 offen offset:2048 lds
    v_mfma_f32_16x16x32_bf16 v[48:51], a[144:147], v[136:139], v[48:51]
    ds_read_b128 v[136:139], v16 offset:28672
    v_mfma_f32_16x16x32_bf16 v[48:51], a[152:155], v[140:143], v[48:51]
    ds_read_b64_tr_b16 v[206:207], v7 offset:16896
    s_waitcnt lgkmcnt(8)
    v_mfma_f32_16x16x32_bf16 v[36:39], a[0:3], v[112:115], 0
    ds_read_b128 v[140:143], v17 offset:28672
    v_mfma_f32_16x16x32_bf16 v[36:39], a[8:11], v[116:119], v[36:39]
    buffer_load_dwordx4 v235, s[20:23], s47 offen offset:3072 lds
    v_mfma_f32_16x16x32_bf16 v[44:47], a[4:7], v[112:115], 0
    s_waitcnt vmcnt(8)
    s_barrier
    ds_read_b128 v[112:115], v16 offset:32768
    v_mfma_f32_16x16x32_bf16 v[44:47], a[12:15], v[116:119], v[44:47]
    ds_read_b64_tr_b16 v[208:209], v4 offset:32768
    s_add_u32 m0, s45, 0
    s_waitcnt lgkmcnt(8)
    v_mfma_f32_16x16x32_bf16 v[44:47], a[20:23], v[120:123], v[44:47]
    ds_read_b128 v[116:119], v17 offset:32768
    v_readlane_b32 s88, v24, 6
    v_mul_f32 v48, v48, v56
    v_mul_f32 v49, v49, v57
    v_mfma_f32_16x16x32_bf16 v[44:47], a[28:31], v[124:127], v[44:47]
    buffer_load_dwordx4 v232, s[20:23], s46 offen offset:0 lds
    v_mul_f32 v50, v50, v58
    v_mfma_f32_16x16x32_bf16 v[36:39], a[16:19], v[120:123], v[36:39]
    ds_read_b128 v[120:123], v16 offset:36864
    s_load_dword s82, s[70:71], 23680
    s_load_dword s83, s[70:71], 24960
    v_mfma_f32_16x16x32_bf16 v[36:39], a[24:27], v[124:127], v[36:39]
    ds_read_b64_tr_b16 v[210:211], v4 offset:33280
    v_mul_f32 v51, v51, v59
    v_mul_f32 v52, v52, v60
    s_waitcnt lgkmcnt(8)
    v_mfma_f32_16x16x32_bf16 v[32:35], a[0:3], v[128:131], 0
    ds_read_b128 v[124:127], v17 offset:36864
    v_mul_f32 v53, v53, v61
    v_mfma_f32_16x16x32_bf16 v[32:35], a[8:11], v[132:135], v[32:35]
    buffer_load_dwordx4 v233, s[20:23], s46 offen offset:1024 lds
    v_mul_f32 v54, v54, v62
    v_mfma_f32_16x16x32_bf16 v[40:43], a[4:7], v[128:131], 0
    ds_read_b128 v[128:131], v16 offset:40960
    s_min_u32 s47, s54, 2211840
    v_mul_f32 v55, v55, v63
    v_mfma_f32_16x16x32_bf16 v[40:43], a[12:15], v[132:135], v[40:43]
    ds_read_b64_tr_b16 v[212:213], v5 offset:32768
    v_cvt_pk_bf16_f32 v56, v48, v49
    v_cvt_pk_bf16_f32 v58, v52, v53
    s_waitcnt lgkmcnt(8)
    v_mfma_f32_16x16x32_bf16 v[40:43], a[20:23], v[136:139], v[40:43]
    ds_read_b128 v[132:135], v17 offset:40960
    v_cvt_pk_bf16_f32 v57, v50, v51
    v_mfma_f32_16x16x32_bf16 v[40:43], a[28:31], v[140:143], v[40:43]
    buffer_load_dwordx4 v234, s[20:23], s46 offen offset:2048 lds
    v_cvt_pk_bf16_f32 v59, v54, v55
    v_mfma_f32_16x16x32_bf16 v[32:35], a[16:19], v[136:139], v[32:35]
    ds_read_b128 v[136:139], v16 offset:45056
    v_permlane16_swap_b32 v56, v58
    v_mfma_f32_16x16x32_bf16 v[32:35], a[24:27], v[140:143], v[32:35]
    ds_read_b64_tr_b16 v[214:215], v5 offset:33280
    v_permlane16_swap_b32 v57, v59
    buffer_store_dwordx4 v[56:59], v21, s[16:19], s88 offen sc1
    s_waitcnt lgkmcnt(8)
    v_mfma_f32_16x16x32_bf16 v[32:35], a[32:35], v[112:115], v[32:35]
    ds_read_b128 v[140:143], v17 offset:45056
    v_mfma_f32_16x16x32_bf16 v[32:35], a[40:43], v[116:119], v[32:35]
    buffer_load_dwordx4 v235, s[20:23], s46 offen offset:3072 lds
    v_mfma_f32_16x16x32_bf16 v[40:43], a[36:39], v[112:115], v[40:43]
    ds_read_b128 v[112:115], v16 offset:34816
    s_add_u32 m0, s45, 16384
    v_mfma_f32_16x16x32_bf16 v[40:43], a[44:47], v[116:119], v[40:43]
    ds_read_b64_tr_b16 v[216:217], v6 offset:32768
    s_waitcnt lgkmcnt(8)
    v_mfma_f32_16x16x32_bf16 v[40:43], a[52:55], v[120:123], v[40:43]
    ds_read_b128 v[116:119], v17 offset:34816
    v_mfma_f32_16x16x32_bf16 v[40:43], a[60:63], v[124:127], v[40:43]
    buffer_load_dwordx4 v232, s[20:23], s47 offen offset:0 lds
    v_mfma_f32_16x16x32_bf16 v[32:35], a[48:51], v[120:123], v[32:35]
    ds_read_b128 v[120:123], v16 offset:38912
    v_mfma_f32_16x16x32_bf16 v[32:35], a[56:59], v[124:127], v[32:35]
    ds_read_b64_tr_b16 v[218:219], v6 offset:33280
    s_waitcnt lgkmcnt(8)
    v_mfma_f32_16x16x32_bf16 v[32:35], a[64:67], v[128:131], v[32:35]
    ds_read_b128 v[124:127], v17 offset:38912
    v_mfma_f32_16x16x32_bf16 v[32:35], a[72:75], v[132:135], v[32:35]
    buffer_load_dwordx4 v233, s[20:23], s47 offen offset:1024 lds
    v_mfma_f32_16x16x32_bf16 v[40:43], a[68:71], v[128:131], v[40:43]
    ds_read_b128 v[128:131], v16 offset:43008
    v_mfma_f32_16x16x32_bf16 v[40:43], a[76:79], v[132:135], v[40:43]
    ds_read_b64_tr_b16 v[220:221], v7 offset:32768
    s_waitcnt lgkmcnt(8)
    v_mfma_f32_16x16x32_bf16 v[40:43], a[84:87], v[136:139], v[40:43]
    ds_read_b128 v[132:135], v17 offset:43008
    v_mfma_f32_16x16x32_bf16 v[40:43], a[92:95], v[140:143], v[40:43]
    buffer_load_dwordx4 v234, s[20:23], s47 offen offset:2048 lds
    v_mfma_f32_16x16x32_bf16 v[32:35], a[80:83], v[136:139], v[32:35]
    ds_read_b128 v[136:139], v16 offset:47104
    v_mfma_f32_16x16x32_bf16 v[32:35], a[88:91], v[140:143], v[32:35]
    ds_read_b64_tr_b16 v[222:223], v7 offset:33280
    s_waitcnt lgkmcnt(8)
    v_mfma_f32_16x16x32_bf16 v[36:39], a[32:35], v[112:115], v[36:39]
    s_waitcnt lgkmcnt(0)
    s_xor_b64 s[74:75], s[74:75], s[50:51]
    s_xor_b64 s[76:77], s[76:77], s[50:51]
    s_xor_b64 s[78:79], s[78:79], s[50:51]
    s_xor_b64 s[80:81], s[80:81], s[50:51]
    s_xor_b64 s[82:83], s[82:83], s[50:51]
    s_or_b64 s[74:75], s[74:75], s[76:77]
    s_or_b64 s[74:75], s[74:75], s[78:79]
    s_or_b64 s[74:75], s[74:75], s[80:81]
    s_or_b64 s[74:75], s[74:75], s[82:83]
    s_cbranch_scc1 L_slow_n4c0
L_ok_n4c0:
    ds_read_b128 v[140:143], v17 offset:47104
    v_mfma_f32_16x16x32_bf16 v[36:39], a[40:43], v[116:119], v[36:39]
    buffer_load_dwordx4 v235, s[20:23], s47 offen offset:3072 lds
    v_mfma_f32_16x16x32_bf16 v[44:47], a[36:39], v[112:115], v[44:47]
    s_waitcnt vmcnt(9)
    s_barrier
    ds_read_b128 v[112:115], v16 offset:51200
    v_mfma_f32_16x16x32_bf16 v[44:47], a[44:47], v[116:119], v[44:47]
    ds_read_b64_tr_b16 v[64:65], v4 offset:49152
    v_mfma_f32_16x16x32_bf16 v[44:47], a[52:55], v[120:123], v[44:47]
    ds_read_b128 v[116:119], v17 offset:51200
    v_mfma_f32_16x16x32_bf16 v[44:47], a[60:63], v[124:127], v[44:47]
    buffer_load_dwordx4 v[224:227], v30, s[16:19], s57 offen offset:0 sc1
    v_mfma_f32_16x16x32_bf16 v[36:39], a[48:51], v[120:123], v[36:39]
    ds_read_b128 v[120:123], v16 offset:55296
    v_mfma_f32_16x16x32_bf16 v[36:39], a[56:59], v[124:127], v[36:39]
    ds_read_b64_tr_b16 v[66:67], v4 offset:49664
    v_mfma_f32_16x16x32_bf16 v[36:39], a[64:67], v[128:131], v[36:39]
    ds_read_b128 v[124:127], v17 offset:55296
    v_mfma_f32_16x16x32_bf16 v[36:39], a[72:75], v[132:135], v[36:39]
    buffer_load_dwordx4 v[228:231], v30, s[16:19], s58 offen offset:0 sc1
    v_mfma_f32_16x16x32_bf16 v[44:47], a[68:71], v[128:131], v[44:47]
    ds_read_b128 v[128:131], v16 offset:59392
    v_mfma_f32_16x16x32_bf16 v[44:47], a[76:79], v[132:135], v[44:47]
    ds_read_b64_tr_b16 v[68:69], v5 offset:49152
    s_waitcnt lgkmcnt(8)
    v_mfma_f32_16x16x32_bf16 v[44:47], a[84:87], v[136:139], v[44:47]
    ds_read_b128 v[132:135], v17 offset:59392
    v_mfma_f32_16x16x32_bf16 v[44:47], a[92:95], v[140:143], v[44:47]
    buffer_load_dwordx4 v[232:235], v30, s[16:19], s57 offen offset:1024 sc1
    v_mfma_f32_16x16x32_bf16 v[36:39], a[80:83], v[136:139], v[36:39]
    ds_read_b128 v[136:139], v16 offset:63488
    v_mfma_f32_16x16x32_bf16 v[36:39], a[88:91], v[140:143], v[36:39]
    ds_read_b64_tr_b16 v[70:71], v5 offset:49664
    s_waitcnt lgkmcnt(8)
    v_mfma_f32_16x16x32_bf16 v[36:39], a[96:99], v[112:115], v[36:39]
    ds_read_b128 v[140:143], v17 offset:63488
    v_mfma_f32_16x16x32_bf16 v[36:39], a[104:107], v[116:119], v[36:39]
    buffer_load_dwordx4 v[236:239], v30, s[16:19], s58 offen offset:1024 sc1
    v_mfma_f32_16x16x32_bf16 v[44:47], a[100:103], v[112:115], v[44:47]
    ds_read_b128 v[112:115], v16 offset:49152
    v_mfma_f32_16x16x32_bf16 v[44:47], a[108:111], v[116:119], v[44:47]
    ds_read_b64_tr_b16 v[72:73], v6 offset:49152
    s_waitcnt lgkmcnt(8)
    v_mfma_f32_16x16x32_bf16 v[44:47], a[116:119], v[120:123], v[44:47]
    ds_read_b128 v[116:119], v17 offset:49152
    v_mfma_f32_16x16x32_bf16 v[44:47], a[124:127], v[124:127], v[44:47]
    buffer_load_dwordx4 v[240:243], v30, s[16:19], s57 offen offset:2048 sc1
    v_mfma_f32_16x16x32_bf16 v[36:39], a[112:115], v[120:123], v[36:39]
    ds_read_b128 v[120:123], v16 offset:53248
    v_mfma_f32_16x16x32_bf16 v[36:39], a[120:123], v[124:127], v[36:39]
    ds_read_b64_tr_b16 v[74:75], v6 offset:49664
    s_waitcnt lgkmcnt(8)
    v_mfma_f32_16x16x32_bf16 v[36:39], a[128:131], v[128:131], v[36:39]
    ds_read_b128 v[124:127], v17 offset:53248
    v_mfma_f32_16x16x32_bf16 v[36:39], a[136:139], v[132:135], v[36:39]
    buffer_load_dwordx4 v[244:247], v30, s[16:19], s58 offen offset:2048 sc1
    v_mfma_f32_16x16x32_bf16 v[44:47], a[132:135], v[128:131], v[44:47]
    ds_read_b128 v[128:131], v16 offset:57344
    v_mfma_f32_16x16x32_bf16 v[44:47], a[140:143], v[132:135], v[44:47]
    ds_read_b64_tr_b16 v[76:77], v7 offset:49152
    s_waitcnt lgkmcnt(8)
    v_mfma_f32_16x16x32_bf16 v[44:47], a[148:151], v[136:139], v[44:47]
    ds_read_b128 v[132:135], v17 offset:57344
    v_mfma_f32_16x16x32_bf16 v[44:47], a[156:159], v[140:143], v[44:47]
    buffer_load_dwordx4 a[0:3], v30, s[16:19], s57 offen offset:3072 sc1
    v_mfma_f32_16x16x32_bf16 v[36:39], a[144:147], v[136:139], v[36:39]
    ds_read_b128 v[136:139], v16 offset:61440
    v_mfma_f32_16x16x32_bf16 v[36:39], a[152:155], v[140:143], v[36:39]
    ds_read_b64_tr_b16 v[78:79], v7 offset:49664
    s_waitcnt lgkmcnt(8)
    v_mfma_f32_16x16x32_bf16 v[32:35], a[96:99], v[112:115], v[32:35]
    ds_read_b128 v[140:143], v17 offset:61440
    v_mfma_f32_16x16x32_bf16 v[32:35], a[104:107], v[116:119], v[32:35]
    buffer_load_dwordx4 a[4:7], v30, s[16:19], s58 offen offset:3072 sc1
    v_mfma_f32_16x16x32_bf16 v[40:43], a[100:103], v[112:115], v[40:43]
    s_waitcnt vmcnt(12)
    v_mfma_f32_16x16x32_bf16 v[40:43], a[108:111], v[116:119], v[40:43]
    ds_read_b64_tr_b16 v[80:81], v4 offset:0
    s_waitcnt lgkmcnt(7)
    v_mfma_f32_16x16x32_bf16 v[40:43], a[116:119], v[120:123], v[40:43]
    v_mfma_f32_16x16x32_bf16 v[40:43], a[124:127], v[124:127], v[40:43]
    ds_read_b64_tr_b16 v[82:83], v4 offset:512
    buffer_load_dwordx4 a[8:11], v31, s[16:19], s57 offen offset:0 sc1
    v_mfma_f32_16x16x32_bf16 v[32:35], a[112:115], v[120:123], v[32:35]
    v_mfma_f32_16x16x32_bf16 v[32:35], a[120:123], v[124:127], v[32:35]
    ds_read_b64_tr_b16 v[84:85], v5 offset:0
    s_waitcnt lgkmcnt(6)
    v_mfma_f32_16x16x32_bf16 v[32:35], a[128:131], v[128:131], v[32:35]
    v_mfma_f32_16x16x32_bf16 v[32:35], a[136:139], v[132:135], v[32:35]
    ds_read_b64_tr_b16 v[86:87], v5 offset:512
    buffer_load_dwordx4 a[12:15], v31, s[16:19], s58 offen offset:0 sc1
    v_mfma_f32_16x16x32_bf16 v[40:43], a[132:135], v[128:131], v[40:43]
    v_mfma_f32_16x16x32_bf16 v[40:43], a[140:143], v[132:135], v[40:43]
    ds_read_b64_tr_b16 v[88:89], v6 offset:0
    s_waitcnt lgkmcnt(5)
    v_mfma_f32_16x16x32_bf16 v[40:43], a[148:151], v[136:139], v[40:43]
    v_mfma_f32_16x16x32_bf16 v[40:43], a[156:159], v[140:143], v[40:43]
    ds_read_b64_tr_b16 v[90:91], v6 offset:512
    v_mfma_f32_16x16x32_bf16 v[32:35], a[144:147], v[136:139], v[32:35]
    v_mfma_f32_16x16x32_bf16 v[32:35], a[152:155], v[140:143], v[32:35]
    ds_read_b64_tr_b16 v[92:93], v7 offset:0
    ds_read_b64_tr_b16 v[94:95], v7 offset:512
    s_waitcnt vmcnt(8)
    v_mfma_f32_16x16x32_bf16 a[40:43], v[160:163], v[224:227], 0
    s_barrier
    s_cmp_lg_u32 s36, 0
    s_cbranch_scc1 L_pub_n42
    s_atomic_swap s50, s[64:65], 256
L_pub_n42:
    v_mfma_f32_16x16x32_bf16 a[40:43], v[176:179], v[228:231], a[40:43]
    buffer_load_dwordx4 a[16:19], v30, s[16:19], s59 offen offset:0 sc1
    v_mfma_f32_16x16x32_bf16 a[44:47], v[164:167], v[224:227], 0
    v_readlane_b32 s89, v24, 7
    v_mul_f32 v32, v32, v40
    v_mfma_f32_16x16x32_bf16 a[44:47], v[180:183], v[228:231], a[44:47]
    v_mul_f32 v33, v33, v41
    v_mul_f32 v34, v34, v42
    v_mfma_f32_16x16x32_bf16 a[48:51], v[168:171], v[224:227], 0
    v_mul_f32 v35, v35, v43
    v_mul_f32 v36, v36, v44
    v_mfma_f32_16x16x32_bf16 a[48:51], v[184:187], v[228:231], a[48:51]
    buffer_load_dwordx4 a[20:23], v30, s[16:19], s41 offen offset:0 sc1
    v_mfma_f32_16x16x32_bf16 a[52:55], v[172:175], v[224:227], 0
    v_mul_f32 v37, v37, v45
    v_mul_f32 v38, v38, v46
    v_mfma_f32_16x16x32_bf16 a[52:55], v[188:191], v[228:231], a[52:55]
    v_mul_f32 v39, v39, v47
    v_cvt_pk_bf16_f32 v40, v32, v33
    s_waitcnt vmcnt(8)
    v_mfma_f32_16x16x32_bf16 a[56:59], v[160:163], v[232:235], 0
    v_cvt_pk_bf16_f32 v42, v36, v37
    v_cvt_pk_bf16_f32 v41, v34, v35
    v_mfma_f32_16x16x32_bf16 a[56:59], v[176:179], v[236:239], a[56:59]
    buffer_load_dwordx4 a[24:27], v30, s[16:19], s59 offen offset:1024 sc1
    v_mfma_f32_16x16x32_bf16 a[60:63], v[164:167], v[232:235], 0
    v_cvt_pk_bf16_f32 v43, v38, v39
    s_nop 1
    v_permlane16_swap_b32 v40, v42
    v_mfma_f32_16x16x32_bf16 a[60:63], v[180:183], v[236:239], a[60:63]
    v_permlane16_swap_b32 v41, v43
    buffer_store_dwordx4 v[40:43], v21, s[16:19], s89 offen sc1
    v_mfma_f32_16x16x32_bf16 a[64:67], v[168:171], v[232:235], 0
    v_mfma_f32_16x16x32_bf16 a[64:67], v[184:187], v[236:239], a[64:67]
    buffer_load_dwordx4 a[28:31], v30, s[16:19], s66 offen offset:1024 sc1
    v_mfma_f32_16x16x32_bf16 a[68:71], v[172:175], v[232:235], 0
    v_mfma_f32_16x16x32_bf16 a[68:71], v[188:191], v[236:239], a[68:71]
    ds_read_b64_tr_b16 v[96:97], v4 offset:16384
    s_waitcnt vmcnt(9)
    v_mfma_f32_16x16x32_bf16 a[72:75], v[160:163], v[240:243], 0
    ds_read_b64_tr_b16 v[98:99], v4 offset:16896
    v_mfma_f32_16x16x32_bf16 a[72:75], v[176:179], v[244:247], a[72:75]
    buffer_load_dwordx4 a[32:35], v30, s[16:19], s59 offen offset:2048 sc1
    v_mfma_f32_16x16x32_bf16 a[76:79], v[164:167], v[240:243], 0
    v_mfma_f32_16x16x32_bf16 a[76:79], v[180:183], v[244:247], a[76:79]
    ds_read_b64_tr_b16 v[100:101], v5 offset:16384
    v_mfma_f32_16x16x32_bf16 a[80:83], v[168:171], v[240:243], 0
    ds_read_b64_tr_b16 v[102:103], v5 offset:16896
    v_mfma_f32_16x16x32_bf16 a[80:83], v[184:187], v[244:247], a[80:83]
    buffer_load_dwordx4 v[224:227], v30, s[16:19], s66 offen offset:2048 sc1
    v_mfma_f32_16x16x32_bf16 a[84:87], v[172:175], v[240:243], 0
    v_mfma_f32_16x16x32_bf16 a[84:87], v[188:191], v[244:247], a[84:87]
    ds_read_b64_tr_b16 v[104:105], v6 offset:16384
    s_waitcnt vmcnt(9)
    v_mfma_f32_16x16x32_bf16 a[88:91], v[160:163], a[0:3], 0
    ds_read_b64_tr_b16 v[106:107], v6 offset:16896
    v_mfma_f32_16x16x32_bf16 a[88:91], v[176:179], a[4:7], a[88:91]
    buffer_load_dwordx4 v[228:231], v30, s[16:19], s59 offen offset:3072 sc1
    v_mfma_f32_16x16x32_bf16 a[92:95], v[164:167], a[0:3], 0
    v_mfma_f32_16x16x32_bf16 a[92:95], v[180:183], a[4:7], a[92:95]
    ds_read_b64_tr_b16 v[108:109], v7 offset:16384
    v_mfma_f32_16x16x32_bf16 a[96:99], v[168:171], a[0:3], 0
    ds_read_b64_tr_b16 v[110:111], v7 offset:16896
    v_mfma_f32_16x16x32_bf16 a[96:99], v[184:187], a[4:7], a[96:99]
    buffer_load_dwordx4 v[232:235], v30, s[16:19], s66 offen offset:3072 sc1
    v_mfma_f32_16x16x32_bf16 a[100:103], v[172:175], a[0:3], 0
    v_mfma_f32_16x16x32_bf16 a[100:103], v[188:191], a[4:7], a[100:103]
    s_waitcnt vmcnt(9)
    v_mfma_f32_16x16x32_bf16 a[104:107], v[160:163], a[8:11], 0
    v_mfma_f32_16x16x32_bf16 a[104:107], v[176:179], a[12:15], a[104:107]
    buffer_load_dwordx4 v[236:239], v31, s[16:19], s59 offen offset:0 sc1
    v_mfma_f32_16x16x32_bf16 a[108:111], v[164:167], a[8:11], 0
    v_mfma_f32_16x16x32_bf16 a[108:111], v[180:183], a[12:15], a[108:111]
    v_mfma_f32_16x16x32_bf16 a[112:115], v[168:171], a[8:11], 0
    v_mfma_f32_16x16x32_bf16 a[112:115], v[184:187], a[12:15], a[112:115]
    buffer_load_dwordx4 v[240:243], v31, s[16:19], s66 offen offset:0 sc1
    v_mfma_f32_16x16x32_bf16 a[116:119], v[172:175], a[8:11], 0
    v_mfma_f32_16x16x32_bf16 a[116:119], v[188:191], a[12:15], a[116:119]
    s_waitcnt vmcnt(9)
    v_mfma_f32_16x16x32_bf16 a[40:43], v[192:195], a[16:19], a[40:43]
    s_load_dword s74, s[70:71], 22528
    s_load_dword s75, s[70:71], 23808
    v_mfma_f32_16x16x32_bf16 a[40:43], a[224:227], a[20:23], a[40:43]
    buffer_load_dwordx4 v[244:247], v30, s[16:19], s67 offen offset:1024 sc1
    v_mfma_f32_16x16x32_bf16 a[44:47], v[196:199], a[16:19], a[44:47]
    s_load_dword s76, s[70:71], 25088
    v_mfma_f32_16x16x32_bf16 a[44:47], a[228:231], a[20:23], a[44:47]
    s_load_dword s77, s[70:71], 17408
    v_mfma_f32_16x16x32_bf16 a[48:51], v[200:203], a[16:19], a[48:51]
    s_load_dword s78, s[70:71], 18688
    s_load_dword s79, s[70:71], 19968
    v_mfma_f32_16x16x32_bf16 a[48:51], a[232:235], a[20:23], a[48:51]
    buffer_load_dwordx4 a[0:3], v30, s[16:19], s68 offen offset:1024 sc1
    v_mfma_f32_16x16x32_bf16 a[52:55], v[204:207], a[16:19], a[52:55]
    s_load_dword s80, s[70:71], 21248
    v_mfma_f32_16x16x32_bf16 a[52:55], a[236:239], a[20:23], a[52:55]
    s_load_dword s81, s[70:71], 21248
    s_waitcnt vmcnt(8)
    v_mfma_f32_16x16x32_bf16 a[56:59], v[192:195], a[24:27], a[56:59]
    s_waitcnt lgkmcnt(0)
    s_barrier
    s_cmp_lg_u32 s36, 0
    s_cbranch_scc1 L_pub_n43
    s_atomic_swap s50, s[64:65], 384
L_pub_n43:
    v_mfma_f32_16x16x32_bf16 a[56:59], v[208:211], a[28:31], a[56:59]
    buffer_load_dwordx4 a[4:7], v30, s[16:19], s67 offen offset:2048 sc1
    v_mfma_f32_16x16x32_bf16 a[60:63], v[196:199], a[24:27], a[60:63]
    v_mfma_f32_16x16x32_bf16 a[60:63], v[212:215], a[28:31], a[60:63]
    v_mfma_f32_16x16x32_bf16 a[64:67], v[200:203], a[24:27], a[64:67]
    v_mfma_f32_16x16x32_bf16 a[64:67], v[216:219], a[28:31], a[64:67]
    buffer_load_dwordx4 a[8:11], v30, s[16:19], s68 offen offset:2048 sc1
    v_mfma_f32_16x16x32_bf16 a[68:71], v[204:207], a[24:27], a[68:71]
    v_mfma_f32_16x16x32_bf16 a[68:71], v[220:223], a[28:31], a[68:71]
    s_waitcnt vmcnt(8)
    v_mfma_f32_16x16x32_bf16 a[72:75], v[192:195], a[32:35], a[72:75]
    v_and_b32 v1, 15, v0
    v_mfma_f32_16x16x32_bf16 a[72:75], v[208:211], v[224:227], a[72:75]
    buffer_load_dwordx4 a[12:15], v30, s[16:19], s67 offen offset:3072 sc1
    v_mfma_f32_16x16x32_bf16 a[76:79], v[196:199], a[32:35], a[76:79]
    v_lshrrev_b32 v2, 4, v0
    v_mfma_f32_16x16x32_bf16 a[76:79], v[212:215], v[224:227], a[76:79]
    v_and_b32 v3, 7, v0
    v_mfma_f32_16x16x32_bf16 a[80:83], v[200:203], a[32:35], a[80:83]
    v_xor_b32 v2, v2, v3
    v_mfma_f32_16x16x32_bf16 a[80:83], v[216:219], v[224:227], a[80:83]
    buffer_load_dwordx4 a[16:19], v30, s[16:19], s68 offen offset:3072 sc1
    v_mfma_f32_16x16x32_bf16 a[84:87], v[204:207], a[32:35], a[84:87]
    v_lshlrev_b32 v2, 4, v2
    v_mfma_f32_16x16x32_bf16 a[84:87], v[220:223], v[224:227], a[84:87]
    v_lshl_add_u32 v1, v1, 8, v2
    s_waitcnt vmcnt(8)
    v_mfma_f32_16x16x32_bf16 a[88:91], v[192:195], v[228:231], a[88:91]
    v_add_u32 v16, s43, v1
    v_mfma_f32_16x16x32_bf16 a[88:91], v[208:211], v[232:235], a[88:91]
    buffer_load_dwordx4 a[20:23], v31, s[16:19], s67 offen offset:0 sc1
    v_mfma_f32_16x16x32_bf16 a[92:95], v[196:199], v[228:231], a[92:95]
    v_xor_b32 v17, 64, v16
    v_mfma_f32_16x16x32_bf16 a[92:95], v[212:215], v[232:235], a[92:95]
    v_lshrrev_b32 v1, 3, v0
    v_mfma_f32_16x16x32_bf16 a[96:99], v[200:203], v[228:231], a[96:99]
    v_lshlrev_b32 v2, 1, v3
    v_mfma_f32_16x16x32_bf16 a[96:99], v[216:219], v[232:235], a[96:99]
    buffer_load_dwordx4 a[24:27], v31, s[16:19], s68 offen offset:0 sc1
    v_mfma_f32_16x16x32_bf16 a[100:103], v[204:207], v[228:231], a[100:103]
    v_xor_b32 v2, v2, v1
    v_mfma_f32_16x16x32_bf16 a[100:103], v[220:223], v[232:235], a[100:103]
    v_lshlrev_b32 v2, 4, v2
    s_waitcnt vmcnt(8)
    v_mfma_f32_16x16x32_bf16 a[104:107], v[192:195], v[236:239], a[104:107]
    s_lshl_b32 s61, s36, 3
    v_mfma_f32_16x16x32_bf16 a[104:107], v[208:211], v[240:243], a[104:107]
    buffer_load_dwordx4 a[28:31], v30, s[16:19], s69 offen offset:3072 sc1
    v_mfma_f32_16x16x32_bf16 a[108:111], v[196:199], v[236:239], a[108:111]
    v_add_u32 v1, s61, v1
    v_mfma_f32_16x16x32_bf16 a[108:111], v[212:215], v[240:243], a[108:111]
    v_lshl_add_u32 v8, v1, 8, v2
    v_mfma_f32_16x16x32_bf16 a[112:115], v[200:203], v[236:239], a[112:115]
    s_waitcnt lgkmcnt(0)
    v_mfma_f32_16x16x32_bf16 a[112:115], v[216:219], v[240:243], a[112:115]
    buffer_load_dwordx4 a[32:35], v31, s[16:19], s69 offen offset:0 sc1
    v_mfma_f32_16x16x32_bf16 a[116:119], v[204:207], v[236:239], a[116:119]
    s_xor_b64 s[74:75], s[74:75], s[50:51]
    v_mfma_f32_16x16x32_bf16 a[116:119], v[220:223], v[240:243], a[116:119]
    s_xor_b64 s[76:77], s[76:77], s[50:51]
    s_waitcnt vmcnt(8)
    v_mfma_f32_16x16x32_bf16 a[56:59], v[64:67], v[244:247], a[56:59]
    s_xor_b64 s[78:79], s[78:79], s[50:51]
    v_mfma_f32_16x16x32_bf16 a[56:59], v[80:83], a[0:3], a[56:59]
    buffer_load_dwordx4 v[224:227], v30, s[16:19], s42 offen offset:0 sc1
    v_mfma_f32_16x16x32_bf16 a[60:63], v[68:71], v[244:247], a[60:63]
    s_xor_b64 s[80:81], s[80:81], s[50:51]
    v_mfma_f32_16x16x32_bf16 a[60:63], v[84:87], a[0:3], a[60:63]
    s_or_b64 s[74:75], s[74:75], s[76:77]
    v_mfma_f32_16x16x32_bf16 a[64:67], v[72:75], v[244:247], a[64:67]
    s_or_b64 s[74:75], s[74:75], s[78:79]
    v_mfma_f32_16x16x32_bf16 a[64:67], v[88:91], a[0:3], a[64:67]
    buffer_load_dwordx4 v[228:231], v30, s[16:19], s49 offen offset:0 sc1
    v_mfma_f32_16x16x32_bf16 a[68:71], v[76:79], v[244:247], a[68:71]
    s_or_b64 s[74:75], s[74:75], s[80:81]
    s_cbranch_scc1 L_slow_n4c1
L_ok_n4c1:
    v_mfma_f32_16x16x32_bf16 a[68:71], v[92:95], a[0:3], a[68:71]
    s_waitcnt vmcnt(8)
    v_mfma_f32_16x16x32_bf16 a[72:75], v[64:67], a[4:7], a[72:75]
    v_xor_b32 v9, 16, v8
    v_mfma_f32_16x16x32_bf16 a[72:75], v[80:83], a[8:11], a[72:75]
    buffer_load_dwordx4 v[232:235], v30, s[16:19], s41 offen offset:1024 sc1
    v_mfma_f32_16x16x32_bf16 a[76:79], v[68:71], a[4:7], a[76:79]
    v_add_u32 v10, 40960, v8
    v_mfma_f32_16x16x32_bf16 a[76:79], v[84:87], a[8:11], a[76:79]
    v_add_u32 v11, 40960, v9
    v_mfma_f32_16x16x32_bf16 a[80:83], v[72:75], a[4:7], a[80:83]
    v_mul_u32_u24 v1, 1280, v1
    v_mfma_f32_16x16x32_bf16 a[80:83], v[88:91], a[8:11], a[80:83]
    buffer_load_dwordx4 v[236:239], v30, s[16:19], s42 offen offset:1024 sc1
    v_mfma_f32_16x16x32_bf16 a[84:87], v[76:79], a[4:7], a[84:87]
    v_lshl_add_u32 v18, v3, 4, v1
    v_mfma_f32_16x16x32_bf16 a[84:87], v[92:95], a[8:11], a[84:87]
    s_lshl_b32 s61, s36, 2
    s_waitcnt vmcnt(8)
    v_mfma_f32_16x16x32_bf16 a[88:91], v[64:67], a[12:15], a[88:91]
    v_lshrrev_b32 v1, 4, v0
    v_mfma_f32_16x16x32_bf16 a[88:91], v[80:83], a[16:19], a[88:91]
    buffer_load_dwordx4 v[240:243], v30, s[16:19], s41 offen offset:2048 sc1
    v_mfma_f32_16x16x32_bf16 a[92:95], v[68:71], a[12:15], a[92:95]
    v_add_u32 v1, s61, v1
    v_mfma_f32_16x16x32_bf16 a[92:95], v[84:87], a[16:19], a[92:95]
    v_and_b32 v2, 15, v0
    v_mfma_f32_16x16x32_bf16 a[96:99], v[72:75], a[12:15], a[96:99]
    s_load_dword s74, s[70:71], 17536
    s_load_dword s75, s[70:71], 18816
    v_mfma_f32_16x16x32_bf16 a[96:99], v[88:91], a[16:19], a[96:99]
    buffer_load_dwordx4 v[244:247], v30, s[16:19], s42 offen offset:2048 sc1
    v_mfma_f32_16x16x32_bf16 a[100:103], v[76:79], a[12:15], a[100:103]
    s_load_dword s76, s[70:71], 20096
    v_mfma_f32_16x16x32_bf16 a[100:103], v[92:95], a[16:19], a[100:103]
    s_load_dword s77, s[70:71], 21376
    s_waitcnt vmcnt(8)
    v_mfma_f32_16x16x32_bf16 a[104:107], v[64:67], a[20:23], a[104:107]
    v_and_b32 v3, 7, v1
    v_mfma_f32_16x16x32_bf16 a[104:107], v[80:83], a[24:27], a[104:107]
    buffer_load_dwordx4 a[0:3], v30, s[16:19], s41 offen offset:3072 sc1
    v_mfma_f32_16x16x32_bf16 a[108:111], v[68:71], a[20:23], a[108:111]
    v_xor_b32 v3, v3, v2
    v_mfma_f32_16x16x32_bf16 a[108:111], v[84:87], a[24:27], a[108:111]
    v_lshlrev_b32 v3, 4, v3
    v_mfma_f32_16x16x32_bf16 a[112:115], v[72:75], a[20:23], a[112:115]
    v_lshl_add_u32 v12, v1, 8, v3
    v_mfma_f32_16x16x32_bf16 a[112:115], v[88:91], a[24:27], a[112:115]
    buffer_load_dwordx4 a[4:7], v30, s[16:19], s42 offen offset:3072 sc1
    v_mfma_f32_16x16x32_bf16 a[116:119], v[76:79], a[20:23], a[116:119]
    v_add_u32 v13, 40960, v12
    v_mfma_f32_16x16x32_bf16 a[116:119], v[92:95], a[24:27], a[116:119]
    v_mul_u32_u24 v1, 1280, v1
    s_waitcnt vmcnt(9)
    v_mfma_f32_16x16x32_bf16 a[88:91], v[96:99], a[28:31], a[88:91]
    v_lshl_add_u32 v19, v2, 3, v1
    v_mfma_f32_16x16x32_bf16 a[92:95], v[100:103], a[28:31], a[92:95]
    buffer_load_dwordx4 a[8:11], v31, s[16:19], s41 offen offset:0 sc1
    v_mfma_f32_16x16x32_bf16 a[96:99], v[104:107], a[28:31], a[96:99]
    v_mfma_f32_16x16x32_bf16 a[100:103], v[108:111], a[28:31], a[100:103]
    s_waitcnt vmcnt(9)
    v_mfma_f32_16x16x32_bf16 a[104:107], v[96:99], a[32:35], a[104:107]
    v_mfma_f32_16x16x32_bf16 a[108:111], v[100:103], a[32:35], a[108:111]
    buffer_load_dwordx4 a[12:15], v31, s[16:19], s42 offen offset:0 sc1
    v_mfma_f32_16x16x32_bf16 a[112:115], v[104:107], a[32:35], a[112:115]
    v_mfma_f32_16x16x32_bf16 a[116:119], v[108:111], a[32:35], a[116:119]
    s_waitcnt vmcnt(8)
    v_mfma_f32_16x16x32_bf16 a[40:43], a[240:243], v[224:227], a[40:43]
    v_mfma_f32_16x16x32_bf16 a[40:43], v[144:147], v[228:231], a[40:43]
    buffer_load_dwordx4 a[16:19], v30, s[16:19], s49 offen offset:1024 sc1
    v_mfma_f32_16x16x32_bf16 a[44:47], a[244:247], v[224:227], a[44:47]
    v_mfma_f32_16x16x32_bf16 a[44:47], v[148:151], v[228:231], a[44:47]
    v_mfma_f32_16x16x32_bf16 a[48:51], a[248:251], v[224:227], a[48:51]
    v_mfma_f32_16x16x32_bf16 a[48:51], v[152:155], v[228:231], a[48:51]
    buffer_load_dwordx4 a[20:23], v30, s[16:19], s49 offen offset:2048 sc1
    v_mfma_f32_16x16x32_bf16 a[52:55], a[252:255], v[224:227], a[52:55]
    v_mfma_f32_16x16x32_bf16 a[52:55], v[156:159], v[228:231], a[52:55]
    s_waitcnt vmcnt(8)
    v_mfma_f32_16x16x32_bf16 a[56:59], a[224:227], v[232:235], a[56:59]
    v_mfma_f32_16x16x32_bf16 a[56:59], a[240:243], v[236:239], a[56:59]
    buffer_load_dwordx4 a[24:27], v30, s[16:19], s49 offen offset:3072 sc1
    v_mfma_f32_16x16x32_bf16 a[60:63], a[228:231], v[232:235], a[60:63]
    v_mfma_f32_16x16x32_bf16 a[60:63], a[244:247], v[236:239], a[60:63]
L_tv4_1:
    s_cbranch_execz L_base
    v_mfma_f32_16x16x32_bf16 a[64:67], a[232:235], v[232:235], a[64:67]
    v_mfma_f32_16x16x32_bf16 a[64:67], a[248:251], v[236:239], a[64:67]
    buffer_load_dwordx4 a[28:31], v31, s[16:19], s49 offen offset:0 sc1
    v_mfma_f32_16x16x32_bf16 a[68:71], a[236:239], v[232:235], a[68:71]
    v_mfma_f32_16x16x32_bf16 a[68:71], a[252:255], v[236:239], a[68:71]
    s_waitcnt vmcnt(8)
    v_mfma_f32_16x16x32_bf16 a[72:75], a[224:227], v[240:243], a[72:75]
    s_waitcnt lgkmcnt(0)
    v_mfma_f32_16x16x32_bf16 a[72:75], a[240:243], v[244:247], a[72:75]
    buffer_load_dwordx4 a[32:35], v30, s[16:19], s37 offen offset:0 sc1
    v_mfma_f32_16x16x32_bf16 a[76:79], a[228:231], v[240:243], a[76:79]
    s_xor_b64 s[74:75], s[74:75], s[50:51]
    v_mfma_f32_16x16x32_bf16 a[76:79], a[244:247], v[244:247], a[76:79]
    s_xor_b64 s[76:77], s[76:77], s[50:51]
    v_mfma_f32_16x16x32_bf16 a[80:83], a[232:235], v[240:243], a[80:83]
    s_or_b64 s[74:75], s[74:75], s[76:77]
    s_cbranch_scc1 L_slow_n4c2
L_ok_n4c2:
    v_mfma_f32_16x16x32_bf16 a[80:83], a[248:251], v[244:247], a[80:83]
    buffer_load_dwordx4 v[224:227], v30, s[16:19], s38 offen offset:0 sc1
    v_mfma_f32_16x16x32_bf16 a[84:87], a[236:239], v[240:243], a[84:87]
    v_mfma_f32_16x16x32_bf16 a[84:87], a[252:255], v[244:247], a[84:87]
    s_waitcnt vmcnt(8)
    v_mfma_f32_16x16x32_bf16 a[88:91], a[224:227], a[0:3], a[88:91]
    s_load_dword s74, s[70:71], 30464
    s_load_dword s75, s[70:71], 31744
    v_mfma_f32_16x16x32_bf16 a[88:91], a[240:243], a[4:7], a[88:91]
    buffer_load_dwordx4 v[228:231], v30, s[16:19], s39 offen offset:0 sc1
    v_mfma_f32_16x16x32_bf16 a[92:95], a[228:231], a[0:3], a[92:95]
    s_load_dword s76, s[70:71], 33024
    v_mfma_f32_16x16x32_bf16 a[92:95], a[244:247], a[4:7], a[92:95]
    s_load_dword s77, s[72:73], 34304
    v_mfma_f32_16x16x32_bf16 a[96:99], a[232:235], a[0:3], a[96:99]
    s_load_dword s78, s[70:71], 17664
    s_load_dword s79, s[70:71], 18944
    v_mfma_f32_16x16x32_bf16 a[96:99], a[248:251], a[4:7], a[96:99]
    buffer_load_dwordx4 v[232:235], v30, s[16:19], s40 offen offset:0 sc1
    v_mfma_f32_16x16x32_bf16 a[100:103], a[236:239], a[0:3], a[100:103]
    s_load_dword s80, s[70:71], 20224
    v_mfma_f32_16x16x32_bf16 a[100:103], a[252:255], a[4:7], a[100:103]
    s_load_dword s81, s[70:71], 21504
    s_waitcnt vmcnt(8)
    v_mfma_f32_16x16x32_bf16 a[104:107], a[224:227], a[8:11], a[104:107]
    v_mfma_f32_16x16x32_bf16 a[104:107], a[240:243], a[12:15], a[104:107]
    buffer_load_dwordx4 v[236:239], v30, s[16:19], s37 offen offset:1024 sc1
    v_mfma_f32_16x16x32_bf16 a[108:111], a[228:231], a[8:11], a[108:111]
    v_mfma_f32_16x16x32_bf16 a[108:111], a[244:247], a[12:15], a[108:111]
    v_mfma_f32_16x16x32_bf16 a[112:115], a[232:235], a[8:11], a[112:115]
    v_mfma_f32_16x16x32_bf16 a[112:115], a[248:251], a[12:15], a[112:115]
    buffer_load_dwordx4 v[240:243], v30, s[16:19], s38 offen offset:1024 sc1
    v_mfma_f32_16x16x32_bf16 a[116:119], a[236:239], a[8:11], a[116:119]
    v_mfma_f32_16x16x32_bf16 a[116:119], a[252:255], a[12:15], a[116:119]
    s_waitcnt vmcnt(9)
    v_mfma_f32_16x16x32_bf16 a[56:59], v[144:147], a[16:19], a[56:59]
    v_mfma_f32_16x16x32_bf16 a[60:63], v[148:151], a[16:19], a[60:63]
    buffer_load_dwordx4 v[244:247], v30, s[16:19], s37 offen offset:2048 sc1
    v_mfma_f32_16x16x32_bf16 a[64:67], v[152:155], a[16:19], a[64:67]
    v_mfma_f32_16x16x32_bf16 a[68:71], v[156:159], a[16:19], a[68:71]
    s_waitcnt vmcnt(9)
    v_mfma_f32_16x16x32_bf16 a[72:75], v[144:147], a[20:23], a[72:75]
    v_mfma_f32_16x16x32_bf16 a[76:79], v[148:151], a[20:23], a[76:79]
    buffer_load_dwordx4 a[0:3], v30, s[16:19], s38 offen offset:2048 sc1
    v_mfma_f32_16x16x32_bf16 a[80:83], v[152:155], a[20:23], a[80:83]
    v_mfma_f32_16x16x32_bf16 a[84:87], v[156:159], a[20:23], a[84:87]
    s_waitcnt vmcnt(9)
    v_mfma_f32_16x16x32_bf16 a[88:91], v[144:147], a[24:27], a[88:91]
    v_mfma_f32_16x16x32_bf16 a[92:95], v[148:151], a[24:27], a[92:95]
    buffer_load_dwordx4 a[4:7], v30, s[16:19], s69 offen offset:1024 sc1
    v_mfma_f32_16x16x32_bf16 a[96:99], v[152:155], a[24:27], a[96:99]
    v_mfma_f32_16x16x32_bf16 a[100:103], v[156:159], a[24:27], a[100:103]
    s_waitcnt vmcnt(9)
    v_mfma_f32_16x16x32_bf16 a[104:107], v[144:147], a[28:31], a[104:107]
    v_mfma_f32_16x16x32_bf16 a[108:111], v[148:151], a[28:31], a[108:111]
    buffer_load_dwordx4 a[8:11], v30, s[16:19], s39 offen offset:1024 sc1
    v_mfma_f32_16x16x32_bf16 a[112:115], v[152:155], a[28:31], a[112:115]
    v_mfma_f32_16x16x32_bf16 a[116:119], v[156:159], a[28:31], a[116:119]
    s_waitcnt vmcnt(8)
    v_mfma_f32_16x16x32_bf16 a[40:43], a[160:163], a[32:35], a[40:43]
    v_mfma_f32_16x16x32_bf16 a[40:43], a[176:179], v[224:227], a[40:43]
    buffer_load_dwordx4 a[12:15], v30, s[16:19], s40 offen offset:1024 sc1
    v_mfma_f32_16x16x32_bf16 a[44:47], a[164:167], a[32:35], a[44:47]
    v_mfma_f32_16x16x32_bf16 a[44:47], a[180:183], v[224:227], a[44:47]
    v_mfma_f32_16x16x32_bf16 a[48:51], a[168:171], a[32:35], a[48:51]
    s_waitcnt lgkmcnt(0)
    v_mfma_f32_16x16x32_bf16 a[48:51], a[184:187], v[224:227], a[48:51]
    buffer_load_dwordx4 a[16:19], v30, s[16:19], s69 offen offset:2048 sc1
    v_mfma_f32_16x16x32_bf16 a[52:55], a[172:175], a[32:35], a[52:55]
    s_xor_b64 s[74:75], s[74:75], s[50:51]
    v_mfma_f32_16x16x32_bf16 a[52:55], a[188:191], v[224:227], a[52:55]
    s_xor_b64 s[76:77], s[76:77], s[50:51]
    s_waitcnt vmcnt(8)
    v_mfma_f32_16x16x32_bf16 a[40:43], a[192:195], v[228:231], a[40:43]
    s_xor_b64 s[78:79], s[78:79], s[50:51]
    v_mfma_f32_16x16x32_bf16 a[40:43], a[208:211], v[232:235], a[40:43]
    buffer_load_dwordx4 a[20:23], v30, s[16:19], s39 offen offset:2048 sc1
    v_mfma_f32_16x16x32_bf16 a[44:47], a[196:199], v[228:231], a[44:47]
    s_xor_b64 s[80:81], s[80:81], s[50:51]
    v_mfma_f32_16x16x32_bf16 a[44:47], a[212:215], v[232:235], a[44:47]
    s_or_b64 s[74:75], s[74:75], s[76:77]
    v_mfma_f32_16x16x32_bf16 a[48:51], a[200:203], v[228:231], a[48:51]
    s_or_b64 s[74:75], s[74:75], s[78:79]
    v_mfma_f32_16x16x32_bf16 a[48:51], a[216:219], v[232:235], a[48:51]
    buffer_load_dwordx4 a[24:27], v30, s[16:19], s40 offen offset:2048 sc1
    v_mfma_f32_16x16x32_bf16 a[52:55], a[204:207], v[228:231], a[52:55]
    s_or_b64 s[74:75], s[74:75], s[80:81]
    s_cbranch_scc1 L_slow_n4c3
L_ok_n4c3:
    v_mfma_f32_16x16x32_bf16 a[52:55], a[220:223], v[232:235], a[52:55]
    s_waitcnt vmcnt(8)
    v_mfma_f32_16x16x32_bf16 a[56:59], a[160:163], v[236:239], a[56:59]
    v_mfma_f32_16x16x32_bf16 a[56:59], a[176:179], v[240:243], a[56:59]
    buffer_load_dwordx4 a[28:31], v30, s[16:19], s66 offen offset:0 sc1
    v_mfma_f32_16x16x32_bf16 a[60:63], a[164:167], v[236:239], a[60:63]
    v_mfma_f32_16x16x32_bf16 a[60:63], a[180:183], v[240:243], a[60:63]
    v_mfma_f32_16x16x32_bf16 a[64:67], a[168:171], v[236:239], a[64:67]
    v_mfma_f32_16x16x32_bf16 a[64:67], a[184:187], v[240:243], a[64:67]
    buffer_load_dwordx4 a[32:35], v30, s[16:19], s67 offen offset:0 sc1
    v_mfma_f32_16x16x32_bf16 a[68:71], a[172:175], v[236:239], a[68:71]
    v_mfma_f32_16x16x32_bf16 a[68:71], a[188:191], v[240:243], a[68:71]
    s_waitcnt vmcnt(8)
    v_mfma_f32_16x16x32_bf16 a[72:75], a[160:163], v[244:247], a[72:75]
    v_mfma_f32_16x16x32_bf16 a[72:75], a[176:179], a[0:3], a[72:75]
    buffer_load_dwordx4 v[224:227], v30, s[16:19], s68 offen offset:0 sc1
    v_mfma_f32_16x16x32_bf16 a[76:79], a[164:167], v[244:247], a[76:79]
    v_mfma_f32_16x16x32_bf16 a[76:79], a[180:183], a[0:3], a[76:79]
    v_mfma_f32_16x16x32_bf16 a[80:83], a[168:171], v[244:247], a[80:83]
    v_mfma_f32_16x16x32_bf16 a[80:83], a[184:187], a[0:3], a[80:83]
    buffer_load_dwordx4 v[228:231], v30, s[16:19], s69 offen offset:0 sc1
    v_mfma_f32_16x16x32_bf16 a[84:87], a[172:175], v[244:247], a[84:87]
    v_mfma_f32_16x16x32_bf16 a[84:87], a[188:191], a[0:3], a[84:87]
    s_waitcnt vmcnt(7)
    v_mfma_f32_16x16x32_bf16 a[56:59], v[96:99], a[4:7], a[56:59]
    v_mfma_f32_16x16x32_bf16 a[56:59], a[192:195], a[8:11], a[56:59]
    buffer_load_dwordx4 v[232:235], v30, s[16:19], s37 offen offset:3072 sc1
    v_mfma_f32_16x16x32_bf16 a[56:59], a[208:211], a[12:15], a[56:59]
    v_mfma_f32_16x16x32_bf16 a[60:63], v[100:103], a[4:7], a[60:63]
    v_mfma_f32_16x16x32_bf16 a[60:63], a[196:199], a[8:11], a[60:63]
    v_mfma_f32_16x16x32_bf16 a[60:63], a[212:215], a[12:15], a[60:63]
    buffer_load_dwordx4 v[236:239], v30, s[16:19], s38 offen offset:3072 sc1
    v_mfma_f32_16x16x32_bf16 a[64:67], v[104:107], a[4:7], a[64:67]
    v_mfma_f32_16x16x32_bf16 a[64:67], a[200:203], a[8:11], a[64:67]
    s_nop 2
    ds_write_b128 v16, a[56:59] offset:4096
    v_mfma_f32_16x16x32_bf16 a[64:67], a[216:219], a[12:15], a[64:67]
    v_mfma_f32_16x16x32_bf16 a[68:71], v[108:111], a[4:7], a[68:71]
    buffer_load_dwordx4 v[240:243], v30, s[16:19], s39 offen offset:3072 sc1
    v_mfma_f32_16x16x32_bf16 a[68:71], a[204:207], a[8:11], a[68:71]
    ds_write_b128 v17, a[60:63] offset:4096
    v_mfma_f32_16x16x32_bf16 a[68:71], a[220:223], a[12:15], a[68:71]
    s_waitcnt vmcnt(7)
    v_mfma_f32_16x16x32_bf16 a[72:75], v[96:99], a[16:19], a[72:75]
    v_mfma_f32_16x16x32_bf16 a[72:75], a[192:195], a[20:23], a[72:75]
    buffer_load_dwordx4 v[244:247], v30, s[16:19], s40 offen offset:3072 sc1
    v_mfma_f32_16x16x32_bf16 a[72:75], a[208:211], a[24:27], a[72:75]
    ds_write_b128 v16, a[64:67] offset:4224
    v_mfma_f32_16x16x32_bf16 a[76:79], v[100:103], a[16:19], a[76:79]
    v_mfma_f32_16x16x32_bf16 a[76:79], a[196:199], a[20:23], a[76:79]
    s_nop 0
    ds_write_b128 v17, a[68:71] offset:4224
    v_mfma_f32_16x16x32_bf16 a[76:79], a[212:215], a[24:27], a[76:79]
    buffer_load_dwordx4 a[0:3], v31, s[16:19], s37 offen offset:0 sc1
    v_mfma_f32_16x16x32_bf16 a[80:83], v[104:107], a[16:19], a[80:83]
    v_mfma_f32_16x16x32_bf16 a[80:83], a[200:203], a[20:23], a[80:83]
    ds_write_b128 v16, a[72:75] offset:8192
    v_mfma_f32_16x16x32_bf16 a[80:83], a[216:219], a[24:27], a[80:83]
    v_mfma_f32_16x16x32_bf16 a[84:87], v[108:111], a[16:19], a[84:87]
    buffer_load_dwordx4 a[4:7], v31, s[16:19], s38 offen offset:0 sc1
    v_mfma_f32_16x16x32_bf16 a[84:87], a[204:207], a[20:23], a[84:87]
    s_nop 0
    ds_write_b128 v17, a[76:79] offset:8192
    v_mfma_f32_16x16x32_bf16 a[84:87], a[220:223], a[24:27], a[84:87]
    s_waitcnt vmcnt(8)
    v_mfma_f32_16x16x32_bf16 a[40:43], v[208:211], a[28:31], a[40:43]
    v_mfma_f32_16x16x32_bf16 a[40:43], v[64:67], a[32:35], a[40:43]
    buffer_load_dwordx4 a[8:11], v31, s[16:19], s39 offen offset:0 sc1
    v_mfma_f32_16x16x32_bf16 a[44:47], v[212:215], a[28:31], a[44:47]
    ds_write_b128 v16, a[80:83] offset:8320
    v_mfma_f32_16x16x32_bf16 a[44:47], v[68:71], a[32:35], a[44:47]
    v_mfma_f32_16x16x32_bf16 a[48:51], v[216:219], a[28:31], a[48:51]
    s_nop 0
    ds_write_b128 v17, a[84:87] offset:8320
    v_mfma_f32_16x16x32_bf16 a[48:51], v[72:75], a[32:35], a[48:51]
    buffer_load_dwordx4 a[12:15], v31, s[16:19], s40 offen offset:0 sc1
    v_mfma_f32_16x16x32_bf16 a[52:55], v[220:223], a[28:31], a[52:55]
    v_mfma_f32_16x16x32_bf16 a[52:55], v[76:79], a[32:35], a[52:55]
    s_waitcnt vmcnt(8)
    v_mfma_f32_16x16x32_bf16 a[40:43], v[80:83], v[224:227], a[40:43]
    v_mfma_f32_16x16x32_bf16 a[40:43], v[96:99], v[228:231], a[40:43]
    v_mfma_f32_16x16x32_bf16 a[44:47], v[84:87], v[224:227], a[44:47]
    v_mfma_f32_16x16x32_bf16 a[44:47], v[100:103], v[228:231], a[44:47]
    v_mfma_f32_16x16x32_bf16 a[48:51], v[88:91], v[224:227], a[48:51]
    v_mfma_f32_16x16x32_bf16 a[48:51], v[104:107], v[228:231], a[48:51]
    v_mfma_f32_16x16x32_bf16 a[52:55], v[92:95], v[224:227], a[52:55]
    s_nop 3
    ds_write_b128 v16, a[40:43] offset:0
    v_mfma_f32_16x16x32_bf16 a[52:55], v[108:111], v[228:231], a[52:55]
    s_waitcnt vmcnt(6)
    v_mfma_f32_16x16x32_bf16 a[88:91], a[160:163], v[232:235], a[88:91]
    ds_write_b128 v17, a[44:47] offset:0
    v_mfma_f32_16x16x32_bf16 a[88:91], a[176:179], v[236:239], a[88:91]
    v_mfma_f32_16x16x32_bf16 a[92:95], a[164:167], v[232:235], a[92:95]
    ds_write_b128 v16, a[48:51] offset:128
    v_mfma_f32_16x16x32_bf16 a[92:95], a[180:183], v[236:239], a[92:95]
    v_mfma_f32_16x16x32_bf16 a[96:99], a[168:171], v[232:235], a[96:99]
    s_nop 0
    ds_write_b128 v17, a[52:55] offset:128
    v_mfma_f32_16x16x32_bf16 a[96:99], a[184:187], v[236:239], a[96:99]
    v_mfma_f32_16x16x32_bf16 a[100:103], a[172:175], v[232:235], a[100:103]
    v_mfma_f32_16x16x32_bf16 a[100:103], a[188:191], v[236:239], a[100:103]
    s_waitcnt vmcnt(4)
    v_mfma_f32_16x16x32_bf16 a[88:91], a[192:195], v[240:243], a[88:91]
    v_mfma_f32_16x16x32_bf16 a[88:91], a[208:211], v[244:247], a[88:91]
    v_mfma_f32_16x16x32_bf16 a[92:95], a[196:199], v[240:243], a[92:95]
    v_mfma_f32_16x16x32_bf16 a[92:95], a[212:215], v[244:247], a[92:95]
    v_mfma_f32_16x16x32_bf16 a[96:99], a[200:203], v[240:243], a[96:99]
    v_mfma_f32_16x16x32_bf16 a[96:99], a[216:219], v[244:247], a[96:99]
    v_mfma_f32_16x16x32_bf16 a[100:103], a[204:207], v[240:243], a[100:103]
    s_nop 3
    ds_write_b128 v16, a[88:91] offset:12288
    v_mfma_f32_16x16x32_bf16 a[100:103], a[220:223], v[244:247], a[100:103]
    s_waitcnt vmcnt(2)
    v_mfma_f32_16x16x32_bf16 a[104:107], a[160:163], a[0:3], a[104:107]
    ds_write_b128 v17, a[92:95] offset:12288
    v_mfma_f32_16x16x32_bf16 a[104:107], a[176:179], a[4:7], a[104:107]
    v_mfma_f32_16x16x32_bf16 a[108:111], a[164:167], a[0:3], a[108:111]
    ds_write_b128 v16, a[96:99] offset:12416
    v_mfma_f32_16x16x32_bf16 a[108:111], a[180:183], a[4:7], a[108:111]
    v_mfma_f32_16x16x32_bf16 a[112:115], a[168:171], a[0:3], a[112:115]
    s_nop 0
    ds_write_b128 v17, a[100:103] offset:12416
    v_mfma_f32_16x16x32_bf16 a[112:115], a[184:187], a[4:7], a[112:115]
    v_mfma_f32_16x16x32_bf16 a[116:119], a[172:175], a[0:3], a[116:119]
    v_mfma_f32_16x16x32_bf16 a[116:119], a[188:191], a[4:7], a[116:119]
    s_waitcnt vmcnt(0)
    v_mfma_f32_16x16x32_bf16 a[104:107], a[192:195], a[8:11], a[104:107]
    v_mfma_f32_16x16x32_bf16 a[104:107], a[208:211], a[12:15], a[104:107]
    v_mfma_f32_16x16x32_bf16 a[108:111], a[196:199], a[8:11], a[108:111]
    v_mfma_f32_16x16x32_bf16 a[108:111], a[212:215], a[12:15], a[108:111]
    v_mfma_f32_16x16x32_bf16 a[112:115], a[200:203], a[8:11], a[112:115]
    v_mfma_f32_16x16x32_bf16 a[112:115], a[216:219], a[12:15], a[112:115]
    v_mfma_f32_16x16x32_bf16 a[116:119], a[204:207], a[8:11], a[116:119]
    s_nop 3
    ds_write_b128 v16, a[104:107] offset:16384
    v_mfma_f32_16x16x32_bf16 a[116:119], a[220:223], a[12:15], a[116:119]
    ds_write_b128 v17, a[108:111] offset:16384
    s_nop 0
    ds_write_b128 v16, a[112:115] offset:16512
    s_nop 5
    ds_write_b128 v17, a[116:119] offset:16512
    s_waitcnt lgkmcnt(0)
    s_barrier
    ds_read_b128 v[32:35], v8 offset:0
    ds_read_b128 v[36:39], v9 offset:0
    ds_read_b128 v[40:43], v8 offset:20480
    ds_read_b128 v[44:47], v9 offset:20480
    ds_read_b128 v[48:51], v10 offset:0
    ds_read_b128 v[52:55], v11 offset:0
    ds_read_b128 v[56:59], v10 offset:20480
    ds_read_b128 v[60:63], v11 offset:20480
    ds_read_b128 v[64:67], v8 offset:8192
    ds_read_b128 v[68:71], v9 offset:8192
    ds_read_b128 v[72:75], v8 offset:28672
    ds_read_b128 v[76:79], v9 offset:28672
    ds_read_b128 v[80:83], v10 offset:8192
    ds_read_b128 v[84:87], v11 offset:8192
    ds_read_b128 v[88:91], v10 offset:28672
    ds_read_b128 v[92:95], v11 offset:28672
    s_waitcnt lgkmcnt(12)
    v_pk_add_f32 v[32:33], v[32:33], v[40:41]
    v_pk_add_f32 v[34:35], v[34:35], v[42:43]
    v_pk_add_f32 v[36:37], v[36:37], v[44:45]
    v_pk_add_f32 v[38:39], v[38:39], v[46:47]
    s_waitcnt lgkmcnt(8)
    ds_read_b128 v[96:99], v12 offset:16384
    ds_read_b128 v[100:103], v12 offset:36864
    ds_read_b128 v[104:107], v13 offset:16384
    ds_read_b128 v[108:111], v13 offset:36864
    v_pk_add_f32 v[48:49], v[48:49], v[56:57]
    v_pk_add_f32 v[50:51], v[50:51], v[58:59]
    v_pk_add_f32 v[52:53], v[52:53], v[60:61]
    v_pk_add_f32 v[54:55], v[54:55], v[62:63]
    v_pk_add_f32 v[32:33], v[32:33], v[48:49]
    v_pk_add_f32 v[34:35], v[34:35], v[50:51]
    v_pk_add_f32 v[36:37], v[36:37], v[52:53]
    v_pk_add_f32 v[38:39], v[38:39], v[54:55]
    v_cvt_pk_bf16_f32 v40, v32, v33
    v_cvt_pk_bf16_f32 v41, v34, v35
    v_cvt_pk_bf16_f32 v42, v36, v37
    v_cvt_pk_bf16_f32 v43, v38, v39
    buffer_store_dwordx4 v[40:43], v18, s[24:27], s53 offen nt
    s_add_u32 s53, s53, 40960
    s_waitcnt lgkmcnt(8)
    v_pk_add_f32 v[64:65], v[64:65], v[72:73]
    v_pk_add_f32 v[66:67], v[66:67], v[74:75]
    v_pk_add_f32 v[68:69], v[68:69], v[76:77]
    v_pk_add_f32 v[70:71], v[70:71], v[78:79]
    s_waitcnt lgkmcnt(4)
    v_pk_add_f32 v[80:81], v[80:81], v[88:89]
    v_pk_add_f32 v[82:83], v[82:83], v[90:91]
    v_pk_add_f32 v[84:85], v[84:85], v[92:93]
    v_pk_add_f32 v[86:87], v[86:87], v[94:95]
    v_pk_add_f32 v[64:65], v[64:65], v[80:81]
    v_pk_add_f32 v[66:67], v[66:67], v[82:83]
    v_pk_add_f32 v[68:69], v[68:69], v[84:85]
    v_pk_add_f32 v[70:71], v[70:71], v[86:87]
    v_cvt_pk_bf16_f32 v72, v64, v65
    v_cvt_pk_bf16_f32 v73, v66, v67
    v_cvt_pk_bf16_f32 v74, v68, v69
    v_cvt_pk_bf16_f32 v75, v70, v71
    buffer_store_dwordx4 v[72:75], v18, s[24:27], s53 offen nt
    s_add_u32 s53, s53, 40960
    s_waitcnt lgkmcnt(2)
    v_pk_add_f32 v[96:97], v[96:97], v[100:101]
    v_pk_add_f32 v[98:99], v[98:99], v[102:103]
    s_waitcnt lgkmcnt(0)
    v_pk_add_f32 v[104:105], v[104:105], v[108:109]
    v_pk_add_f32 v[106:107], v[106:107], v[110:111]
    v_pk_add_f32 v[96:97], v[96:97], v[104:105]
    v_pk_add_f32 v[98:99], v[98:99], v[106:107]
    v_cvt_pk_bf16_f32 v100, v96, v97
    v_cvt_pk_bf16_f32 v101, v98, v99
    buffer_store_dwordx2 v[100:101], v19, s[24:27], s53 offen nt
    s_endpgm
L_slow_n4c0:
    s_mov_b32 s62, 0x3ff00000
    s_mov_b32 s63, 0x0
    s_mov_b64 exec, s[62:63]
    buffer_load_dword v26, v25, s[28:31], 0 offen offset:0 sc1
    s_mov_b64 exec, -1
    s_waitcnt vmcnt(0)
    v_cmp_eq_u32 vcc, s50, v26
    s_andn2_b64 s[62:63], s[62:63], vcc
    s_cbranch_scc0 L_ok_n4c0
    s_cmp_eq_u32 s52, 0
    s_cbranch_scc1 L_ok_n4c0
    s_sub_u32 s52, s52, 1
    s_sleep 1
    s_branch L_slow_n4c0
L_slow_n4c1:
    s_mov_b32 s62, 0x7f0000
    s_mov_b32 s63, 0x0
    s_mov_b64 exec, s[62:63]
    buffer_load_dword v26, v25, s[28:31], 0 offen offset:128 sc1
    s_mov_b64 exec, -1
    s_waitcnt vmcnt(0)
    v_cmp_eq_u32 vcc, s50, v26
    s_andn2_b64 s[62:63], s[62:63], vcc
    s_cbranch_scc0 L_ok_n4c1
    s_cmp_eq_u32 s52, 0
    s_cbranch_scc1 L_ok_n4c1
    s_sub_u32 s52, s52, 1
    s_sleep 1
    s_branch L_slow_n4c1
L_slow_n4c2:
    s_mov_b32 s62, 0xf0000
    s_mov_b32 s63, 0x0
    s_mov_b64 exec, s[62:63]
    buffer_load_dword v26, v25, s[28:31], 0 offen offset:256 sc1
    s_mov_b64 exec, -1
    s_waitcnt vmcnt(0)
    v_cmp_eq_u32 vcc, s50, v26
    s_andn2_b64 s[62:63], s[62:63], vcc
    s_cbranch_scc0 L_ok_n4c2
    s_cmp_eq_u32 s52, 0
    s_cbranch_scc1 L_ok_n4c2
    s_sub_u32 s52, s52, 1
    s_sleep 1
    s_branch L_slow_n4c2
L_slow_n4c3:
    s_mov_b32 s62, 0x3c0f0000
    s_mov_b32 s63, 0x0
    s_mov_b64 exec, s[62:63]
    buffer_load_dword v26, v25, s[28:31], 0 offen offset:384 sc1
    s_mov_b64 exec, -1
    s_waitcnt vmcnt(0)
    v_cmp_eq_u32 vcc, s50, v26
    s_andn2_b64 s[62:63], s[62:63], vcc
    s_cbranch_scc0 L_ok_n4c3
    s_cmp_eq_u32 s52, 0
    s_cbranch_scc1 L_ok_n4c3
    s_sub_u32 s52, s52, 1
    s_sleep 1
    s_branch L_slow_n4c3
.p2align 12
L_var5:
L_tv5_0:
    s_cbranch_execz L_base
    v_mfma_f32_16x16x32_bf16 v[48:51], a[112:115], v[136:139], v[48:51]
    ds_read_b128 v[136:139], v16 offset:14336
    s_load_dword s74, s[70:71], 8960
    s_load_dword s75, s[70:71], 10240
    v_mfma_f32_16x16x32_bf16 v[48:51], a[120:123], v[140:143], v[48:51]
    ds_read_b64_tr_b16 v[190:191], v7 offset:512
    s_load_dword s76, s[70:71], 43520
    s_waitcnt lgkmcnt(8)
    v_mfma_f32_16x16x32_bf16 v[52:55], a[64:67], v[112:115], v[52:55]
    ds_read_b128 v[140:143], v17 offset:14336
    s_load_dword s77, s[70:71], 44800
    v_mfma_f32_16x16x32_bf16 v[52:55], a[72:75], v[116:119], v[52:55]
    buffer_load_dwordx4 v235, s[20:23], s47 offen offset:3072 lds
    v_mfma_f32_16x16x32_bf16 v[60:63], a[68:71], v[112:115], v[60:63]
    s_waitcnt vmcnt(8)
    s_barrier
    s_cmp_lg_u32 s36, 0
    s_cbranch_scc1 L_pub_n51
    s_atomic_swap s50, s[64:65], 128
L_pub_n51:
    ds_read_b128 v[112:115], v16 offset:18432
    v_mfma_f32_16x16x32_bf16 v[60:63], a[76:79], v[116:119], v[60:63]
    ds_read_b64_tr_b16 v[192:193], v4 offset:16384
    s_add_u32 m0, s44, 49152
    s_waitcnt lgkmcnt(8)
    v_mfma_f32_16x16x32_bf16 v[60:63], a[84:87], v[120:123], v[60:63]
    ds_read_b128 v[116:119], v17 offset:18432
    v_mfma_f32_16x16x32_bf16 v[60:63], a[92:95], v[124:127], v[60:63]
    buffer_load_dwordx4 v8, s[8:11], s46 offen offset:0 lds
    v_mfma_f32_16x16x32_bf16 v[52:55], a[80:83], v[120:123], v[52:55]
    ds_read_b128 v[120:123], v16 offset:22528
    v_mfma_f32_16x16x32_bf16 v[52:55], a[88:91], v[124:127], v[52:55]
    ds_read_b64_tr_b16 v[194:195], v4 offset:16896
    s_waitcnt lgkmcnt(8)
    v_mfma_f32_16x16x32_bf16 v[52:55], a[96:99], v[128:131], v[52:55]
    ds_read_b128 v[124:127], v17 offset:22528
    v_mfma_f32_16x16x32_bf16 v[52:55], a[104:107], v[132:135], v[52:55]
    buffer_load_dwordx4 v9, s[8:11], s46 offen offset:1024 lds
    v_mfma_f32_16x16x32_bf16 v[60:63], a[100:103], v[128:131], v[60:63]
    ds_read_b128 v[128:131], v16 offset:16384
    s_mov_b32 s47, s54
    s_add_u32 s54, s54, s55
    v_mfma_f32_16x16x32_bf16 v[60:63], a[108:111], v[132:135], v[60:63]
    ds_read_b64_tr_b16 v[196:197], v5 offset:16384
    s_waitcnt lgkmcnt(8)
    v_mfma_f32_16x16x32_bf16 v[60:63], a[116:119], v[136:139], v[60:63]
    ds_read_b128 v[132:135], v17 offset:16384
    v_mfma_f32_16x16x32_bf16 v[60:63], a[124:127], v[140:143], v[60:63]
    buffer_load_dwordx4 v10, s[8:11], s46 offen offset:2048 lds
    v_mfma_f32_16x16x32_bf16 v[52:55], a[112:115], v[136:139], v[52:55]
    ds_read_b128 v[136:139], v16 offset:20480
    v_mfma_f32_16x16x32_bf16 v[52:55], a[120:123], v[140:143], v[52:55]
    ds_read_b64_tr_b16 v[198:199], v5 offset:16896
    s_waitcnt lgkmcnt(8)
    v_mfma_f32_16x16x32_bf16 v[52:55], a[128:131], v[112:115], v[52:55]
    ds_read_b128 v[140:143], v17 offset:20480
    v_mfma_f32_16x16x32_bf16 v[52:55], a[136:139], v[116:119], v[52:55]
    buffer_load_dwordx4 v11, s[8:11], s46 offen offset:3072 lds
    v_mfma_f32_16x16x32_bf16 v[60:63], a[132:135], v[112:115], v[60:63]
    ds_read_b128 v[112:115], v16 offset:26624
    s_add_u32 m0, s45, 49152
    s_load_dword s78, s[70:71], 78080
    v_mfma_f32_16x16x32_bf16 v[60:63], a[140:143], v[116:119], v[60:63]
    ds_read_b64_tr_b16 v[200:201], v6 offset:16384
    s_load_dword s79, s[70:71], 79360
    s_waitcnt lgkmcnt(8)
    v_mfma_f32_16x16x32_bf16 v[60:63], a[148:151], v[120:123], v[60:63]
    ds_read_b128 v[116:119], v17 offset:26624
    s_load_dword s80, s[70:71], 112640
    s_load_dword s81, s[70:71], 113920
    v_mfma_f32_16x16x32_bf16 v[60:63], a[156:159], v[124:127], v[60:63]
    buffer_load_dwordx4 v232, s[20:23], s47 offen offset:0 lds
    v_mfma_f32_16x16x32_bf16 v[52:55], a[144:147], v[120:123], v[52:55]
    ds_read_b128 v[120:123], v16 offset:30720
    v_mfma_f32_16x16x32_bf16 v[52:55], a[152:155], v[124:127], v[52:55]
    ds_read_b64_tr_b16 v[202:203], v6 offset:16896
    s_waitcnt lgkmcnt(8)
    v_mfma_f32_16x16x32_bf16 v[48:51], a[128:131], v[128:131], v[48:51]
    ds_read_b128 v[124:127], v17 offset:30720
    v_mfma_f32_16x16x32_bf16 v[48:51], a[136:139], v[132:135], v[48:51]
    buffer_load_dwordx4 v233, s[20:23], s47 offen offset:1024 lds
    v_mfma_f32_16x16x32_bf16 v[56:59], a[132:135], v[128:131], v[56:59]
    ds_read_b128 v[128:131], v16 offset:24576
    s_mov_b32 s46, s54
    s_add_u32 s54, s54, s55
    v_mfma_f32_16x16x32_bf16 v[56:59], a[140:143], v[132:135], v[56:59]
    ds_read_b64_tr_b16 v[204:205], v7 offset:16384
    s_waitcnt lgkmcnt(8)
    v_mfma_f32_16x16x32_bf16 v[56:59], a[148:151], v[136:139], v[56:59]
    ds_read_b128 v[132:135], v17 offset:24576
    v_mfma_f32_16x16x32_bf16 v[56:59], a[156:159], v[140:143], v[56:59]
    buffer_load_dwordx4 v234, s[20:23], s47 offen offset:2048 lds
    v_mfma_f32_16x16x32_bf16 v[48:51], a[144:147], v[136:139], v[48:51]
    ds_read_b128 v[136:139], v16 offset:28672
    v_mfma_f32_16x16x32_bf16 v[48:51], a[152:155], v[140:143], v[48:51]
    ds_read_b64_tr_b16 v[206:207], v7 offset:16896
    s_waitcnt lgkmcnt(8)
    v_mfma_f32_16x16x32_bf16 v[36:39], a[0:3], v[112:115], 0
    ds_read_b128 v[140:143], v17 offset:28672
    v_mfma_f32_16x16x32_bf16 v[36:39], a[8:11], v[116:119], v[36:39]
    buffer_load_dwordx4 v235, s[20:23], s47 offen offset:3072 lds
    v_mfma_f32_16x16x32_bf16 v[44:47], a[4:7], v[112:115], 0
    s_waitcnt vmcnt(8)
    s_barrier
    ds_read_b128 v[112:115], v16 offset:32768
    v_mfma_f32_16x16x32_bf16 v[44:47], a[12:15], v[116:119], v[44:47]
    ds_read_b64_tr_b16 v[208:209], v4 offset:32768
    s_add_u32 m0, s45, 0
    s_waitcnt lgkmcnt(8)
    v_mfma_f32_16x16x32_bf16 v[44:47], a[20:23], v[120:123], v[44:47]
    ds_read_b128 v[116:119], v17 offset:32768
    v_readlane_b32 s88, v24, 6
    v_mul_f32 v48, v48, v56
    v_mul_f32 v49, v49, v57
    v_mfma_f32_16x16x32_bf16 v[44:47], a[28:31], v[124:127], v[44:47]
    buffer_load_dwordx4 v232, s[20:23], s46 offen offset:0 lds
    v_mul_f32 v50, v50, v58
    v_mfma_f32_16x16x32_bf16 v[36:39], a[16:19], v[120:123], v[36:39]
    ds_read_b128 v[120:123], v16 offset:36864
    s_load_dword s82, s[70:71], 11520
    s_load_dword s83, s[70:71], 12800
    v_mfma_f32_16x16x32_bf16 v[36:39], a[24:27], v[124:127], v[36:39]
    ds_read_b64_tr_b16 v[210:211], v4 offset:33280
    s_load_dword s84, s[70:71], 46080
    s_waitcnt lgkmcnt(8)
    v_mfma_f32_16x16x32_bf16 v[32:35], a[0:3], v[128:131], 0
    ds_read_b128 v[124:127], v17 offset:36864
    s_load_dword s85, s[70:71], 47360
    v_mul_f32 v51, v51, v59
    v_mul_f32 v52, v52, v60
    v_mul_f32 v53, v53, v61
    v_mfma_f32_16x16x32_bf16 v[32:35], a[8:11], v[132:135], v[32:35]
    buffer_load_dwordx4 v233, s[20:23], s46 offen offset:1024 lds
    v_mul_f32 v54, v54, v62
    v_mfma_f32_16x16x32_bf16 v[40:43], a[4:7], v[128:131], 0
    ds_read_b128 v[128:131], v16 offset:40960
    s_min_u32 s47, s54, 2211840
    v_mul_f32 v55, v55, v63
    v_mfma_f32_16x16x32_bf16 v[40:43], a[12:15], v[132:135], v[40:43]
    ds_read_b64_tr_b16 v[212:213], v5 offset:32768
    v_cvt_pk_bf16_f32 v56, v48, v49
    v_cvt_pk_bf16_f32 v58, v52, v53
    s_waitcnt lgkmcnt(8)
    v_mfma_f32_16x16x32_bf16 v[40:43], a[20:23], v[136:139], v[40:43]
    ds_read_b128 v[132:135], v17 offset:40960
    v_cvt_pk_bf16_f32 v57, v50, v51
    v_mfma_f32_16x16x32_bf16 v[40:43], a[28:31], v[140:143], v[40:43]
    buffer_load_dwordx4 v234, s[20:23], s46 offen offset:2048 lds
    v_cvt_pk_bf16_f32 v59, v54, v55
    v_mfma_f32_16x16x32_bf16 v[32:35], a[16:19], v[136:139], v[32:35]
    ds_read_b128 v[136:139], v16 offset:45056
    v_permlane16_swap_b32 v56, v58
    v_mfma_f32_16x16x32_bf16 v[32:35], a[24:27], v[140:143], v[32:35]
    ds_read_b64_tr_b16 v[214:215], v5 offset:33280
    v_permlane16_swap_b32 v57, v59
    buffer_store_dwordx4 v[56:59], v21, s[16:19], s88 offen sc1
    s_waitcnt lgkmcnt(8)
    v_mfma_f32_16x16x32_bf16 v[32:35], a[32:35], v[112:115], v[32:35]
    ds_read_b128 v[140:143], v17 offset:45056
    v_mfma_f32_16x16x32_bf16 v[32:35], a[40:43], v[116:119], v[32:35]
    buffer_load_dwordx4 v235, s[20:23], s46 offen offset:3072 lds
    v_mfma_f32_16x16x32_bf16 v[40:43], a[36:39], v[112:115], v[40:43]
    ds_read_b128 v[112:115], v16 offset:34816
    s_add_u32 m0, s45, 16384
    v_mfma_f32_16x16x32_bf16 v[40:43], a[44:47], v[116:119], v[40:43]
    ds_read_b64_tr_b16 v[216:217], v6 offset:32768
    s_waitcnt lgkmcnt(8)
    v_mfma_f32_16x16x32_bf16 v[40:43], a[52:55], v[120:123], v[40:43]
    ds_read_b128 v[116:119], v17 offset:34816
    v_mfma_f32_16x16x32_bf16 v[40:43], a[60:63], v[124:127], v[40:43]
    buffer_load_dwordx4 v232, s[20:23], s47 offen offset:0 lds
    v_mfma_f32_16x16x32_bf16 v[32:35], a[48:51], v[120:123], v[32:35]
    ds_read_b128 v[120:123], v16 offset:38912
    v_mfma_f32_16x16x32_bf16 v[32:35], a[56:59], v[124:127], v[32:35]
    ds_read_b64_tr_b16 v[218:219], v6 offset:33280
    s_waitcnt lgkmcnt(8)
    v_mfma_f32_16x16x32_bf16 v[32:35], a[64:67], v[128:131], v[32:35]
    ds_read_b128 v[124:127], v17 offset:38912
    v_mfma_f32_16x16x32_bf16 v[32:35], a[72:75], v[132:135], v[32:35]
    buffer_load_dwordx4 v233, s[20:23], s47 offen offset:1024 lds
    v_mfma_f32_16x16x32_bf16 v[40:43], a[68:71], v[128:131], v[40:43]
    ds_read_b128 v[128:131], v16 offset:43008
    v_mfma_f32_16x16x32_bf16 v[40:43], a[76:79], v[132:135], v[40:43]
    ds_read_b64_tr_b16 v[220:221], v7 offset:32768
    s_waitcnt lgkmcnt(8)
    v_mfma_f32_16x16x32_bf16 v[40:43], a[84:87], v[136:139], v[40:43]
    ds_read_b128 v[132:135], v17 offset:43008
    v_mfma_f32_16x16x32_bf16 v[40:43], a[92:95], v[140:143], v[40:43]
    buffer_load_dwordx4 v234, s[20:23], s47 offen offset:2048 lds
    v_mfma_f32_16x16x32_bf16 v[32:35], a[80:83], v[136:139], v[32:35]
    ds_read_b128 v[136:139], v16 offset:47104
    v_mfma_f32_16x16x32_bf16 v[32:35], a[88:91], v[140:143], v[32:35]
    ds_read_b64_tr_b16 v[222:223], v7 offset:33280
    s_waitcnt lgkmcnt(8)
    v_mfma_f32_16x16x32_bf16 v[36:39], a[32:35], v[112:115], v[36:39]
    s_waitcnt lgkmcnt(0)
    s_xor_b64 s[74:75], s[74:75], s[50:51]
    s_xor_b64 s[76:77], s[76:77], s[50:51]
    s_xor_b64 s[78:79], s[78:79], s[50:51]
    s_xor_b64 s[80:81], s[80:81], s[50:51]
    s_xor_b64 s[82:83], s[82:83], s[50:51]
    s_xor_b64 s[84:85], s[84:85], s[50:51]
    s_or_b64 s[74:75], s[74:75], s[76:77]
    s_or_b64 s[74:75], s[74:75], s[78:79]
    s_or_b64 s[74:75], s[74:75], s[80:81]
    s_or_b64 s[74:75], s[74:75], s[82:83]
    s_or_b64 s[74:75], s[74:75], s[84:85]
    s_cbranch_scc1 L_slow_n5c0
L_ok_n5c0:
    ds_read_b128 v[140:143], v17 offset:47104
    v_mfma_f32_16x16x32_bf16 v[36:39], a[40:43], v[116:119], v[36:39]
    buffer_load_dwordx4 v235, s[20:23], s47 offen offset:3072 lds
    v_mfma_f32_16x16x32_bf16 v[44:47], a[36:39], v[112:115], v[44:47]
    s_waitcnt vmcnt(9)
    s_barrier
    ds_read_b128 v[112:115], v16 offset:51200
    v_mfma_f32_16x16x32_bf16 v[44:47], a[44:47], v[116:119], v[44:47]
    ds_read_b64_tr_b16 v[64:65], v4 offset:49152
    v_mfma_f32_16x16x32_bf16 v[44:47], a[52:55], v[120:123], v[44:47]
    ds_read_b128 v[116:119], v17 offset:51200
    v_mfma_f32_16x16x32_bf16 v[44:47], a[60:63], v[124:127], v[44:47]
    buffer_load_dwordx4 v[224:227], v30, s[16:19], s57 offen offset:0 sc1
    v_mfma_f32_16x16x32_bf16 v[36:39], a[48:51], v[120:123], v[36:39]
    ds_read_b128 v[120:123], v16 offset:55296
    v_mfma_f32_16x16x32_bf16 v[36:39], a[56:59], v[124:127], v[36:39]
    ds_read_b64_tr_b16 v[66:67], v4 offset:49664
    v_mfma_f32_16x16x32_bf16 v[36:39], a[64:67], v[128:131], v[36:39]
    ds_read_b128 v[124:127], v17 offset:55296
    v_mfma_f32_16x16x32_bf16 v[36:39], a[72:75], v[132:135], v[36:39]
    buffer_load_dwordx4 v[228:231], v30, s[16:19], s58 offen offset:0 sc1
    v_mfma_f32_16x16x32_bf16 v[44:47], a[68:71], v[128:131], v[44:47]
    ds_read_b128 v[128:131], v16 offset:59392
    v_mfma_f32_16x16x32_bf16 v[44:47], a[76:79], v[132:135], v[44:47]
    ds_read_b64_tr_b16 v[68:69], v5 offset:49152
    s_waitcnt lgkmcnt(8)
    v_mfma_f32_16x16x32_bf16 v[44:47], a[84:87], v[136:139], v[44:47]
    ds_read_b128 v[132:135], v17 offset:59392
    v_mfma_f32_16x16x32_bf16 v[44:47], a[92:95], v[140:143], v[44:47]
    buffer_load_dwordx4 v[232:235], v31, s[16:19], s57 offen offset:0 sc1
    v_mfma_f32_16x16x32_bf16 v[36:39], a[80:83], v[136:139], v[36:39]
    ds_read_b128 v[136:139], v16 offset:63488
    v_mfma_f32_16x16x32_bf16 v[36:39], a[88:91], v[140:143], v[36:39]
    ds_read_b64_tr_b16 v[70:71], v5 offset:49664
    s_waitcnt lgkmcnt(8)
    v_mfma_f32_16x16x32_bf16 v[36:39], a[96:99], v[112:115], v[36:39]
    ds_read_b128 v[140:143], v17 offset:63488
    v_mfma_f32_16x16x32_bf16 v[36:39], a[104:107], v[116:119], v[36:39]
    buffer_load_dwordx4 v[236:239], v31, s[16:19], s58 offen offset:0 sc1
    v_mfma_f32_16x16x32_bf16 v[44:47], a[100:103], v[112:115], v[44:47]
    ds_read_b128 v[112:115], v16 offset:49152
    v_mfma_f32_16x16x32_bf16 v[44:47], a[108:111], v[116:119], v[44:47]
    ds_read_b64_tr_b16 v[72:73], v6 offset:49152
    s_waitcnt lgkmcnt(8)
    v_mfma_f32_16x16x32_bf16 v[44:47], a[116:119], v[120:123], v[44:47]
    ds_read_b128 v[116:119], v17 offset:49152
    v_mfma_f32_16x16x32_bf16 v[44:47], a[124:127], v[124:127], v[44:47]
    buffer_load_dwordx4 v[240:243], v27, s[16:19], s57 offen offset:0 sc1
    v_mfma_f32_16x16x32_bf16 v[36:39], a[112:115], v[120:123], v[36:39]
    ds_read_b128 v[120:123], v16 offset:53248
    v_mfma_f32_16x16x32_bf16 v[36:39], a[120:123], v[124:127], v[36:39]
    ds_read_b64_tr_b16 v[74:75], v6 offset:49664
    s_waitcnt lgkmcnt(8)
    v_mfma_f32_16x16x32_bf16 v[36:39], a[128:131], v[128:131], v[36:39]
    ds_read_b128 v[124:127], v17 offset:53248
    v_mfma_f32_16x16x32_bf16 v[36:39], a[136:139], v[132:135], v[36:39]
    buffer_load_dwordx4 v[244:247], v27, s[16:19], s58 offen offset:0 sc1
    v_mfma_f32_16x16x32_bf16 v[44:47], a[132:135], v[128:131], v[44:47]
    ds_read_b128 v[128:131], v16 offset:57344
    v_mfma_f32_16x16x32_bf16 v[44:47], a[140:143], v[132:135], v[44:47]
    ds_read_b64_tr_b16 v[76:77], v7 offset:49152
    s_waitcnt lgkmcnt(8)
    v_mfma_f32_16x16x32_bf16 v[44:47], a[148:151], v[136:139], v[44:47]
    ds_read_b128 v[132:135], v17 offset:57344
    v_mfma_f32_16x16x32_bf16 v[44:47], a[156:159], v[140:143], v[44:47]
    buffer_load_dwordx4 a[0:3], v28, s[16:19], s57 offen offset:0 sc1
    v_mfma_f32_16x16x32_bf16 v[36:39], a[144:147], v[136:139], v[36:39]
    ds_read_b128 v[136:139], v16 offset:61440
    v_mfma_f32_16x16x32_bf16 v[36:39], a[152:155], v[140:143], v[36:39]
    ds_read_b64_tr_b16 v[78:79], v7 offset:49664
    s_waitcnt lgkmcnt(8)
    v_mfma_f32_16x16x32_bf16 v[32:35], a[96:99], v[112:115], v[32:35]
    ds_read_b128 v[140:143], v17 offset:61440
    v_mfma_f32_16x16x32_bf16 v[32:35], a[104:107], v[116:119], v[32:35]
    buffer_load_dwordx4 a[4:7], v28, s[16:19], s58 offen offset:0 sc1
    v_mfma_f32_16x16x32_bf16 v[40:43], a[100:103], v[112:115], v[40:43]
    s_waitcnt vmcnt(12)
    v_mfma_f32_16x16x32_bf16 v[40:43], a[108:111], v[116:119], v[40:43]
    ds_read_b64_tr_b16 v[80:81], v4 offset:0
    s_waitcnt lgkmcnt(7)
    v_mfma_f32_16x16x32_bf16 v[40:43], a[116:119], v[120:123], v[40:43]
    v_mfma_f32_16x16x32_bf16 v[40:43], a[124:127], v[124:127], v[40:43]
    ds_read_b64_tr_b16 v[82:83], v4 offset:512
    buffer_load_dwordx4 a[8:11], v30, s[16:19], s59 offen offset:0 sc1
    v_mfma_f32_16x16x32_bf16 v[32:35], a[112:115], v[120:123], v[32:35]
    v_mfma_f32_16x16x32_bf16 v[32:35], a[120:123], v[124:127], v[32:35]
    ds_read_b64_tr_b16 v[84:85], v5 offset:0
    s_waitcnt lgkmcnt(6)
    v_mfma_f32_16x16x32_bf16 v[32:35], a[128:131], v[128:131], v[32:35]
    v_mfma_f32_16x16x32_bf16 v[32:35], a[136:139], v[132:135], v[32:35]
    ds_read_b64_tr_b16 v[86:87], v5 offset:512
    buffer_load_dwordx4 a[12:15], v30, s[16:19], s66 offen offset:0 sc1
    v_mfma_f32_16x16x32_bf16 v[40:43], a[132:135], v[128:131], v[40:43]
    v_mfma_f32_16x16x32_bf16 v[40:43], a[140:143], v[132:135], v[40:43]
    ds_read_b64_tr_b16 v[88:89], v6 offset:0
    s_waitcnt lgkmcnt(5)
    v_mfma_f32_16x16x32_bf16 v[40:43], a[148:151], v[136:139], v[40:43]
    v_mfma_f32_16x16x32_bf16 v[40:43], a[156:159], v[140:143], v[40:43]
    ds_read_b64_tr_b16 v[90:91], v6 offset:512
    v_mfma_f32_16x16x32_bf16 v[32:35], a[144:147], v[136:139], v[32:35]
    v_mfma_f32_16x16x32_bf16 v[32:35], a[152:155], v[140:143], v[32:35]
    ds_read_b64_tr_b16 v[92:93], v7 offset:0
    ds_read_b64_tr_b16 v[94:95], v7 offset:512
    s_waitcnt vmcnt(8)
    v_mfma_f32_16x16x32_bf16 a[40:43], v[160:163], v[224:227], 0
    s_load_dword s74, s[70:71], 80640
    s_load_dword s75, s[70:71], 81920
    s_barrier
    s_cmp_lg_u32 s36, 0
    s_cbranch_scc1 L_pub_n52
    s_atomic_swap s50, s[64:65], 256
L_pub_n52:
    v_mfma_f32_16x16x32_bf16 a[40:43], v[176:179], v[228:231], a[40:43]
    buffer_load_dwordx4 a[16:19], v31, s[16:19], s59 offen offset:0 sc1
    v_mfma_f32_16x16x32_bf16 a[44:47], v[164:167], v[224:227], 0
    s_load_dword s76, s[70:71], 115200
    s_load_dword s77, s[70:71], 116480
    v_readlane_b32 s89, v24, 7
    v_mul_f32 v32, v32, v40
    v_mfma_f32_16x16x32_bf16 a[44:47], v[180:183], v[228:231], a[44:47]
    s_load_dword s78, s[70:71], 14080
    s_load_dword s79, s[70:71], 15360
    v_mul_f32 v33, v33, v41
    v_mul_f32 v34, v34, v42
    v_mfma_f32_16x16x32_bf16 a[48:51], v[168:171], v[224:227], 0
    s_load_dword s80, s[70:71], 48640
    s_load_dword s81, s[70:71], 49920
    s_load_dword s82, s[70:71], 83200
    s_load_dword s83, s[70:71], 84480
    s_load_dword s84, s[70:71], 117760
    s_load_dword s85, s[70:71], 119040
    v_mul_f32 v35, v35, v43
    v_mul_f32 v36, v36, v44
    v_mfma_f32_16x16x32_bf16 a[48:51], v[184:187], v[228:231], a[48:51]
    buffer_load_dwordx4 a[20:23], v31, s[16:19], s66 offen offset:0 sc1
    v_mfma_f32_16x16x32_bf16 a[52:55], v[172:175], v[224:227], 0
    s_waitcnt lgkmcnt(0)
    s_xor_b64 s[74:75], s[74:75], s[50:51]
    s_xor_b64 s[76:77], s[76:77], s[50:51]
    s_xor_b64 s[78:79], s[78:79], s[50:51]
    s_xor_b64 s[80:81], s[80:81], s[50:51]
    s_xor_b64 s[82:83], s[82:83], s[50:51]
    v_mul_f32 v37, v37, v45
    v_mul_f32 v38, v38, v46
    v_mfma_f32_16x16x32_bf16 a[52:55], v[188:191], v[228:231], a[52:55]
    s_xor_b64 s[84:85], s[84:85], s[50:51]
    s_or_b64 s[74:75], s[74:75], s[76:77]
    s_or_b64 s[74:75], s[74:75], s[78:79]
    s_or_b64 s[74:75], s[74:75], s[80:81]
    s_or_b64 s[74:75], s[74:75], s[82:83]
    s_or_b64 s[74:75], s[74:75], s[84:85]
    s_cbranch_scc1 L_slow_n5c1
L_ok_n5c1:
    v_mul_f32 v39, v39, v47
    v_cvt_pk_bf16_f32 v40, v32, v33
    s_waitcnt vmcnt(8)
    v_mfma_f32_16x16x32_bf16 a[56:59], v[160:163], v[232:235], 0
    v_cvt_pk_bf16_f32 v42, v36, v37
    v_cvt_pk_bf16_f32 v41, v34, v35
    v_mfma_f32_16x16x32_bf16 a[56:59], v[176:179], v[236:239], a[56:59]
    buffer_load_dwordx4 a[24:27], v27, s[16:19], s59 offen offset:0 sc1
    v_mfma_f32_16x16x32_bf16 a[60:63], v[164:167], v[232:235], 0
    v_cvt_pk_bf16_f32 v43, v38, v39
    s_nop 1
    v_permlane16_swap_b32 v40, v42
    v_mfma_f32_16x16x32_bf16 a[60:63], v[180:183], v[236:239], a[60:63]
    v_permlane16_swap_b32 v41, v43
    buffer_store_dwordx4 v[40:43], v21, s[16:19], s89 offen sc1
    v_mfma_f32_16x16x32_bf16 a[64:67], v[168:171], v[232:235], 0
    v_and_b32 v1, 15, v0
    v_mfma_f32_16x16x32_bf16 a[64:67], v[184:187], v[236:239], a[64:67]
    buffer_load_dwordx4 a[28:31], v27, s[16:19], s66 offen offset:0 sc1
    v_mfma_f32_16x16x32_bf16 a[68:71], v[172:175], v[232:235], 0
    v_lshrrev_b32 v2, 4, v0
    v_mfma_f32_16x16x32_bf16 a[68:71], v[188:191], v[236:239], a[68:71]
    ds_read_b64_tr_b16 v[96:97], v4 offset:16384
    v_and_b32 v3, 7, v0
    s_waitcnt vmcnt(9)
    v_mfma_f32_16x16x32_bf16 a[72:75], v[160:163], v[240:243], 0
    s_load_dword s74, s[72:73], 16640
    s_load_dword s75, s[72:73], 51200
    ds_read_b64_tr_b16 v[98:99], v4 offset:16896
    v_mfma_f32_16x16x32_bf16 a[72:75], v[176:179], v[244:247], a[72:75]
    buffer_load_dwordx4 a[32:35], v28, s[16:19], s59 offen offset:0 sc1
    v_mfma_f32_16x16x32_bf16 a[76:79], v[164:167], v[240:243], 0
    s_load_dword s76, s[72:73], 85760
    v_mfma_f32_16x16x32_bf16 a[76:79], v[180:183], v[244:247], a[76:79]
    s_load_dword s77, s[72:73], 120320
    ds_read_b64_tr_b16 v[100:101], v5 offset:16384
    v_mfma_f32_16x16x32_bf16 a[80:83], v[168:171], v[240:243], 0
    ds_read_b64_tr_b16 v[102:103], v5 offset:16896
    v_xor_b32 v2, v2, v3
    v_mfma_f32_16x16x32_bf16 a[80:83], v[184:187], v[244:247], a[80:83]
    buffer_load_dwordx4 v[224:227], v28, s[16:19], s66 offen offset:0 sc1
    v_mfma_f32_16x16x32_bf16 a[84:87], v[172:175], v[240:243], 0
    v_lshlrev_b32 v2, 4, v2
    v_mfma_f32_16x16x32_bf16 a[84:87], v[188:191], v[244:247], a[84:87]
    ds_read_b64_tr_b16 v[104:105], v6 offset:16384
    v_lshl_add_u32 v1, v1, 8, v2
    s_waitcnt vmcnt(9)
    v_mfma_f32_16x16x32_bf16 a[88:91], v[160:163], a[0:3], 0
    ds_read_b64_tr_b16 v[106:107], v6 offset:16896
    v_add_u32 v16, s43, v1
    v_mfma_f32_16x16x32_bf16 a[88:91], v[176:179], a[4:7], a[88:91]
    buffer_load_dwordx4 v[228:231], v30, s[16:19], s67 offen offset:0 sc1
    v_mfma_f32_16x16x32_bf16 a[92:95], v[164:167], a[0:3], 0
    v_xor_b32 v17, 64, v16
    v_mfma_f32_16x16x32_bf16 a[92:95], v[180:183], a[4:7], a[92:95]
    ds_read_b64_tr_b16 v[108:109], v7 offset:16384
    v_lshrrev_b32 v1, 3, v0
    v_mfma_f32_16x16x32_bf16 a[96:99], v[168:171], a[0:3], 0
    ds_read_b64_tr_b16 v[110:111], v7 offset:16896
    v_lshlrev_b32 v2, 1, v3
    v_mfma_f32_16x16x32_bf16 a[96:99], v[184:187], a[4:7], a[96:99]
    buffer_load_dwordx4 v[232:235], v30, s[16:19], s68 offen offset:0 sc1
    v_mfma_f32_16x16x32_bf16 a[100:103], v[172:175], a[0:3], 0
    v_xor_b32 v2, v2, v1
    v_mfma_f32_16x16x32_bf16 a[100:103], v[188:191], a[4:7], a[100:103]
    v_lshlrev_b32 v2, 4, v2
    s_waitcnt vmcnt(9)
    v_mfma_f32_16x16x32_bf16 a[40:43], v[192:195], a[8:11], a[40:43]
    s_lshl_b32 s61, s36, 3
    v_mfma_f32_16x16x32_bf16 a[40:43], v[208:211], a[12:15], a[40:43]
    buffer_load_dwordx4 v[236:239], v31, s[16:19], s67 offen offset:0 sc1
    v_mfma_f32_16x16x32_bf16 a[44:47], v[196:199], a[8:11], a[44:47]
    v_add_u32 v1, s61, v1
    v_mfma_f32_16x16x32_bf16 a[44:47], v[212:215], a[12:15], a[44:47]
    v_lshl_add_u32 v8, v1, 8, v2
    v_mfma_f32_16x16x32_bf16 a[48:51], v[200:203], a[8:11], a[48:51]
    v_xor_b32 v9, 16, v8
    v_mfma_f32_16x16x32_bf16 a[48:51], v[216:219], a[12:15], a[48:51]
    buffer_load_dwordx4 v[240:243], v31, s[16:19], s68 offen offset:0 sc1
    v_mfma_f32_16x16x32_bf16 a[52:55], v[204:207], a[8:11], a[52:55]
    v_add_u32 v10, 40960, v8
    v_mfma_f32_16x16x32_bf16 a[52:55], v[220:223], a[12:15], a[52:55]
    v_add_u32 v11, 40960, v9
    s_waitcnt vmcnt(9)
    v_mfma_f32_16x16x32_bf16 a[56:59], v[192:195], a[16:19], a[56:59]
    s_lshr_b32 s61, s36, 1
    v_mfma_f32_16x16x32_bf16 a[56:59], v[208:211], a[20:23], a[56:59]
    buffer_load_dwordx4 v[244:247], v27, s[16:19], s67 offen offset:0 sc1
    v_mfma_f32_16x16x32_bf16 a[60:63], v[196:199], a[16:19], a[60:63]
    s_mul_i32 s61, s61, 496
    v_mfma_f32_16x16x32_bf16 a[60:63], v[212:215], a[20:23], a[60:63]
    v_add_u32 v1, s61, v1
    v_mfma_f32_16x16x32_bf16 a[64:67], v[200:203], a[16:19], a[64:67]
    v_mul_u32_u24 v1, 1280, v1
    v_mfma_f32_16x16x32_bf16 a[64:67], v[216:219], a[20:23], a[64:67]
    buffer_load_dwordx4 a[0:3], v27, s[16:19], s68 offen offset:0 sc1
    v_mfma_f32_16x16x32_bf16 a[68:71], v[204:207], a[16:19], a[68:71]
    v_lshl_add_u32 v18, v3, 4, v1
    v_mfma_f32_16x16x32_bf16 a[68:71], v[220:223], a[20:23], a[68:71]
    s_waitcnt vmcnt(8)
    v_mfma_f32_16x16x32_bf16 a[72:75], v[192:195], a[24:27], a[72:75]
    s_waitcnt lgkmcnt(0)
    s_barrier
    s_cmp_lg_u32 s36, 0
    s_cbranch_scc1 L_pub_n53
    s_atomic_swap s50, s[64:65], 384
L_pub_n53:
    v_mfma_f32_16x16x32_bf16 a[72:75], v[208:211], a[28:31], a[72:75]
    buffer_load_dwordx4 a[4:7], v28, s[16:19], s67 offen offset:0 sc1
    v_mfma_f32_16x16x32_bf16 a[76:79], v[196:199], a[24:27], a[76:79]
    v_mfma_f32_16x16x32_bf16 a[76:79], v[212:215], a[28:31], a[76:79]
    v_mfma_f32_16x16x32_bf16 a[80:83], v[200:203], a[24:27], a[80:83]
    s_waitcnt lgkmcnt(0)
    s_xor_b64 s[74:75], s[74:75], s[50:51]
    v_mfma_f32_16x16x32_bf16 a[80:83], v[216:219], a[28:31], a[80:83]
    buffer_load_dwordx4 a[8:11], v28, s[16:19], s68 offen offset:0 sc1
    v_mfma_f32_16x16x32_bf16 a[84:87], v[204:207], a[24:27], a[84:87]
    s_xor_b64 s[76:77], s[76:77], s[50:51]
    v_mfma_f32_16x16x32_bf16 a[84:87], v[220:223], a[28:31], a[84:87]
    s_or_b64 s[74:75], s[74:75], s[76:77]
    s_cbranch_scc1 L_slow_n5c2
L_ok_n5c2:
    s_waitcnt vmcnt(8)
    v_mfma_f32_16x16x32_bf16 a[88:91], v[192:195], a[32:35], a[88:91]
    s_load_dword s74, s[70:71], 5248
    s_load_dword s75, s[70:71], 6528
    v_mfma_f32_16x16x32_bf16 a[88:91], v[208:211], v[224:227], a[88:91]
    buffer_load_dwordx4 a[12:15], v30, s[16:19], s69 offen offset:0 sc1
    v_mfma_f32_16x16x32_bf16 a[92:95], v[196:199], a[32:35], a[92:95]
    s_load_dword s76, s[70:71], 39808
    s_load_dword s77, s[70:71], 41088
    v_mfma_f32_16x16x32_bf16 a[92:95], v[212:215], v[224:227], a[92:95]
    s_load_dword s78, s[70:71], 74368
    s_load_dword s79, s[70:71], 75648
    v_mfma_f32_16x16x32_bf16 a[96:99], v[200:203], a[32:35], a[96:99]
    s_load_dword s80, s[70:71], 108928
    s_load_dword s81, s[70:71], 110208
    v_mfma_f32_16x16x32_bf16 a[96:99], v[216:219], v[224:227], a[96:99]
    buffer_load_dwordx4 a[16:19], v31, s[16:19], s69 offen offset:0 sc1
    v_mfma_f32_16x16x32_bf16 a[100:103], v[204:207], a[32:35], a[100:103]
    s_load_dword s82, s[70:71], 7808
    s_load_dword s83, s[70:71], 42368
    v_mfma_f32_16x16x32_bf16 a[100:103], v[220:223], v[224:227], a[100:103]
    s_load_dword s84, s[70:71], 76928
    s_load_dword s85, s[70:71], 111488
    s_waitcnt vmcnt(8)
    v_mfma_f32_16x16x32_bf16 a[40:43], v[64:67], v[228:231], a[40:43]
    v_mfma_f32_16x16x32_bf16 a[40:43], v[80:83], v[232:235], a[40:43]
    buffer_load_dwordx4 a[20:23], v27, s[16:19], s69 offen offset:0 sc1
    v_mfma_f32_16x16x32_bf16 a[44:47], v[68:71], v[228:231], a[44:47]
    v_mfma_f32_16x16x32_bf16 a[44:47], v[84:87], v[232:235], a[44:47]
    v_mfma_f32_16x16x32_bf16 a[48:51], v[72:75], v[228:231], a[48:51]
    s_waitcnt lgkmcnt(0)
    s_xor_b64 s[74:75], s[74:75], s[50:51]
    s_xor_b64 s[76:77], s[76:77], s[50:51]
    s_xor_b64 s[78:79], s[78:79], s[50:51]
    v_mfma_f32_16x16x32_bf16 a[48:51], v[88:91], v[232:235], a[48:51]
    buffer_load_dwordx4 a[24:27], v28, s[16:19], s69 offen offset:0 sc1
    v_mfma_f32_16x16x32_bf16 a[52:55], v[76:79], v[228:231], a[52:55]
    s_xor_b64 s[80:81], s[80:81], s[50:51]
    s_xor_b64 s[82:83], s[82:83], s[50:51]
    s_xor_b64 s[84:85], s[84:85], s[50:51]
    s_or_b64 s[74:75], s[74:75], s[76:77]
    v_mfma_f32_16x16x32_bf16 a[52:55], v[92:95], v[232:235], a[52:55]
    s_or_b64 s[74:75], s[74:75], s[78:79]
    s_or_b64 s[74:75], s[74:75], s[80:81]
    s_or_b64 s[74:75], s[74:75], s[82:83]
    s_or_b64 s[74:75], s[74:75], s[84:85]
    s_cbranch_scc1 L_slow_n5c3
L_ok_n5c3:
    s_waitcnt vmcnt(8)
    v_mfma_f32_16x16x32_bf16 a[56:59], v[64:67], v[236:239], a[56:59]
    v_mfma_f32_16x16x32_bf16 a[56:59], v[80:83], v[240:243], a[56:59]
    buffer_load_dwordx4 a[28:31], v30, s[16:19], s41 offen offset:0 sc1
    v_mfma_f32_16x16x32_bf16 a[60:63], v[68:71], v[236:239], a[60:63]
    v_mfma_f32_16x16x32_bf16 a[60:63], v[84:87], v[240:243], a[60:63]
    v_mfma_f32_16x16x32_bf16 a[64:67], v[72:75], v[236:239], a[64:67]
    v_mfma_f32_16x16x32_bf16 a[64:67], v[88:91], v[240:243], a[64:67]
    buffer_load_dwordx4 a[32:35], v30, s[16:19], s42 offen offset:0 sc1
    v_mfma_f32_16x16x32_bf16 a[68:71], v[76:79], v[236:239], a[68:71]
    v_mfma_f32_16x16x32_bf16 a[68:71], v[92:95], v[240:243], a[68:71]
    s_waitcnt vmcnt(8)
    v_mfma_f32_16x16x32_bf16 a[72:75], v[64:67], v[244:247], a[72:75]
    s_load_dword s74, s[70:71], 384
    s_load_dword s75, s[70:71], 1664
    v_mfma_f32_16x16x32_bf16 a[72:75], v[80:83], a[0:3], a[72:75]
    buffer_load_dwordx4 v[224:227], v31, s[16:19], s41 offen offset:0 sc1
    v_mfma_f32_16x16x32_bf16 a[76:79], v[68:71], v[244:247], a[76:79]
    s_load_dword s76, s[70:71], 2944
    s_load_dword s77, s[70:71], 4224
    v_mfma_f32_16x16x32_bf16 a[76:79], v[84:87], a[0:3], a[76:79]
    s_load_dword s78, s[70:71], 34944
    s_load_dword s79, s[70:71], 36224
    v_mfma_f32_16x16x32_bf16 a[80:83], v[72:75], v[244:247], a[80:83]
    s_load_dword s80, s[70:71], 37504
    s_load_dword s81, s[70:71], 38784
    v_mfma_f32_16x16x32_bf16 a[80:83], v[88:91], a[0:3], a[80:83]
    buffer_load_dwordx4 v[228:231], v31, s[16:19], s42 offen offset:0 sc1
    v_mfma_f32_16x16x32_bf16 a[84:87], v[76:79], v[244:247], a[84:87]
    s_load_dword s82, s[70:71], 69504
    s_load_dword s83, s[70:71], 70784
    v_mfma_f32_16x16x32_bf16 a[84:87], v[92:95], a[0:3], a[84:87]
    s_load_dword s84, s[70:71], 72064
    s_load_dword s85, s[70:71], 73344
    s_waitcnt vmcnt(8)
    v_mfma_f32_16x16x32_bf16 a[88:91], v[64:67], a[4:7], a[88:91]
    v_mfma_f32_16x16x32_bf16 a[88:91], v[80:83], a[8:11], a[88:91]
    buffer_load_dwordx4 v[232:235], v27, s[16:19], s41 offen offset:0 sc1
    v_mfma_f32_16x16x32_bf16 a[92:95], v[68:71], a[4:7], a[92:95]
    v_mfma_f32_16x16x32_bf16 a[92:95], v[84:87], a[8:11], a[92:95]
    v_mfma_f32_16x16x32_bf16 a[96:99], v[72:75], a[4:7], a[96:99]
    v_mfma_f32_16x16x32_bf16 a[96:99], v[88:91], a[8:11], a[96:99]
    buffer_load_dwordx4 v[236:239], v27, s[16:19], s42 offen offset:0 sc1
    v_mfma_f32_16x16x32_bf16 a[100:103], v[76:79], a[4:7], a[100:103]
    v_mfma_f32_16x16x32_bf16 a[100:103], v[92:95], a[8:11], a[100:103]
    s_waitcnt vmcnt(9)
    v_mfma_f32_16x16x32_bf16 a[40:43], v[96:99], a[12:15], a[40:43]
    v_mfma_f32_16x16x32_bf16 a[44:47], v[100:103], a[12:15], a[44:47]
    buffer_load_dwordx4 v[240:243], v28, s[16:19], s41 offen offset:0 sc1
    v_mfma_f32_16x16x32_bf16 a[48:51], v[104:107], a[12:15], a[48:51]
    v_mfma_f32_16x16x32_bf16 a[52:55], v[108:111], a[12:15], a[52:55]
    s_waitcnt vmcnt(9)
    v_mfma_f32_16x16x32_bf16 a[56:59], v[96:99], a[16:19], a[56:59]
    v_mfma_f32_16x16x32_bf16 a[60:63], v[100:103], a[16:19], a[60:63]
    buffer_load_dwordx4 v[244:247], v28, s[16:19], s42 offen offset:0 sc1
    v_mfma_f32_16x16x32_bf16 a[64:67], v[104:107], a[16:19], a[64:67]
    v_mfma_f32_16x16x32_bf16 a[68:71], v[108:111], a[16:19], a[68:71]
    s_waitcnt vmcnt(9)
L_tv5_1:
    s_cbranch_execz L_base
    v_mfma_f32_16x16x32_bf16 a[72:75], v[96:99], a[20:23], a[72:75]
    v_mfma_f32_16x16x32_bf16 a[76:79], v[100:103], a[20:23], a[76:79]
    buffer_load_dwordx4 a[0:3], v30, s[16:19], s49 offen offset:0 sc1
    v_mfma_f32_16x16x32_bf16 a[80:83], v[104:107], a[20:23], a[80:83]
    v_mfma_f32_16x16x32_bf16 a[84:87], v[108:111], a[20:23], a[84:87]
    s_waitcnt vmcnt(9)
    v_mfma_f32_16x16x32_bf16 a[88:91], v[96:99], a[24:27], a[88:91]
    v_mfma_f32_16x16x32_bf16 a[92:95], v[100:103], a[24:27], a[92:95]
    buffer_load_dwordx4 a[4:7], v31, s[16:19], s49 offen offset:0 sc1
    v_mfma_f32_16x16x32_bf16 a[96:99], v[104:107], a[24:27], a[96:99]
    v_mfma_f32_16x16x32_bf16 a[100:103], v[108:111], a[24:27], a[100:103]
    s_waitcnt vmcnt(8)
    v_mfma_f32_16x16x32_bf16 a[40:43], a[224:227], a[28:31], a[40:43]
    v_mfma_f32_16x16x32_bf16 a[40:43], a[240:243], a[32:35], a[40:43]
    buffer_load_dwordx4 a[8:11], v27, s[16:19], s49 offen offset:0 sc1
    v_mfma_f32_16x16x32_bf16 a[44:47], a[228:231], a[28:31], a[44:47]
    v_mfma_f32_16x16x32_bf16 a[44:47], a[244:247], a[32:35], a[44:47]
    v_mfma_f32_16x16x32_bf16 a[48:51], a[232:235], a[28:31], a[48:51]
    s_waitcnt lgkmcnt(0)
    s_xor_b64 s[74:75], s[74:75], s[50:51]
    s_xor_b64 s[76:77], s[76:77], s[50:51]
    s_xor_b64 s[78:79], s[78:79], s[50:51]
    v_mfma_f32_16x16x32_bf16 a[48:51], a[248:251], a[32:35], a[48:51]
    buffer_load_dwordx4 a[12:15], v28, s[16:19], s49 offen offset:0 sc1
    v_mfma_f32_16x16x32_bf16 a[52:55], a[236:239], a[28:31], a[52:55]
    s_xor_b64 s[80:81], s[80:81], s[50:51]
    s_xor_b64 s[82:83], s[82:83], s[50:51]
    s_xor_b64 s[84:85], s[84:85], s[50:51]
    s_or_b64 s[74:75], s[74:75], s[76:77]
    v_mfma_f32_16x16x32_bf16 a[52:55], a[252:255], a[32:35], a[52:55]
    s_or_b64 s[74:75], s[74:75], s[78:79]
    s_or_b64 s[74:75], s[74:75], s[80:81]
    s_or_b64 s[74:75], s[74:75], s[82:83]
    s_or_b64 s[74:75], s[74:75], s[84:85]
    s_cbranch_scc1 L_slow_n5c4
L_ok_n5c4:
    s_waitcnt vmcnt(8)
    v_mfma_f32_16x16x32_bf16 a[56:59], a[224:227], v[224:227], a[56:59]
    v_mfma_f32_16x16x32_bf16 a[56:59], a[240:243], v[228:231], a[56:59]
    buffer_load_dwordx4 a[16:19], v30, s[16:19], s37 offen offset:0 sc1
    v_mfma_f32_16x16x32_bf16 a[60:63], a[228:231], v[224:227], a[60:63]
    v_mfma_f32_16x16x32_bf16 a[60:63], a[244:247], v[228:231], a[60:63]
    v_mfma_f32_16x16x32_bf16 a[64:67], a[232:235], v[224:227], a[64:67]
    v_mfma_f32_16x16x32_bf16 a[64:67], a[248:251], v[228:231], a[64:67]
    buffer_load_dwordx4 a[20:23], v30, s[16:19], s38 offen offset:0 sc1
    v_mfma_f32_16x16x32_bf16 a[68:71], a[236:239], v[224:227], a[68:71]
    v_mfma_f32_16x16x32_bf16 a[68:71], a[252:255], v[228:231], a[68:71]
    s_waitcnt vmcnt(8)
    v_mfma_f32_16x16x32_bf16 a[72:75], a[224:227], v[232:235], a[72:75]
    s_load_dword s74, s[70:71], 104064
    s_load_dword s75, s[70:71], 105344
    v_mfma_f32_16x16x32_bf16 a[72:75], a[240:243], v[236:239], a[72:75]
    buffer_load_dwordx4 a[24:27], v30, s[16:19], s39 offen offset:0 sc1
    v_mfma_f32_16x16x32_bf16 a[76:79], a[228:231], v[232:235], a[76:79]
    s_load_dword s76, s[70:71], 106624
    v_mfma_f32_16x16x32_bf16 a[76:79], a[244:247], v[236:239], a[76:79]
    s_load_dword s77, s[70:71], 107904
    v_mfma_f32_16x16x32_bf16 a[80:83], a[232:235], v[232:235], a[80:83]
    v_mfma_f32_16x16x32_bf16 a[80:83], a[248:251], v[236:239], a[80:83]
    buffer_load_dwordx4 a[28:31], v30, s[16:19], s40 offen offset:0 sc1
    v_mfma_f32_16x16x32_bf16 a[84:87], a[236:239], v[232:235], a[84:87]
    v_mfma_f32_16x16x32_bf16 a[84:87], a[252:255], v[236:239], a[84:87]
    s_waitcnt vmcnt(8)
    v_mfma_f32_16x16x32_bf16 a[88:91], a[224:227], v[240:243], a[88:91]
    v_mfma_f32_16x16x32_bf16 a[88:91], a[240:243], v[244:247], a[88:91]
    buffer_load_dwordx4 a[32:35], v31, s[16:19], s37 offen offset:0 sc1
    v_mfma_f32_16x16x32_bf16 a[92:95], a[228:231], v[240:243], a[92:95]
    v_mfma_f32_16x16x32_bf16 a[92:95], a[244:247], v[244:247], a[92:95]
    v_mfma_f32_16x16x32_bf16 a[96:99], a[232:235], v[240:243], a[96:99]
    v_mfma_f32_16x16x32_bf16 a[96:99], a[248:251], v[244:247], a[96:99]
    buffer_load_dwordx4 v[224:227], v31, s[16:19], s38 offen offset:0 sc1
    v_mfma_f32_16x16x32_bf16 a[100:103], a[236:239], v[240:243], a[100:103]
    v_mfma_f32_16x16x32_bf16 a[100:103], a[252:255], v[244:247], a[100:103]
    s_waitcnt vmcnt(9)
    v_mfma_f32_16x16x32_bf16 a[40:43], v[144:147], a[0:3], a[40:43]
    v_mfma_f32_16x16x32_bf16 a[44:47], v[148:151], a[0:3], a[44:47]
    buffer_load_dwordx4 v[228:231], v31, s[16:19], s39 offen offset:0 sc1
    v_mfma_f32_16x16x32_bf16 a[48:51], v[152:155], a[0:3], a[48:51]
    v_mfma_f32_16x16x32_bf16 a[52:55], v[156:159], a[0:3], a[52:55]
    s_waitcnt vmcnt(9)
    v_mfma_f32_16x16x32_bf16 a[56:59], v[144:147], a[4:7], a[56:59]
    v_mfma_f32_16x16x32_bf16 a[60:63], v[148:151], a[4:7], a[60:63]
    buffer_load_dwordx4 v[232:235], v31, s[16:19], s40 offen offset:0 sc1
    v_mfma_f32_16x16x32_bf16 a[64:67], v[152:155], a[4:7], a[64:67]
    v_mfma_f32_16x16x32_bf16 a[68:71], v[156:159], a[4:7], a[68:71]
    s_waitcnt vmcnt(9)
    v_mfma_f32_16x16x32_bf16 a[72:75], v[144:147], a[8:11], a[72:75]
    v_mfma_f32_16x16x32_bf16 a[76:79], v[148:151], a[8:11], a[76:79]
    buffer_load_dwordx4 v[236:239], v27, s[16:19], s37 offen offset:0 sc1
    v_mfma_f32_16x16x32_bf16 a[80:83], v[152:155], a[8:11], a[80:83]
    v_mfma_f32_16x16x32_bf16 a[84:87], v[156:159], a[8:11], a[84:87]
    s_waitcnt vmcnt(9)
    v_mfma_f32_16x16x32_bf16 a[88:91], v[144:147], a[12:15], a[88:91]
    v_mfma_f32_16x16x32_bf16 a[92:95], v[148:151], a[12:15], a[92:95]
    buffer_load_dwordx4 v[240:243], v27, s[16:19], s38 offen offset:0 sc1
    v_mfma_f32_16x16x32_bf16 a[96:99], v[152:155], a[12:15], a[96:99]
    v_mfma_f32_16x16x32_bf16 a[100:103], v[156:159], a[12:15], a[100:103]
    s_waitcnt vmcnt(8)
    v_mfma_f32_16x16x32_bf16 a[40:43], a[160:163], a[16:19], a[40:43]
    v_mfma_f32_16x16x32_bf16 a[40:43], a[176:179], a[20:23], a[40:43]
    buffer_load_dwordx4 v[244:247], v27, s[16:19], s39 offen offset:0 sc1
    v_mfma_f32_16x16x32_bf16 a[44:47], a[164:167], a[16:19], a[44:47]
    v_mfma_f32_16x16x32_bf16 a[44:47], a[180:183], a[20:23], a[44:47]
    v_mfma_f32_16x16x32_bf16 a[48:51], a[168:171], a[16:19], a[48:51]
    s_waitcnt lgkmcnt(0)
    s_xor_b64 s[74:75], s[74:75], s[50:51]
    v_mfma_f32_16x16x32_bf16 a[48:51], a[184:187], a[20:23], a[48:51]
    buffer_load_dwordx4 a[0:3], v27, s[16:19], s40 offen offset:0 sc1
    v_mfma_f32_16x16x32_bf16 a[52:55], a[172:175], a[16:19], a[52:55]
    s_xor_b64 s[76:77], s[76:77], s[50:51]
    v_mfma_f32_16x16x32_bf16 a[52:55], a[188:191], a[20:23], a[52:55]
    s_or_b64 s[74:75], s[74:75], s[76:77]
    s_cbranch_scc1 L_slow_n5c5
L_ok_n5c5:
    s_waitcnt vmcnt(8)
    v_mfma_f32_16x16x32_bf16 a[40:43], a[192:195], a[24:27], a[40:43]
    v_mfma_f32_16x16x32_bf16 a[40:43], a[208:211], a[28:31], a[40:43]
    buffer_load_dwordx4 a[4:7], v28, s[16:19], s37 offen offset:0 sc1
    v_mfma_f32_16x16x32_bf16 a[44:47], a[196:199], a[24:27], a[44:47]
    v_mfma_f32_16x16x32_bf16 a[44:47], a[212:215], a[28:31], a[44:47]
    v_mfma_f32_16x16x32_bf16 a[48:51], a[200:203], a[24:27], a[48:51]
    v_mfma_f32_16x16x32_bf16 a[48:51], a[216:219], a[28:31], a[48:51]
    buffer_load_dwordx4 a[8:11], v28, s[16:19], s38 offen offset:0 sc1
    v_mfma_f32_16x16x32_bf16 a[52:55], a[204:207], a[24:27], a[52:55]
    s_nop 1
    ds_write_b128 v16, a[40:43] offset:0
    v_mfma_f32_16x16x32_bf16 a[52:55], a[220:223], a[28:31], a[52:55]
    s_waitcnt vmcnt(8)
    v_mfma_f32_16x16x32_bf16 a[56:59], a[160:163], a[32:35], a[56:59]
    ds_write_b128 v17, a[44:47] offset:0
    v_mfma_f32_16x16x32_bf16 a[56:59], a[176:179], v[224:227], a[56:59]
    buffer_load_dwordx4 a[12:15], v28, s[16:19], s39 offen offset:0 sc1
    v_mfma_f32_16x16x32_bf16 a[60:63], a[164:167], a[32:35], a[60:63]
    ds_write_b128 v16, a[48:51] offset:128
    v_mfma_f32_16x16x32_bf16 a[60:63], a[180:183], v[224:227], a[60:63]
    v_mfma_f32_16x16x32_bf16 a[64:67], a[168:171], a[32:35], a[64:67]
    ds_write_b128 v17, a[52:55] offset:128
    v_mfma_f32_16x16x32_bf16 a[64:67], a[184:187], v[224:227], a[64:67]
    buffer_load_dwordx4 a[16:19], v28, s[16:19], s40 offen offset:0 sc1
    v_mfma_f32_16x16x32_bf16 a[68:71], a[172:175], a[32:35], a[68:71]
    v_mfma_f32_16x16x32_bf16 a[68:71], a[188:191], v[224:227], a[68:71]
    s_waitcnt vmcnt(8)
    v_mfma_f32_16x16x32_bf16 a[56:59], a[192:195], v[228:231], a[56:59]
    v_mfma_f32_16x16x32_bf16 a[56:59], a[208:211], v[232:235], a[56:59]
    v_mfma_f32_16x16x32_bf16 a[60:63], a[196:199], v[228:231], a[60:63]
    v_mfma_f32_16x16x32_bf16 a[60:63], a[212:215], v[232:235], a[60:63]
    v_mfma_f32_16x16x32_bf16 a[64:67], a[200:203], v[228:231], a[64:67]
    v_mfma_f32_16x16x32_bf16 a[64:67], a[216:219], v[232:235], a[64:67]
    v_mfma_f32_16x16x32_bf16 a[68:71], a[204:207], v[228:231], a[68:71]
    s_nop 3
    ds_write_b128 v16, a[56:59] offset:4096
    v_mfma_f32_16x16x32_bf16 a[68:71], a[220:223], v[232:235], a[68:71]
    s_waitcnt vmcnt(6)
    v_mfma_f32_16x16x32_bf16 a[72:75], a[160:163], v[236:239], a[72:75]
    ds_write_b128 v17, a[60:63] offset:4096
    v_mfma_f32_16x16x32_bf16 a[72:75], a[176:179], v[240:243], a[72:75]
    v_mfma_f32_16x16x32_bf16 a[76:79], a[164:167], v[236:239], a[76:79]
    ds_write_b128 v16, a[64:67] offset:4224
    v_mfma_f32_16x16x32_bf16 a[76:79], a[180:183], v[240:243], a[76:79]
    v_mfma_f32_16x16x32_bf16 a[80:83], a[168:171], v[236:239], a[80:83]
    s_nop 0
    ds_write_b128 v17, a[68:71] offset:4224
    v_mfma_f32_16x16x32_bf16 a[80:83], a[184:187], v[240:243], a[80:83]
    v_mfma_f32_16x16x32_bf16 a[84:87], a[172:175], v[236:239], a[84:87]
    v_mfma_f32_16x16x32_bf16 a[84:87], a[188:191], v[240:243], a[84:87]
    s_waitcnt vmcnt(4)
    v_mfma_f32_16x16x32_bf16 a[72:75], a[192:195], v[244:247], a[72:75]
    v_mfma_f32_16x16x32_bf16 a[72:75], a[208:211], a[0:3], a[72:75]
    v_mfma_f32_16x16x32_bf16 a[76:79], a[196:199], v[244:247], a[76:79]
    v_mfma_f32_16x16x32_bf16 a[76:79], a[212:215], a[0:3], a[76:79]
    v_mfma_f32_16x16x32_bf16 a[80:83], a[200:203], v[244:247], a[80:83]
    v_mfma_f32_16x16x32_bf16 a[80:83], a[216:219], a[0:3], a[80:83]
    v_mfma_f32_16x16x32_bf16 a[84:87], a[204:207], v[244:247], a[84:87]
    s_nop 3
    ds_write_b128 v16, a[72:75] offset:8192
    v_mfma_f32_16x16x32_bf16 a[84:87], a[220:223], a[0:3], a[84:87]
    s_waitcnt vmcnt(2)
    v_mfma_f32_16x16x32_bf16 a[88:91], a[160:163], a[4:7], a[88:91]
    ds_write_b128 v17, a[76:79] offset:8192
    v_mfma_f32_16x16x32_bf16 a[88:91], a[176:179], a[8:11], a[88:91]
    v_mfma_f32_16x16x32_bf16 a[92:95], a[164:167], a[4:7], a[92:95]
    ds_write_b128 v16, a[80:83] offset:8320
    v_mfma_f32_16x16x32_bf16 a[92:95], a[180:183], a[8:11], a[92:95]
    v_mfma_f32_16x16x32_bf16 a[96:99], a[168:171], a[4:7], a[96:99]
    s_nop 0
    ds_write_b128 v17, a[84:87] offset:8320
    v_mfma_f32_16x16x32_bf16 a[96:99], a[184:187], a[8:11], a[96:99]
    v_mfma_f32_16x16x32_bf16 a[100:103], a[172:175], a[4:7], a[100:103]
    v_mfma_f32_16x16x32_bf16 a[100:103], a[188:191], a[8:11], a[100:103]
    s_waitcnt vmcnt(0)
    v_mfma_f32_16x16x32_bf16 a[88:91], a[192:195], a[12:15], a[88:91]
    v_mfma_f32_16x16x32_bf16 a[88:91], a[208:211], a[16:19], a[88:91]
    v_mfma_f32_16x16x32_bf16 a[92:95], a[196:199], a[12:15], a[92:95]
    v_mfma_f32_16x16x32_bf16 a[92:95], a[212:215], a[16:19], a[92:95]
    v_mfma_f32_16x16x32_bf16 a[96:99], a[200:203], a[12:15], a[96:99]
    v_mfma_f32_16x16x32_bf16 a[96:99], a[216:219], a[16:19], a[96:99]
    v_mfma_f32_16x16x32_bf16 a[100:103], a[204:207], a[12:15], a[100:103]
    s_nop 3
    ds_write_b128 v16, a[88:91] offset:12288
    v_mfma_f32_16x16x32_bf16 a[100:103], a[220:223], a[16:19], a[100:103]
    ds_write_b128 v17, a[92:95] offset:12288
    s_nop 0
    ds_write_b128 v16, a[96:99] offset:12416
    s_nop 5
    ds_write_b128 v17, a[100:103] offset:12416
    s_waitcnt lgkmcnt(0)
    s_barrier
    ds_read_b128 v[32:35], v8 offset:0
    ds_read_b128 v[36:39], v9 offset:0
    ds_read_b128 v[40:43], v8 offset:20480
    ds_read_b128 v[44:47], v9 offset:20480
    ds_read_b128 v[48:51], v10 offset:0
    ds_read_b128 v[52:55], v11 offset:0
    ds_read_b128 v[56:59], v10 offset:20480
    ds_read_b128 v[60:63], v11 offset:20480
    ds_read_b128 v[64:67], v8 offset:8192
    ds_read_b128 v[68:71], v9 offset:8192
    ds_read_b128 v[72:75], v8 offset:28672
    ds_read_b128 v[76:79], v9 offset:28672
    ds_read_b128 v[80:83], v10 offset:8192
    ds_read_b128 v[84:87], v11 offset:8192
    ds_read_b128 v[88:91], v10 offset:28672
    ds_read_b128 v[92:95], v11 offset:28672
    s_waitcnt lgkmcnt(12)
    v_pk_add_f32 v[32:33], v[32:33], v[40:41]
    v_pk_add_f32 v[34:35], v[34:35], v[42:43]
    v_pk_add_f32 v[36:37], v[36:37], v[44:45]
    v_pk_add_f32 v[38:39], v[38:39], v[46:47]
    s_waitcnt lgkmcnt(8)
    v_pk_add_f32 v[48:49], v[48:49], v[56:57]
    v_pk_add_f32 v[50:51], v[50:51], v[58:59]
    v_pk_add_f32 v[52:53], v[52:53], v[60:61]
    v_pk_add_f32 v[54:55], v[54:55], v[62:63]
    v_pk_add_f32 v[32:33], v[32:33], v[48:49]
    v_pk_add_f32 v[34:35], v[34:35], v[50:51]
    v_pk_add_f32 v[36:37], v[36:37], v[52:53]
    v_pk_add_f32 v[38:39], v[38:39], v[54:55]
    v_cvt_pk_bf16_f32 v40, v32, v33
    v_cvt_pk_bf16_f32 v41, v34, v35
    v_cvt_pk_bf16_f32 v42, v36, v37
    v_cvt_pk_bf16_f32 v43, v38, v39
    buffer_store_dwordx4 v[40:43], v18, s[24:27], s53 offen nt
    s_add_u32 s53, s53, 1310720
    s_waitcnt lgkmcnt(4)
    v_pk_add_f32 v[64:65], v[64:65], v[72:73]
    v_pk_add_f32 v[66:67], v[66:67], v[74:75]
    v_pk_add_f32 v[68:69], v[68:69], v[76:77]
    v_pk_add_f32 v[70:71], v[70:71], v[78:79]
    s_waitcnt lgkmcnt(0)
    v_pk_add_f32 v[80:81], v[80:81], v[88:89]
    v_pk_add_f32 v[82:83], v[82:83], v[90:91]
    v_pk_add_f32 v[84:85], v[84:85], v[92:93]
    v_pk_add_f32 v[86:87], v[86:87], v[94:95]
    v_pk_add_f32 v[64:65], v[64:65], v[80:81]
    v_pk_add_f32 v[66:67], v[66:67], v[82:83]
    v_pk_add_f32 v[68:69], v[68:69], v[84:85]
    v_pk_add_f32 v[70:71], v[70:71], v[86:87]
    v_cvt_pk_bf16_f32 v72, v64, v65
    v_cvt_pk_bf16_f32 v73, v66, v67
    v_cvt_pk_bf16_f32 v74, v68, v69
    v_cvt_pk_bf16_f32 v75, v70, v71
    buffer_store_dwordx4 v[72:75], v18, s[24:27], s53 offen nt
    s_endpgm
L_slow_n5c0:
    s_mov_b32 s62, 0x7800780
    s_mov_b32 s63, 0x1800180
    s_mov_b64 exec, s[62:63]
    buffer_load_dword v26, v25, s[28:31], 0 offen offset:0 sc1
    s_mov_b64 exec, -1
    s_waitcnt vmcnt(0)
    v_cmp_eq_u32 vcc, s50, v26
    s_andn2_b64 s[62:63], s[62:63], vcc
    s_cbranch_scc0 L_ok_n5c0
    s_cmp_eq_u32 s52, 0
    s_cbranch_scc1 L_ok_n5c0
    s_sub_u32 s52, s52, 1
    s_sleep 1
    s_branch L_slow_n5c0
L_slow_n5c1:
    s_mov_b32 s62, 0x18001800
    s_mov_b32 s63, 0x1e001e00
    s_mov_b64 exec, s[62:63]
    buffer_load_dword v26, v25, s[28:31], 0 offen offset:0 sc1
    s_mov_b64 exec, -1
    s_waitcnt vmcnt(0)
    v_cmp_eq_u32 vcc, s50, v26
    s_andn2_b64 s[62:63], s[62:63], vcc
    s_cbranch_scc0 L_ok_n5c1
    s_cmp_eq_u32 s52, 0
    s_cbranch_scc1 L_ok_n5c1
    s_sub_u32 s52, s52, 1
    s_sleep 1
    s_branch L_slow_n5c1
L_slow_n5c2:
    s_mov_b32 s62, 0x20002000
    s_mov_b32 s63, 0x20002000
    s_mov_b64 exec, s[62:63]
    buffer_load_dword v26, v25, s[28:31], 0 offen offset:0 sc1
    s_mov_b64 exec, -1
    s_waitcnt vmcnt(0)
    v_cmp_eq_u32 vcc, s50, v26
    s_andn2_b64 s[62:63], s[62:63], vcc
    s_cbranch_scc0 L_ok_n5c2
    s_cmp_eq_u32 s52, 0
    s_cbranch_scc1 L_ok_n5c2
    s_sub_u32 s52, s52, 1
    s_sleep 1
    s_branch L_slow_n5c2
L_slow_n5c3:
    s_mov_b32 s62, 0x700070
    s_mov_b32 s63, 0x700070
    s_mov_b64 exec, s[62:63]
    buffer_load_dword v26, v25, s[28:31], 0 offen offset:128 sc1
    s_mov_b64 exec, -1
    s_waitcnt vmcnt(0)
    v_cmp_eq_u32 vcc, s50, v26
    s_andn2_b64 s[62:63], s[62:63], vcc
    s_cbranch_scc0 L_ok_n5c3
    s_cmp_eq_u32 s52, 0
    s_cbranch_scc1 L_ok_n5c3
    s_sub_u32 s52, s52, 1
    s_sleep 1
    s_branch L_slow_n5c3
L_slow_n5c4:
    s_mov_b32 s62, 0xf000f
    s_mov_b32 s63, 0xf
    s_mov_b64 exec, s[62:63]
    buffer_load_dword v26, v25, s[28:31], 0 offen offset:384 sc1
    s_mov_b64 exec, -1
    s_waitcnt vmcnt(0)
    v_cmp_eq_u32 vcc, s50, v26
    s_andn2_b64 s[62:63], s[62:63], vcc
    s_cbranch_scc0 L_ok_n5c4
    s_cmp_eq_u32 s52, 0
    s_cbranch_scc1 L_ok_n5c4
    s_sub_u32 s52, s52, 1
    s_sleep 1
    s_branch L_slow_n5c4
L_slow_n5c5:
    s_mov_b32 s62, 0x0
    s_mov_b32 s63, 0xf0000
    s_mov_b64 exec, s[62:63]
    buffer_load_dword v26, v25, s[28:31], 0 offen offset:384 sc1
    s_mov_b64 exec, -1
    s_waitcnt vmcnt(0)
    v_cmp_eq_u32 vcc, s50, v26
    s_andn2_b64 s[62:63], s[62:63], vcc
    s_cbranch_scc0 L_ok_n5c5
    s_cmp_eq_u32 s52, 0
    s_cbranch_scc1 L_ok_n5c5
    s_sub_u32 s52, s52, 1
    s_sleep 1
    s_branch L_slow_n5c5
L_free:
    s_sub_u32 s54, s54, 27
    s_and_b32 s60, s55, 1
    s_mul_i32 s60, s60, 5
    s_add_u32 s42, s60, s54
    s_lshr_b32 s60, s55, 1
    s_lshl_b32 s41, s60, 5
    s_add_u32 s41, s41, 16
    s_lshl_b32 s45, s36, 15
    s_and_b32 s82, s55, 1
    s_lshl_b32 s82, s82, 2
    s_add_u32 s82, s82, s36
    s_mul_i32 s82, s82, 327680
    s_lshl_b32 s83, s54, 13
    s_add_u32 s82, s82, s83
    s_and_b32 s83, s55, 6
    s_mov_b32 s10, 2621440
    s_mov_b32 s11, 0x00020000
    s_mov_b32 s14, 2211840
    s_mov_b32 s15, 0x00020000
    s_cmp_ge_u32 s36, 2
    s_waitcnt lgkmcnt(0)
    s_mov_b32 s8, s4
    s_mov_b32 s9, s5
    s_cselect_b32 s12, s64, s6
    s_cselect_b32 s13, s65, s7
    s_mov_b32 s16, s68
    s_mov_b32 s17, s69
    s_mov_b32 s18, 7077888
    s_mov_b32 s19, 0x00020000
    s_mov_b32 s20, s66
    s_mov_b32 s21, s67
    s_mov_b32 s22, 2211840
    s_mov_b32 s23, 0x00020000
    s_mov_b32 s32, s26
    s_mov_b32 s33, s27
    s_mov_b32 s34, 256
    s_mov_b32 s35, 0x00020000
    s_mov_b32 s26, 2621440
    s_mov_b32 s27, 0x00020000
    s_add_u32 s28, s68, 8388608
    s_addc_u32 s29, s69, 0
    s_mov_b32 s30, 138240
    s_mov_b32 s31, 0x00020000
    s_mov_b32 s52, 100000
    s_mov_b32 s48, s54
    s_mov_b32 s84, s6
    s_mov_b32 s85, s7
    s_and_b32 s4, s55, 6
    s_mul_i32 s4, s4, 17280
    s_mov_b32 s7, 27
    s_mov_b32 s60, 4096
    s_add_u32 s72, s28, s4
    s_addc_u32 s73, s29, 0
    s_lshr_b32 s5, s36, 1
    s_mul_i32 s6, s5, 640
    s_add_u32 s70, s72, s6
    s_addc_u32 s71, s73, 0
    v_and_b32 v1, 15, v0
    v_lshl_add_u32 v1, v1, 1, s5
    v_min_u32 v1, 26, v1
    v_lshrrev_b32 v2, 4, v0
    v_mul_u32_u24 v2, s7, v2
    v_add_u32 v1, v1, v2
    v_mul_u32_u24 v1, 640, v1
    v_add_u32 v25, s4, v1
    v_lshlrev_b32 v30, 4, v0
    v_add_u32 v31, s60, v30
    v_add_u32 v27, s60, v31
    v_add_u32 v28, s60, v27
    s_lshl_b32 s6, s42, 7
    s_mul_i32 s53, s41, 20480
    s_add_u32 s53, s53, s6
    s_mul_i32 s4, s36, 40960
    s_add_u32 s54, s4, s6
    s_mov_b32 s55, 163840
    s_lshl_b32 s4, s36, 7
    s_add_u32 s4, s4, s41
    s_lshl_b32 s4, s4, 10
    s_mov_b32 s5, 524288
    s_mov_b32 s37, s4
    s_add_u32 s38, s37, s5
    s_add_u32 s39, s38, s5
    s_add_u32 s40, s39, s5
    s_add_u32 s41, s40, s5
    s_add_u32 s42, s41, s5
    s_add_u32 s49, s42, s5
    s_add_u32 s57, s49, s5
    s_add_u32 s58, s57, s5
    s_add_u32 s59, s58, s5
    s_add_u32 s66, s59, s5
    s_add_u32 s67, s66, s5
    s_add_u32 s68, s67, s5
    s_add_u32 s69, s68, s5
    s_min_u32 s69, s69, 7077888
    v_bfe_u32 v1, v0, 4, 1
    v_lshlrev_b32 v1, 1, v1
    v_and_b32 v2, 7, v0
    v_xor_b32 v1, v1, v2
    v_lshrrev_b32 v2, 3, v0
    v_mul_u32_u24 v2, 1280, v2
    v_lshl_add_u32 v12, v1, 4, v2
    v_xor_b32 v1, 4, v1
    v_lshl_add_u32 v1, v1, 4, v2
    v_add_u32 v13, 9216, v1
    v_add_u32 v14, 18432, v12
    v_add_u32 v15, 27648, v1
    s_add_u32 m0, s45, 0
    s_min_u32 s46, s54, 2211840
    s_add_u32 s54, s54, s55
    buffer_load_dwordx4 v12, s[20:23], s46 offen offset:0 lds
    buffer_load_dwordx4 v13, s[20:23], s46 offen offset:1024 lds
    buffer_load_dwordx4 v14, s[20:23], s46 offen offset:2048 lds
    buffer_load_dwordx4 v15, s[20:23], s46 offen offset:3072 lds
    s_add_u32 m0, s45, 4096
    s_min_u32 s46, s54, 2211840
    s_add_u32 s54, s54, s55
    buffer_load_dwordx4 v12, s[20:23], s46 offen offset:0 lds
    buffer_load_dwordx4 v13, s[20:23], s46 offen offset:1024 lds
    buffer_load_dwordx4 v14, s[20:23], s46 offen offset:2048 lds
    buffer_load_dwordx4 v15, s[20:23], s46 offen offset:3072 lds
    s_lshl_b32 s4, s48, 2
    s_add_u32 s4, s4, s36
    s_mul_i32 s5, s83, 27
    s_lshr_b32 s5, s5, 3
    s_lshl_b32 s5, s5, 7
    s_mul_i32 s4, s4, 27648
    s_add_u32 s4, s4, s5
    s_add_u32 s4, s4, 1769472
    s_min_u32 s4, s4, 2211840
    v_lshrrev_b32 v1, 3, v0
    v_and_b32 v2, 7, v0
    v_mul_u32_u24 v1, 3456, v1
    v_lshl_add_u32 v1, v2, 7, v1
    s_mov_b32 s12, s84
    s_mov_b32 s13, s85
    buffer_load_dword v254, v1, s[12:15], s4 offen
    s_mov_b32 s12, s64
    s_mov_b32 s13, s65
    buffer_load_dword v254, v1, s[12:15], s4 offen
    s_add_u32 s5, s83, s48
    s_and_b32 s5, s5, 7
    s_mul_i32 s5, s5, 40960
    s_lshl_b32 s4, s48, 13
    s_sub_u32 s4, s82, s4
    s_add_u32 s4, s4, s5
    v_lshrrev_b32 v1, 1, v0
    v_and_b32 v2, 1, v0
    v_mul_u32_u24 v1, 1280, v1
    v_lshl_add_u32 v1, v2, 7, v1
    buffer_load_dword v254, v1, s[8:11], s4 offen offset:1024
    v_lshrrev_b32 v1, 4, v0
    v_bfe_u32 v2, v0, 2, 2
    v_lshl_add_u32 v1, v1, 3, v2
    v_lshlrev_b32 v1, 7, v1
    v_bfe_u32 v2, v0, 3, 2
    v_lshlrev_b32 v2, 5, v2
    v_and_b32 v3, 3, v0
    v_lshlrev_b32 v3, 3, v3
    v_add3_u32 v1, v1, v2, v3
    v_add_u32 v4, s45, v1
    v_xor_b32 v5, 32, v4
    v_xor_b32 v6, 64, v4
    v_xor_b32 v7, 96, v4
    s_add_u32 m0, s45, 8192
    s_min_u32 s46, s54, 2211840
    s_add_u32 s54, s54, s55
    buffer_load_dwordx4 v12, s[20:23], s46 offen offset:0 lds
    buffer_load_dwordx4 v13, s[20:23], s46 offen offset:1024 lds
    buffer_load_dwordx4 v14, s[20:23], s46 offen offset:2048 lds
    buffer_load_dwordx4 v15, s[20:23], s46 offen offset:3072 lds
    s_add_u32 m0, s45, 12288
    s_min_u32 s46, s54, 2211840
    s_add_u32 s54, s54, s55
    buffer_load_dwordx4 v12, s[20:23], s46 offen offset:0 lds
    buffer_load_dwordx4 v13, s[20:23], s46 offen offset:1024 lds
    buffer_load_dwordx4 v14, s[20:23], s46 offen offset:2048 lds
    buffer_load_dwordx4 v15, s[20:23], s46 offen offset:3072 lds
    s_waitcnt vmcnt(15)
    ds_read_b64_tr_b16 a[0:1], v4 offset:0
    ds_read_b64_tr_b16 a[2:3], v4 offset:512
    ds_read_b64_tr_b16 a[4:5], v5 offset:0
    ds_read_b64_tr_b16 a[6:7], v5 offset:512
    ds_read_b64_tr_b16 a[8:9], v6 offset:0
    ds_read_b64_tr_b16 a[10:11], v6 offset:512
    ds_read_b64_tr_b16 a[12:13], v7 offset:0
    ds_read_b64_tr_b16 a[14:15], v7 offset:512
    s_add_u32 m0, s45, 16384
    s_min_u32 s46, s54, 2211840
    s_add_u32 s54, s54, s55
    buffer_load_dwordx4 v12, s[20:23], s46 offen offset:0 lds
    buffer_load_dwordx4 v13, s[20:23], s46 offen offset:1024 lds
    buffer_load_dwordx4 v14, s[20:23], s46 offen offset:2048 lds
    buffer_load_dwordx4 v15, s[20:23], s46 offen offset:3072 lds
    s_waitcnt vmcnt(15)
    ds_read_b64_tr_b16 a[16:17], v4 offset:4096
    ds_read_b64_tr_b16 a[18:19], v4 offset:4608
    ds_read_b64_tr_b16 a[20:21], v5 offset:4096
    ds_read_b64_tr_b16 a[22:23], v5 offset:4608
    ds_read_b64_tr_b16 a[24:25], v6 offset:4096
    ds_read_b64_tr_b16 a[26:27], v6 offset:4608
    ds_read_b64_tr_b16 a[28:29], v7 offset:4096
    ds_read_b64_tr_b16 a[30:31], v7 offset:4608
    s_add_u32 m0, s45, 20480
    s_min_u32 s46, s54, 2211840
    s_add_u32 s54, s54, s55
    buffer_load_dwordx4 v12, s[20:23], s46 offen offset:0 lds
    buffer_load_dwordx4 v13, s[20:23], s46 offen offset:1024 lds
    buffer_load_dwordx4 v14, s[20:23], s46 offen offset:2048 lds
    buffer_load_dwordx4 v15, s[20:23], s46 offen offset:3072 lds
    s_waitcnt vmcnt(12)
    ds_read_b64_tr_b16 a[32:33], v4 offset:8192
    ds_read_b64_tr_b16 a[34:35], v4 offset:8704
    ds_read_b64_tr_b16 a[36:37], v5 offset:8192
    ds_read_b64_tr_b16 a[38:39], v5 offset:8704
    ds_read_b64_tr_b16 a[40:41], v6 offset:8192
    ds_read_b64_tr_b16 a[42:43], v6 offset:8704
    ds_read_b64_tr_b16 a[44:45], v7 offset:8192
    ds_read_b64_tr_b16 a[46:47], v7 offset:8704
    s_add_u32 m0, s45, 24576
    s_min_u32 s46, s54, 2211840
    s_add_u32 s54, s54, s55
    buffer_load_dwordx4 v12, s[20:23], s46 offen offset:0 lds
    buffer_load_dwordx4 v13, s[20:23], s46 offen offset:1024 lds
    buffer_load_dwordx4 v14, s[20:23], s46 offen offset:2048 lds
    buffer_load_dwordx4 v15, s[20:23], s46 offen offset:3072 lds
    s_waitcnt vmcnt(12)
    ds_read_b64_tr_b16 a[48:49], v4 offset:12288
    ds_read_b64_tr_b16 a[50:51], v4 offset:12800
    ds_read_b64_tr_b16 a[52:53], v5 offset:12288
    ds_read_b64_tr_b16 a[54:55], v5 offset:12800
    ds_read_b64_tr_b16 a[56:57], v6 offset:12288
    ds_read_b64_tr_b16 a[58:59], v6 offset:12800
    ds_read_b64_tr_b16 a[60:61], v7 offset:12288
    ds_read_b64_tr_b16 a[62:63], v7 offset:12800
    s_waitcnt lgkmcnt(15)
    s_add_u32 m0, s45, 28672
    s_min_u32 s46, s54, 2211840
    s_add_u32 s54, s54, s55
    buffer_load_dwordx4 v12, s[20:23], s46 offen offset:0 lds
    buffer_load_dwordx4 v13, s[20:23], s46 offen offset:1024 lds
    buffer_load_dwordx4 v14, s[20:23], s46 offen offset:2048 lds
    buffer_load_dwordx4 v15, s[20:23], s46 offen offset:3072 lds
    s_waitcnt vmcnt(12)
    ds_read_b64_tr_b16 a[64:65], v4 offset:16384
    ds_read_b64_tr_b16 a[66:67], v4 offset:16896
    ds_read_b64_tr_b16 a[68:69], v5 offset:16384
    ds_read_b64_tr_b16 a[70:71], v5 offset:16896
    ds_read_b64_tr_b16 a[72:73], v6 offset:16384
    ds_read_b64_tr_b16 a[74:75], v6 offset:16896
    ds_read_b64_tr_b16 a[76:77], v7 offset:16384
    ds_read_b64_tr_b16 a[78:79], v7 offset:16896
    s_add_u32 m0, s45, 0
    s_min_u32 s46, s54, 2211840
    s_add_u32 s54, s54, s55
    buffer_load_dwordx4 v12, s[20:23], s46 offen offset:0 lds
    buffer_load_dwordx4 v13, s[20:23], s46 offen offset:1024 lds
    buffer_load_dwordx4 v14, s[20:23], s46 offen offset:2048 lds
    buffer_load_dwordx4 v15, s[20:23], s46 offen offset:3072 lds
    s_waitcnt vmcnt(12)
    ds_read_b64_tr_b16 a[80:81], v4 offset:20480
    ds_read_b64_tr_b16 a[82:83], v4 offset:20992
    ds_read_b64_tr_b16 a[84:85], v5 offset:20480
    ds_read_b64_tr_b16 a[86:87], v5 offset:20992
    ds_read_b64_tr_b16 a[88:89], v6 offset:20480
    ds_read_b64_tr_b16 a[90:91], v6 offset:20992
    ds_read_b64_tr_b16 a[92:93], v7 offset:20480
    ds_read_b64_tr_b16 a[94:95], v7 offset:20992
    s_waitcnt lgkmcnt(15)
    s_add_u32 m0, s45, 4096
    s_min_u32 s46, s54, 2211840
    s_add_u32 s54, s54, s55
    buffer_load_dwordx4 v12, s[20:23], s46 offen offset:0 lds
    buffer_load_dwordx4 v13, s[20:23], s46 offen offset:1024 lds
    buffer_load_dwordx4 v14, s[20:23], s46 offen offset:2048 lds
    buffer_load_dwordx4 v15, s[20:23], s46 offen offset:3072 lds
    s_waitcnt vmcnt(12)
    ds_read_b64_tr_b16 a[96:97], v4 offset:24576
    ds_read_b64_tr_b16 a[98:99], v4 offset:25088
    ds_read_b64_tr_b16 a[100:101], v5 offset:24576
    ds_read_b64_tr_b16 a[102:103], v5 offset:25088
    ds_read_b64_tr_b16 a[104:105], v6 offset:24576
    ds_read_b64_tr_b16 a[106:107], v6 offset:25088
    ds_read_b64_tr_b16 a[108:109], v7 offset:24576
    ds_read_b64_tr_b16 a[110:111], v7 offset:25088
    s_add_u32 m0, s45, 8192
    s_min_u32 s46, s54, 2211840
    s_add_u32 s54, s54, s55
    buffer_load_dwordx4 v12, s[20:23], s46 offen offset:0 lds
    buffer_load_dwordx4 v13, s[20:23], s46 offen offset:1024 lds
    buffer_load_dwordx4 v14, s[20:23], s46 offen offset:2048 lds
    buffer_load_dwordx4 v15, s[20:23], s46 offen offset:3072 lds
    s_waitcnt vmcnt(12)
    ds_read_b64_tr_b16 a[112:113], v4 offset:28672
    ds_read_b64_tr_b16 a[114:115], v4 offset:29184
    ds_read_b64_tr_b16 a[116:117], v5 offset:28672
    ds_read_b64_tr_b16 a[118:119], v5 offset:29184
    ds_read_b64_tr_b16 a[120:121], v6 offset:28672
    ds_read_b64_tr_b16 a[122:123], v6 offset:29184
    ds_read_b64_tr_b16 a[124:125], v7 offset:28672
    ds_read_b64_tr_b16 a[126:127], v7 offset:29184
    s_waitcnt lgkmcnt(15)
    s_add_u32 m0, s45, 12288
    s_min_u32 s46, s54, 2211840
    s_add_u32 s54, s54, s55
    buffer_load_dwordx4 v12, s[20:23], s46 offen offset:0 lds
    buffer_load_dwordx4 v13, s[20:23], s46 offen offset:1024 lds
    buffer_load_dwordx4 v14, s[20:23], s46 offen offset:2048 lds
    buffer_load_dwordx4 v15, s[20:23], s46 offen offset:3072 lds
    s_waitcnt vmcnt(12)
    ds_read_b64_tr_b16 a[128:129], v4 offset:0
    ds_read_b64_tr_b16 a[130:131], v4 offset:512
    ds_read_b64_tr_b16 a[132:133], v5 offset:0
    ds_read_b64_tr_b16 a[134:135], v5 offset:512
    ds_read_b64_tr_b16 a[136:137], v6 offset:0
    ds_read_b64_tr_b16 a[138:139], v6 offset:512
    ds_read_b64_tr_b16 a[140:141], v7 offset:0
    ds_read_b64_tr_b16 a[142:143], v7 offset:512
    s_add_u32 m0, s45, 16384
    s_min_u32 s46, s54, 2211840
    s_add_u32 s54, s54, s55
    buffer_load_dwordx4 v12, s[20:23], s46 offen offset:0 lds
    buffer_load_dwordx4 v13, s[20:23], s46 offen offset:1024 lds
    buffer_load_dwordx4 v14, s[20:23], s46 offen offset:2048 lds
    buffer_load_dwordx4 v15, s[20:23], s46 offen offset:3072 lds
    s_waitcnt vmcnt(12)
    ds_read_b64_tr_b16 a[144:145], v4 offset:4096
    ds_read_b64_tr_b16 a[146:147], v4 offset:4608
    ds_read_b64_tr_b16 a[148:149], v5 offset:4096
    ds_read_b64_tr_b16 a[150:151], v5 offset:4608
    ds_read_b64_tr_b16 a[152:153], v6 offset:4096
    ds_read_b64_tr_b16 a[154:155], v6 offset:4608
    ds_read_b64_tr_b16 a[156:157], v7 offset:4096
    ds_read_b64_tr_b16 a[158:159], v7 offset:4608
    s_waitcnt lgkmcnt(15)
    s_add_u32 m0, s45, 20480
    s_min_u32 s46, s54, 2211840
    s_add_u32 s54, s54, s55
    buffer_load_dwordx4 v12, s[20:23], s46 offen offset:0 lds
    buffer_load_dwordx4 v13, s[20:23], s46 offen offset:1024 lds
    buffer_load_dwordx4 v14, s[20:23], s46 offen offset:2048 lds
    buffer_load_dwordx4 v15, s[20:23], s46 offen offset:3072 lds
    s_waitcnt vmcnt(12)
    ds_read_b64_tr_b16 a[160:161], v4 offset:8192
    ds_read_b64_tr_b16 a[162:163], v4 offset:8704
    ds_read_b64_tr_b16 a[164:165], v5 offset:8192
    ds_read_b64_tr_b16 a[166:167], v5 offset:8704
    ds_read_b64_tr_b16 a[168:169], v6 offset:8192
    ds_read_b64_tr_b16 a[170:171], v6 offset:8704
    ds_read_b64_tr_b16 a[172:173], v7 offset:8192
    ds_read_b64_tr_b16 a[174:175], v7 offset:8704
    s_waitcnt vmcnt(8)
    ds_read_b64_tr_b16 a[176:177], v4 offset:12288
    ds_read_b64_tr_b16 a[178:179], v4 offset:12800
    ds_read_b64_tr_b16 a[180:181], v5 offset:12288
    ds_read_b64_tr_b16 a[182:183], v5 offset:12800
    ds_read_b64_tr_b16 a[184:185], v6 offset:12288
    ds_read_b64_tr_b16 a[186:187], v6 offset:12800
    ds_read_b64_tr_b16 a[188:189], v7 offset:12288
    ds_read_b64_tr_b16 a[190:191], v7 offset:12800
    s_waitcnt lgkmcnt(15)
    s_waitcnt vmcnt(4)
    ds_read_b64_tr_b16 a[192:193], v4 offset:16384
    ds_read_b64_tr_b16 a[194:195], v4 offset:16896
    ds_read_b64_tr_b16 a[196:197], v5 offset:16384
    ds_read_b64_tr_b16 a[198:199], v5 offset:16896
    ds_read_b64_tr_b16 a[200:201], v6 offset:16384
    ds_read_b64_tr_b16 a[202:203], v6 offset:16896
    ds_read_b64_tr_b16 a[204:205], v7 offset:16384
    ds_read_b64_tr_b16 a[206:207], v7 offset:16896
    s_waitcnt vmcnt(0)
    ds_read_b64_tr_b16 a[208:209], v4 offset:20480
    ds_read_b64_tr_b16 a[210:211], v4 offset:20992
    ds_read_b64_tr_b16 a[212:213], v5 offset:20480
    ds_read_b64_tr_b16 a[214:215], v5 offset:20992
    ds_read_b64_tr_b16 a[216:217], v6 offset:20480
    ds_read_b64_tr_b16 a[218:219], v6 offset:20992
    ds_read_b64_tr_b16 a[220:221], v7 offset:20480
    ds_read_b64_tr_b16 a[222:223], v7 offset:20992
    s_waitcnt lgkmcnt(15)
    buffer_load_dword v29, off, s[32:35], 0 sc1
    s_waitcnt vmcnt(0)
L_nchk_f:
    v_readfirstlane_b32 s50, v29
    s_cmp_eq_u32 s50, 0
    s_cbranch_scc1 L_nslow_f
L_nok_f:
    s_mov_b32 s51, s50
    s_cmp_eq_u32 s48, 1
    s_cbranch_scc1 L_fv1
    s_cmp_eq_u32 s48, 3
    s_cbranch_scc1 L_fv1
    s_load_dword s74, s[70:71], 17280
    s_load_dword s75, s[70:71], 18560
    s_load_dword s76, s[70:71], 19840
    s_load_dword s77, s[70:71], 31360
    s_load_dword s78, s[70:71], 21120
    s_load_dword s79, s[70:71], 32640
    s_load_dword s80, s[72:73], 33920
    s_load_dword s81, s[70:71], 22400
    s_load_dword s82, s[70:71], 23680
    s_load_dword s83, s[70:71], 24960
    s_waitcnt lgkmcnt(0)
    s_xor_b64 s[74:75], s[74:75], s[50:51]
    s_xor_b64 s[76:77], s[76:77], s[50:51]
    s_xor_b64 s[78:79], s[78:79], s[50:51]
    s_xor_b64 s[80:81], s[80:81], s[50:51]
    s_xor_b64 s[82:83], s[82:83], s[50:51]
    s_or_b64 s[74:75], s[74:75], s[76:77]
    s_or_b64 s[74:75], s[74:75], s[78:79]
    s_or_b64 s[74:75], s[74:75], s[80:81]
    s_or_b64 s[74:75], s[74:75], s[82:83]
    s_cbranch_scc1 L_slow_f0c0
L_ok_f0c0:
    buffer_load_dwordx4 v[144:147], v30, s[16:19], s37 offen offset:0 sc1
    buffer_load_dwordx4 v[148:151], v30, s[16:19], s38 offen offset:0 sc1
    buffer_load_dwordx4 v[152:155], v30, s[16:19], s37 offen offset:1024 sc1
    buffer_load_dwordx4 v[156:159], v30, s[16:19], s38 offen offset:1024 sc1
    buffer_load_dwordx4 v[160:163], v30, s[16:19], s37 offen offset:2048 sc1
    buffer_load_dwordx4 v[164:167], v30, s[16:19], s38 offen offset:2048 sc1
    buffer_load_dwordx4 v[168:171], v30, s[16:19], s37 offen offset:3072 sc1
    buffer_load_dwordx4 v[172:175], v30, s[16:19], s38 offen offset:3072 sc1
    buffer_load_dwordx4 v[176:179], v31, s[16:19], s37 offen offset:0 sc1
    buffer_load_dwordx4 v[180:183], v31, s[16:19], s38 offen offset:0 sc1
    s_waitcnt vmcnt(8)
    v_mfma_f32_16x16x32_bf16 v[32:35], a[0:3], v[144:147], 0
    v_mfma_f32_16x16x32_bf16 v[32:35], a[16:19], v[148:151], v[32:35]
    buffer_load_dwordx4 v[184:187], v31, s[16:19], s37 offen offset:1024 sc1
    v_mfma_f32_16x16x32_bf16 v[36:39], a[4:7], v[144:147], 0
    v_mfma_f32_16x16x32_bf16 v[36:39], a[20:23], v[148:151], v[36:39]
    v_mfma_f32_16x16x32_bf16 v[40:43], a[8:11], v[144:147], 0
    v_mfma_f32_16x16x32_bf16 v[40:43], a[24:27], v[148:151], v[40:43]
    buffer_load_dwordx4 v[188:191], v31, s[16:19], s38 offen offset:1024 sc1
    v_mfma_f32_16x16x32_bf16 v[44:47], a[12:15], v[144:147], 0
    v_mfma_f32_16x16x32_bf16 v[44:47], a[28:31], v[148:151], v[44:47]
    s_waitcnt vmcnt(8)
    v_mfma_f32_16x16x32_bf16 v[48:51], a[0:3], v[152:155], 0
    v_mfma_f32_16x16x32_bf16 v[48:51], a[16:19], v[156:159], v[48:51]
    buffer_load_dwordx4 v[192:195], v30, s[16:19], s39 offen offset:0 sc1
    v_mfma_f32_16x16x32_bf16 v[52:55], a[4:7], v[152:155], 0
    v_mfma_f32_16x16x32_bf16 v[52:55], a[20:23], v[156:159], v[52:55]
    v_mfma_f32_16x16x32_bf16 v[56:59], a[8:11], v[152:155], 0
    v_mfma_f32_16x16x32_bf16 v[56:59], a[24:27], v[156:159], v[56:59]
    buffer_load_dwordx4 v[196:199], v30, s[16:19], s67 offen offset:0 sc1
    v_mfma_f32_16x16x32_bf16 v[60:63], a[12:15], v[152:155], 0
    v_mfma_f32_16x16x32_bf16 v[60:63], a[28:31], v[156:159], v[60:63]
    s_waitcnt vmcnt(8)
    v_mfma_f32_16x16x32_bf16 v[64:67], a[0:3], v[160:163], 0
    v_mfma_f32_16x16x32_bf16 v[64:67], a[16:19], v[164:167], v[64:67]
    buffer_load_dwordx4 v[200:203], v30, s[16:19], s39 offen offset:1024 sc1
    v_mfma_f32_16x16x32_bf16 v[68:71], a[4:7], v[160:163], 0
    v_mfma_f32_16x16x32_bf16 v[68:71], a[20:23], v[164:167], v[68:71]
    v_mfma_f32_16x16x32_bf16 v[72:75], a[8:11], v[160:163], 0
    v_mfma_f32_16x16x32_bf16 v[72:75], a[24:27], v[164:167], v[72:75]
    buffer_load_dwordx4 v[204:207], v30, s[16:19], s67 offen offset:1024 sc1
    v_mfma_f32_16x16x32_bf16 v[76:79], a[12:15], v[160:163], 0
    v_mfma_f32_16x16x32_bf16 v[76:79], a[28:31], v[164:167], v[76:79]
    s_waitcnt vmcnt(8)
    v_mfma_f32_16x16x32_bf16 v[80:83], a[0:3], v[168:171], 0
    v_mfma_f32_16x16x32_bf16 v[80:83], a[16:19], v[172:175], v[80:83]
    buffer_load_dwordx4 v[208:211], v30, s[16:19], s39 offen offset:2048 sc1
    v_mfma_f32_16x16x32_bf16 v[84:87], a[4:7], v[168:171], 0
    v_mfma_f32_16x16x32_bf16 v[84:87], a[20:23], v[172:175], v[84:87]
    v_mfma_f32_16x16x32_bf16 v[88:91], a[8:11], v[168:171], 0
    v_mfma_f32_16x16x32_bf16 v[88:91], a[24:27], v[172:175], v[88:91]
    buffer_load_dwordx4 v[212:215], v30, s[16:19], s67 offen offset:2048 sc1
    v_mfma_f32_16x16x32_bf16 v[92:95], a[12:15], v[168:171], 0
    v_mfma_f32_16x16x32_bf16 v[92:95], a[28:31], v[172:175], v[92:95]
    s_waitcnt vmcnt(8)
    v_mfma_f32_16x16x32_bf16 v[96:99], a[0:3], v[176:179], 0
    v_mfma_f32_16x16x32_bf16 v[96:99], a[16:19], v[180:183], v[96:99]
    buffer_load_dwordx4 v[144:147], v30, s[16:19], s39 offen offset:3072 sc1
    v_mfma_f32_16x16x32_bf16 v[100:103], a[4:7], v[176:179], 0
    v_mfma_f32_16x16x32_bf16 v[100:103], a[20:23], v[180:183], v[100:103]
    v_mfma_f32_16x16x32_bf16 v[104:107], a[8:11], v[176:179], 0
    v_mfma_f32_16x16x32_bf16 v[104:107], a[24:27], v[180:183], v[104:107]
    buffer_load_dwordx4 v[148:151], v30, s[16:19], s67 offen offset:3072 sc1
    v_mfma_f32_16x16x32_bf16 v[108:111], a[12:15], v[176:179], 0
    v_mfma_f32_16x16x32_bf16 v[108:111], a[28:31], v[180:183], v[108:111]
    s_waitcnt vmcnt(8)
    v_mfma_f32_16x16x32_bf16 v[112:115], a[0:3], v[184:187], 0
    v_mfma_f32_16x16x32_bf16 v[112:115], a[16:19], v[188:191], v[112:115]
    buffer_load_dwordx4 v[152:155], v31, s[16:19], s39 offen offset:0 sc1
    v_mfma_f32_16x16x32_bf16 v[116:119], a[4:7], v[184:187], 0
    v_mfma_f32_16x16x32_bf16 v[116:119], a[20:23], v[188:191], v[116:119]
    v_mfma_f32_16x16x32_bf16 v[120:123], a[8:11], v[184:187], 0
    v_mfma_f32_16x16x32_bf16 v[120:123], a[24:27], v[188:191], v[120:123]
    buffer_load_dwordx4 v[156:159], v31, s[16:19], s40 offen offset:0 sc1
    v_mfma_f32_16x16x32_bf16 v[124:127], a[12:15], v[184:187], 0
    v_mfma_f32_16x16x32_bf16 v[124:127], a[28:31], v[188:191], v[124:127]
    s_waitcnt vmcnt(8)
    v_mfma_f32_16x16x32_bf16 v[32:35], a[32:35], v[192:195], v[32:35]
    v_mfma_f32_16x16x32_bf16 v[32:35], a[176:179], v[196:199], v[32:35]
    buffer_load_dwordx4 v[160:163], v31, s[16:19], s39 offen offset:1024 sc1
    v_mfma_f32_16x16x32_bf16 v[36:39], a[36:39], v[192:195], v[36:39]
    v_mfma_f32_16x16x32_bf16 v[36:39], a[180:183], v[196:199], v[36:39]
    v_mfma_f32_16x16x32_bf16 v[40:43], a[40:43], v[192:195], v[40:43]
    v_mfma_f32_16x16x32_bf16 v[40:43], a[184:187], v[196:199], v[40:43]
    buffer_load_dwordx4 v[164:167], v31, s[16:19], s40 offen offset:1024 sc1
    v_mfma_f32_16x16x32_bf16 v[44:47], a[44:47], v[192:195], v[44:47]
    v_mfma_f32_16x16x32_bf16 v[44:47], a[188:191], v[196:199], v[44:47]
    s_waitcnt vmcnt(8)
    v_mfma_f32_16x16x32_bf16 v[48:51], a[32:35], v[200:203], v[48:51]
    v_mfma_f32_16x16x32_bf16 v[48:51], a[176:179], v[204:207], v[48:51]
    buffer_load_dwordx4 v[168:171], v30, s[16:19], s68 offen offset:0 sc1
    v_mfma_f32_16x16x32_bf16 v[52:55], a[36:39], v[200:203], v[52:55]
    v_mfma_f32_16x16x32_bf16 v[52:55], a[180:183], v[204:207], v[52:55]
    v_mfma_f32_16x16x32_bf16 v[56:59], a[40:43], v[200:203], v[56:59]
    v_mfma_f32_16x16x32_bf16 v[56:59], a[184:187], v[204:207], v[56:59]
    buffer_load_dwordx4 v[172:175], v30, s[16:19], s69 offen offset:0 sc1
    v_mfma_f32_16x16x32_bf16 v[60:63], a[44:47], v[200:203], v[60:63]
    v_mfma_f32_16x16x32_bf16 v[60:63], a[188:191], v[204:207], v[60:63]
    s_waitcnt vmcnt(8)
    v_mfma_f32_16x16x32_bf16 v[64:67], a[32:35], v[208:211], v[64:67]
    s_load_dword s74, s[70:71], 26368
    s_load_dword s75, s[70:71], 27648
    v_mfma_f32_16x16x32_bf16 v[64:67], a[176:179], v[212:215], v[64:67]
    buffer_load_dwordx4 v[176:179], v30, s[16:19], s68 offen offset:1024 sc1
    v_mfma_f32_16x16x32_bf16 v[68:71], a[36:39], v[208:211], v[68:71]
    s_load_dword s76, s[70:71], 28928
    v_mfma_f32_16x16x32_bf16 v[68:71], a[180:183], v[212:215], v[68:71]
    s_load_dword s77, s[70:71], 30208
    v_mfma_f32_16x16x32_bf16 v[72:75], a[40:43], v[208:211], v[72:75]
    s_load_dword s78, s[70:71], 31488
    s_load_dword s79, s[70:71], 32768
    v_mfma_f32_16x16x32_bf16 v[72:75], a[184:187], v[212:215], v[72:75]
    buffer_load_dwordx4 v[180:183], v30, s[16:19], s69 offen offset:1024 sc1
    v_mfma_f32_16x16x32_bf16 v[76:79], a[44:47], v[208:211], v[76:79]
    s_load_dword s80, s[72:73], 34048
    v_mfma_f32_16x16x32_bf16 v[76:79], a[188:191], v[212:215], v[76:79]
    s_load_dword s81, s[72:73], 34048
    s_waitcnt vmcnt(8)
    v_mfma_f32_16x16x32_bf16 v[80:83], a[32:35], v[144:147], v[80:83]
    v_mfma_f32_16x16x32_bf16 v[80:83], a[176:179], v[148:151], v[80:83]
    buffer_load_dwordx4 v[184:187], v30, s[16:19], s68 offen offset:2048 sc1
    v_mfma_f32_16x16x32_bf16 v[84:87], a[36:39], v[144:147], v[84:87]
    v_mfma_f32_16x16x32_bf16 v[84:87], a[180:183], v[148:151], v[84:87]
    v_mfma_f32_16x16x32_bf16 v[88:91], a[40:43], v[144:147], v[88:91]
    v_mfma_f32_16x16x32_bf16 v[88:91], a[184:187], v[148:151], v[88:91]
    buffer_load_dwordx4 v[188:191], v30, s[16:19], s69 offen offset:2048 sc1
    v_mfma_f32_16x16x32_bf16 v[92:95], a[44:47], v[144:147], v[92:95]
    v_mfma_f32_16x16x32_bf16 v[92:95], a[188:191], v[148:151], v[92:95]
    s_waitcnt vmcnt(8)
    v_mfma_f32_16x16x32_bf16 v[96:99], a[32:35], v[152:155], v[96:99]
    v_mfma_f32_16x16x32_bf16 v[96:99], a[48:51], v[156:159], v[96:99]
    buffer_load_dwordx4 v[192:195], v30, s[16:19], s68 offen offset:3072 sc1
    v_mfma_f32_16x16x32_bf16 v[100:103], a[36:39], v[152:155], v[100:103]
    v_mfma_f32_16x16x32_bf16 v[100:103], a[52:55], v[156:159], v[100:103]
    v_mfma_f32_16x16x32_bf16 v[104:107], a[40:43], v[152:155], v[104:107]
    v_mfma_f32_16x16x32_bf16 v[104:107], a[56:59], v[156:159], v[104:107]
    buffer_load_dwordx4 v[196:199], v30, s[16:19], s69 offen offset:3072 sc1
    v_mfma_f32_16x16x32_bf16 v[108:111], a[44:47], v[152:155], v[108:111]
    v_mfma_f32_16x16x32_bf16 v[108:111], a[60:63], v[156:159], v[108:111]
    s_waitcnt vmcnt(8)
    v_mfma_f32_16x16x32_bf16 v[112:115], a[32:35], v[160:163], v[112:115]
    v_mfma_f32_16x16x32_bf16 v[112:115], a[48:51], v[164:167], v[112:115]
    buffer_load_dwordx4 v[200:203], v31, s[16:19], s41 offen offset:0 sc1
    v_mfma_f32_16x16x32_bf16 v[116:119], a[36:39], v[160:163], v[116:119]
    v_mfma_f32_16x16x32_bf16 v[116:119], a[52:55], v[164:167], v[116:119]
    v_mfma_f32_16x16x32_bf16 v[120:123], a[40:43], v[160:163], v[120:123]
    v_mfma_f32_16x16x32_bf16 v[120:123], a[56:59], v[164:167], v[120:123]
    buffer_load_dwordx4 v[204:207], v31, s[16:19], s42 offen offset:0 sc1
    v_mfma_f32_16x16x32_bf16 v[124:127], a[44:47], v[160:163], v[124:127]
    v_mfma_f32_16x16x32_bf16 v[124:127], a[60:63], v[164:167], v[124:127]
    s_waitcnt vmcnt(8)
    v_mfma_f32_16x16x32_bf16 v[32:35], a[192:195], v[168:171], v[32:35]
    v_mfma_f32_16x16x32_bf16 v[32:35], a[208:211], v[172:175], v[32:35]
    buffer_load_dwordx4 v[208:211], v31, s[16:19], s41 offen offset:1024 sc1
    v_mfma_f32_16x16x32_bf16 v[36:39], a[196:199], v[168:171], v[36:39]
    v_mfma_f32_16x16x32_bf16 v[36:39], a[212:215], v[172:175], v[36:39]
    v_mfma_f32_16x16x32_bf16 v[40:43], a[200:203], v[168:171], v[40:43]
    s_waitcnt lgkmcnt(0)
    v_mfma_f32_16x16x32_bf16 v[40:43], a[216:219], v[172:175], v[40:43]
    buffer_load_dwordx4 v[212:215], v31, s[16:19], s42 offen offset:1024 sc1
    v_mfma_f32_16x16x32_bf16 v[44:47], a[204:207], v[168:171], v[44:47]
    s_xor_b64 s[74:75], s[74:75], s[50:51]
    v_mfma_f32_16x16x32_bf16 v[44:47], a[220:223], v[172:175], v[44:47]
    s_xor_b64 s[76:77], s[76:77], s[50:51]
    s_waitcnt vmcnt(8)
    v_mfma_f32_16x16x32_bf16 v[48:51], a[192:195], v[176:179], v[48:51]
    s_xor_b64 s[78:79], s[78:79], s[50:51]
    v_mfma_f32_16x16x32_bf16 v[48:51], a[208:211], v[180:183], v[48:51]
    buffer_load_dwordx4 v[144:147], v31, s[16:19], s49 offen offset:0 sc1
    v_mfma_f32_16x16x32_bf16 v[52:55], a[196:199], v[176:179], v[52:55]
    s_xor_b64 s[80:81], s[80:81], s[50:51]
    v_mfma_f32_16x16x32_bf16 v[52:55], a[212:215], v[180:183], v[52:55]
    s_or_b64 s[74:75], s[74:75], s[76:77]
    v_mfma_f32_16x16x32_bf16 v[56:59], a[200:203], v[176:179], v[56:59]
    s_or_b64 s[74:75], s[74:75], s[78:79]
    v_mfma_f32_16x16x32_bf16 v[56:59], a[216:219], v[180:183], v[56:59]
    buffer_load_dwordx4 v[148:151], v31, s[16:19], s49 offen offset:1024 sc1
    v_mfma_f32_16x16x32_bf16 v[60:63], a[204:207], v[176:179], v[60:63]
    s_or_b64 s[74:75], s[74:75], s[80:81]
    s_cbranch_scc1 L_slow_f0c1
L_ok_f0c1:
    v_mfma_f32_16x16x32_bf16 v[60:63], a[220:223], v[180:183], v[60:63]
    s_waitcnt vmcnt(8)
    v_mfma_f32_16x16x32_bf16 v[64:67], a[192:195], v[184:187], v[64:67]
    v_and_b32 v1, 15, v0
    v_mfma_f32_16x16x32_bf16 v[64:67], a[208:211], v[188:191], v[64:67]
    buffer_load_dwordx4 v[152:155], v30, s[16:19], s57 offen offset:0 sc1
    v_mfma_f32_16x16x32_bf16 v[68:71], a[196:199], v[184:187], v[68:71]
    v_lshrrev_b32 v2, 4, v0
    v_mfma_f32_16x16x32_bf16 v[68:71], a[212:215], v[188:191], v[68:71]
    v_and_b32 v3, 7, v0
    v_mfma_f32_16x16x32_bf16 v[72:75], a[200:203], v[184:187], v[72:75]
    v_xor_b32 v2, v2, v3
    v_mfma_f32_16x16x32_bf16 v[72:75], a[216:219], v[188:191], v[72:75]
    buffer_load_dwordx4 v[156:159], v30, s[16:19], s58 offen offset:0 sc1
    v_mfma_f32_16x16x32_bf16 v[76:79], a[204:207], v[184:187], v[76:79]
    v_lshlrev_b32 v2, 4, v2
    v_mfma_f32_16x16x32_bf16 v[76:79], a[220:223], v[188:191], v[76:79]
    v_lshl_add_u32 v1, v1, 8, v2
    s_waitcnt vmcnt(8)
    v_mfma_f32_16x16x32_bf16 v[80:83], a[192:195], v[192:195], v[80:83]
    v_add_u32 v16, s45, v1
    v_mfma_f32_16x16x32_bf16 v[80:83], a[208:211], v[196:199], v[80:83]
    buffer_load_dwordx4 v[160:163], v30, s[16:19], s57 offen offset:1024 sc1
    v_mfma_f32_16x16x32_bf16 v[84:87], a[196:199], v[192:195], v[84:87]
    v_xor_b32 v17, 64, v16
    v_mfma_f32_16x16x32_bf16 v[84:87], a[212:215], v[196:199], v[84:87]
    v_lshrrev_b32 v1, 3, v0
    v_mfma_f32_16x16x32_bf16 v[88:91], a[200:203], v[192:195], v[88:91]
    v_lshlrev_b32 v2, 1, v3
    v_mfma_f32_16x16x32_bf16 v[88:91], a[216:219], v[196:199], v[88:91]
    buffer_load_dwordx4 v[164:167], v30, s[16:19], s58 offen offset:1024 sc1
    v_mfma_f32_16x16x32_bf16 v[92:95], a[204:207], v[192:195], v[92:95]
    v_xor_b32 v2, v2, v1
    v_mfma_f32_16x16x32_bf16 v[92:95], a[220:223], v[196:199], v[92:95]
    v_lshlrev_b32 v2, 4, v2
    s_waitcnt vmcnt(8)
    v_mfma_f32_16x16x32_bf16 v[96:99], a[64:67], v[200:203], v[96:99]
    s_lshl_b32 s61, s36, 3
    v_mfma_f32_16x16x32_bf16 v[96:99], a[80:83], v[204:207], v[96:99]
    buffer_load_dwordx4 v[168:171], v30, s[16:19], s57 offen offset:2048 sc1
    v_mfma_f32_16x16x32_bf16 v[100:103], a[68:71], v[200:203], v[100:103]
    v_add_u32 v1, s61, v1
    v_mfma_f32_16x16x32_bf16 v[100:103], a[84:87], v[204:207], v[100:103]
    v_lshl_add_u32 v8, v1, 8, v2
    v_mfma_f32_16x16x32_bf16 v[104:107], a[72:75], v[200:203], v[104:107]
    v_xor_b32 v9, 16, v8
    v_mfma_f32_16x16x32_bf16 v[104:107], a[88:91], v[204:207], v[104:107]
    buffer_load_dwordx4 v[172:175], v30, s[16:19], s58 offen offset:2048 sc1
    v_mfma_f32_16x16x32_bf16 v[108:111], a[76:79], v[200:203], v[108:111]
    v_add_u32 v10, 65536, v8
    v_mfma_f32_16x16x32_bf16 v[108:111], a[92:95], v[204:207], v[108:111]
    v_add_u32 v11, 65536, v9
    s_waitcnt vmcnt(8)
    v_mfma_f32_16x16x32_bf16 v[112:115], a[64:67], v[208:211], v[112:115]
    v_mul_u32_u24 v1, 1280, v1
    v_mfma_f32_16x16x32_bf16 v[112:115], a[80:83], v[212:215], v[112:115]
    buffer_load_dwordx4 v[176:179], v30, s[16:19], s57 offen offset:3072 sc1
    v_mfma_f32_16x16x32_bf16 v[116:119], a[68:71], v[208:211], v[116:119]
    v_lshl_add_u32 v18, v3, 4, v1
    v_mfma_f32_16x16x32_bf16 v[116:119], a[84:87], v[212:215], v[116:119]
    v_mfma_f32_16x16x32_bf16 v[120:123], a[72:75], v[208:211], v[120:123]
    v_mfma_f32_16x16x32_bf16 v[120:123], a[88:91], v[212:215], v[120:123]
    buffer_load_dwordx4 v[180:183], v30, s[16:19], s58 offen offset:3072 sc1
    v_mfma_f32_16x16x32_bf16 v[124:127], a[76:79], v[208:211], v[124:127]
    v_mfma_f32_16x16x32_bf16 v[124:127], a[92:95], v[212:215], v[124:127]
    s_waitcnt vmcnt(9)
    v_mfma_f32_16x16x32_bf16 v[96:99], a[96:99], v[144:147], v[96:99]
    v_mfma_f32_16x16x32_bf16 v[100:103], a[100:103], v[144:147], v[100:103]
    buffer_load_dwordx4 v[184:187], v30, s[16:19], s59 offen offset:0 sc1
    v_mfma_f32_16x16x32_bf16 v[104:107], a[104:107], v[144:147], v[104:107]
    v_mfma_f32_16x16x32_bf16 v[108:111], a[108:111], v[144:147], v[108:111]
    s_waitcnt vmcnt(9)
    v_mfma_f32_16x16x32_bf16 v[112:115], a[96:99], v[148:151], v[112:115]
    v_mfma_f32_16x16x32_bf16 v[116:119], a[100:103], v[148:151], v[116:119]
    buffer_load_dwordx4 v[188:191], v30, s[16:19], s66 offen offset:0 sc1
    v_mfma_f32_16x16x32_bf16 v[120:123], a[104:107], v[148:151], v[120:123]
    v_mfma_f32_16x16x32_bf16 v[124:127], a[108:111], v[148:151], v[124:127]
    s_waitcnt vmcnt(8)
    v_mfma_f32_16x16x32_bf16 v[32:35], a[112:115], v[152:155], v[32:35]
    s_load_dword s74, s[70:71], 21376
    s_load_dword s75, s[70:71], 26496
    v_mfma_f32_16x16x32_bf16 v[32:35], a[128:131], v[156:159], v[32:35]
    buffer_load_dwordx4 v[192:195], v30, s[16:19], s59 offen offset:1024 sc1
    v_mfma_f32_16x16x32_bf16 v[36:39], a[116:119], v[152:155], v[36:39]
    s_load_dword s76, s[70:71], 22656
    v_mfma_f32_16x16x32_bf16 v[36:39], a[132:135], v[156:159], v[36:39]
    s_load_dword s77, s[70:71], 23936
    v_mfma_f32_16x16x32_bf16 v[40:43], a[120:123], v[152:155], v[40:43]
    s_load_dword s78, s[70:71], 25216
    s_load_dword s79, s[70:71], 27776
    v_mfma_f32_16x16x32_bf16 v[40:43], a[136:139], v[156:159], v[40:43]
    buffer_load_dwordx4 v[196:199], v30, s[16:19], s66 offen offset:1024 sc1
    v_mfma_f32_16x16x32_bf16 v[44:47], a[124:127], v[152:155], v[44:47]
    s_load_dword s80, s[70:71], 29056
    v_mfma_f32_16x16x32_bf16 v[44:47], a[140:143], v[156:159], v[44:47]
    s_load_dword s81, s[70:71], 30336
    s_waitcnt vmcnt(8)
    v_mfma_f32_16x16x32_bf16 v[48:51], a[112:115], v[160:163], v[48:51]
    v_mfma_f32_16x16x32_bf16 v[48:51], a[128:131], v[164:167], v[48:51]
    buffer_load_dwordx4 v[200:203], v30, s[16:19], s59 offen offset:2048 sc1
    v_mfma_f32_16x16x32_bf16 v[52:55], a[116:119], v[160:163], v[52:55]
    v_mfma_f32_16x16x32_bf16 v[52:55], a[132:135], v[164:167], v[52:55]
    v_mfma_f32_16x16x32_bf16 v[56:59], a[120:123], v[160:163], v[56:59]
    v_mfma_f32_16x16x32_bf16 v[56:59], a[136:139], v[164:167], v[56:59]
    buffer_load_dwordx4 v[204:207], v30, s[16:19], s66 offen offset:2048 sc1
    v_mfma_f32_16x16x32_bf16 v[60:63], a[124:127], v[160:163], v[60:63]
    v_mfma_f32_16x16x32_bf16 v[60:63], a[140:143], v[164:167], v[60:63]
    s_waitcnt vmcnt(8)
    v_mfma_f32_16x16x32_bf16 v[64:67], a[112:115], v[168:171], v[64:67]
    v_mfma_f32_16x16x32_bf16 v[64:67], a[128:131], v[172:175], v[64:67]
    buffer_load_dwordx4 v[208:211], v30, s[16:19], s59 offen offset:3072 sc1
    v_mfma_f32_16x16x32_bf16 v[68:71], a[116:119], v[168:171], v[68:71]
    v_mfma_f32_16x16x32_bf16 v[68:71], a[132:135], v[172:175], v[68:71]
    v_mfma_f32_16x16x32_bf16 v[72:75], a[120:123], v[168:171], v[72:75]
    v_mfma_f32_16x16x32_bf16 v[72:75], a[136:139], v[172:175], v[72:75]
    buffer_load_dwordx4 v[212:215], v30, s[16:19], s66 offen offset:3072 sc1
    v_mfma_f32_16x16x32_bf16 v[76:79], a[124:127], v[168:171], v[76:79]
    v_mfma_f32_16x16x32_bf16 v[76:79], a[140:143], v[172:175], v[76:79]
    s_waitcnt vmcnt(8)
    v_mfma_f32_16x16x32_bf16 v[80:83], a[112:115], v[176:179], v[80:83]
    v_mfma_f32_16x16x32_bf16 v[80:83], a[128:131], v[180:183], v[80:83]
    buffer_load_dwordx4 v[144:147], v31, s[16:19], s67 offen offset:0 sc1
    v_mfma_f32_16x16x32_bf16 v[84:87], a[116:119], v[176:179], v[84:87]
    v_mfma_f32_16x16x32_bf16 v[84:87], a[132:135], v[180:183], v[84:87]
    v_mfma_f32_16x16x32_bf16 v[88:91], a[120:123], v[176:179], v[88:91]
    v_mfma_f32_16x16x32_bf16 v[88:91], a[136:139], v[180:183], v[88:91]
    buffer_load_dwordx4 v[148:151], v31, s[16:19], s68 offen offset:0 sc1
    v_mfma_f32_16x16x32_bf16 v[92:95], a[124:127], v[176:179], v[92:95]
    v_mfma_f32_16x16x32_bf16 v[92:95], a[140:143], v[180:183], v[92:95]
    s_waitcnt vmcnt(8)
    v_mfma_f32_16x16x32_bf16 v[32:35], a[144:147], v[184:187], v[32:35]
    v_mfma_f32_16x16x32_bf16 v[32:35], a[160:163], v[188:191], v[32:35]
    buffer_load_dwordx4 v[152:155], v31, s[16:19], s67 offen offset:1024 sc1
    v_mfma_f32_16x16x32_bf16 v[36:39], a[148:151], v[184:187], v[36:39]
    v_mfma_f32_16x16x32_bf16 v[36:39], a[164:167], v[188:191], v[36:39]
    v_mfma_f32_16x16x32_bf16 v[40:43], a[152:155], v[184:187], v[40:43]
    s_waitcnt lgkmcnt(0)
    v_mfma_f32_16x16x32_bf16 v[40:43], a[168:171], v[188:191], v[40:43]
    buffer_load_dwordx4 v[156:159], v31, s[16:19], s68 offen offset:1024 sc1
    v_mfma_f32_16x16x32_bf16 v[44:47], a[156:159], v[184:187], v[44:47]
    s_xor_b64 s[74:75], s[74:75], s[50:51]
    v_mfma_f32_16x16x32_bf16 v[44:47], a[172:175], v[188:191], v[44:47]
    s_xor_b64 s[76:77], s[76:77], s[50:51]
    s_waitcnt vmcnt(8)
    v_mfma_f32_16x16x32_bf16 v[48:51], a[144:147], v[192:195], v[48:51]
    s_xor_b64 s[78:79], s[78:79], s[50:51]
    v_mfma_f32_16x16x32_bf16 v[48:51], a[160:163], v[196:199], v[48:51]
    buffer_load_dwordx4 v[160:163], v31, s[16:19], s69 offen offset:0 sc1
    v_mfma_f32_16x16x32_bf16 v[52:55], a[148:151], v[192:195], v[52:55]
    s_xor_b64 s[80:81], s[80:81], s[50:51]
    v_mfma_f32_16x16x32_bf16 v[52:55], a[164:167], v[196:199], v[52:55]
    s_or_b64 s[74:75], s[74:75], s[76:77]
    v_mfma_f32_16x16x32_bf16 v[56:59], a[152:155], v[192:195], v[56:59]
    s_or_b64 s[74:75], s[74:75], s[78:79]
    v_mfma_f32_16x16x32_bf16 v[56:59], a[168:171], v[196:199], v[56:59]
    buffer_load_dwordx4 v[164:167], v31, s[16:19], s69 offen offset:1024 sc1
    v_mfma_f32_16x16x32_bf16 v[60:63], a[156:159], v[192:195], v[60:63]
    s_or_b64 s[74:75], s[74:75], s[80:81]
    s_cbranch_scc1 L_slow_f0c2
L_ok_f0c2:
    v_mfma_f32_16x16x32_bf16 v[60:63], a[172:175], v[196:199], v[60:63]
    s_waitcnt vmcnt(8)
    v_mfma_f32_16x16x32_bf16 v[64:67], a[144:147], v[200:203], v[64:67]
    v_mfma_f32_16x16x32_bf16 v[64:67], a[160:163], v[204:207], v[64:67]
    buffer_load_dwordx4 v[168:171], v30, s[16:19], s40 offen offset:0 sc1
    v_mfma_f32_16x16x32_bf16 v[68:71], a[148:151], v[200:203], v[68:71]
    v_mfma_f32_16x16x32_bf16 v[68:71], a[164:167], v[204:207], v[68:71]
    v_mfma_f32_16x16x32_bf16 v[72:75], a[152:155], v[200:203], v[72:75]
    v_mfma_f32_16x16x32_bf16 v[72:75], a[168:171], v[204:207], v[72:75]
    buffer_load_dwordx4 v[172:175], v30, s[16:19], s40 offen offset:1024 sc1
    v_mfma_f32_16x16x32_bf16 v[76:79], a[156:159], v[200:203], v[76:79]
    v_mfma_f32_16x16x32_bf16 v[76:79], a[172:175], v[204:207], v[76:79]
    s_waitcnt vmcnt(8)
    v_mfma_f32_16x16x32_bf16 v[80:83], a[144:147], v[208:211], v[80:83]
    v_mfma_f32_16x16x32_bf16 v[80:83], a[160:163], v[212:215], v[80:83]
    buffer_load_dwordx4 v[176:179], v31, s[16:19], s57 offen offset:0 sc1
    v_mfma_f32_16x16x32_bf16 v[84:87], a[148:151], v[208:211], v[84:87]
    v_mfma_f32_16x16x32_bf16 v[84:87], a[164:167], v[212:215], v[84:87]
    v_mfma_f32_16x16x32_bf16 v[88:91], a[152:155], v[208:211], v[88:91]
    v_mfma_f32_16x16x32_bf16 v[88:91], a[168:171], v[212:215], v[88:91]
    buffer_load_dwordx4 v[180:183], v31, s[16:19], s57 offen offset:1024 sc1
    v_mfma_f32_16x16x32_bf16 v[92:95], a[156:159], v[208:211], v[92:95]
    v_mfma_f32_16x16x32_bf16 v[92:95], a[172:175], v[212:215], v[92:95]
    s_waitcnt vmcnt(8)
    v_mfma_f32_16x16x32_bf16 v[96:99], a[176:179], v[144:147], v[96:99]
    v_mfma_f32_16x16x32_bf16 v[96:99], a[192:195], v[148:151], v[96:99]
    buffer_load_dwordx4 v[184:187], v30, s[16:19], s41 offen offset:0 sc1
    v_mfma_f32_16x16x32_bf16 v[100:103], a[180:183], v[144:147], v[100:103]
    v_mfma_f32_16x16x32_bf16 v[100:103], a[196:199], v[148:151], v[100:103]
    v_mfma_f32_16x16x32_bf16 v[104:107], a[184:187], v[144:147], v[104:107]
    s_load_dword s74, s[70:71], 21504
    s_load_dword s75, s[70:71], 22784
    v_mfma_f32_16x16x32_bf16 v[104:107], a[200:203], v[148:151], v[104:107]
    buffer_load_dwordx4 v[188:191], v30, s[16:19], s42 offen offset:0 sc1
    v_mfma_f32_16x16x32_bf16 v[108:111], a[188:191], v[144:147], v[108:111]
    s_load_dword s76, s[70:71], 24064
    v_mfma_f32_16x16x32_bf16 v[108:111], a[204:207], v[148:151], v[108:111]
    s_load_dword s77, s[70:71], 25344
    s_waitcnt vmcnt(8)
    v_mfma_f32_16x16x32_bf16 v[112:115], a[176:179], v[152:155], v[112:115]
    v_mfma_f32_16x16x32_bf16 v[112:115], a[192:195], v[156:159], v[112:115]
    buffer_load_dwordx4 v[192:195], v30, s[16:19], s49 offen offset:0 sc1
    v_mfma_f32_16x16x32_bf16 v[116:119], a[180:183], v[152:155], v[116:119]
    v_mfma_f32_16x16x32_bf16 v[116:119], a[196:199], v[156:159], v[116:119]
    v_mfma_f32_16x16x32_bf16 v[120:123], a[184:187], v[152:155], v[120:123]
    v_mfma_f32_16x16x32_bf16 v[120:123], a[200:203], v[156:159], v[120:123]
    buffer_load_dwordx4 v[196:199], v30, s[16:19], s41 offen offset:1024 sc1
    v_mfma_f32_16x16x32_bf16 v[124:127], a[188:191], v[152:155], v[124:127]
    v_mfma_f32_16x16x32_bf16 v[124:127], a[204:207], v[156:159], v[124:127]
    s_waitcnt vmcnt(9)
    v_mfma_f32_16x16x32_bf16 v[96:99], a[208:211], v[160:163], v[96:99]
    v_mfma_f32_16x16x32_bf16 v[100:103], a[212:215], v[160:163], v[100:103]
    buffer_load_dwordx4 v[200:203], v30, s[16:19], s42 offen offset:1024 sc1
    v_mfma_f32_16x16x32_bf16 v[104:107], a[216:219], v[160:163], v[104:107]
    v_mfma_f32_16x16x32_bf16 v[108:111], a[220:223], v[160:163], v[108:111]
    s_waitcnt vmcnt(9)
    v_mfma_f32_16x16x32_bf16 v[112:115], a[208:211], v[164:167], v[112:115]
    v_mfma_f32_16x16x32_bf16 v[116:119], a[212:215], v[164:167], v[116:119]
    buffer_load_dwordx4 v[204:207], v30, s[16:19], s49 offen offset:1024 sc1
    v_mfma_f32_16x16x32_bf16 v[120:123], a[216:219], v[164:167], v[120:123]
    v_mfma_f32_16x16x32_bf16 v[124:127], a[220:223], v[164:167], v[124:127]
    s_waitcnt vmcnt(9)
    v_mfma_f32_16x16x32_bf16 v[32:35], a[48:51], v[168:171], v[32:35]
    v_mfma_f32_16x16x32_bf16 v[36:39], a[52:55], v[168:171], v[36:39]
    buffer_load_dwordx4 v[208:211], v31, s[16:19], s58 offen offset:0 sc1
    v_mfma_f32_16x16x32_bf16 v[40:43], a[56:59], v[168:171], v[40:43]
    v_mfma_f32_16x16x32_bf16 v[44:47], a[60:63], v[168:171], v[44:47]
    s_waitcnt vmcnt(9)
    v_mfma_f32_16x16x32_bf16 v[48:51], a[48:51], v[172:175], v[48:51]
    v_mfma_f32_16x16x32_bf16 v[52:55], a[52:55], v[172:175], v[52:55]
    buffer_load_dwordx4 v[212:215], v31, s[16:19], s59 offen offset:0 sc1
    v_mfma_f32_16x16x32_bf16 v[56:59], a[56:59], v[172:175], v[56:59]
    v_mfma_f32_16x16x32_bf16 v[60:63], a[60:63], v[172:175], v[60:63]
    s_waitcnt vmcnt(9)
    v_mfma_f32_16x16x32_bf16 v[96:99], a[112:115], v[176:179], v[96:99]
    v_mfma_f32_16x16x32_bf16 v[100:103], a[116:119], v[176:179], v[100:103]
    buffer_load_dwordx4 v[144:147], v31, s[16:19], s66 offen offset:0 sc1
    v_mfma_f32_16x16x32_bf16 v[104:107], a[120:123], v[176:179], v[104:107]
    v_mfma_f32_16x16x32_bf16 v[108:111], a[124:127], v[176:179], v[108:111]
    s_waitcnt vmcnt(9)
    v_mfma_f32_16x16x32_bf16 v[112:115], a[112:115], v[180:183], v[112:115]
    v_mfma_f32_16x16x32_bf16 v[116:119], a[116:119], v[180:183], v[116:119]
    buffer_load_dwordx4 v[148:151], v31, s[16:19], s58 offen offset:1024 sc1
    v_mfma_f32_16x16x32_bf16 v[120:123], a[120:123], v[180:183], v[120:123]
    v_mfma_f32_16x16x32_bf16 v[124:127], a[124:127], v[180:183], v[124:127]
    s_waitcnt vmcnt(7)
    v_mfma_f32_16x16x32_bf16 v[32:35], a[64:67], v[184:187], v[32:35]
    s_waitcnt lgkmcnt(0)
    v_mfma_f32_16x16x32_bf16 v[32:35], a[80:83], v[188:191], v[32:35]
    buffer_load_dwordx4 v[152:155], v31, s[16:19], s59 offen offset:1024 sc1
    v_mfma_f32_16x16x32_bf16 v[32:35], a[96:99], v[192:195], v[32:35]
    s_xor_b64 s[74:75], s[74:75], s[50:51]
    v_mfma_f32_16x16x32_bf16 v[36:39], a[68:71], v[184:187], v[36:39]
    s_xor_b64 s[76:77], s[76:77], s[50:51]
    v_mfma_f32_16x16x32_bf16 v[36:39], a[84:87], v[188:191], v[36:39]
    s_or_b64 s[74:75], s[74:75], s[76:77]
    s_cbranch_scc1 L_slow_f0c3
L_ok_f0c3:
    v_mfma_f32_16x16x32_bf16 v[36:39], a[100:103], v[192:195], v[36:39]
    buffer_load_dwordx4 v[156:159], v31, s[16:19], s66 offen offset:1024 sc1
    v_mfma_f32_16x16x32_bf16 v[40:43], a[72:75], v[184:187], v[40:43]
    v_mfma_f32_16x16x32_bf16 v[40:43], a[88:91], v[188:191], v[40:43]
    ds_write_b128 v16, v[32:35] offset:0
    v_mfma_f32_16x16x32_bf16 v[40:43], a[104:107], v[192:195], v[40:43]
    v_mfma_f32_16x16x32_bf16 v[44:47], a[76:79], v[184:187], v[44:47]
    buffer_load_dwordx4 v[160:163], v30, s[16:19], s40 offen offset:2048 sc1
    v_mfma_f32_16x16x32_bf16 v[44:47], a[92:95], v[188:191], v[44:47]
    s_nop 0
    ds_write_b128 v17, v[36:39] offset:0
    v_mfma_f32_16x16x32_bf16 v[44:47], a[108:111], v[192:195], v[44:47]
    s_waitcnt vmcnt(7)
    v_mfma_f32_16x16x32_bf16 v[48:51], a[64:67], v[196:199], v[48:51]
    v_mfma_f32_16x16x32_bf16 v[48:51], a[80:83], v[200:203], v[48:51]
    buffer_load_dwordx4 v[164:167], v30, s[16:19], s41 offen offset:2048 sc1
    v_mfma_f32_16x16x32_bf16 v[48:51], a[96:99], v[204:207], v[48:51]
    ds_write_b128 v16, v[40:43] offset:128
    v_mfma_f32_16x16x32_bf16 v[52:55], a[68:71], v[196:199], v[52:55]
    v_mfma_f32_16x16x32_bf16 v[52:55], a[84:87], v[200:203], v[52:55]
    s_nop 0
    ds_write_b128 v17, v[44:47] offset:128
    v_mfma_f32_16x16x32_bf16 v[52:55], a[100:103], v[204:207], v[52:55]
    buffer_load_dwordx4 v[168:171], v30, s[16:19], s42 offen offset:2048 sc1
    v_mfma_f32_16x16x32_bf16 v[56:59], a[72:75], v[196:199], v[56:59]
    v_mfma_f32_16x16x32_bf16 v[56:59], a[88:91], v[200:203], v[56:59]
    ds_write_b128 v16, v[48:51] offset:4096
    v_mfma_f32_16x16x32_bf16 v[56:59], a[104:107], v[204:207], v[56:59]
    v_mfma_f32_16x16x32_bf16 v[60:63], a[76:79], v[196:199], v[60:63]
    buffer_load_dwordx4 v[172:175], v30, s[16:19], s49 offen offset:2048 sc1
    v_mfma_f32_16x16x32_bf16 v[60:63], a[92:95], v[200:203], v[60:63]
    s_nop 0
    ds_write_b128 v17, v[52:55] offset:4096
    v_mfma_f32_16x16x32_bf16 v[60:63], a[108:111], v[204:207], v[60:63]
    s_waitcnt vmcnt(7)
    v_mfma_f32_16x16x32_bf16 v[96:99], a[128:131], v[208:211], v[96:99]
    v_mfma_f32_16x16x32_bf16 v[96:99], a[144:147], v[212:215], v[96:99]
    buffer_load_dwordx4 v[176:179], v30, s[16:19], s40 offen offset:3072 sc1
    v_mfma_f32_16x16x32_bf16 v[96:99], a[160:163], v[144:147], v[96:99]
    ds_write_b128 v16, v[56:59] offset:4224
    v_mfma_f32_16x16x32_bf16 v[100:103], a[132:135], v[208:211], v[100:103]
    v_mfma_f32_16x16x32_bf16 v[100:103], a[148:151], v[212:215], v[100:103]
    s_nop 0
    ds_write_b128 v17, v[60:63] offset:4224
    v_mfma_f32_16x16x32_bf16 v[100:103], a[164:167], v[144:147], v[100:103]
    buffer_load_dwordx4 v[180:183], v30, s[16:19], s41 offen offset:3072 sc1
    v_mfma_f32_16x16x32_bf16 v[104:107], a[136:139], v[208:211], v[104:107]
    v_mfma_f32_16x16x32_bf16 v[104:107], a[152:155], v[212:215], v[104:107]
    ds_write_b128 v16, v[96:99] offset:16384
    v_mfma_f32_16x16x32_bf16 v[104:107], a[168:171], v[144:147], v[104:107]
    v_mfma_f32_16x16x32_bf16 v[108:111], a[140:143], v[208:211], v[108:111]
    buffer_load_dwordx4 v[184:187], v30, s[16:19], s42 offen offset:3072 sc1
    v_mfma_f32_16x16x32_bf16 v[108:111], a[156:159], v[212:215], v[108:111]
    s_nop 0
    ds_write_b128 v17, v[100:103] offset:16384
    v_mfma_f32_16x16x32_bf16 v[108:111], a[172:175], v[144:147], v[108:111]
    s_waitcnt vmcnt(7)
    v_mfma_f32_16x16x32_bf16 v[112:115], a[128:131], v[148:151], v[112:115]
    v_mfma_f32_16x16x32_bf16 v[112:115], a[144:147], v[152:155], v[112:115]
    buffer_load_dwordx4 v[188:191], v30, s[16:19], s49 offen offset:3072 sc1
    v_mfma_f32_16x16x32_bf16 v[112:115], a[160:163], v[156:159], v[112:115]
    ds_write_b128 v16, v[104:107] offset:16512
    v_mfma_f32_16x16x32_bf16 v[116:119], a[132:135], v[148:151], v[116:119]
    v_mfma_f32_16x16x32_bf16 v[116:119], a[148:151], v[152:155], v[116:119]
    s_nop 0
    ds_write_b128 v17, v[108:111] offset:16512
    v_mfma_f32_16x16x32_bf16 v[116:119], a[164:167], v[156:159], v[116:119]
    v_mfma_f32_16x16x32_bf16 v[120:123], a[136:139], v[148:151], v[120:123]
    v_mfma_f32_16x16x32_bf16 v[120:123], a[152:155], v[152:155], v[120:123]
    s_nop 0
    ds_write_b128 v16, v[112:115] offset:20480
    v_mfma_f32_16x16x32_bf16 v[120:123], a[168:171], v[156:159], v[120:123]
    v_mfma_f32_16x16x32_bf16 v[124:127], a[140:143], v[148:151], v[124:127]
    v_mfma_f32_16x16x32_bf16 v[124:127], a[156:159], v[152:155], v[124:127]
    s_nop 1
    ds_write_b128 v17, v[116:119] offset:20480
    v_mfma_f32_16x16x32_bf16 v[124:127], a[172:175], v[156:159], v[124:127]
    s_waitcnt vmcnt(6)
    v_mfma_f32_16x16x32_bf16 v[64:67], a[48:51], v[160:163], v[64:67]
    v_mfma_f32_16x16x32_bf16 v[64:67], a[64:67], v[164:167], v[64:67]
    ds_write_b128 v16, v[120:123] offset:20608
    v_mfma_f32_16x16x32_bf16 v[68:71], a[52:55], v[160:163], v[68:71]
    v_mfma_f32_16x16x32_bf16 v[68:71], a[68:71], v[164:167], v[68:71]
    v_mfma_f32_16x16x32_bf16 v[72:75], a[56:59], v[160:163], v[72:75]
    s_nop 1
    ds_write_b128 v17, v[124:127] offset:20608
    v_mfma_f32_16x16x32_bf16 v[72:75], a[72:75], v[164:167], v[72:75]
    v_mfma_f32_16x16x32_bf16 v[76:79], a[60:63], v[160:163], v[76:79]
    v_mfma_f32_16x16x32_bf16 v[76:79], a[76:79], v[164:167], v[76:79]
    s_waitcnt vmcnt(4)
    v_mfma_f32_16x16x32_bf16 v[64:67], a[80:83], v[168:171], v[64:67]
    v_mfma_f32_16x16x32_bf16 v[64:67], a[96:99], v[172:175], v[64:67]
    v_mfma_f32_16x16x32_bf16 v[68:71], a[84:87], v[168:171], v[68:71]
    v_mfma_f32_16x16x32_bf16 v[68:71], a[100:103], v[172:175], v[68:71]
    v_mfma_f32_16x16x32_bf16 v[72:75], a[88:91], v[168:171], v[72:75]
    v_mfma_f32_16x16x32_bf16 v[72:75], a[104:107], v[172:175], v[72:75]
    v_mfma_f32_16x16x32_bf16 v[76:79], a[92:95], v[168:171], v[76:79]
    s_nop 3
    ds_write_b128 v16, v[64:67] offset:8192
    v_mfma_f32_16x16x32_bf16 v[76:79], a[108:111], v[172:175], v[76:79]
    s_waitcnt vmcnt(2)
    v_mfma_f32_16x16x32_bf16 v[80:83], a[48:51], v[176:179], v[80:83]
    ds_write_b128 v17, v[68:71] offset:8192
    v_mfma_f32_16x16x32_bf16 v[80:83], a[64:67], v[180:183], v[80:83]
    v_mfma_f32_16x16x32_bf16 v[84:87], a[52:55], v[176:179], v[84:87]
    ds_write_b128 v16, v[72:75] offset:8320
    v_mfma_f32_16x16x32_bf16 v[84:87], a[68:71], v[180:183], v[84:87]
    v_mfma_f32_16x16x32_bf16 v[88:91], a[56:59], v[176:179], v[88:91]
    s_nop 0
    ds_write_b128 v17, v[76:79] offset:8320
    v_mfma_f32_16x16x32_bf16 v[88:91], a[72:75], v[180:183], v[88:91]
    v_mfma_f32_16x16x32_bf16 v[92:95], a[60:63], v[176:179], v[92:95]
    v_mfma_f32_16x16x32_bf16 v[92:95], a[76:79], v[180:183], v[92:95]
    s_waitcnt vmcnt(0)
    v_mfma_f32_16x16x32_bf16 v[80:83], a[80:83], v[184:187], v[80:83]
    v_mfma_f32_16x16x32_bf16 v[80:83], a[96:99], v[188:191], v[80:83]
    v_mfma_f32_16x16x32_bf16 v[84:87], a[84:87], v[184:187], v[84:87]
    v_mfma_f32_16x16x32_bf16 v[84:87], a[100:103], v[188:191], v[84:87]
    v_mfma_f32_16x16x32_bf16 v[88:91], a[88:91], v[184:187], v[88:91]
    v_mfma_f32_16x16x32_bf16 v[88:91], a[104:107], v[188:191], v[88:91]
    v_mfma_f32_16x16x32_bf16 v[92:95], a[92:95], v[184:187], v[92:95]
    s_nop 3
    ds_write_b128 v16, v[80:83] offset:12288
    v_mfma_f32_16x16x32_bf16 v[92:95], a[108:111], v[188:191], v[92:95]
    ds_write_b128 v17, v[84:87] offset:12288
    s_nop 0
    ds_write_b128 v16, v[88:91] offset:12416
    s_nop 5
    ds_write_b128 v17, v[92:95] offset:12416
    s_waitcnt lgkmcnt(0)
    s_barrier
    ds_read_b128 v[32:35], v8 offset:0
    ds_read_b128 v[36:39], v9 offset:0
    ds_read_b128 v[40:43], v8 offset:32768
    ds_read_b128 v[44:47], v9 offset:32768
    ds_read_b128 v[48:51], v10 offset:0
    ds_read_b128 v[52:55], v11 offset:0
    ds_read_b128 v[56:59], v10 offset:32768
    ds_read_b128 v[60:63], v11 offset:32768
    ds_read_b128 v[64:67], v8 offset:8192
    ds_read_b128 v[68:71], v9 offset:8192
    ds_read_b128 v[72:75], v8 offset:40960
    ds_read_b128 v[76:79], v9 offset:40960
    ds_read_b128 v[80:83], v10 offset:8192
    ds_read_b128 v[84:87], v11 offset:8192
    ds_read_b128 v[88:91], v10 offset:40960
    ds_read_b128 v[92:95], v11 offset:40960
    s_waitcnt lgkmcnt(12)
    v_pk_add_f32 v[32:33], v[32:33], v[40:41]
    v_pk_add_f32 v[34:35], v[34:35], v[42:43]
    v_pk_add_f32 v[36:37], v[36:37], v[44:45]
    v_pk_add_f32 v[38:39], v[38:39], v[46:47]
    s_waitcnt lgkmcnt(8)
    ds_read_b128 v[96:99], v8 offset:16384
    ds_read_b128 v[100:103], v9 offset:16384
    ds_read_b128 v[104:107], v8 offset:49152
    ds_read_b128 v[108:111], v9 offset:49152
    ds_read_b128 v[112:115], v10 offset:16384
    ds_read_b128 v[116:119], v11 offset:16384
    ds_read_b128 v[120:123], v10 offset:49152
    ds_read_b128 v[124:127], v11 offset:49152
    v_pk_add_f32 v[48:49], v[48:49], v[56:57]
    v_pk_add_f32 v[50:51], v[50:51], v[58:59]
    v_pk_add_f32 v[52:53], v[52:53], v[60:61]
    v_pk_add_f32 v[54:55], v[54:55], v[62:63]
    v_pk_add_f32 v[32:33], v[32:33], v[48:49]
    v_pk_add_f32 v[34:35], v[34:35], v[50:51]
    v_pk_add_f32 v[36:37], v[36:37], v[52:53]
    v_pk_add_f32 v[38:39], v[38:39], v[54:55]
    v_cvt_pk_bf16_f32 v40, v32, v33
    v_cvt_pk_bf16_f32 v41, v34, v35
    v_cvt_pk_bf16_f32 v42, v36, v37
    v_cvt_pk_bf16_f32 v43, v38, v39
    buffer_store_dwordx4 v[40:43], v18, s[24:27], s53 offen nt
    s_add_u32 s53, s53, 40960
    s_waitcnt lgkmcnt(12)
    v_pk_add_f32 v[64:65], v[64:65], v[72:73]
    v_pk_add_f32 v[66:67], v[66:67], v[74:75]
    v_pk_add_f32 v[68:69], v[68:69], v[76:77]
    v_pk_add_f32 v[70:71], v[70:71], v[78:79]
    s_waitcnt lgkmcnt(8)
    v_pk_add_f32 v[80:81], v[80:81], v[88:89]
    v_pk_add_f32 v[82:83], v[82:83], v[90:91]
    v_pk_add_f32 v[84:85], v[84:85], v[92:93]
    v_pk_add_f32 v[86:87], v[86:87], v[94:95]
    v_pk_add_f32 v[64:65], v[64:65], v[80:81]
    v_pk_add_f32 v[66:67], v[66:67], v[82:83]
    v_pk_add_f32 v[68:69], v[68:69], v[84:85]
    v_pk_add_f32 v[70:71], v[70:71], v[86:87]
    v_cvt_pk_bf16_f32 v72, v64, v65
    v_cvt_pk_bf16_f32 v73, v66, v67
    v_cvt_pk_bf16_f32 v74, v68, v69
    v_cvt_pk_bf16_f32 v75, v70, v71
    buffer_store_dwordx4 v[72:75], v18, s[24:27], s53 offen nt
    s_add_u32 s53, s53, 40960
    s_waitcnt lgkmcnt(4)
    v_pk_add_f32 v[96:97], v[96:97], v[104:105]
    v_pk_add_f32 v[98:99], v[98:99], v[106:107]
    v_pk_add_f32 v[100:101], v[100:101], v[108:109]
    v_pk_add_f32 v[102:103], v[102:103], v[110:111]
    s_waitcnt lgkmcnt(0)
    v_pk_add_f32 v[112:113], v[112:113], v[120:121]
    v_pk_add_f32 v[114:115], v[114:115], v[122:123]
    v_pk_add_f32 v[116:117], v[116:117], v[124:125]
    v_pk_add_f32 v[118:119], v[118:119], v[126:127]
    v_pk_add_f32 v[96:97], v[96:97], v[112:113]
    v_pk_add_f32 v[98:99], v[98:99], v[114:115]
    v_pk_add_f32 v[100:101], v[100:101], v[116:117]
    v_pk_add_f32 v[102:103], v[102:103], v[118:119]
    v_cvt_pk_bf16_f32 v104, v96, v97
    v_cvt_pk_bf16_f32 v105, v98, v99
    v_cvt_pk_bf16_f32 v106, v100, v101
    v_cvt_pk_bf16_f32 v107, v102, v103
    buffer_store_dwordx4 v[104:107], v18, s[24:27], s53 offen nt
    s_endpgm
L_slow_f0c0:
    s_mov_b32 s62, 0x387f0000
    s_mov_b32 s63, 0x0
    s_mov_b64 exec, s[62:63]
    buffer_load_dword v26, v25, s[28:31], 0 offen offset:0 sc1
    s_mov_b64 exec, -1
    s_waitcnt vmcnt(0)
    v_cmp_eq_u32 vcc, s50, v26
    s_andn2_b64 s[62:63], s[62:63], vcc
    s_cbranch_scc0 L_ok_f0c0
    s_cmp_eq_u32 s52, 0
    s_cbranch_scc1 L_ok_f0c0
    s_sub_u32 s52, s52, 1
    s_sleep 4
    s_branch L_slow_f0c0
L_slow_f0c1:
    s_mov_b32 s62, 0x3f800000
    s_mov_b32 s63, 0x0
    s_mov_b64 exec, s[62:63]
    buffer_load_dword v26, v25, s[28:31], 0 offen offset:128 sc1
    s_mov_b64 exec, -1
    s_waitcnt vmcnt(0)
    v_cmp_eq_u32 vcc, s50, v26
    s_andn2_b64 s[62:63], s[62:63], vcc
    s_cbranch_scc0 L_ok_f0c1
    s_cmp_eq_u32 s52, 0
    s_cbranch_scc1 L_ok_f0c1
    s_sub_u32 s52, s52, 1
    s_sleep 1
    s_branch L_slow_f0c1
L_slow_f0c2:
    s_mov_b32 s62, 0x7f80000
    s_mov_b32 s63, 0x0
    s_mov_b64 exec, s[62:63]
    buffer_load_dword v26, v25, s[28:31], 0 offen offset:256 sc1
    s_mov_b64 exec, -1
    s_waitcnt vmcnt(0)
    v_cmp_eq_u32 vcc, s50, v26
    s_andn2_b64 s[62:63], s[62:63], vcc
    s_cbranch_scc0 L_ok_f0c2
    s_cmp_eq_u32 s52, 0
    s_cbranch_scc1 L_ok_f0c2
    s_sub_u32 s52, s52, 1
    s_sleep 1
    s_branch L_slow_f0c2
L_slow_f0c3:
    s_mov_b32 s62, 0x780000
    s_mov_b32 s63, 0x0
    s_mov_b64 exec, s[62:63]
    buffer_load_dword v26, v25, s[28:31], 0 offen offset:384 sc1
    s_mov_b64 exec, -1
    s_waitcnt vmcnt(0)
    v_cmp_eq_u32 vcc, s50, v26
    s_andn2_b64 s[62:63], s[62:63], vcc
    s_cbranch_scc0 L_ok_f0c3
    s_cmp_eq_u32 s52, 0
    s_cbranch_scc1 L_ok_f0c3
    s_sub_u32 s52, s52, 1
    s_sleep 1
    s_branch L_slow_f0c3
L_fv1:
    s_load_dword s74, s[70:71], 19840
    s_load_dword s75, s[70:71], 21120
    s_load_dword s76, s[70:71], 32640
    s_load_dword s77, s[72:73], 33920
    s_load_dword s78, s[70:71], 22400
    s_load_dword s79, s[70:71], 23680
    s_load_dword s80, s[70:71], 24960
    s_load_dword s81, s[70:71], 17280
    s_load_dword s82, s[70:71], 18560
    s_load_dword s83, s[70:71], 31360
    s_waitcnt lgkmcnt(0)
    s_xor_b64 s[74:75], s[74:75], s[50:51]
    s_xor_b64 s[76:77], s[76:77], s[50:51]
    s_xor_b64 s[78:79], s[78:79], s[50:51]
    s_xor_b64 s[80:81], s[80:81], s[50:51]
    s_xor_b64 s[82:83], s[82:83], s[50:51]
    s_or_b64 s[74:75], s[74:75], s[76:77]
    s_or_b64 s[74:75], s[74:75], s[78:79]
    s_or_b64 s[74:75], s[74:75], s[80:81]
    s_or_b64 s[74:75], s[74:75], s[82:83]
    s_cbranch_scc1 L_slow_f1c0
L_ok_f1c0:
    buffer_load_dwordx4 v[144:147], v31, s[16:19], s39 offen offset:0 sc1
    buffer_load_dwordx4 v[148:151], v31, s[16:19], s40 offen offset:0 sc1
    buffer_load_dwordx4 v[152:155], v31, s[16:19], s39 offen offset:1024 sc1
    buffer_load_dwordx4 v[156:159], v31, s[16:19], s40 offen offset:1024 sc1
    buffer_load_dwordx4 v[160:163], v30, s[16:19], s68 offen offset:0 sc1
    buffer_load_dwordx4 v[164:167], v30, s[16:19], s69 offen offset:0 sc1
    buffer_load_dwordx4 v[168:171], v30, s[16:19], s68 offen offset:1024 sc1
    buffer_load_dwordx4 v[172:175], v30, s[16:19], s69 offen offset:1024 sc1
    buffer_load_dwordx4 v[176:179], v30, s[16:19], s68 offen offset:2048 sc1
    buffer_load_dwordx4 v[180:183], v30, s[16:19], s69 offen offset:2048 sc1
    s_waitcnt vmcnt(8)
    v_mfma_f32_16x16x32_bf16 v[96:99], a[32:35], v[144:147], 0
    v_mfma_f32_16x16x32_bf16 v[96:99], a[48:51], v[148:151], v[96:99]
    buffer_load_dwordx4 v[184:187], v30, s[16:19], s68 offen offset:3072 sc1
    v_mfma_f32_16x16x32_bf16 v[100:103], a[36:39], v[144:147], 0
    v_mfma_f32_16x16x32_bf16 v[100:103], a[52:55], v[148:151], v[100:103]
    v_mfma_f32_16x16x32_bf16 v[104:107], a[40:43], v[144:147], 0
    v_mfma_f32_16x16x32_bf16 v[104:107], a[56:59], v[148:151], v[104:107]
    buffer_load_dwordx4 v[188:191], v30, s[16:19], s69 offen offset:3072 sc1
    v_mfma_f32_16x16x32_bf16 v[108:111], a[44:47], v[144:147], 0
    v_mfma_f32_16x16x32_bf16 v[108:111], a[60:63], v[148:151], v[108:111]
    s_waitcnt vmcnt(8)
    v_mfma_f32_16x16x32_bf16 v[112:115], a[32:35], v[152:155], 0
    v_mfma_f32_16x16x32_bf16 v[112:115], a[48:51], v[156:159], v[112:115]
    buffer_load_dwordx4 v[192:195], v31, s[16:19], s41 offen offset:0 sc1
    v_mfma_f32_16x16x32_bf16 v[116:119], a[36:39], v[152:155], 0
    v_mfma_f32_16x16x32_bf16 v[116:119], a[52:55], v[156:159], v[116:119]
    v_mfma_f32_16x16x32_bf16 v[120:123], a[40:43], v[152:155], 0
    v_mfma_f32_16x16x32_bf16 v[120:123], a[56:59], v[156:159], v[120:123]
    buffer_load_dwordx4 v[196:199], v31, s[16:19], s42 offen offset:0 sc1
    v_mfma_f32_16x16x32_bf16 v[124:127], a[44:47], v[152:155], 0
    v_mfma_f32_16x16x32_bf16 v[124:127], a[60:63], v[156:159], v[124:127]
    s_waitcnt vmcnt(8)
    v_mfma_f32_16x16x32_bf16 v[32:35], a[192:195], v[160:163], 0
    v_mfma_f32_16x16x32_bf16 v[32:35], a[208:211], v[164:167], v[32:35]
    buffer_load_dwordx4 v[200:203], v31, s[16:19], s41 offen offset:1024 sc1
    v_mfma_f32_16x16x32_bf16 v[36:39], a[196:199], v[160:163], 0
    v_mfma_f32_16x16x32_bf16 v[36:39], a[212:215], v[164:167], v[36:39]
    v_mfma_f32_16x16x32_bf16 v[40:43], a[200:203], v[160:163], 0
    v_mfma_f32_16x16x32_bf16 v[40:43], a[216:219], v[164:167], v[40:43]
    buffer_load_dwordx4 v[204:207], v31, s[16:19], s42 offen offset:1024 sc1
    v_mfma_f32_16x16x32_bf16 v[44:47], a[204:207], v[160:163], 0
    v_mfma_f32_16x16x32_bf16 v[44:47], a[220:223], v[164:167], v[44:47]
    s_waitcnt vmcnt(8)
    v_mfma_f32_16x16x32_bf16 v[48:51], a[192:195], v[168:171], 0
    v_mfma_f32_16x16x32_bf16 v[48:51], a[208:211], v[172:175], v[48:51]
    buffer_load_dwordx4 v[208:211], v31, s[16:19], s49 offen offset:0 sc1
    v_mfma_f32_16x16x32_bf16 v[52:55], a[196:199], v[168:171], 0
    v_mfma_f32_16x16x32_bf16 v[52:55], a[212:215], v[172:175], v[52:55]
    v_mfma_f32_16x16x32_bf16 v[56:59], a[200:203], v[168:171], 0
    v_mfma_f32_16x16x32_bf16 v[56:59], a[216:219], v[172:175], v[56:59]
    buffer_load_dwordx4 v[212:215], v31, s[16:19], s49 offen offset:1024 sc1
    v_mfma_f32_16x16x32_bf16 v[60:63], a[204:207], v[168:171], 0
    v_mfma_f32_16x16x32_bf16 v[60:63], a[220:223], v[172:175], v[60:63]
    s_waitcnt vmcnt(8)
    v_mfma_f32_16x16x32_bf16 v[64:67], a[192:195], v[176:179], 0
    v_mfma_f32_16x16x32_bf16 v[64:67], a[208:211], v[180:183], v[64:67]
    buffer_load_dwordx4 v[144:147], v30, s[16:19], s37 offen offset:0 sc1
    v_mfma_f32_16x16x32_bf16 v[68:71], a[196:199], v[176:179], 0
    v_mfma_f32_16x16x32_bf16 v[68:71], a[212:215], v[180:183], v[68:71]
    v_mfma_f32_16x16x32_bf16 v[72:75], a[200:203], v[176:179], 0
    v_mfma_f32_16x16x32_bf16 v[72:75], a[216:219], v[180:183], v[72:75]
    buffer_load_dwordx4 v[148:151], v30, s[16:19], s38 offen offset:0 sc1
    v_mfma_f32_16x16x32_bf16 v[76:79], a[204:207], v[176:179], 0
    v_mfma_f32_16x16x32_bf16 v[76:79], a[220:223], v[180:183], v[76:79]
    s_waitcnt vmcnt(8)
    v_mfma_f32_16x16x32_bf16 v[80:83], a[192:195], v[184:187], 0
    v_mfma_f32_16x16x32_bf16 v[80:83], a[208:211], v[188:191], v[80:83]
    buffer_load_dwordx4 v[152:155], v30, s[16:19], s37 offen offset:1024 sc1
    v_mfma_f32_16x16x32_bf16 v[84:87], a[196:199], v[184:187], 0
    v_mfma_f32_16x16x32_bf16 v[84:87], a[212:215], v[188:191], v[84:87]
    v_mfma_f32_16x16x32_bf16 v[88:91], a[200:203], v[184:187], 0
    v_mfma_f32_16x16x32_bf16 v[88:91], a[216:219], v[188:191], v[88:91]
    buffer_load_dwordx4 v[156:159], v30, s[16:19], s38 offen offset:1024 sc1
    v_mfma_f32_16x16x32_bf16 v[92:95], a[204:207], v[184:187], 0
    v_mfma_f32_16x16x32_bf16 v[92:95], a[220:223], v[188:191], v[92:95]
    s_waitcnt vmcnt(8)
    v_mfma_f32_16x16x32_bf16 v[96:99], a[64:67], v[192:195], v[96:99]
    v_mfma_f32_16x16x32_bf16 v[96:99], a[80:83], v[196:199], v[96:99]
    buffer_load_dwordx4 v[160:163], v30, s[16:19], s37 offen offset:2048 sc1
    v_mfma_f32_16x16x32_bf16 v[100:103], a[68:71], v[192:195], v[100:103]
    v_mfma_f32_16x16x32_bf16 v[100:103], a[84:87], v[196:199], v[100:103]
    v_mfma_f32_16x16x32_bf16 v[104:107], a[72:75], v[192:195], v[104:107]
    v_mfma_f32_16x16x32_bf16 v[104:107], a[88:91], v[196:199], v[104:107]
    buffer_load_dwordx4 v[164:167], v30, s[16:19], s38 offen offset:2048 sc1
    v_mfma_f32_16x16x32_bf16 v[108:111], a[76:79], v[192:195], v[108:111]
    v_mfma_f32_16x16x32_bf16 v[108:111], a[92:95], v[196:199], v[108:111]
    s_waitcnt vmcnt(8)
    v_mfma_f32_16x16x32_bf16 v[112:115], a[64:67], v[200:203], v[112:115]
    v_mfma_f32_16x16x32_bf16 v[112:115], a[80:83], v[204:207], v[112:115]
    buffer_load_dwordx4 v[168:171], v30, s[16:19], s37 offen offset:3072 sc1
    v_mfma_f32_16x16x32_bf16 v[116:119], a[68:71], v[200:203], v[116:119]
    v_mfma_f32_16x16x32_bf16 v[116:119], a[84:87], v[204:207], v[116:119]
    v_mfma_f32_16x16x32_bf16 v[120:123], a[72:75], v[200:203], v[120:123]
    v_mfma_f32_16x16x32_bf16 v[120:123], a[88:91], v[204:207], v[120:123]
    buffer_load_dwordx4 v[172:175], v30, s[16:19], s38 offen offset:3072 sc1
    v_mfma_f32_16x16x32_bf16 v[124:127], a[76:79], v[200:203], v[124:127]
    v_mfma_f32_16x16x32_bf16 v[124:127], a[92:95], v[204:207], v[124:127]
    s_waitcnt vmcnt(9)
    v_mfma_f32_16x16x32_bf16 v[96:99], a[96:99], v[208:211], v[96:99]
    s_load_dword s74, s[70:71], 28928
    s_load_dword s75, s[70:71], 30208
    v_mfma_f32_16x16x32_bf16 v[100:103], a[100:103], v[208:211], v[100:103]
    buffer_load_dwordx4 v[176:179], v31, s[16:19], s37 offen offset:0 sc1
    v_mfma_f32_16x16x32_bf16 v[104:107], a[104:107], v[208:211], v[104:107]
    s_load_dword s76, s[70:71], 31488
    v_mfma_f32_16x16x32_bf16 v[108:111], a[108:111], v[208:211], v[108:111]
    s_load_dword s77, s[70:71], 32768
    s_waitcnt vmcnt(9)
    v_mfma_f32_16x16x32_bf16 v[112:115], a[96:99], v[212:215], v[112:115]
    s_load_dword s78, s[72:73], 34048
    s_load_dword s79, s[70:71], 26368
    v_mfma_f32_16x16x32_bf16 v[116:119], a[100:103], v[212:215], v[116:119]
    buffer_load_dwordx4 v[180:183], v31, s[16:19], s38 offen offset:0 sc1
    v_mfma_f32_16x16x32_bf16 v[120:123], a[104:107], v[212:215], v[120:123]
    s_load_dword s80, s[70:71], 27648
    v_mfma_f32_16x16x32_bf16 v[124:127], a[108:111], v[212:215], v[124:127]
    s_load_dword s81, s[70:71], 27648
    s_waitcnt vmcnt(8)
    v_mfma_f32_16x16x32_bf16 v[32:35], a[0:3], v[144:147], v[32:35]
    v_mfma_f32_16x16x32_bf16 v[32:35], a[16:19], v[148:151], v[32:35]
    buffer_load_dwordx4 v[184:187], v31, s[16:19], s37 offen offset:1024 sc1
    v_mfma_f32_16x16x32_bf16 v[36:39], a[4:7], v[144:147], v[36:39]
    v_mfma_f32_16x16x32_bf16 v[36:39], a[20:23], v[148:151], v[36:39]
    v_mfma_f32_16x16x32_bf16 v[40:43], a[8:11], v[144:147], v[40:43]
    v_mfma_f32_16x16x32_bf16 v[40:43], a[24:27], v[148:151], v[40:43]
    buffer_load_dwordx4 v[188:191], v31, s[16:19], s38 offen offset:1024 sc1
    v_mfma_f32_16x16x32_bf16 v[44:47], a[12:15], v[144:147], v[44:47]
    v_mfma_f32_16x16x32_bf16 v[44:47], a[28:31], v[148:151], v[44:47]
    s_waitcnt vmcnt(8)
    v_mfma_f32_16x16x32_bf16 v[48:51], a[0:3], v[152:155], v[48:51]
    v_mfma_f32_16x16x32_bf16 v[48:51], a[16:19], v[156:159], v[48:51]
    buffer_load_dwordx4 v[192:195], v30, s[16:19], s39 offen offset:0 sc1
    v_mfma_f32_16x16x32_bf16 v[52:55], a[4:7], v[152:155], v[52:55]
    v_mfma_f32_16x16x32_bf16 v[52:55], a[20:23], v[156:159], v[52:55]
    v_mfma_f32_16x16x32_bf16 v[56:59], a[8:11], v[152:155], v[56:59]
    v_mfma_f32_16x16x32_bf16 v[56:59], a[24:27], v[156:159], v[56:59]
    buffer_load_dwordx4 v[196:199], v30, s[16:19], s67 offen offset:0 sc1
    v_mfma_f32_16x16x32_bf16 v[60:63], a[12:15], v[152:155], v[60:63]
    v_mfma_f32_16x16x32_bf16 v[60:63], a[28:31], v[156:159], v[60:63]
    s_waitcnt vmcnt(8)
    v_mfma_f32_16x16x32_bf16 v[64:67], a[0:3], v[160:163], v[64:67]
    v_mfma_f32_16x16x32_bf16 v[64:67], a[16:19], v[164:167], v[64:67]
    buffer_load_dwordx4 v[200:203], v30, s[16:19], s39 offen offset:1024 sc1
    v_mfma_f32_16x16x32_bf16 v[68:71], a[4:7], v[160:163], v[68:71]
    v_mfma_f32_16x16x32_bf16 v[68:71], a[20:23], v[164:167], v[68:71]
    v_mfma_f32_16x16x32_bf16 v[72:75], a[8:11], v[160:163], v[72:75]
    v_mfma_f32_16x16x32_bf16 v[72:75], a[24:27], v[164:167], v[72:75]
    buffer_load_dwordx4 v[204:207], v30, s[16:19], s67 offen offset:1024 sc1
    v_mfma_f32_16x16x32_bf16 v[76:79], a[12:15], v[160:163], v[76:79]
    v_mfma_f32_16x16x32_bf16 v[76:79], a[28:31], v[164:167], v[76:79]
    s_waitcnt vmcnt(8)
    v_mfma_f32_16x16x32_bf16 v[80:83], a[0:3], v[168:171], v[80:83]
    v_mfma_f32_16x16x32_bf16 v[80:83], a[16:19], v[172:175], v[80:83]
    buffer_load_dwordx4 v[208:211], v30, s[16:19], s39 offen offset:2048 sc1
    v_mfma_f32_16x16x32_bf16 v[84:87], a[4:7], v[168:171], v[84:87]
    v_mfma_f32_16x16x32_bf16 v[84:87], a[20:23], v[172:175], v[84:87]
    v_mfma_f32_16x16x32_bf16 v[88:91], a[8:11], v[168:171], v[88:91]
    s_waitcnt lgkmcnt(0)
    v_mfma_f32_16x16x32_bf16 v[88:91], a[24:27], v[172:175], v[88:91]
    buffer_load_dwordx4 v[212:215], v30, s[16:19], s67 offen offset:2048 sc1
    v_mfma_f32_16x16x32_bf16 v[92:95], a[12:15], v[168:171], v[92:95]
    s_xor_b64 s[74:75], s[74:75], s[50:51]
    v_mfma_f32_16x16x32_bf16 v[92:95], a[28:31], v[172:175], v[92:95]
    s_xor_b64 s[76:77], s[76:77], s[50:51]
    s_waitcnt vmcnt(8)
    v_mfma_f32_16x16x32_bf16 v[96:99], a[0:3], v[176:179], v[96:99]
    s_xor_b64 s[78:79], s[78:79], s[50:51]
    v_mfma_f32_16x16x32_bf16 v[96:99], a[16:19], v[180:183], v[96:99]
    buffer_load_dwordx4 v[144:147], v30, s[16:19], s39 offen offset:3072 sc1
    v_mfma_f32_16x16x32_bf16 v[100:103], a[4:7], v[176:179], v[100:103]
    s_xor_b64 s[80:81], s[80:81], s[50:51]
    v_mfma_f32_16x16x32_bf16 v[100:103], a[20:23], v[180:183], v[100:103]
    s_or_b64 s[74:75], s[74:75], s[76:77]
    v_mfma_f32_16x16x32_bf16 v[104:107], a[8:11], v[176:179], v[104:107]
    s_or_b64 s[74:75], s[74:75], s[78:79]
    v_mfma_f32_16x16x32_bf16 v[104:107], a[24:27], v[180:183], v[104:107]
    buffer_load_dwordx4 v[148:151], v30, s[16:19], s67 offen offset:3072 sc1
    v_mfma_f32_16x16x32_bf16 v[108:111], a[12:15], v[176:179], v[108:111]
    s_or_b64 s[74:75], s[74:75], s[80:81]
    s_cbranch_scc1 L_slow_f1c1
L_ok_f1c1:
    v_mfma_f32_16x16x32_bf16 v[108:111], a[28:31], v[180:183], v[108:111]
    s_waitcnt vmcnt(8)
    v_mfma_f32_16x16x32_bf16 v[112:115], a[0:3], v[184:187], v[112:115]
    v_and_b32 v1, 15, v0
    v_mfma_f32_16x16x32_bf16 v[112:115], a[16:19], v[188:191], v[112:115]
    buffer_load_dwordx4 v[152:155], v30, s[16:19], s59 offen offset:2048 sc1
    v_mfma_f32_16x16x32_bf16 v[116:119], a[4:7], v[184:187], v[116:119]
    v_lshrrev_b32 v2, 4, v0
    v_mfma_f32_16x16x32_bf16 v[116:119], a[20:23], v[188:191], v[116:119]
    v_and_b32 v3, 7, v0
    v_mfma_f32_16x16x32_bf16 v[120:123], a[8:11], v[184:187], v[120:123]
    v_xor_b32 v2, v2, v3
    v_mfma_f32_16x16x32_bf16 v[120:123], a[24:27], v[188:191], v[120:123]
    buffer_load_dwordx4 v[156:159], v30, s[16:19], s66 offen offset:2048 sc1
    v_mfma_f32_16x16x32_bf16 v[124:127], a[12:15], v[184:187], v[124:127]
    v_lshlrev_b32 v2, 4, v2
    v_mfma_f32_16x16x32_bf16 v[124:127], a[28:31], v[188:191], v[124:127]
    v_lshl_add_u32 v1, v1, 8, v2
    s_waitcnt vmcnt(8)
    v_mfma_f32_16x16x32_bf16 v[32:35], a[32:35], v[192:195], v[32:35]
    v_add_u32 v16, s45, v1
    v_mfma_f32_16x16x32_bf16 v[32:35], a[176:179], v[196:199], v[32:35]
    buffer_load_dwordx4 v[160:163], v30, s[16:19], s59 offen offset:3072 sc1
    v_mfma_f32_16x16x32_bf16 v[36:39], a[36:39], v[192:195], v[36:39]
    v_xor_b32 v17, 64, v16
    v_mfma_f32_16x16x32_bf16 v[36:39], a[180:183], v[196:199], v[36:39]
    v_lshrrev_b32 v1, 3, v0
    v_mfma_f32_16x16x32_bf16 v[40:43], a[40:43], v[192:195], v[40:43]
    v_lshlrev_b32 v2, 1, v3
    v_mfma_f32_16x16x32_bf16 v[40:43], a[184:187], v[196:199], v[40:43]
    buffer_load_dwordx4 v[164:167], v30, s[16:19], s66 offen offset:3072 sc1
    v_mfma_f32_16x16x32_bf16 v[44:47], a[44:47], v[192:195], v[44:47]
    v_xor_b32 v2, v2, v1
    v_mfma_f32_16x16x32_bf16 v[44:47], a[188:191], v[196:199], v[44:47]
    v_lshlrev_b32 v2, 4, v2
    s_waitcnt vmcnt(8)
    v_mfma_f32_16x16x32_bf16 v[48:51], a[32:35], v[200:203], v[48:51]
    s_lshl_b32 s61, s36, 3
    v_mfma_f32_16x16x32_bf16 v[48:51], a[176:179], v[204:207], v[48:51]
    buffer_load_dwordx4 v[168:171], v31, s[16:19], s67 offen offset:0 sc1
    v_mfma_f32_16x16x32_bf16 v[52:55], a[36:39], v[200:203], v[52:55]
    v_add_u32 v1, s61, v1
    v_mfma_f32_16x16x32_bf16 v[52:55], a[180:183], v[204:207], v[52:55]
    v_lshl_add_u32 v8, v1, 8, v2
    v_mfma_f32_16x16x32_bf16 v[56:59], a[40:43], v[200:203], v[56:59]
    v_xor_b32 v9, 16, v8
    v_mfma_f32_16x16x32_bf16 v[56:59], a[184:187], v[204:207], v[56:59]
    buffer_load_dwordx4 v[172:175], v31, s[16:19], s68 offen offset:0 sc1
    v_mfma_f32_16x16x32_bf16 v[60:63], a[44:47], v[200:203], v[60:63]
    v_add_u32 v10, 65536, v8
    v_mfma_f32_16x16x32_bf16 v[60:63], a[188:191], v[204:207], v[60:63]
    v_add_u32 v11, 65536, v9
    s_waitcnt vmcnt(8)
    v_mfma_f32_16x16x32_bf16 v[64:67], a[32:35], v[208:211], v[64:67]
    v_mul_u32_u24 v1, 1280, v1
    v_mfma_f32_16x16x32_bf16 v[64:67], a[176:179], v[212:215], v[64:67]
    buffer_load_dwordx4 v[176:179], v31, s[16:19], s67 offen offset:1024 sc1
    v_mfma_f32_16x16x32_bf16 v[68:71], a[36:39], v[208:211], v[68:71]
    v_lshl_add_u32 v18, v3, 4, v1
    v_mfma_f32_16x16x32_bf16 v[68:71], a[180:183], v[212:215], v[68:71]
    v_mfma_f32_16x16x32_bf16 v[72:75], a[40:43], v[208:211], v[72:75]
    v_mfma_f32_16x16x32_bf16 v[72:75], a[184:187], v[212:215], v[72:75]
    buffer_load_dwordx4 v[180:183], v31, s[16:19], s68 offen offset:1024 sc1
    v_mfma_f32_16x16x32_bf16 v[76:79], a[44:47], v[208:211], v[76:79]
    v_mfma_f32_16x16x32_bf16 v[76:79], a[188:191], v[212:215], v[76:79]
    s_waitcnt vmcnt(8)
    v_mfma_f32_16x16x32_bf16 v[80:83], a[32:35], v[144:147], v[80:83]
    v_mfma_f32_16x16x32_bf16 v[80:83], a[176:179], v[148:151], v[80:83]
    buffer_load_dwordx4 v[184:187], v31, s[16:19], s69 offen offset:0 sc1
    v_mfma_f32_16x16x32_bf16 v[84:87], a[36:39], v[144:147], v[84:87]
    v_mfma_f32_16x16x32_bf16 v[84:87], a[180:183], v[148:151], v[84:87]
    v_mfma_f32_16x16x32_bf16 v[88:91], a[40:43], v[144:147], v[88:91]
    v_mfma_f32_16x16x32_bf16 v[88:91], a[184:187], v[148:151], v[88:91]
    buffer_load_dwordx4 v[188:191], v31, s[16:19], s69 offen offset:1024 sc1
    v_mfma_f32_16x16x32_bf16 v[92:95], a[44:47], v[144:147], v[92:95]
    v_mfma_f32_16x16x32_bf16 v[92:95], a[188:191], v[148:151], v[92:95]
    s_waitcnt vmcnt(8)
    v_mfma_f32_16x16x32_bf16 v[64:67], a[144:147], v[152:155], v[64:67]
    s_load_dword s74, s[70:71], 26496
    s_load_dword s75, s[70:71], 21376
    v_mfma_f32_16x16x32_bf16 v[64:67], a[160:163], v[156:159], v[64:67]
    buffer_load_dwordx4 v[192:195], v30, s[16:19], s57 offen offset:0 sc1
    v_mfma_f32_16x16x32_bf16 v[68:71], a[148:151], v[152:155], v[68:71]
    s_load_dword s76, s[70:71], 22656
    v_mfma_f32_16x16x32_bf16 v[68:71], a[164:167], v[156:159], v[68:71]
    s_load_dword s77, s[70:71], 23936
    v_mfma_f32_16x16x32_bf16 v[72:75], a[152:155], v[152:155], v[72:75]
    s_load_dword s78, s[70:71], 25216
    s_load_dword s79, s[70:71], 27776
    v_mfma_f32_16x16x32_bf16 v[72:75], a[168:171], v[156:159], v[72:75]
    buffer_load_dwordx4 v[196:199], v30, s[16:19], s58 offen offset:0 sc1
    v_mfma_f32_16x16x32_bf16 v[76:79], a[156:159], v[152:155], v[76:79]
    s_load_dword s80, s[70:71], 29056
    v_mfma_f32_16x16x32_bf16 v[76:79], a[172:175], v[156:159], v[76:79]
    s_load_dword s81, s[70:71], 30336
    s_waitcnt vmcnt(8)
    v_mfma_f32_16x16x32_bf16 v[80:83], a[144:147], v[160:163], v[80:83]
    v_mfma_f32_16x16x32_bf16 v[80:83], a[160:163], v[164:167], v[80:83]
    buffer_load_dwordx4 v[200:203], v30, s[16:19], s57 offen offset:1024 sc1
    v_mfma_f32_16x16x32_bf16 v[84:87], a[148:151], v[160:163], v[84:87]
    v_mfma_f32_16x16x32_bf16 v[84:87], a[164:167], v[164:167], v[84:87]
    v_mfma_f32_16x16x32_bf16 v[88:91], a[152:155], v[160:163], v[88:91]
    v_mfma_f32_16x16x32_bf16 v[88:91], a[168:171], v[164:167], v[88:91]
    buffer_load_dwordx4 v[204:207], v30, s[16:19], s58 offen offset:1024 sc1
    v_mfma_f32_16x16x32_bf16 v[92:95], a[156:159], v[160:163], v[92:95]
    v_mfma_f32_16x16x32_bf16 v[92:95], a[172:175], v[164:167], v[92:95]
    s_waitcnt vmcnt(8)
    v_mfma_f32_16x16x32_bf16 v[96:99], a[176:179], v[168:171], v[96:99]
    v_mfma_f32_16x16x32_bf16 v[96:99], a[192:195], v[172:175], v[96:99]
    buffer_load_dwordx4 v[208:211], v30, s[16:19], s57 offen offset:2048 sc1
    v_mfma_f32_16x16x32_bf16 v[100:103], a[180:183], v[168:171], v[100:103]
    v_mfma_f32_16x16x32_bf16 v[100:103], a[196:199], v[172:175], v[100:103]
    v_mfma_f32_16x16x32_bf16 v[104:107], a[184:187], v[168:171], v[104:107]
    v_mfma_f32_16x16x32_bf16 v[104:107], a[200:203], v[172:175], v[104:107]
    buffer_load_dwordx4 v[212:215], v30, s[16:19], s58 offen offset:2048 sc1
    v_mfma_f32_16x16x32_bf16 v[108:111], a[188:191], v[168:171], v[108:111]
    v_mfma_f32_16x16x32_bf16 v[108:111], a[204:207], v[172:175], v[108:111]
    s_waitcnt vmcnt(8)
    v_mfma_f32_16x16x32_bf16 v[112:115], a[176:179], v[176:179], v[112:115]
    v_mfma_f32_16x16x32_bf16 v[112:115], a[192:195], v[180:183], v[112:115]
    buffer_load_dwordx4 v[144:147], v30, s[16:19], s57 offen offset:3072 sc1
    v_mfma_f32_16x16x32_bf16 v[116:119], a[180:183], v[176:179], v[116:119]
    v_mfma_f32_16x16x32_bf16 v[116:119], a[196:199], v[180:183], v[116:119]
    v_mfma_f32_16x16x32_bf16 v[120:123], a[184:187], v[176:179], v[120:123]
    v_mfma_f32_16x16x32_bf16 v[120:123], a[200:203], v[180:183], v[120:123]
    buffer_load_dwordx4 v[148:151], v30, s[16:19], s58 offen offset:3072 sc1
    v_mfma_f32_16x16x32_bf16 v[124:127], a[188:191], v[176:179], v[124:127]
    v_mfma_f32_16x16x32_bf16 v[124:127], a[204:207], v[180:183], v[124:127]
    s_waitcnt vmcnt(9)
    v_mfma_f32_16x16x32_bf16 v[96:99], a[208:211], v[184:187], v[96:99]
    v_mfma_f32_16x16x32_bf16 v[100:103], a[212:215], v[184:187], v[100:103]
    buffer_load_dwordx4 v[152:155], v30, s[16:19], s59 offen offset:0 sc1
    v_mfma_f32_16x16x32_bf16 v[104:107], a[216:219], v[184:187], v[104:107]
    v_mfma_f32_16x16x32_bf16 v[108:111], a[220:223], v[184:187], v[108:111]
    s_waitcnt vmcnt(9)
    v_mfma_f32_16x16x32_bf16 v[112:115], a[208:211], v[188:191], v[112:115]
    s_waitcnt lgkmcnt(0)
    v_mfma_f32_16x16x32_bf16 v[116:119], a[212:215], v[188:191], v[116:119]
    buffer_load_dwordx4 v[156:159], v30, s[16:19], s66 offen offset:0 sc1
    v_mfma_f32_16x16x32_bf16 v[120:123], a[216:219], v[188:191], v[120:123]
    s_xor_b64 s[74:75], s[74:75], s[50:51]
    v_mfma_f32_16x16x32_bf16 v[124:127], a[220:223], v[188:191], v[124:127]
    s_xor_b64 s[76:77], s[76:77], s[50:51]
    s_waitcnt vmcnt(8)
    v_mfma_f32_16x16x32_bf16 v[32:35], a[112:115], v[192:195], v[32:35]
    s_xor_b64 s[78:79], s[78:79], s[50:51]
    v_mfma_f32_16x16x32_bf16 v[32:35], a[128:131], v[196:199], v[32:35]
    buffer_load_dwordx4 v[160:163], v30, s[16:19], s59 offen offset:1024 sc1
    v_mfma_f32_16x16x32_bf16 v[36:39], a[116:119], v[192:195], v[36:39]
    s_xor_b64 s[80:81], s[80:81], s[50:51]
    v_mfma_f32_16x16x32_bf16 v[36:39], a[132:135], v[196:199], v[36:39]
    s_or_b64 s[74:75], s[74:75], s[76:77]
    v_mfma_f32_16x16x32_bf16 v[40:43], a[120:123], v[192:195], v[40:43]
    s_or_b64 s[74:75], s[74:75], s[78:79]
    v_mfma_f32_16x16x32_bf16 v[40:43], a[136:139], v[196:199], v[40:43]
    buffer_load_dwordx4 v[164:167], v30, s[16:19], s66 offen offset:1024 sc1
    v_mfma_f32_16x16x32_bf16 v[44:47], a[124:127], v[192:195], v[44:47]
    s_or_b64 s[74:75], s[74:75], s[80:81]
    s_cbranch_scc1 L_slow_f1c2
L_ok_f1c2:
    v_mfma_f32_16x16x32_bf16 v[44:47], a[140:143], v[196:199], v[44:47]
    s_waitcnt vmcnt(8)
    v_mfma_f32_16x16x32_bf16 v[48:51], a[112:115], v[200:203], v[48:51]
    v_mfma_f32_16x16x32_bf16 v[48:51], a[128:131], v[204:207], v[48:51]
    buffer_load_dwordx4 v[168:171], v31, s[16:19], s57 offen offset:0 sc1
    v_mfma_f32_16x16x32_bf16 v[52:55], a[116:119], v[200:203], v[52:55]
    v_mfma_f32_16x16x32_bf16 v[52:55], a[132:135], v[204:207], v[52:55]
    v_mfma_f32_16x16x32_bf16 v[56:59], a[120:123], v[200:203], v[56:59]
    v_mfma_f32_16x16x32_bf16 v[56:59], a[136:139], v[204:207], v[56:59]
    buffer_load_dwordx4 v[172:175], v31, s[16:19], s57 offen offset:1024 sc1
    v_mfma_f32_16x16x32_bf16 v[60:63], a[124:127], v[200:203], v[60:63]
    v_mfma_f32_16x16x32_bf16 v[60:63], a[140:143], v[204:207], v[60:63]
    s_waitcnt vmcnt(8)
    v_mfma_f32_16x16x32_bf16 v[64:67], a[112:115], v[208:211], v[64:67]
    v_mfma_f32_16x16x32_bf16 v[64:67], a[128:131], v[212:215], v[64:67]
    buffer_load_dwordx4 v[176:179], v30, s[16:19], s40 offen offset:0 sc1
    v_mfma_f32_16x16x32_bf16 v[68:71], a[116:119], v[208:211], v[68:71]
    v_mfma_f32_16x16x32_bf16 v[68:71], a[132:135], v[212:215], v[68:71]
    v_mfma_f32_16x16x32_bf16 v[72:75], a[120:123], v[208:211], v[72:75]
    v_mfma_f32_16x16x32_bf16 v[72:75], a[136:139], v[212:215], v[72:75]
    buffer_load_dwordx4 v[180:183], v30, s[16:19], s40 offen offset:1024 sc1
    v_mfma_f32_16x16x32_bf16 v[76:79], a[124:127], v[208:211], v[76:79]
    v_mfma_f32_16x16x32_bf16 v[76:79], a[140:143], v[212:215], v[76:79]
    s_waitcnt vmcnt(8)
    v_mfma_f32_16x16x32_bf16 v[80:83], a[112:115], v[144:147], v[80:83]
    v_mfma_f32_16x16x32_bf16 v[80:83], a[128:131], v[148:151], v[80:83]
    buffer_load_dwordx4 v[184:187], v30, s[16:19], s41 offen offset:0 sc1
    v_mfma_f32_16x16x32_bf16 v[84:87], a[116:119], v[144:147], v[84:87]
    v_mfma_f32_16x16x32_bf16 v[84:87], a[132:135], v[148:151], v[84:87]
    v_mfma_f32_16x16x32_bf16 v[88:91], a[120:123], v[144:147], v[88:91]
    s_load_dword s74, s[70:71], 21504
    s_load_dword s75, s[70:71], 22784
    v_mfma_f32_16x16x32_bf16 v[88:91], a[136:139], v[148:151], v[88:91]
    buffer_load_dwordx4 v[188:191], v30, s[16:19], s42 offen offset:0 sc1
    v_mfma_f32_16x16x32_bf16 v[92:95], a[124:127], v[144:147], v[92:95]
    s_load_dword s76, s[70:71], 24064
    v_mfma_f32_16x16x32_bf16 v[92:95], a[140:143], v[148:151], v[92:95]
    s_load_dword s77, s[70:71], 25344
    s_waitcnt vmcnt(8)
    v_mfma_f32_16x16x32_bf16 v[32:35], a[144:147], v[152:155], v[32:35]
    v_mfma_f32_16x16x32_bf16 v[32:35], a[160:163], v[156:159], v[32:35]
    buffer_load_dwordx4 v[192:195], v30, s[16:19], s49 offen offset:0 sc1
    v_mfma_f32_16x16x32_bf16 v[36:39], a[148:151], v[152:155], v[36:39]
    v_mfma_f32_16x16x32_bf16 v[36:39], a[164:167], v[156:159], v[36:39]
    v_mfma_f32_16x16x32_bf16 v[40:43], a[152:155], v[152:155], v[40:43]
    v_mfma_f32_16x16x32_bf16 v[40:43], a[168:171], v[156:159], v[40:43]
    buffer_load_dwordx4 v[196:199], v30, s[16:19], s41 offen offset:1024 sc1
    v_mfma_f32_16x16x32_bf16 v[44:47], a[156:159], v[152:155], v[44:47]
    v_mfma_f32_16x16x32_bf16 v[44:47], a[172:175], v[156:159], v[44:47]
    s_waitcnt vmcnt(8)
    v_mfma_f32_16x16x32_bf16 v[48:51], a[144:147], v[160:163], v[48:51]
    v_mfma_f32_16x16x32_bf16 v[48:51], a[160:163], v[164:167], v[48:51]
    buffer_load_dwordx4 v[200:203], v30, s[16:19], s42 offen offset:1024 sc1
    v_mfma_f32_16x16x32_bf16 v[52:55], a[148:151], v[160:163], v[52:55]
    v_mfma_f32_16x16x32_bf16 v[52:55], a[164:167], v[164:167], v[52:55]
    v_mfma_f32_16x16x32_bf16 v[56:59], a[152:155], v[160:163], v[56:59]
    v_mfma_f32_16x16x32_bf16 v[56:59], a[168:171], v[164:167], v[56:59]
    buffer_load_dwordx4 v[204:207], v30, s[16:19], s49 offen offset:1024 sc1
    v_mfma_f32_16x16x32_bf16 v[60:63], a[156:159], v[160:163], v[60:63]
    v_mfma_f32_16x16x32_bf16 v[60:63], a[172:175], v[164:167], v[60:63]
    s_waitcnt vmcnt(9)
    v_mfma_f32_16x16x32_bf16 v[96:99], a[112:115], v[168:171], v[96:99]
    v_mfma_f32_16x16x32_bf16 v[100:103], a[116:119], v[168:171], v[100:103]
    buffer_load_dwordx4 v[208:211], v31, s[16:19], s58 offen offset:0 sc1
    v_mfma_f32_16x16x32_bf16 v[104:107], a[120:123], v[168:171], v[104:107]
    v_mfma_f32_16x16x32_bf16 v[108:111], a[124:127], v[168:171], v[108:111]
    s_waitcnt vmcnt(9)
    v_mfma_f32_16x16x32_bf16 v[112:115], a[112:115], v[172:175], v[112:115]
    v_mfma_f32_16x16x32_bf16 v[116:119], a[116:119], v[172:175], v[116:119]
    buffer_load_dwordx4 v[212:215], v31, s[16:19], s59 offen offset:0 sc1
    v_mfma_f32_16x16x32_bf16 v[120:123], a[120:123], v[172:175], v[120:123]
    v_mfma_f32_16x16x32_bf16 v[124:127], a[124:127], v[172:175], v[124:127]
    s_waitcnt vmcnt(9)
    v_mfma_f32_16x16x32_bf16 v[32:35], a[48:51], v[176:179], v[32:35]
    v_mfma_f32_16x16x32_bf16 v[36:39], a[52:55], v[176:179], v[36:39]
    buffer_load_dwordx4 v[144:147], v31, s[16:19], s66 offen offset:0 sc1
    v_mfma_f32_16x16x32_bf16 v[40:43], a[56:59], v[176:179], v[40:43]
    v_mfma_f32_16x16x32_bf16 v[44:47], a[60:63], v[176:179], v[44:47]
    s_waitcnt vmcnt(9)
    v_mfma_f32_16x16x32_bf16 v[48:51], a[48:51], v[180:183], v[48:51]
    v_mfma_f32_16x16x32_bf16 v[52:55], a[52:55], v[180:183], v[52:55]
    buffer_load_dwordx4 v[148:151], v31, s[16:19], s58 offen offset:1024 sc1
    v_mfma_f32_16x16x32_bf16 v[56:59], a[56:59], v[180:183], v[56:59]
    v_mfma_f32_16x16x32_bf16 v[60:63], a[60:63], v[180:183], v[60:63]
    s_waitcnt vmcnt(7)
    v_mfma_f32_16x16x32_bf16 v[32:35], a[64:67], v[184:187], v[32:35]
    s_waitcnt lgkmcnt(0)
    v_mfma_f32_16x16x32_bf16 v[32:35], a[80:83], v[188:191], v[32:35]
    buffer_load_dwordx4 v[152:155], v31, s[16:19], s59 offen offset:1024 sc1
    v_mfma_f32_16x16x32_bf16 v[32:35], a[96:99], v[192:195], v[32:35]
    s_xor_b64 s[74:75], s[74:75], s[50:51]
    v_mfma_f32_16x16x32_bf16 v[36:39], a[68:71], v[184:187], v[36:39]
    s_xor_b64 s[76:77], s[76:77], s[50:51]
    v_mfma_f32_16x16x32_bf16 v[36:39], a[84:87], v[188:191], v[36:39]
    s_or_b64 s[74:75], s[74:75], s[76:77]
    s_cbranch_scc1 L_slow_f1c3
L_ok_f1c3:
    v_mfma_f32_16x16x32_bf16 v[36:39], a[100:103], v[192:195], v[36:39]
    buffer_load_dwordx4 v[156:159], v31, s[16:19], s66 offen offset:1024 sc1
    v_mfma_f32_16x16x32_bf16 v[40:43], a[72:75], v[184:187], v[40:43]
    v_mfma_f32_16x16x32_bf16 v[40:43], a[88:91], v[188:191], v[40:43]
    ds_write_b128 v16, v[32:35] offset:0
    v_mfma_f32_16x16x32_bf16 v[40:43], a[104:107], v[192:195], v[40:43]
    v_mfma_f32_16x16x32_bf16 v[44:47], a[76:79], v[184:187], v[44:47]
    buffer_load_dwordx4 v[160:163], v30, s[16:19], s40 offen offset:2048 sc1
    v_mfma_f32_16x16x32_bf16 v[44:47], a[92:95], v[188:191], v[44:47]
    s_nop 0
    ds_write_b128 v17, v[36:39] offset:0
    v_mfma_f32_16x16x32_bf16 v[44:47], a[108:111], v[192:195], v[44:47]
    s_waitcnt vmcnt(7)
    v_mfma_f32_16x16x32_bf16 v[48:51], a[64:67], v[196:199], v[48:51]
    v_mfma_f32_16x16x32_bf16 v[48:51], a[80:83], v[200:203], v[48:51]
    buffer_load_dwordx4 v[164:167], v30, s[16:19], s41 offen offset:2048 sc1
    v_mfma_f32_16x16x32_bf16 v[48:51], a[96:99], v[204:207], v[48:51]
    ds_write_b128 v16, v[40:43] offset:128
    v_mfma_f32_16x16x32_bf16 v[52:55], a[68:71], v[196:199], v[52:55]
    v_mfma_f32_16x16x32_bf16 v[52:55], a[84:87], v[200:203], v[52:55]
    s_nop 0
    ds_write_b128 v17, v[44:47] offset:128
    v_mfma_f32_16x16x32_bf16 v[52:55], a[100:103], v[204:207], v[52:55]
    buffer_load_dwordx4 v[168:171], v30, s[16:19], s42 offen offset:2048 sc1
    v_mfma_f32_16x16x32_bf16 v[56:59], a[72:75], v[196:199], v[56:59]
    v_mfma_f32_16x16x32_bf16 v[56:59], a[88:91], v[200:203], v[56:59]
    ds_write_b128 v16, v[48:51] offset:4096
    v_mfma_f32_16x16x32_bf16 v[56:59], a[104:107], v[204:207], v[56:59]
    v_mfma_f32_16x16x32_bf16 v[60:63], a[76:79], v[196:199], v[60:63]
    buffer_load_dwordx4 v[172:175], v30, s[16:19], s49 offen offset:2048 sc1
    v_mfma_f32_16x16x32_bf16 v[60:63], a[92:95], v[200:203], v[60:63]
    s_nop 0
    ds_write_b128 v17, v[52:55] offset:4096
    v_mfma_f32_16x16x32_bf16 v[60:63], a[108:111], v[204:207], v[60:63]
    s_waitcnt vmcnt(7)
    v_mfma_f32_16x16x32_bf16 v[96:99], a[128:131], v[208:211], v[96:99]
    v_mfma_f32_16x16x32_bf16 v[96:99], a[144:147], v[212:215], v[96:99]
    buffer_load_dwordx4 v[176:179], v30, s[16:19], s40 offen offset:3072 sc1
    v_mfma_f32_16x16x32_bf16 v[96:99], a[160:163], v[144:147], v[96:99]
    ds_write_b128 v16, v[56:59] offset:4224
    v_mfma_f32_16x16x32_bf16 v[100:103], a[132:135], v[208:211], v[100:103]
    v_mfma_f32_16x16x32_bf16 v[100:103], a[148:151], v[212:215], v[100:103]
    s_nop 0
    ds_write_b128 v17, v[60:63] offset:4224
    v_mfma_f32_16x16x32_bf16 v[100:103], a[164:167], v[144:147], v[100:103]
    buffer_load_dwordx4 v[180:183], v30, s[16:19], s41 offen offset:3072 sc1
    v_mfma_f32_16x16x32_bf16 v[104:107], a[136:139], v[208:211], v[104:107]
    v_mfma_f32_16x16x32_bf16 v[104:107], a[152:155], v[212:215], v[104:107]
    ds_write_b128 v16, v[96:99] offset:16384
    v_mfma_f32_16x16x32_bf16 v[104:107], a[168:171], v[144:147], v[104:107]
    v_mfma_f32_16x16x32_bf16 v[108:111], a[140:143], v[208:211], v[108:111]
    buffer_load_dwordx4 v[184:187], v30, s[16:19], s42 offen offset:3072 sc1
    v_mfma_f32_16x16x32_bf16 v[108:111], a[156:159], v[212:215], v[108:111]
    s_nop 0
    ds_write_b128 v17, v[100:103] offset:16384
    v_mfma_f32_16x16x32_bf16 v[108:111], a[172:175], v[144:147], v[108:111]
    s_waitcnt vmcnt(7)
    v_mfma_f32_16x16x32_bf16 v[112:115], a[128:131], v[148:151], v[112:115]
    v_mfma_f32_16x16x32_bf16 v[112:115], a[144:147], v[152:155], v[112:115]
    buffer_load_dwordx4 v[188:191], v30, s[16:19], s49 offen offset:3072 sc1
    v_mfma_f32_16x16x32_bf16 v[112:115], a[160:163], v[156:159], v[112:115]
    ds_write_b128 v16, v[104:107] offset:16512
    v_mfma_f32_16x16x32_bf16 v[116:119], a[132:135], v[148:151], v[116:119]
    v_mfma_f32_16x16x32_bf16 v[116:119], a[148:151], v[152:155], v[116:119]
    s_nop 0
    ds_write_b128 v17, v[108:111] offset:16512
    v_mfma_f32_16x16x32_bf16 v[116:119], a[164:167], v[156:159], v[116:119]
    v_mfma_f32_16x16x32_bf16 v[120:123], a[136:139], v[148:151], v[120:123]
    v_mfma_f32_16x16x32_bf16 v[120:123], a[152:155], v[152:155], v[120:123]
    s_nop 0
    ds_write_b128 v16, v[112:115] offset:20480
    v_mfma_f32_16x16x32_bf16 v[120:123], a[168:171], v[156:159], v[120:123]
    v_mfma_f32_16x16x32_bf16 v[124:127], a[140:143], v[148:151], v[124:127]
    v_mfma_f32_16x16x32_bf16 v[124:127], a[156:159], v[152:155], v[124:127]
    s_nop 1
    ds_write_b128 v17, v[116:119] offset:20480
    v_mfma_f32_16x16x32_bf16 v[124:127], a[172:175], v[156:159], v[124:127]
    s_waitcnt vmcnt(6)
    v_mfma_f32_16x16x32_bf16 v[64:67], a[48:51], v[160:163], v[64:67]
    v_mfma_f32_16x16x32_bf16 v[64:67], a[64:67], v[164:167], v[64:67]
    ds_write_b128 v16, v[120:123] offset:20608
    v_mfma_f32_16x16x32_bf16 v[68:71], a[52:55], v[160:163], v[68:71]
    v_mfma_f32_16x16x32_bf16 v[68:71], a[68:71], v[164:167], v[68:71]
    v_mfma_f32_16x16x32_bf16 v[72:75], a[56:59], v[160:163], v[72:75]
    s_nop 1
    ds_write_b128 v17, v[124:127] offset:20608
    v_mfma_f32_16x16x32_bf16 v[72:75], a[72:75], v[164:167], v[72:75]
    v_mfma_f32_16x16x32_bf16 v[76:79], a[60:63], v[160:163], v[76:79]
    v_mfma_f32_16x16x32_bf16 v[76:79], a[76:79], v[164:167], v[76:79]
    s_waitcnt vmcnt(4)
    v_mfma_f32_16x16x32_bf16 v[64:67], a[80:83], v[168:171], v[64:67]
    v_mfma_f32_16x16x32_bf16 v[64:67], a[96:99], v[172:175], v[64:67]
    v_mfma_f32_16x16x32_bf16 v[68:71], a[84:87], v[168:171], v[68:71]
    v_mfma_f32_16x16x32_bf16 v[68:71], a[100:103], v[172:175], v[68:71]
    v_mfma_f32_16x16x32_bf16 v[72:75], a[88:91], v[168:171], v[72:75]
    v_mfma_f32_16x16x32_bf16 v[72:75], a[104:107], v[172:175], v[72:75]
    v_mfma_f32_16x16x32_bf16 v[76:79], a[92:95], v[168:171], v[76:79]
    s_nop 3
    ds_write_b128 v16, v[64:67] offset:8192
    v_mfma_f32_16x16x32_bf16 v[76:79], a[108:111], v[172:175], v[76:79]
    s_waitcnt vmcnt(2)
    v_mfma_f32_16x16x32_bf16 v[80:83], a[48:51], v[176:179], v[80:83]
    ds_write_b128 v17, v[68:71] offset:8192
    v_mfma_f32_16x16x32_bf16 v[80:83], a[64:67], v[180:183], v[80:83]
    v_mfma_f32_16x16x32_bf16 v[84:87], a[52:55], v[176:179], v[84:87]
    ds_write_b128 v16, v[72:75] offset:8320
    v_mfma_f32_16x16x32_bf16 v[84:87], a[68:71], v[180:183], v[84:87]
    v_mfma_f32_16x16x32_bf16 v[88:91], a[56:59], v[176:179], v[88:91]
    s_nop 0
    ds_write_b128 v17, v[76:79] offset:8320
    v_mfma_f32_16x16x32_bf16 v[88:91], a[72:75], v[180:183], v[88:91]
    v_mfma_f32_16x16x32_bf16 v[92:95], a[60:63], v[176:179], v[92:95]
    v_mfma_f32_16x16x32_bf16 v[92:95], a[76:79], v[180:183], v[92:95]
    s_waitcnt vmcnt(0)
    v_mfma_f32_16x16x32_bf16 v[80:83], a[80:83], v[184:187], v[80:83]
    v_mfma_f32_16x16x32_bf16 v[80:83], a[96:99], v[188:191], v[80:83]
    v_mfma_f32_16x16x32_bf16 v[84:87], a[84:87], v[184:187], v[84:87]
    v_mfma_f32_16x16x32_bf16 v[84:87], a[100:103], v[188:191], v[84:87]
    v_mfma_f32_16x16x32_bf16 v[88:91], a[88:91], v[184:187], v[88:91]
    v_mfma_f32_16x16x32_bf16 v[88:91], a[104:107], v[188:191], v[88:91]
    v_mfma_f32_16x16x32_bf16 v[92:95], a[92:95], v[184:187], v[92:95]
    s_nop 3
    ds_write_b128 v16, v[80:83] offset:12288
    v_mfma_f32_16x16x32_bf16 v[92:95], a[108:111], v[188:191], v[92:95]
    ds_write_b128 v17, v[84:87] offset:12288
    s_nop 0
    ds_write_b128 v16, v[88:91] offset:12416
    s_nop 5
    ds_write_b128 v17, v[92:95] offset:12416
    s_waitcnt lgkmcnt(0)
    s_barrier
    ds_read_b128 v[32:35], v8 offset:0
    ds_read_b128 v[36:39], v9 offset:0
    ds_read_b128 v[40:43], v8 offset:32768
    ds_read_b128 v[44:47], v9 offset:32768
    ds_read_b128 v[48:51], v10 offset:0
    ds_read_b128 v[52:55], v11 offset:0
    ds_read_b128 v[56:59], v10 offset:32768
    ds_read_b128 v[60:63], v11 offset:32768
    ds_read_b128 v[64:67], v8 offset:8192
    ds_read_b128 v[68:71], v9 offset:8192
    ds_read_b128 v[72:75], v8 offset:40960
    ds_read_b128 v[76:79], v9 offset:40960
    ds_read_b128 v[80:83], v10 offset:8192
    ds_read_b128 v[84:87], v11 offset:8192
    ds_read_b128 v[88:91], v10 offset:40960
    ds_read_b128 v[92:95], v11 offset:40960
    s_waitcnt lgkmcnt(12)
    v_pk_add_f32 v[32:33], v[32:33], v[40:41]
    v_pk_add_f32 v[34:35], v[34:35], v[42:43]
    v_pk_add_f32 v[36:37], v[36:37], v[44:45]
    v_pk_add_f32 v[38:39], v[38:39], v[46:47]
    s_waitcnt lgkmcnt(8)
    ds_read_b128 v[96:99], v8 offset:16384
    ds_read_b128 v[100:103], v9 offset:16384
    ds_read_b128 v[104:107], v8 offset:49152
    ds_read_b128 v[108:111], v9 offset:49152
    ds_read_b128 v[112:115], v10 offset:16384
    ds_read_b128 v[116:119], v11 offset:16384
    ds_read_b128 v[120:123], v10 offset:49152
    ds_read_b128 v[124:127], v11 offset:49152
    v_pk_add_f32 v[48:49], v[48:49], v[56:57]
    v_pk_add_f32 v[50:51], v[50:51], v[58:59]
    v_pk_add_f32 v[52:53], v[52:53], v[60:61]
    v_pk_add_f32 v[54:55], v[54:55], v[62:63]
    v_pk_add_f32 v[32:33], v[32:33], v[48:49]
    v_pk_add_f32 v[34:35], v[34:35], v[50:51]
    v_pk_add_f32 v[36:37], v[36:37], v[52:53]
    v_pk_add_f32 v[38:39], v[38:39], v[54:55]
    v_cvt_pk_bf16_f32 v40, v32, v33
    v_cvt_pk_bf16_f32 v41, v34, v35
    v_cvt_pk_bf16_f32 v42, v36, v37
    v_cvt_pk_bf16_f32 v43, v38, v39
    buffer_store_dwordx4 v[40:43], v18, s[24:27], s53 offen nt
    s_add_u32 s53, s53, 40960
    s_waitcnt lgkmcnt(12)
    v_pk_add_f32 v[64:65], v[64:65], v[72:73]
    v_pk_add_f32 v[66:67], v[66:67], v[74:75]
    v_pk_add_f32 v[68:69], v[68:69], v[76:77]
    v_pk_add_f32 v[70:71], v[70:71], v[78:79]
    s_waitcnt lgkmcnt(8)
    v_pk_add_f32 v[80:81], v[80:81], v[88:89]
    v_pk_add_f32 v[82:83], v[82:83], v[90:91]
    v_pk_add_f32 v[84:85], v[84:85], v[92:93]
    v_pk_add_f32 v[86:87], v[86:87], v[94:95]
    v_pk_add_f32 v[64:65], v[64:65], v[80:81]
    v_pk_add_f32 v[66:67], v[66:67], v[82:83]
    v_pk_add_f32 v[68:69], v[68:69], v[84:85]
    v_pk_add_f32 v[70:71], v[70:71], v[86:87]
    v_cvt_pk_bf16_f32 v72, v64, v65
    v_cvt_pk_bf16_f32 v73, v66, v67
    v_cvt_pk_bf16_f32 v74, v68, v69
    v_cvt_pk_bf16_f32 v75, v70, v71
    buffer_store_dwordx4 v[72:75], v18, s[24:27], s53 offen nt
    s_add_u32 s53, s53, 40960
    s_waitcnt lgkmcnt(4)
    v_pk_add_f32 v[96:97], v[96:97], v[104:105]
    v_pk_add_f32 v[98:99], v[98:99], v[106:107]
    v_pk_add_f32 v[100:101], v[100:101], v[108:109]
    v_pk_add_f32 v[102:103], v[102:103], v[110:111]
    s_waitcnt lgkmcnt(0)
    v_pk_add_f32 v[112:113], v[112:113], v[120:121]
    v_pk_add_f32 v[114:115], v[114:115], v[122:123]
    v_pk_add_f32 v[116:117], v[116:117], v[124:125]
    v_pk_add_f32 v[118:119], v[118:119], v[126:127]
    v_pk_add_f32 v[96:97], v[96:97], v[112:113]
    v_pk_add_f32 v[98:99], v[98:99], v[114:115]
    v_pk_add_f32 v[100:101], v[100:101], v[116:117]
    v_pk_add_f32 v[102:103], v[102:103], v[118:119]
    v_cvt_pk_bf16_f32 v104, v96, v97
    v_cvt_pk_bf16_f32 v105, v98, v99
    v_cvt_pk_bf16_f32 v106, v100, v101
    v_cvt_pk_bf16_f32 v107, v102, v103
    buffer_store_dwordx4 v[104:107], v18, s[24:27], s53 offen nt
    s_endpgm
L_slow_f1c0:
    s_mov_b32 s62, 0x387f0000
    s_mov_b32 s63, 0x0
    s_mov_b64 exec, s[62:63]
    buffer_load_dword v26, v25, s[28:31], 0 offen offset:0 sc1
    s_mov_b64 exec, -1
    s_waitcnt vmcnt(0)
    v_cmp_eq_u32 vcc, s50, v26
    s_andn2_b64 s[62:63], s[62:63], vcc
    s_cbranch_scc0 L_ok_f1c0
    s_cmp_eq_u32 s52, 0
    s_cbranch_scc1 L_ok_f1c0
    s_sub_u32 s52, s52, 1
    s_sleep 4
    s_branch L_slow_f1c0
L_slow_f1c1:
    s_mov_b32 s62, 0x3f800000
    s_mov_b32 s63, 0x0
    s_mov_b64 exec, s[62:63]
    buffer_load_dword v26, v25, s[28:31], 0 offen offset:128 sc1
    s_mov_b64 exec, -1
    s_waitcnt vmcnt(0)
    v_cmp_eq_u32 vcc, s50, v26
    s_andn2_b64 s[62:63], s[62:63], vcc
    s_cbranch_scc0 L_ok_f1c1
    s_cmp_eq_u32 s52, 0
    s_cbranch_scc1 L_ok_f1c1
    s_sub_u32 s52, s52, 1
    s_sleep 1
    s_branch L_slow_f1c1
L_slow_f1c2:
    s_mov_b32 s62, 0x7f80000
    s_mov_b32 s63, 0x0
    s_mov_b64 exec, s[62:63]
    buffer_load_dword v26, v25, s[28:31], 0 offen offset:256 sc1
    s_mov_b64 exec, -1
    s_waitcnt vmcnt(0)
    v_cmp_eq_u32 vcc, s50, v26
    s_andn2_b64 s[62:63], s[62:63], vcc
    s_cbranch_scc0 L_ok_f1c2
    s_cmp_eq_u32 s52, 0
    s_cbranch_scc1 L_ok_f1c2
    s_sub_u32 s52, s52, 1
    s_sleep 1
    s_branch L_slow_f1c2
L_slow_f1c3:
    s_mov_b32 s62, 0x780000
    s_mov_b32 s63, 0x0
    s_mov_b64 exec, s[62:63]
    buffer_load_dword v26, v25, s[28:31], 0 offen offset:384 sc1
    s_mov_b64 exec, -1
    s_waitcnt vmcnt(0)
    v_cmp_eq_u32 vcc, s50, v26
    s_andn2_b64 s[62:63], s[62:63], vcc
    s_cbranch_scc0 L_ok_f1c3
    s_cmp_eq_u32 s52, 0
    s_cbranch_scc1 L_ok_f1c3
    s_sub_u32 s52, s52, 1
    s_sleep 1
    s_branch L_slow_f1c3
L_code_end:
.section .rodata,"a"
.p2align 6
.amdhsa_kernel standalone__glu_gated_bilinear__prompt_kernel
  .amdhsa_next_free_vgpr 512
  .amdhsa_next_free_sgpr 102
  .amdhsa_accum_offset 256
  .amdhsa_group_segment_fixed_size 0
  .amdhsa_kernarg_size 56
  .amdhsa_user_sgpr_count 2
  .amdhsa_user_sgpr_kernarg_segment_ptr 1
  .amdhsa_system_sgpr_workgroup_id_x 1
.end_amdhsa_kernel
.text
```
